```python
import torch

def _softmax(x, axis=-1):
    return torch.softmax(x, dim=axis)
def _gelu(x):
    return torch.nn.functional.gelu(x, approximate="tanh")
def _silu(x):
    return torch.nn.functional.silu(x)
def _sigmoid(x):
    return torch.sigmoid(x)
def _layernorm(x, axis=-1, eps=1e-5):
    m = x.mean(dim=axis, keepdim=True)
    v = x.var(dim=axis, keepdim=True, unbiased=False)
    return (x - m) / torch.sqrt(v + eps)
def _scatter_add(tgt, idx, src, axis=0):
    return tgt.clone().index_add_(axis, idx, src)
def _segment_sum(src, seg, n):
    out = torch.zeros((n,) + src.shape[1:], dtype=src.dtype)
    return out.index_add_(0, seg, src)
def _pad(x, pw):
    flat = tuple(v for pair in reversed(pw) for v in pair)
    return torch.nn.functional.pad(x, flat)

kernel_name = 'interleave_layers__spectral_gfnet__dense_activation_gelu__prompt'

def setup_inputs():

    _w = (lambda a: (lambda t: t.to(torch.bfloat16) if t.is_floating_point() else t)(torch.as_tensor(a)))
    def _A_setup():
        B, S, D = 1, 2048, 512
        Df = D // 2 + 1
        return {
            "x": _w((lambda *s: torch.randn(*s, dtype=torch.bfloat16) * 0.05)(B, S, D)),
            "w_r": _w((lambda *s: torch.randn(*s, dtype=torch.bfloat16) * 0.4)(S, Df) * 0.02),
            "w_i": _w((lambda *s: torch.randn(*s, dtype=torch.bfloat16) * 0.4)(S, Df) * 0.02),
        }
    _A_in = _A_setup()

    def _B_setup():
        B, S, D, F = 1, 2048, 512, 1792
        return {
            "x": _w((lambda *s: torch.randn(*s, dtype=torch.bfloat16) * 0.05)(B, S, D)),
            "w1": _w((lambda *s: torch.randn(*s, dtype=torch.bfloat16) * 0.4)(D, F) * (D ** -0.5)),
            "b1": _w((lambda *s: torch.randn(*s, dtype=torch.bfloat16) * 12.8)(F) * 0.01),
            "w2": _w((lambda *s: torch.randn(*s, dtype=torch.bfloat16) * 0.1)(F, D) * (F ** -0.5)),
            "b2": _w((lambda *s: torch.randn(*s, dtype=torch.bfloat16) * 0.8)(D) * 0.01),
        }
    _B_in = _B_setup()

    return {
        "A_x": _A_in["x"],
        "A_w_r": _A_in["w_r"],
        "A_w_i": _A_in["w_i"],
        "B_x": _B_in["x"],
        "B_w1": _B_in["w1"],
        "B_b1": _B_in["b1"],
        "B_w2": _B_in["w2"],
        "B_b2": _B_in["b2"],
    }

def reference(A_x, A_w_r, A_w_i, B_x, B_w1, B_b1, B_w2, B_b2):
    def _A_ref(x, w_r, w_i):
        B, S, D = x.shape
        X = (lambda x, axes=(-2,-1): torch.fft.rfft2(x.float(), dim=axes))(x, axes=(-2, -1))
        W = w_r + 1j * w_i
        X = X * W
        y = (lambda x, s, axes=(-2,-1): torch.fft.irfft2(x, s=s, dim=axes).to(torch.bfloat16))(X, (S, D), axes=(-2, -1))
        return y

    def _B_ref(x, w1, b1, w2, b2):
        h = torch.einsum("bsd,df->bsf", x, w1) + b1
        h = _gelu(h)
        return torch.einsum("bsf,fd->bsd", h, w2) + b2

    x = A_x
    x = x + _A_ref(_layernorm(x, axis=-1), A_w_r, A_w_i)
    x = x + _B_ref(_layernorm(x, axis=-1), B_w1, B_b1, B_w2, B_b2)
    x = x + _A_ref(_layernorm(x, axis=-1), A_w_r, A_w_i)
    x = x + _B_ref(_layernorm(x, axis=-1), B_w1, B_b1, B_w2, B_b2)
    return x
```

```asm
; @launch kernel=mega_kernel grid=(256,1,1) block=(512,1,1) lds=163840
.amdgcn_target "amdgcn-amd-amdhsa--gfx950"
.text
.p2align 8
code_start:
.globl mega_kernel
.p2align 8
.type mega_kernel,@function
mega_kernel:
    s_cmp_ge_u32 s2, 256
    s_cbranch_scc1 Lend_1
    s_load_dwordx16 s[64:79], s[0:1], 0
    s_load_dwordx4 s[80:83], s[0:1], 64
    s_load_dwordx2 s[84:85], s[0:1], 80
    v_and_b32 v1, 63, v0
    v_lshrrev_b32 v2, 6, v0
    s_nop 0
    v_readfirstlane_b32 s3, v2
    s_waitcnt lgkmcnt(0)
    s_add_u32 s96, s84, 0x3000000
    s_addc_u32 s97, s85, 0
    s_and_b32 s97, s97, 0xffff
    s_mov_b32 s98, 0x18000
    s_mov_b32 s99, 0x00020000
    s_mov_b32 s95, s2
    s_cmp_eq_u32 s2, 0
    s_cselect_b32 s95, 200, s95
    s_cmp_eq_u32 s2, 200
    s_cselect_b32 s95, 0, s95
    s_cmp_ge_u32 s3, 4
    s_cbranch_scc1 Lskip_2
    s_getpc_b64 s[16:17]
Lpc_6:
    s_add_u32 s16, s16, tab_tw2048a-Lpc_6
    s_addc_u32 s17, s17, 0
    s_and_b32 s17, s17, 0xffff
    s_mov_b32 s18, 0x800
    s_mov_b32 s19, 0x00020000
    s_mov_b32 s20, 0x3f3504f3
    s_mov_b32 s21, s20
    s_mov_b32 s22, 0x3b000000
    s_mov_b32 s23, s22
    s_waitcnt lgkmcnt(0)
    s_mov_b64 s[4:5], s[64:65]
    s_mov_b64 s[6:7], s[84:85]
    s_mov_b32 s8, s4
    s_and_b32 s9, s5, 0xffff
    s_mov_b32 s10, 0x200000
    s_mov_b32 s11, 0x00020000
    s_mov_b32 s12, s6
    s_and_b32 s13, s7, 0xffff
    s_mov_b32 s14, 0x10000000
    s_mov_b32 s15, 0x00020000
    s_lshl_b32 s28, s2, 13
    s_lshl_b32 s29, s3, 11
    s_add_u32 s28, s28, s29
    v_lshlrev_b32 v3, 4, v1
    v_add_u32 v3, s28, v3
    buffer_load_dwordx4 v[42:45], v3, s[8:11], 0 offen
    buffer_load_dwordx4 v[46:49], v3, s[8:11], 0 offen offset:1024
    v_lshlrev_b32 v4, 5, v1
    buffer_load_dwordx2 v[52:53], v4, s[16:19], 0 offen
    v_and_b32 v5, 7, v1
    v_lshlrev_b32 v5, 8, v5
    buffer_load_dwordx2 v[68:69], v5, s[16:19], 0 offen
    s_mul_i32 s30, s3, 4768
    v_lshlrev_b32 v96, 3, v1
    v_add_u32 v96, s30, v96
    v_lshrrev_b32 v86, 3, v1
    v_mul_u32_u24 v97, 72, v86
    v_and_b32 v87, 7, v1
    v_add_u32 v97, v97, v87
    v_lshlrev_b32 v97, 3, v97
    v_add_u32 v97, s30, v97
    v_mul_u32_u24 v98, 66, v87
    v_add_u32 v98, v98, v86
    v_lshlrev_b32 v98, 3, v98
    v_add_u32 v98, s30, v98
    v_lshrrev_b32 v86, 1, v1
    v_lshlrev_b32 v87, 6, v1
    v_add_u32 v87, s30, v87
    v_add_u32 v88, 0, v86
    v_and_b32 v88, 3, v88
    v_lshlrev_b32 v88, 4, v88
    v_add_u32 v102, v87, v88
    v_add_u32 v88, 1, v86
    v_and_b32 v88, 3, v88
    v_lshlrev_b32 v88, 4, v88
    v_add_u32 v103, v87, v88
    v_add_u32 v88, 2, v86
    v_and_b32 v88, 3, v88
    v_lshlrev_b32 v88, 4, v88
    v_add_u32 v104, v87, v88
    v_add_u32 v88, 3, v86
    v_and_b32 v88, 3, v88
    v_lshlrev_b32 v88, 4, v88
    v_add_u32 v105, v87, v88
    v_lshrrev_b32 v86, 3, v1
    v_lshlrev_b32 v86, 6, v86
    v_bfe_u32 v87, v1, 1, 2
    v_lshrrev_b32 v88, 4, v1
    v_add_u32 v87, v87, v88
    v_and_b32 v87, 3, v87
    v_lshlrev_b32 v87, 4, v87
    v_and_b32 v88, 1, v1
    v_lshlrev_b32 v88, 3, v88
    v_add3_u32 v101, v86, v87, v88
    v_add_u32 v101, s30, v101
    s_waitcnt vmcnt(0)
    v_pk_mul_f32 v[26:27], v[52:53], v[52:53] op_sel_hi:[1,0]
    v_pk_fma_f32 v[54:55], v[52:53], v[52:53], v[26:27] op_sel:[1,1,0] op_sel_hi:[0,1,1] neg_lo:[1,0,0]
    v_pk_mul_f32 v[28:29], v[54:55], v[52:53] op_sel_hi:[1,0]
    v_pk_fma_f32 v[56:57], v[54:55], v[52:53], v[28:29] op_sel:[1,1,0] op_sel_hi:[0,1,1] neg_lo:[1,0,0]
    v_pk_mul_f32 v[26:27], v[54:55], v[54:55] op_sel_hi:[1,0]
    v_pk_fma_f32 v[58:59], v[54:55], v[54:55], v[26:27] op_sel:[1,1,0] op_sel_hi:[0,1,1] neg_lo:[1,0,0]
    v_pk_mul_f32 v[28:29], v[58:59], v[52:53] op_sel_hi:[1,0]
    v_pk_fma_f32 v[60:61], v[58:59], v[52:53], v[28:29] op_sel:[1,1,0] op_sel_hi:[0,1,1] neg_lo:[1,0,0]
    v_pk_mul_f32 v[26:27], v[56:57], v[56:57] op_sel_hi:[1,0]
    v_pk_fma_f32 v[62:63], v[56:57], v[56:57], v[26:27] op_sel:[1,1,0] op_sel_hi:[0,1,1] neg_lo:[1,0,0]
    v_pk_mul_f32 v[28:29], v[58:59], v[56:57] op_sel_hi:[1,0]
    v_pk_fma_f32 v[64:65], v[58:59], v[56:57], v[28:29] op_sel:[1,1,0] op_sel_hi:[0,1,1] neg_lo:[1,0,0]
    v_pk_mul_f32 v[26:27], v[68:69], v[68:69] op_sel_hi:[1,0]
    v_pk_fma_f32 v[70:71], v[68:69], v[68:69], v[26:27] op_sel:[1,1,0] op_sel_hi:[0,1,1] neg_lo:[1,0,0]
    v_pk_mul_f32 v[28:29], v[70:71], v[68:69] op_sel_hi:[1,0]
    v_pk_fma_f32 v[72:73], v[70:71], v[68:69], v[28:29] op_sel:[1,1,0] op_sel_hi:[0,1,1] neg_lo:[1,0,0]
    v_pk_mul_f32 v[26:27], v[70:71], v[70:71] op_sel_hi:[1,0]
    v_pk_fma_f32 v[74:75], v[70:71], v[70:71], v[26:27] op_sel:[1,1,0] op_sel_hi:[0,1,1] neg_lo:[1,0,0]
    v_pk_mul_f32 v[28:29], v[74:75], v[68:69] op_sel_hi:[1,0]
    v_pk_fma_f32 v[76:77], v[74:75], v[68:69], v[28:29] op_sel:[1,1,0] op_sel_hi:[0,1,1] neg_lo:[1,0,0]
    v_pk_mul_f32 v[26:27], v[72:73], v[72:73] op_sel_hi:[1,0]
    v_pk_fma_f32 v[78:79], v[72:73], v[72:73], v[26:27] op_sel:[1,1,0] op_sel_hi:[0,1,1] neg_lo:[1,0,0]
    v_pk_mul_f32 v[28:29], v[74:75], v[72:73] op_sel_hi:[1,0]
    v_pk_fma_f32 v[80:81], v[74:75], v[72:73], v[28:29] op_sel:[1,1,0] op_sel_hi:[0,1,1] neg_lo:[1,0,0]
    v_lshlrev_b32 v10, 16, v42
    v_lshlrev_b32 v11, 16, v46
    v_and_b32 v12, 0xffff0000, v42
    v_and_b32 v13, 0xffff0000, v46
    v_lshlrev_b32 v14, 16, v43
    v_lshlrev_b32 v15, 16, v47
    v_and_b32 v16, 0xffff0000, v43
    v_and_b32 v17, 0xffff0000, v47
    v_lshlrev_b32 v18, 16, v44
    v_lshlrev_b32 v19, 16, v48
    v_and_b32 v20, 0xffff0000, v44
    v_and_b32 v21, 0xffff0000, v48
    v_lshlrev_b32 v22, 16, v45
    v_lshlrev_b32 v23, 16, v49
    v_and_b32 v24, 0xffff0000, v45
    v_and_b32 v25, 0xffff0000, v49
    v_readfirstlane_b32 s48, v10
    v_readfirstlane_b32 s49, v11
    s_nop 0
    v_pk_add_f32 v[86:87], v[10:11], s[48:49] neg_lo:[0,1] neg_hi:[0,1]
    v_pk_mul_f32 v[84:85], v[86:87], v[86:87]
    v_pk_add_f32 v[88:89], v[12:13], s[48:49] neg_lo:[0,1] neg_hi:[0,1]
    v_pk_fma_f32 v[84:85], v[88:89], v[88:89], v[84:85]
    v_pk_add_f32 v[82:83], v[86:87], v[88:89]
    v_pk_add_f32 v[86:87], v[14:15], s[48:49] neg_lo:[0,1] neg_hi:[0,1]
    v_pk_fma_f32 v[84:85], v[86:87], v[86:87], v[84:85]
    v_pk_add_f32 v[82:83], v[82:83], v[86:87]
    v_pk_add_f32 v[88:89], v[16:17], s[48:49] neg_lo:[0,1] neg_hi:[0,1]
    v_pk_fma_f32 v[84:85], v[88:89], v[88:89], v[84:85]
    v_pk_add_f32 v[82:83], v[82:83], v[88:89]
    v_pk_add_f32 v[86:87], v[18:19], s[48:49] neg_lo:[0,1] neg_hi:[0,1]
    v_pk_fma_f32 v[84:85], v[86:87], v[86:87], v[84:85]
    v_pk_add_f32 v[82:83], v[82:83], v[86:87]
    v_pk_add_f32 v[88:89], v[20:21], s[48:49] neg_lo:[0,1] neg_hi:[0,1]
    v_pk_fma_f32 v[84:85], v[88:89], v[88:89], v[84:85]
    v_pk_add_f32 v[82:83], v[82:83], v[88:89]
    v_pk_add_f32 v[86:87], v[22:23], s[48:49] neg_lo:[0,1] neg_hi:[0,1]
    v_pk_fma_f32 v[84:85], v[86:87], v[86:87], v[84:85]
    v_pk_add_f32 v[82:83], v[82:83], v[86:87]
    v_pk_add_f32 v[88:89], v[24:25], s[48:49] neg_lo:[0,1] neg_hi:[0,1]
    v_pk_fma_f32 v[84:85], v[88:89], v[88:89], v[84:85]
    v_pk_add_f32 v[82:83], v[82:83], v[88:89]
    v_pk_mul_f32 v[82:83], v[82:83], s[22:23]
    v_pk_mul_f32 v[84:85], v[84:85], s[22:23]
    s_nop 1
    v_add_f32_dpp v82, v82, v82 row_shr:1 row_mask:0xf bank_mask:0xf bound_ctrl:0
    v_add_f32_dpp v83, v83, v83 row_shr:1 row_mask:0xf bank_mask:0xf bound_ctrl:0
    v_add_f32_dpp v84, v84, v84 row_shr:1 row_mask:0xf bank_mask:0xf bound_ctrl:0
    v_add_f32_dpp v85, v85, v85 row_shr:1 row_mask:0xf bank_mask:0xf bound_ctrl:0
    v_add_f32_dpp v82, v82, v82 row_shr:2 row_mask:0xf bank_mask:0xf bound_ctrl:0
    v_add_f32_dpp v83, v83, v83 row_shr:2 row_mask:0xf bank_mask:0xf bound_ctrl:0
    v_add_f32_dpp v84, v84, v84 row_shr:2 row_mask:0xf bank_mask:0xf bound_ctrl:0
    v_add_f32_dpp v85, v85, v85 row_shr:2 row_mask:0xf bank_mask:0xf bound_ctrl:0
    v_add_f32_dpp v82, v82, v82 row_shr:4 row_mask:0xf bank_mask:0xf bound_ctrl:0
    v_add_f32_dpp v83, v83, v83 row_shr:4 row_mask:0xf bank_mask:0xf bound_ctrl:0
    v_add_f32_dpp v84, v84, v84 row_shr:4 row_mask:0xf bank_mask:0xf bound_ctrl:0
    v_add_f32_dpp v85, v85, v85 row_shr:4 row_mask:0xf bank_mask:0xf bound_ctrl:0
    v_add_f32_dpp v82, v82, v82 row_shr:8 row_mask:0xf bank_mask:0xf bound_ctrl:0
    v_add_f32_dpp v83, v83, v83 row_shr:8 row_mask:0xf bank_mask:0xf bound_ctrl:0
    v_add_f32_dpp v84, v84, v84 row_shr:8 row_mask:0xf bank_mask:0xf bound_ctrl:0
    v_add_f32_dpp v85, v85, v85 row_shr:8 row_mask:0xf bank_mask:0xf bound_ctrl:0
    v_add_f32_dpp v82, v82, v82 row_bcast:15 row_mask:0xa bank_mask:0xf
    v_add_f32_dpp v83, v83, v83 row_bcast:15 row_mask:0xa bank_mask:0xf
    v_add_f32_dpp v84, v84, v84 row_bcast:15 row_mask:0xa bank_mask:0xf
    v_add_f32_dpp v85, v85, v85 row_bcast:15 row_mask:0xa bank_mask:0xf
    v_add_f32_dpp v82, v82, v82 row_bcast:31 row_mask:0xc bank_mask:0xf
    v_add_f32_dpp v83, v83, v83 row_bcast:31 row_mask:0xc bank_mask:0xf
    v_add_f32_dpp v84, v84, v84 row_bcast:31 row_mask:0xc bank_mask:0xf
    v_add_f32_dpp v85, v85, v85 row_bcast:31 row_mask:0xc bank_mask:0xf
    s_nop 0
    v_readlane_b32 s44, v82, 63
    v_readlane_b32 s45, v83, 63
    v_readlane_b32 s46, v84, 63
    v_readlane_b32 s47, v85, 63
    s_nop 1
    v_mov_b32 v82, s44
    v_mov_b32 v83, s45
    v_mov_b32 v84, s46
    v_mov_b32 v85, s47
    v_pk_fma_f32 v[84:85], v[82:83], v[82:83], v[84:85] neg_lo:[1,0,0] neg_hi:[1,0,0]
    v_max_f32 v84, 0, v84
    v_max_f32 v85, 0, v85
    v_pk_add_f32 v[82:83], v[82:83], s[48:49]
    v_cvt_pk_bf16_f32 v90, v82, v83
    v_lshlrev_b32 v82, 16, v90
    v_and_b32 v83, 0xffff0000, v90
    v_cvt_pk_bf16_f32 v91, v84, v85
    v_lshlrev_b32 v84, 16, v91
    v_and_b32 v85, 0xffff0000, v91
    v_add_f32 v84, 0x3727c5ac, v84
    v_add_f32 v85, 0x3727c5ac, v85
    v_cvt_pk_bf16_f32 v91, v84, v85
    v_lshlrev_b32 v84, 16, v91
    v_and_b32 v85, 0xffff0000, v91
    v_sqrt_f32 v84, v84
    v_sqrt_f32 v85, v85
    v_pk_add_f32 v[10:11], v[10:11], v[82:83] neg_lo:[0,1] neg_hi:[0,1]
    v_pk_add_f32 v[12:13], v[12:13], v[82:83] neg_lo:[0,1] neg_hi:[0,1]
    v_pk_add_f32 v[14:15], v[14:15], v[82:83] neg_lo:[0,1] neg_hi:[0,1]
    v_pk_add_f32 v[16:17], v[16:17], v[82:83] neg_lo:[0,1] neg_hi:[0,1]
    v_pk_add_f32 v[18:19], v[18:19], v[82:83] neg_lo:[0,1] neg_hi:[0,1]
    v_pk_add_f32 v[20:21], v[20:21], v[82:83] neg_lo:[0,1] neg_hi:[0,1]
    v_pk_add_f32 v[22:23], v[22:23], v[82:83] neg_lo:[0,1] neg_hi:[0,1]
    v_pk_add_f32 v[24:25], v[24:25], v[82:83] neg_lo:[0,1] neg_hi:[0,1]
    v_cvt_pk_bf16_f32 v94, v84, v85
    v_lshlrev_b32 v84, 16, v94
    v_and_b32 v85, 0xffff0000, v94
    v_rcp_f32 v84, v84
    v_rcp_f32 v85, v85
    v_cvt_pk_bf16_f32 v86, v10, v11
    v_cvt_pk_bf16_f32 v87, v12, v13
    v_cvt_pk_bf16_f32 v88, v14, v15
    v_cvt_pk_bf16_f32 v89, v16, v17
    v_cvt_pk_bf16_f32 v90, v18, v19
    v_cvt_pk_bf16_f32 v91, v20, v21
    v_cvt_pk_bf16_f32 v92, v22, v23
    v_cvt_pk_bf16_f32 v93, v24, v25
    v_lshlrev_b32 v10, 16, v86
    v_and_b32 v11, 0xffff0000, v86
    v_lshlrev_b32 v12, 16, v87
    v_and_b32 v13, 0xffff0000, v87
    v_lshlrev_b32 v14, 16, v88
    v_and_b32 v15, 0xffff0000, v88
    v_lshlrev_b32 v16, 16, v89
    v_and_b32 v17, 0xffff0000, v89
    v_lshlrev_b32 v18, 16, v90
    v_and_b32 v19, 0xffff0000, v90
    v_lshlrev_b32 v20, 16, v91
    v_and_b32 v21, 0xffff0000, v91
    v_lshlrev_b32 v22, 16, v92
    v_and_b32 v23, 0xffff0000, v92
    v_lshlrev_b32 v24, 16, v93
    v_and_b32 v25, 0xffff0000, v93
    v_pk_mul_f32 v[10:11], v[10:11], v[84:85]
    v_pk_mul_f32 v[12:13], v[12:13], v[84:85]
    v_pk_mul_f32 v[14:15], v[14:15], v[84:85]
    v_pk_mul_f32 v[16:17], v[16:17], v[84:85]
    v_pk_mul_f32 v[18:19], v[18:19], v[84:85]
    v_pk_mul_f32 v[20:21], v[20:21], v[84:85]
    v_pk_mul_f32 v[22:23], v[22:23], v[84:85]
    v_pk_mul_f32 v[24:25], v[24:25], v[84:85]
    v_cvt_pk_bf16_f32 v86, v10, v11
    v_cvt_pk_bf16_f32 v87, v12, v13
    v_cvt_pk_bf16_f32 v88, v14, v15
    v_cvt_pk_bf16_f32 v89, v16, v17
    v_cvt_pk_bf16_f32 v90, v18, v19
    v_cvt_pk_bf16_f32 v91, v20, v21
    v_cvt_pk_bf16_f32 v92, v22, v23
    v_cvt_pk_bf16_f32 v93, v24, v25
    v_lshlrev_b32 v10, 16, v86
    v_and_b32 v11, 0xffff0000, v86
    v_lshlrev_b32 v12, 16, v87
    v_and_b32 v13, 0xffff0000, v87
    v_lshlrev_b32 v14, 16, v88
    v_and_b32 v15, 0xffff0000, v88
    v_lshlrev_b32 v16, 16, v89
    v_and_b32 v17, 0xffff0000, v89
    v_lshlrev_b32 v18, 16, v90
    v_and_b32 v19, 0xffff0000, v90
    v_lshlrev_b32 v20, 16, v91
    v_and_b32 v21, 0xffff0000, v91
    v_lshlrev_b32 v22, 16, v92
    v_and_b32 v23, 0xffff0000, v92
    v_lshlrev_b32 v24, 16, v93
    v_and_b32 v25, 0xffff0000, v93
    ds_write_b128 v102, v[10:13]
    ds_write_b128 v103, v[14:17]
    ds_write_b128 v104, v[18:21]
    ds_write_b128 v105, v[22:25]
    ds_read_b64 v[10:11], v101 offset:0
    ds_read_b64 v[12:13], v101 offset:512
    ds_read_b64 v[14:15], v101 offset:1024
    ds_read_b64 v[16:17], v101 offset:1536
    ds_read_b64 v[18:19], v101 offset:2048
    ds_read_b64 v[20:21], v101 offset:2560
    ds_read_b64 v[22:23], v101 offset:3072
    ds_read_b64 v[24:25], v101 offset:3584
    s_waitcnt vmcnt(0) lgkmcnt(0)
    v_pk_add_f32 v[26:27], v[10:11], v[18:19]
    v_pk_add_f32 v[34:35], v[10:11], v[18:19] neg_lo:[0,1] neg_hi:[0,1]
    v_pk_add_f32 v[28:29], v[12:13], v[20:21]
    v_pk_add_f32 v[36:37], v[12:13], v[20:21] neg_lo:[0,1] neg_hi:[0,1]
    v_pk_add_f32 v[30:31], v[14:15], v[22:23]
    v_pk_add_f32 v[38:39], v[14:15], v[22:23] neg_lo:[0,1] neg_hi:[0,1]
    v_pk_add_f32 v[32:33], v[16:17], v[24:25]
    v_pk_add_f32 v[40:41], v[16:17], v[24:25] neg_lo:[0,1] neg_hi:[0,1]
    v_pk_add_f32 v[12:13], v[26:27], v[30:31]
    v_pk_add_f32 v[16:17], v[26:27], v[30:31] neg_lo:[0,1] neg_hi:[0,1]
    v_pk_add_f32 v[20:21], v[28:29], v[32:33]
    v_pk_add_f32 v[24:25], v[28:29], v[32:33] neg_lo:[0,1] neg_hi:[0,1]
    v_pk_add_f32 v[10:11], v[12:13], v[20:21]
    v_pk_add_f32 v[18:19], v[12:13], v[20:21] neg_lo:[0,1] neg_hi:[0,1]
    v_pk_add_f32 v[14:15], v[16:17], v[24:25] op_sel:[0,1] op_sel_hi:[1,0] neg_hi:[0,1]
    v_pk_add_f32 v[22:23], v[16:17], v[24:25] op_sel:[0,1] op_sel_hi:[1,0] neg_lo:[0,1]
    v_pk_add_f32 v[26:27], v[36:37], v[36:37] op_sel:[0,1] op_sel_hi:[1,0] neg_hi:[0,1]
    v_pk_add_f32 v[28:29], v[40:41], v[40:41] op_sel:[0,1] op_sel_hi:[1,0] neg_lo:[1,0] neg_hi:[1,1]
    v_pk_add_f32 v[30:31], v[26:27], v[28:29]
    v_pk_add_f32 v[32:33], v[26:27], v[28:29] neg_lo:[0,1] neg_hi:[0,1]
    v_pk_add_f32 v[36:37], v[34:35], v[38:39] op_sel:[0,1] op_sel_hi:[1,0] neg_hi:[0,1]
    v_pk_add_f32 v[40:41], v[34:35], v[38:39] op_sel:[0,1] op_sel_hi:[1,0] neg_lo:[0,1]
    v_pk_fma_f32 v[12:13], v[30:31], s[20:21], v[36:37]
    v_pk_fma_f32 v[20:21], v[30:31], s[20:21], v[36:37] neg_lo:[1,0,0] neg_hi:[1,0,0]
    v_pk_fma_f32 v[16:17], v[32:33], s[20:21], v[40:41] op_sel:[1,0,0] op_sel_hi:[0,1,1] neg_hi:[1,0,0]
    v_pk_fma_f32 v[24:25], v[32:33], s[20:21], v[40:41] op_sel:[1,0,0] op_sel_hi:[0,1,1] neg_lo:[1,0,0]
    ds_write_b64 v96, v[10:11] offset:0
    v_pk_mul_f32 v[28:29], v[12:13], v[52:53] op_sel_hi:[1,0]
    v_pk_fma_f32 v[12:13], v[12:13], v[52:53], v[28:29] op_sel:[1,1,0] op_sel_hi:[0,1,1] neg_lo:[1,0,0]
    ds_write_b64 v96, v[12:13] offset:576
    v_pk_mul_f32 v[30:31], v[14:15], v[54:55] op_sel_hi:[1,0]
    v_pk_fma_f32 v[14:15], v[14:15], v[54:55], v[30:31] op_sel:[1,1,0] op_sel_hi:[0,1,1] neg_lo:[1,0,0]
    ds_write_b64 v96, v[14:15] offset:1152
    v_pk_mul_f32 v[32:33], v[16:17], v[56:57] op_sel_hi:[1,0]
    v_pk_fma_f32 v[16:17], v[16:17], v[56:57], v[32:33] op_sel:[1,1,0] op_sel_hi:[0,1,1] neg_lo:[1,0,0]
    ds_write_b64 v96, v[16:17] offset:1728
    v_pk_mul_f32 v[34:35], v[18:19], v[58:59] op_sel_hi:[1,0]
    v_pk_fma_f32 v[18:19], v[18:19], v[58:59], v[34:35] op_sel:[1,1,0] op_sel_hi:[0,1,1] neg_lo:[1,0,0]
    ds_write_b64 v96, v[18:19] offset:2304
    v_pk_mul_f32 v[36:37], v[20:21], v[60:61] op_sel_hi:[1,0]
    v_pk_fma_f32 v[20:21], v[20:21], v[60:61], v[36:37] op_sel:[1,1,0] op_sel_hi:[0,1,1] neg_lo:[1,0,0]
    ds_write_b64 v96, v[20:21] offset:2880
    v_pk_mul_f32 v[38:39], v[22:23], v[62:63] op_sel_hi:[1,0]
    v_pk_fma_f32 v[22:23], v[22:23], v[62:63], v[38:39] op_sel:[1,1,0] op_sel_hi:[0,1,1] neg_lo:[1,0,0]
    ds_write_b64 v96, v[22:23] offset:3456
    v_pk_mul_f32 v[40:41], v[24:25], v[64:65] op_sel_hi:[1,0]
    v_pk_fma_f32 v[24:25], v[24:25], v[64:65], v[40:41] op_sel:[1,1,0] op_sel_hi:[0,1,1] neg_lo:[1,0,0]
    ds_write_b64 v96, v[24:25] offset:4032
    ds_read_b64 v[10:11], v97 offset:0
    ds_read_b64 v[18:19], v97 offset:256
    ds_read_b64 v[12:13], v97 offset:64
    ds_read_b64 v[20:21], v97 offset:320
    ds_read_b64 v[14:15], v97 offset:128
    ds_read_b64 v[22:23], v97 offset:384
    ds_read_b64 v[16:17], v97 offset:192
    ds_read_b64 v[24:25], v97 offset:448
    s_waitcnt lgkmcnt(6)
    v_pk_add_f32 v[26:27], v[10:11], v[18:19]
    v_pk_add_f32 v[34:35], v[10:11], v[18:19] neg_lo:[0,1] neg_hi:[0,1]
    s_waitcnt lgkmcnt(4)
    v_pk_add_f32 v[28:29], v[12:13], v[20:21]
    v_pk_add_f32 v[36:37], v[12:13], v[20:21] neg_lo:[0,1] neg_hi:[0,1]
    s_waitcnt lgkmcnt(2)
    v_pk_add_f32 v[30:31], v[14:15], v[22:23]
    v_pk_add_f32 v[38:39], v[14:15], v[22:23] neg_lo:[0,1] neg_hi:[0,1]
    s_waitcnt lgkmcnt(0)
    v_pk_add_f32 v[32:33], v[16:17], v[24:25]
    v_pk_add_f32 v[40:41], v[16:17], v[24:25] neg_lo:[0,1] neg_hi:[0,1]
    v_pk_add_f32 v[12:13], v[26:27], v[30:31]
    v_pk_add_f32 v[16:17], v[26:27], v[30:31] neg_lo:[0,1] neg_hi:[0,1]
    v_pk_add_f32 v[20:21], v[28:29], v[32:33]
    v_pk_add_f32 v[24:25], v[28:29], v[32:33] neg_lo:[0,1] neg_hi:[0,1]
    v_pk_add_f32 v[10:11], v[12:13], v[20:21]
    v_pk_add_f32 v[18:19], v[12:13], v[20:21] neg_lo:[0,1] neg_hi:[0,1]
    v_pk_add_f32 v[14:15], v[16:17], v[24:25] op_sel:[0,1] op_sel_hi:[1,0] neg_hi:[0,1]
    v_pk_add_f32 v[22:23], v[16:17], v[24:25] op_sel:[0,1] op_sel_hi:[1,0] neg_lo:[0,1]
    v_pk_add_f32 v[26:27], v[36:37], v[36:37] op_sel:[0,1] op_sel_hi:[1,0] neg_hi:[0,1]
    v_pk_add_f32 v[28:29], v[40:41], v[40:41] op_sel:[0,1] op_sel_hi:[1,0] neg_lo:[1,0] neg_hi:[1,1]
    v_pk_add_f32 v[30:31], v[26:27], v[28:29]
    v_pk_add_f32 v[32:33], v[26:27], v[28:29] neg_lo:[0,1] neg_hi:[0,1]
    v_pk_add_f32 v[36:37], v[34:35], v[38:39] op_sel:[0,1] op_sel_hi:[1,0] neg_hi:[0,1]
    v_pk_add_f32 v[40:41], v[34:35], v[38:39] op_sel:[0,1] op_sel_hi:[1,0] neg_lo:[0,1]
    v_pk_fma_f32 v[12:13], v[30:31], s[20:21], v[36:37]
    v_pk_fma_f32 v[20:21], v[30:31], s[20:21], v[36:37] neg_lo:[1,0,0] neg_hi:[1,0,0]
    v_pk_fma_f32 v[16:17], v[32:33], s[20:21], v[40:41] op_sel:[1,0,0] op_sel_hi:[0,1,1] neg_hi:[1,0,0]
    v_pk_fma_f32 v[24:25], v[32:33], s[20:21], v[40:41] op_sel:[1,0,0] op_sel_hi:[0,1,1] neg_lo:[1,0,0]
    ds_write_b64 v98, v[10:11] offset:0
    v_pk_mul_f32 v[28:29], v[12:13], v[68:69] op_sel_hi:[1,0]
    v_pk_fma_f32 v[12:13], v[12:13], v[68:69], v[28:29] op_sel:[1,1,0] op_sel_hi:[0,1,1] neg_lo:[1,0,0]
    ds_write_b64 v98, v[12:13] offset:64
    v_pk_mul_f32 v[30:31], v[14:15], v[70:71] op_sel_hi:[1,0]
    v_pk_fma_f32 v[14:15], v[14:15], v[70:71], v[30:31] op_sel:[1,1,0] op_sel_hi:[0,1,1] neg_lo:[1,0,0]
    ds_write_b64 v98, v[14:15] offset:128
    v_pk_mul_f32 v[32:33], v[16:17], v[72:73] op_sel_hi:[1,0]
    v_pk_fma_f32 v[16:17], v[16:17], v[72:73], v[32:33] op_sel:[1,1,0] op_sel_hi:[0,1,1] neg_lo:[1,0,0]
    ds_write_b64 v98, v[16:17] offset:192
    v_pk_mul_f32 v[34:35], v[18:19], v[74:75] op_sel_hi:[1,0]
    v_pk_fma_f32 v[18:19], v[18:19], v[74:75], v[34:35] op_sel:[1,1,0] op_sel_hi:[0,1,1] neg_lo:[1,0,0]
    ds_write_b64 v98, v[18:19] offset:256
    v_pk_mul_f32 v[36:37], v[20:21], v[76:77] op_sel_hi:[1,0]
    v_pk_fma_f32 v[20:21], v[20:21], v[76:77], v[36:37] op_sel:[1,1,0] op_sel_hi:[0,1,1] neg_lo:[1,0,0]
    ds_write_b64 v98, v[20:21] offset:320
    v_pk_mul_f32 v[38:39], v[22:23], v[78:79] op_sel_hi:[1,0]
    v_pk_fma_f32 v[22:23], v[22:23], v[78:79], v[38:39] op_sel:[1,1,0] op_sel_hi:[0,1,1] neg_lo:[1,0,0]
    ds_write_b64 v98, v[22:23] offset:384
    v_pk_mul_f32 v[40:41], v[24:25], v[80:81] op_sel_hi:[1,0]
    v_pk_fma_f32 v[24:25], v[24:25], v[80:81], v[40:41] op_sel:[1,1,0] op_sel_hi:[0,1,1] neg_lo:[1,0,0]
    ds_write_b64 v98, v[24:25] offset:448
    ds_read_b64 v[10:11], v96 offset:0
    ds_read_b64 v[18:19], v96 offset:2112
    ds_read_b64 v[12:13], v96 offset:528
    ds_read_b64 v[20:21], v96 offset:2640
    ds_read_b64 v[14:15], v96 offset:1056
    ds_read_b64 v[22:23], v96 offset:3168
    ds_read_b64 v[16:17], v96 offset:1584
    ds_read_b64 v[24:25], v96 offset:3696
    s_waitcnt lgkmcnt(6)
    v_pk_add_f32 v[26:27], v[10:11], v[18:19]
    v_pk_add_f32 v[34:35], v[10:11], v[18:19] neg_lo:[0,1] neg_hi:[0,1]
    s_waitcnt lgkmcnt(4)
    v_pk_add_f32 v[28:29], v[12:13], v[20:21]
    v_pk_add_f32 v[36:37], v[12:13], v[20:21] neg_lo:[0,1] neg_hi:[0,1]
    s_waitcnt lgkmcnt(2)
    v_pk_add_f32 v[30:31], v[14:15], v[22:23]
    v_pk_add_f32 v[38:39], v[14:15], v[22:23] neg_lo:[0,1] neg_hi:[0,1]
    s_waitcnt lgkmcnt(0)
    v_pk_add_f32 v[32:33], v[16:17], v[24:25]
    v_pk_add_f32 v[40:41], v[16:17], v[24:25] neg_lo:[0,1] neg_hi:[0,1]
    v_pk_add_f32 v[12:13], v[26:27], v[30:31]
    v_pk_add_f32 v[16:17], v[26:27], v[30:31] neg_lo:[0,1] neg_hi:[0,1]
    v_pk_add_f32 v[20:21], v[28:29], v[32:33]
    v_pk_add_f32 v[24:25], v[28:29], v[32:33] neg_lo:[0,1] neg_hi:[0,1]
    v_pk_add_f32 v[10:11], v[12:13], v[20:21]
    v_pk_add_f32 v[18:19], v[12:13], v[20:21] neg_lo:[0,1] neg_hi:[0,1]
    v_pk_add_f32 v[14:15], v[16:17], v[24:25] op_sel:[0,1] op_sel_hi:[1,0] neg_hi:[0,1]
    v_pk_add_f32 v[22:23], v[16:17], v[24:25] op_sel:[0,1] op_sel_hi:[1,0] neg_lo:[0,1]
    v_pk_add_f32 v[26:27], v[36:37], v[36:37] op_sel:[0,1] op_sel_hi:[1,0] neg_hi:[0,1]
    v_pk_add_f32 v[28:29], v[40:41], v[40:41] op_sel:[0,1] op_sel_hi:[1,0] neg_lo:[1,0] neg_hi:[1,1]
    v_pk_add_f32 v[30:31], v[26:27], v[28:29]
    v_pk_add_f32 v[32:33], v[26:27], v[28:29] neg_lo:[0,1] neg_hi:[0,1]
    v_pk_add_f32 v[36:37], v[34:35], v[38:39] op_sel:[0,1] op_sel_hi:[1,0] neg_hi:[0,1]
    v_pk_add_f32 v[40:41], v[34:35], v[38:39] op_sel:[0,1] op_sel_hi:[1,0] neg_lo:[0,1]
    v_pk_fma_f32 v[12:13], v[30:31], s[20:21], v[36:37]
    v_pk_fma_f32 v[20:21], v[30:31], s[20:21], v[36:37] neg_lo:[1,0,0] neg_hi:[1,0,0]
    v_pk_fma_f32 v[16:17], v[32:33], s[20:21], v[40:41] op_sel:[1,0,0] op_sel_hi:[0,1,1] neg_hi:[1,0,0]
    v_pk_fma_f32 v[24:25], v[32:33], s[20:21], v[40:41] op_sel:[1,0,0] op_sel_hi:[0,1,1] neg_lo:[1,0,0]
    ds_write_b64 v96, v[10:11] offset:0
    ds_write_b64 v96, v[12:13] offset:512
    ds_write_b64 v96, v[14:15] offset:1024
    ds_write_b64 v96, v[16:17] offset:1536
    ds_write_b64 v96, v[18:19] offset:2048
    ds_write_b64 v96, v[20:21] offset:2560
    ds_write_b64 v96, v[22:23] offset:3072
    ds_write_b64 v96, v[24:25] offset:3584
    v_cmp_eq_u32 vcc, 0, v1
    s_and_saveexec_b64 s[34:35], vcc
    ds_write_b64 v96, v[10:11] offset:4096
    s_mov_b64 exec, s[34:35]
    v_lshrrev_b32 v5, 2, v0
    v_and_b32 v6, 3, v0
    v_mul_u32_u24 v4, 4768, v6
    v_lshl_add_u32 v3, v5, 3, v4
    v_sub_u32 v7, 256, v5
    v_lshl_add_u32 v99, v7, 3, v4
    v_lshlrev_b32 v6, 4, v6
    v_mul_u32_u24 v5, 16640, v5
    v_add_u32 v6, v5, v6
    s_lshl_b32 s28, s2, 6
    s_waitcnt lgkmcnt(0)
    s_barrier
    ds_read_b64 v[10:11], v3 offset:0
    ds_read_b64 v[26:27], v99 offset:2048
    ds_read_b64 v[12:13], v3 offset:512
    ds_read_b64 v[28:29], v99 offset:1536
    ds_read_b64 v[14:15], v3 offset:1024
    ds_read_b64 v[30:31], v99 offset:1024
    ds_read_b64 v[16:17], v3 offset:1536
    ds_read_b64 v[32:33], v99 offset:512
    ds_read_b64 v[18:19], v3 offset:2048
    ds_read_b64 v[34:35], v99 offset:0
    v_cmp_gt_u32 vcc, 4, v0
    s_waitcnt lgkmcnt(0)
    v_pk_add_f32 v[50:51], v[10:11], v[26:27] neg_hi:[0,1]
    v_pk_add_f32 v[52:53], v[10:11], v[26:27] op_sel:[1,1] op_sel_hi:[0,0] neg_hi:[1,0]
    v_pk_add_f32 v[54:55], v[12:13], v[28:29] neg_hi:[0,1]
    v_pk_add_f32 v[56:57], v[12:13], v[28:29] op_sel:[1,1] op_sel_hi:[0,0] neg_hi:[1,0]
    s_add_u32 s29, s28, 0x104000
    buffer_store_dwordx4 v[54:57], v6, s[12:15], s29 offen sc1
    v_pk_add_f32 v[58:59], v[14:15], v[30:31] neg_hi:[0,1]
    v_pk_add_f32 v[60:61], v[14:15], v[30:31] op_sel:[1,1] op_sel_hi:[0,0] neg_hi:[1,0]
    s_add_u32 s29, s28, 0x208000
    buffer_store_dwordx4 v[58:61], v6, s[12:15], s29 offen sc1
    v_pk_add_f32 v[62:63], v[16:17], v[32:33] neg_hi:[0,1]
    v_pk_add_f32 v[64:65], v[16:17], v[32:33] op_sel:[1,1] op_sel_hi:[0,0] neg_hi:[1,0]
    s_add_u32 s29, s28, 0x30c000
    buffer_store_dwordx4 v[62:65], v6, s[12:15], s29 offen sc1
    v_pk_add_f32 v[66:67], v[18:19], v[34:35] neg_hi:[0,1]
    v_pk_add_f32 v[68:69], v[18:19], v[34:35] op_sel:[1,1] op_sel_hi:[0,0] neg_hi:[1,0]
    v_cndmask_b32 v51, v51, v66, vcc
    v_cndmask_b32 v53, v53, v68, vcc
    s_add_u32 s29, s28, 0x0
    buffer_store_dwordx4 v[50:53], v6, s[12:15], s29 offen sc1
Lsk_7:
    s_mov_b64 exec, -1
    s_branch Ljoin_3
Lskip_2:
    v_subrev_u32 v0, 256, v0
    s_getpc_b64 s[48:49]
Lpc_11:
    s_sub_u32 s48, s48, Lpc_11-code_start
    s_subb_u32 s49, s49, 0
    s_and_b32 s49, s49, 0xffff
    s_mov_b32 s50, code_end-code_start
    s_mov_b32 s51, 0x00020000
    s_lshr_b32 s29, s2, 3
    s_lshl_b32 s29, s29, 12
    v_lshlrev_b32 v3, 4, v0
    buffer_load_dwordx4 v[80:83], v3, s[48:51], s29 offen
    s_mov_b64 s[6:7], s[84:85]
    s_mov_b32 s12, s6
    s_and_b32 s13, s7, 0xffff
    s_mov_b32 s14, 0x10000000
    s_mov_b32 s15, 0x00020000
    s_mov_b32 s44, s82
    s_and_b32 s45, s83, 0xffff
    s_mov_b32 s46, 0x100
    s_mov_b32 s47, 0x00020000
    s_cmp_lg_u32 s2, 255
    s_cbranch_scc1 Lalt_10
    v_lshlrev_b32 v3, 8, v0
    v_mov_b32 v4, 0
    buffer_store_dword v4, v3, s[96:99], 0 offen sc1
    s_mov_b32 s29, 65536
    buffer_store_dword v4, v3, s[96:99], s29 offen sc1
    s_waitcnt vmcnt(0)
    v_mov_b32 v4, 1
    v_mov_b32 v3, 0
    s_mov_b64 exec, 1
    buffer_atomic_add v4, v3, s[44:47], 0 offen sc1
    s_mov_b64 exec, -1
Lalt_10:
    s_mov_b64 s[24:25], s[66:67]
    s_mov_b64 s[26:27], s[68:69]
    s_mov_b32 s36, s24
    s_and_b32 s37, s25, 0xffff
    s_mov_b32 s38, 0x101000
    s_mov_b32 s39, 0x00020000
    s_mov_b32 s40, s26
    s_and_b32 s41, s27, 0xffff
    s_mov_b32 s42, 0x101000
    s_mov_b32 s43, 0x00020000
    s_mov_b32 s28, s2
    s_branch Lz_12
    s_cmp_lg_u32 s28, 0
    s_cbranch_scc1 Lz_12
    v_cmp_gt_u32 vcc, 128, v0
    s_and_saveexec_b64 s[34:35], vcc
    s_cbranch_execz Lz_12r
    v_lshlrev_b32 v3, 8, v0
    v_mov_b32 v4, 0
    s_mov_b32 s29, 0x1e40000
    buffer_store_dword v4, v3, s[12:15], s29 offen sc1
Lz_12r:
    s_mov_b64 exec, s[34:35]
Lz_12:
    s_mul_i32 s29, s28, 4112
    v_lshlrev_b32 v3, 4, v0
    buffer_load_dwordx4 v[10:13], v3, s[36:39], s29 offen offset:0
    buffer_load_dwordx4 v[14:17], v3, s[40:43], s29 offen offset:0
    s_add_u32 s29, s29, 4096
    buffer_load_dwordx4 v[18:21], v3, s[36:39], s29 offen offset:0
    buffer_load_dwordx4 v[22:25], v3, s[40:43], s29 offen offset:0
    s_add_u32 s29, s29, 4096
    s_waitcnt vmcnt(2)
    ds_write_b128 v3, v[10:13] offset:20480
    ds_write_b128 v3, v[14:17] offset:28688
    s_waitcnt vmcnt(0)
    ds_write_b128 v3, v[18:21] offset:24576
    ds_write_b128 v3, v[22:25] offset:32784
    s_waitcnt lgkmcnt(0)
    s_barrier
    v_and_b32 v4, 7, v0
    v_lshrrev_b32 v5, 3, v0
    v_mul_u32_u24 v6, 514, v4
    v_lshl_add_u32 v6, v5, 1, v6
    v_lshlrev_b32 v7, 13, v5
    v_lshl_add_u32 v7, v4, 2, v7
    s_lshl_b32 s29, s28, 5
    s_add_u32 s29, s29, 0x420000
    ds_read_u16 v10, v6 offset:20480
    ds_read_u16 v11, v6 offset:28688
    ds_read_u16 v12, v6 offset:20544
    ds_read_u16 v13, v6 offset:28752
    ds_read_u16 v14, v6 offset:20608
    ds_read_u16 v15, v6 offset:28816
    ds_read_u16 v16, v6 offset:20672
    ds_read_u16 v17, v6 offset:28880
    ds_read_u16 v18, v6 offset:20736
    ds_read_u16 v19, v6 offset:28944
    ds_read_u16 v20, v6 offset:20800
    ds_read_u16 v21, v6 offset:29008
    ds_read_u16 v22, v6 offset:20864
    ds_read_u16 v23, v6 offset:29072
    ds_read_u16 v24, v6 offset:20928
    ds_read_u16 v25, v6 offset:29136
    ds_read_u16 v26, v6 offset:20992
    ds_read_u16 v27, v6 offset:29200
    s_waitcnt lgkmcnt(0)
    v_lshl_or_b32 v10, v11, 16, v10
    buffer_store_dword v10, v7, s[12:15], s29 offen sc1
    s_add_u32 s29, s29, 262144
    v_lshl_or_b32 v12, v13, 16, v12
    buffer_store_dword v12, v7, s[12:15], s29 offen sc1
    s_add_u32 s29, s29, 262144
    v_lshl_or_b32 v14, v15, 16, v14
    buffer_store_dword v14, v7, s[12:15], s29 offen sc1
    s_add_u32 s29, s29, 262144
    v_lshl_or_b32 v16, v17, 16, v16
    buffer_store_dword v16, v7, s[12:15], s29 offen sc1
    s_add_u32 s29, s29, 262144
    v_lshl_or_b32 v18, v19, 16, v18
    buffer_store_dword v18, v7, s[12:15], s29 offen sc1
    s_add_u32 s29, s29, 262144
    v_lshl_or_b32 v20, v21, 16, v20
    buffer_store_dword v20, v7, s[12:15], s29 offen sc1
    s_add_u32 s29, s29, 262144
    v_lshl_or_b32 v22, v23, 16, v22
    buffer_store_dword v22, v7, s[12:15], s29 offen sc1
    s_add_u32 s29, s29, 262144
    v_lshl_or_b32 v24, v25, 16, v24
    buffer_store_dword v24, v7, s[12:15], s29 offen sc1
    s_add_u32 s29, s29, 262144
    v_lshl_or_b32 v26, v27, 16, v26
    v_cmp_gt_u32 vcc, 8, v0
    s_and_saveexec_b64 s[34:35], vcc
    buffer_store_dword v26, v7, s[12:15], s29 offen sc1
    s_add_u32 s29, s29, 262144
    s_mov_b64 exec, -1
    s_cmp_lg_u32 s3, 7
    s_cbranch_scc1 Lw_13
    v_mov_b32 v3, 0
    s_mov_b32 s93, 0
Lwl_14:
    buffer_load_dword v4, v3, s[44:47], 0 offen sc0 sc1
    s_waitcnt vmcnt(0)
    v_readfirstlane_b32 s94, v4
    s_add_u32 s93, s93, 1
    s_cmp_ge_u32 s94, 4
    s_cbranch_scc1 Lw_13
    s_cmp_gt_u32 s93, 0x40000
    s_cbranch_scc1 Lw_13
    s_sleep 8
    s_branch Lwl_14
Lw_13:
    v_add_u32 v0, 256, v0
Ljoin_3:
    s_waitcnt vmcnt(0)
    s_barrier
    s_cmp_lg_u32 s3, 0
    s_cbranch_scc1 Lpub_15
    s_lshr_b32 s92, s2, 4
    s_lshl_b32 s92, s92, 8
    s_add_u32 s92, s92, 32768
    v_mov_b32 v158, 1
    v_mov_b32 v159, 0
    s_mov_b64 exec, 1
    buffer_atomic_add v158, v159, s[96:99], s92 offen sc0 sc1
    s_waitcnt vmcnt(0)
    v_readfirstlane_b32 s94, v158
    s_cmp_lg_u32 s94, 15
    s_cbranch_scc1 Lpub_15x
    s_mov_b64 exec, 0xffff
    v_mov_b32 v158, 1
    v_lshlrev_b32 v159, 8, v1
    s_mov_b32 s92, 36864
    buffer_atomic_add v158, v159, s[96:99], s92 offen sc1
Lpub_15x:
    s_mov_b64 exec, -1
Lpub_15:
    s_cmp_eq_u32 s2, 200
    s_cbranch_scc1 Lsp_16
    s_cmp_ge_u32 s3, 4
    s_cbranch_scc1 Lskip_18
    s_getpc_b64 s[16:17]
Lpc_20:
    s_add_u32 s16, s16, tab_tw2048a-Lpc_20
    s_addc_u32 s17, s17, 0
    s_and_b32 s17, s17, 0xffff
    s_mov_b32 s18, 0x800
    s_mov_b32 s19, 0x00020000
    s_mov_b32 s20, 0x3f3504f3
    s_mov_b32 s21, s20
    s_mov_b64 s[6:7], s[84:85]
    s_mov_b32 s12, s6
    s_and_b32 s13, s7, 0xffff
    s_mov_b32 s14, 0x10000000
    s_mov_b32 s15, 0x00020000
    v_lshlrev_b32 v3, 3, v0
    buffer_load_dwordx2 v[44:45], v3, s[16:19], 0 offen
    v_and_b32 v5, 31, v0
    v_lshlrev_b32 v5, 6, v5
    buffer_load_dwordx2 v[60:61], v5, s[16:19], 0 offen
    v_and_b32 v5, 3, v0
    v_lshlrev_b32 v5, 9, v5
    buffer_load_dwordx2 v[76:77], v5, s[16:19], 0 offen
    v_lshlrev_b32 v98, 3, v0
    v_lshrrev_b32 v7, 5, v0
    v_and_b32 v8, 31, v0
    v_lshl_add_u32 v9, v7, 8, v8
    v_lshlrev_b32 v99, 3, v9
    v_mul_u32_u24 v9, 288, v7
    v_add_u32 v8, v9, v8
    v_lshlrev_b32 v100, 3, v8
    v_bfe_u32 v8, v0, 2, 3
    v_mul_u32_u24 v8, 36, v8
    v_add_u32 v9, v9, v8
    v_and_b32 v8, 3, v0
    v_add_u32 v9, v9, v8
    v_lshlrev_b32 v101, 3, v9
    v_lshlrev_b32 v9, 2, v7
    v_bfe_u32 v7, v0, 2, 2
    v_add_u32 v9, v9, v7
    v_bfe_u32 v7, v0, 4, 1
    v_lshl_add_u32 v9, v7, 5, v9
    v_mul_u32_u24 v8, 68, v8
    v_add_u32 v9, v9, v8
    v_lshlrev_b32 v102, 3, v9
    v_and_b32 v7, 7, v0
    v_lshlrev_b32 v9, 2, v7
    v_bfe_u32 v7, v0, 3, 2
    v_add_u32 v9, v9, v7
    v_bfe_u32 v7, v0, 5, 1
    v_lshl_add_u32 v9, v7, 5, v9
    v_lshrrev_b32 v7, 6, v0
    v_mul_u32_u24 v7, 272, v7
    v_add_u32 v9, v9, v7
    v_lshlrev_b32 v103, 3, v9
    s_cmp_lg_u32 s3, 0
    s_cbranch_scc1 Lpd_21
    s_lshr_b32 s92, s2, 4
    s_lshl_b32 s92, s92, 8
    s_add_u32 s92, s92, 36864
    v_mov_b32 v159, 0
    s_mov_b32 s93, 0
Lpl_22:
    v_mov_b32 v158, 0
    s_mov_b64 exec, 1
    buffer_atomic_add v158, v159, s[96:99], s92 offen sc0 sc1
    s_mov_b64 exec, -1
    s_waitcnt vmcnt(0)
    v_readfirstlane_b32 s94, v158
    s_add_u32 s93, s93, 1
    s_cmp_ge_u32 s94, 16
    s_cbranch_scc1 Lpd_21
    s_cmp_gt_u32 s93, 0x40000
    s_cbranch_scc1 Lpd_21
    s_sleep 2
    s_branch Lpl_22
Lpd_21:
    s_barrier
    s_mul_i32 s28, s95, 16640
    s_add_u32 s28, s28, 0x0
    s_add_u32 s36, s28, 0
    s_add_u32 s37, s28, 4096
    s_add_u32 s38, s28, 8192
    s_add_u32 s39, s28, 12288
    buffer_load_dwordx2 v[10:11], v3, s[12:15], s36 offen offset:0
    buffer_load_dwordx2 v[12:13], v3, s[12:15], s36 offen offset:2048
    buffer_load_dwordx2 v[14:15], v3, s[12:15], s37 offen offset:0
    buffer_load_dwordx2 v[16:17], v3, s[12:15], s37 offen offset:2048
    buffer_load_dwordx2 v[18:19], v3, s[12:15], s38 offen offset:0
    buffer_load_dwordx2 v[20:21], v3, s[12:15], s38 offen offset:2048
    buffer_load_dwordx2 v[22:23], v3, s[12:15], s39 offen offset:0
    buffer_load_dwordx2 v[24:25], v3, s[12:15], s39 offen offset:2048
    v_lshlrev_b32 v6, 2, v0
    s_lshl_b32 s29, s95, 13
    s_add_u32 s29, s29, 0x420000
    s_add_u32 s30, s29, 4096
    buffer_load_dword v90, v6, s[12:15], s29 offen offset:0
    buffer_load_dword v91, v6, s[12:15], s29 offen offset:1024
    buffer_load_dword v92, v6, s[12:15], s29 offen offset:2048
    buffer_load_dword v93, v6, s[12:15], s29 offen offset:3072
    buffer_load_dword v94, v6, s[12:15], s30 offen offset:0
    buffer_load_dword v95, v6, s[12:15], s30 offen offset:1024
    buffer_load_dword v96, v6, s[12:15], s30 offen offset:2048
    buffer_load_dword v97, v6, s[12:15], s30 offen offset:3072
    s_waitcnt vmcnt(16)
    v_pk_mul_f32 v[26:27], v[44:45], v[44:45] op_sel_hi:[1,0]
    v_pk_fma_f32 v[46:47], v[44:45], v[44:45], v[26:27] op_sel:[1,1,0] op_sel_hi:[0,1,1] neg_lo:[1,0,0]
    v_pk_mul_f32 v[28:29], v[46:47], v[44:45] op_sel_hi:[1,0]
    v_pk_fma_f32 v[48:49], v[46:47], v[44:45], v[28:29] op_sel:[1,1,0] op_sel_hi:[0,1,1] neg_lo:[1,0,0]
    v_pk_mul_f32 v[26:27], v[46:47], v[46:47] op_sel_hi:[1,0]
    v_pk_fma_f32 v[50:51], v[46:47], v[46:47], v[26:27] op_sel:[1,1,0] op_sel_hi:[0,1,1] neg_lo:[1,0,0]
    v_pk_mul_f32 v[28:29], v[50:51], v[44:45] op_sel_hi:[1,0]
    v_pk_fma_f32 v[52:53], v[50:51], v[44:45], v[28:29] op_sel:[1,1,0] op_sel_hi:[0,1,1] neg_lo:[1,0,0]
    v_pk_mul_f32 v[26:27], v[48:49], v[48:49] op_sel_hi:[1,0]
    v_pk_fma_f32 v[54:55], v[48:49], v[48:49], v[26:27] op_sel:[1,1,0] op_sel_hi:[0,1,1] neg_lo:[1,0,0]
    v_pk_mul_f32 v[28:29], v[50:51], v[48:49] op_sel_hi:[1,0]
    v_pk_fma_f32 v[56:57], v[50:51], v[48:49], v[28:29] op_sel:[1,1,0] op_sel_hi:[0,1,1] neg_lo:[1,0,0]
    v_pk_mul_f32 v[26:27], v[60:61], v[60:61] op_sel_hi:[1,0]
    v_pk_fma_f32 v[62:63], v[60:61], v[60:61], v[26:27] op_sel:[1,1,0] op_sel_hi:[0,1,1] neg_lo:[1,0,0]
    v_pk_mul_f32 v[28:29], v[62:63], v[60:61] op_sel_hi:[1,0]
    v_pk_fma_f32 v[64:65], v[62:63], v[60:61], v[28:29] op_sel:[1,1,0] op_sel_hi:[0,1,1] neg_lo:[1,0,0]
    v_pk_mul_f32 v[26:27], v[62:63], v[62:63] op_sel_hi:[1,0]
    v_pk_fma_f32 v[66:67], v[62:63], v[62:63], v[26:27] op_sel:[1,1,0] op_sel_hi:[0,1,1] neg_lo:[1,0,0]
    v_pk_mul_f32 v[28:29], v[66:67], v[60:61] op_sel_hi:[1,0]
    v_pk_fma_f32 v[68:69], v[66:67], v[60:61], v[28:29] op_sel:[1,1,0] op_sel_hi:[0,1,1] neg_lo:[1,0,0]
    v_pk_mul_f32 v[26:27], v[64:65], v[64:65] op_sel_hi:[1,0]
    v_pk_fma_f32 v[70:71], v[64:65], v[64:65], v[26:27] op_sel:[1,1,0] op_sel_hi:[0,1,1] neg_lo:[1,0,0]
    v_pk_mul_f32 v[28:29], v[66:67], v[64:65] op_sel_hi:[1,0]
    v_pk_fma_f32 v[72:73], v[66:67], v[64:65], v[28:29] op_sel:[1,1,0] op_sel_hi:[0,1,1] neg_lo:[1,0,0]
    v_pk_mul_f32 v[26:27], v[76:77], v[76:77] op_sel_hi:[1,0]
    v_pk_fma_f32 v[78:79], v[76:77], v[76:77], v[26:27] op_sel:[1,1,0] op_sel_hi:[0,1,1] neg_lo:[1,0,0]
    v_pk_mul_f32 v[28:29], v[78:79], v[76:77] op_sel_hi:[1,0]
    v_pk_fma_f32 v[80:81], v[78:79], v[76:77], v[28:29] op_sel:[1,1,0] op_sel_hi:[0,1,1] neg_lo:[1,0,0]
    v_pk_mul_f32 v[26:27], v[78:79], v[78:79] op_sel_hi:[1,0]
    v_pk_fma_f32 v[82:83], v[78:79], v[78:79], v[26:27] op_sel:[1,1,0] op_sel_hi:[0,1,1] neg_lo:[1,0,0]
    v_pk_mul_f32 v[28:29], v[82:83], v[76:77] op_sel_hi:[1,0]
    v_pk_fma_f32 v[84:85], v[82:83], v[76:77], v[28:29] op_sel:[1,1,0] op_sel_hi:[0,1,1] neg_lo:[1,0,0]
    v_pk_mul_f32 v[26:27], v[80:81], v[80:81] op_sel_hi:[1,0]
    v_pk_fma_f32 v[86:87], v[80:81], v[80:81], v[26:27] op_sel:[1,1,0] op_sel_hi:[0,1,1] neg_lo:[1,0,0]
    v_pk_mul_f32 v[28:29], v[82:83], v[80:81] op_sel_hi:[1,0]
    v_pk_fma_f32 v[88:89], v[82:83], v[80:81], v[28:29] op_sel:[1,1,0] op_sel_hi:[0,1,1] neg_lo:[1,0,0]
    s_waitcnt vmcnt(8)
    v_pk_add_f32 v[26:27], v[10:11], v[18:19]
    v_pk_add_f32 v[34:35], v[10:11], v[18:19] neg_lo:[0,1] neg_hi:[0,1]
    v_pk_add_f32 v[28:29], v[12:13], v[20:21]
    v_pk_add_f32 v[36:37], v[12:13], v[20:21] neg_lo:[0,1] neg_hi:[0,1]
    v_pk_add_f32 v[30:31], v[14:15], v[22:23]
    v_pk_add_f32 v[38:39], v[14:15], v[22:23] neg_lo:[0,1] neg_hi:[0,1]
    v_pk_add_f32 v[32:33], v[16:17], v[24:25]
    v_pk_add_f32 v[40:41], v[16:17], v[24:25] neg_lo:[0,1] neg_hi:[0,1]
    v_pk_add_f32 v[12:13], v[26:27], v[30:31]
    v_pk_add_f32 v[16:17], v[26:27], v[30:31] neg_lo:[0,1] neg_hi:[0,1]
    v_pk_add_f32 v[20:21], v[28:29], v[32:33]
    v_pk_add_f32 v[24:25], v[28:29], v[32:33] neg_lo:[0,1] neg_hi:[0,1]
    v_pk_add_f32 v[10:11], v[12:13], v[20:21]
    v_pk_add_f32 v[18:19], v[12:13], v[20:21] neg_lo:[0,1] neg_hi:[0,1]
    v_pk_add_f32 v[14:15], v[16:17], v[24:25] op_sel:[0,1] op_sel_hi:[1,0] neg_hi:[0,1]
    v_pk_add_f32 v[22:23], v[16:17], v[24:25] op_sel:[0,1] op_sel_hi:[1,0] neg_lo:[0,1]
    v_pk_add_f32 v[26:27], v[36:37], v[36:37] op_sel:[0,1] op_sel_hi:[1,0] neg_hi:[0,1]
    v_pk_add_f32 v[28:29], v[40:41], v[40:41] op_sel:[0,1] op_sel_hi:[1,0] neg_lo:[1,0] neg_hi:[1,1]
    v_pk_add_f32 v[30:31], v[26:27], v[28:29]
    v_pk_add_f32 v[32:33], v[26:27], v[28:29] neg_lo:[0,1] neg_hi:[0,1]
    v_pk_add_f32 v[36:37], v[34:35], v[38:39] op_sel:[0,1] op_sel_hi:[1,0] neg_hi:[0,1]
    v_pk_add_f32 v[40:41], v[34:35], v[38:39] op_sel:[0,1] op_sel_hi:[1,0] neg_lo:[0,1]
    v_pk_fma_f32 v[12:13], v[30:31], s[20:21], v[36:37]
    v_pk_fma_f32 v[20:21], v[30:31], s[20:21], v[36:37] neg_lo:[1,0,0] neg_hi:[1,0,0]
    v_pk_fma_f32 v[16:17], v[32:33], s[20:21], v[40:41] op_sel:[1,0,0] op_sel_hi:[0,1,1] neg_hi:[1,0,0]
    v_pk_fma_f32 v[24:25], v[32:33], s[20:21], v[40:41] op_sel:[1,0,0] op_sel_hi:[0,1,1] neg_lo:[1,0,0]
    ds_write_b64 v98, v[10:11] offset:0
    v_pk_mul_f32 v[28:29], v[12:13], v[44:45] op_sel_hi:[1,0]
    v_pk_fma_f32 v[12:13], v[12:13], v[44:45], v[28:29] op_sel:[1,1,0] op_sel_hi:[0,1,1] neg_lo:[1,0,0]
    ds_write_b64 v98, v[12:13] offset:2048
    v_pk_mul_f32 v[30:31], v[14:15], v[46:47] op_sel_hi:[1,0]
    v_pk_fma_f32 v[14:15], v[14:15], v[46:47], v[30:31] op_sel:[1,1,0] op_sel_hi:[0,1,1] neg_lo:[1,0,0]
    ds_write_b64 v98, v[14:15] offset:4096
    v_pk_mul_f32 v[32:33], v[16:17], v[48:49] op_sel_hi:[1,0]
    v_pk_fma_f32 v[16:17], v[16:17], v[48:49], v[32:33] op_sel:[1,1,0] op_sel_hi:[0,1,1] neg_lo:[1,0,0]
    ds_write_b64 v98, v[16:17] offset:6144
    v_pk_mul_f32 v[34:35], v[18:19], v[50:51] op_sel_hi:[1,0]
    v_pk_fma_f32 v[18:19], v[18:19], v[50:51], v[34:35] op_sel:[1,1,0] op_sel_hi:[0,1,1] neg_lo:[1,0,0]
    ds_write_b64 v98, v[18:19] offset:8192
    v_pk_mul_f32 v[36:37], v[20:21], v[52:53] op_sel_hi:[1,0]
    v_pk_fma_f32 v[20:21], v[20:21], v[52:53], v[36:37] op_sel:[1,1,0] op_sel_hi:[0,1,1] neg_lo:[1,0,0]
    ds_write_b64 v98, v[20:21] offset:10240
    v_pk_mul_f32 v[38:39], v[22:23], v[54:55] op_sel_hi:[1,0]
    v_pk_fma_f32 v[22:23], v[22:23], v[54:55], v[38:39] op_sel:[1,1,0] op_sel_hi:[0,1,1] neg_lo:[1,0,0]
    ds_write_b64 v98, v[22:23] offset:12288
    v_pk_mul_f32 v[40:41], v[24:25], v[56:57] op_sel_hi:[1,0]
    v_pk_fma_f32 v[24:25], v[24:25], v[56:57], v[40:41] op_sel:[1,1,0] op_sel_hi:[0,1,1] neg_lo:[1,0,0]
    ds_write_b64 v98, v[24:25] offset:14336
    s_waitcnt lgkmcnt(0)
    s_barrier
    ds_read_b64 v[10:11], v99 offset:0
    ds_read_b64 v[18:19], v99 offset:1024
    ds_read_b64 v[12:13], v99 offset:256
    ds_read_b64 v[20:21], v99 offset:1280
    ds_read_b64 v[14:15], v99 offset:512
    ds_read_b64 v[22:23], v99 offset:1536
    ds_read_b64 v[16:17], v99 offset:768
    ds_read_b64 v[24:25], v99 offset:1792
    s_waitcnt lgkmcnt(6)
    v_pk_add_f32 v[26:27], v[10:11], v[18:19]
    v_pk_add_f32 v[34:35], v[10:11], v[18:19] neg_lo:[0,1] neg_hi:[0,1]
    s_waitcnt lgkmcnt(4)
    v_pk_add_f32 v[28:29], v[12:13], v[20:21]
    v_pk_add_f32 v[36:37], v[12:13], v[20:21] neg_lo:[0,1] neg_hi:[0,1]
    s_waitcnt lgkmcnt(2)
    v_pk_add_f32 v[30:31], v[14:15], v[22:23]
    v_pk_add_f32 v[38:39], v[14:15], v[22:23] neg_lo:[0,1] neg_hi:[0,1]
    s_waitcnt lgkmcnt(0)
    v_pk_add_f32 v[32:33], v[16:17], v[24:25]
    v_pk_add_f32 v[40:41], v[16:17], v[24:25] neg_lo:[0,1] neg_hi:[0,1]
    v_pk_add_f32 v[12:13], v[26:27], v[30:31]
    v_pk_add_f32 v[16:17], v[26:27], v[30:31] neg_lo:[0,1] neg_hi:[0,1]
    v_pk_add_f32 v[20:21], v[28:29], v[32:33]
    v_pk_add_f32 v[24:25], v[28:29], v[32:33] neg_lo:[0,1] neg_hi:[0,1]
    v_pk_add_f32 v[10:11], v[12:13], v[20:21]
    v_pk_add_f32 v[18:19], v[12:13], v[20:21] neg_lo:[0,1] neg_hi:[0,1]
    v_pk_add_f32 v[14:15], v[16:17], v[24:25] op_sel:[0,1] op_sel_hi:[1,0] neg_hi:[0,1]
    v_pk_add_f32 v[22:23], v[16:17], v[24:25] op_sel:[0,1] op_sel_hi:[1,0] neg_lo:[0,1]
    v_pk_add_f32 v[26:27], v[36:37], v[36:37] op_sel:[0,1] op_sel_hi:[1,0] neg_hi:[0,1]
    v_pk_add_f32 v[28:29], v[40:41], v[40:41] op_sel:[0,1] op_sel_hi:[1,0] neg_lo:[1,0] neg_hi:[1,1]
    v_pk_add_f32 v[30:31], v[26:27], v[28:29]
    v_pk_add_f32 v[32:33], v[26:27], v[28:29] neg_lo:[0,1] neg_hi:[0,1]
    v_pk_add_f32 v[36:37], v[34:35], v[38:39] op_sel:[0,1] op_sel_hi:[1,0] neg_hi:[0,1]
    v_pk_add_f32 v[40:41], v[34:35], v[38:39] op_sel:[0,1] op_sel_hi:[1,0] neg_lo:[0,1]
    v_pk_fma_f32 v[12:13], v[30:31], s[20:21], v[36:37]
    v_pk_fma_f32 v[20:21], v[30:31], s[20:21], v[36:37] neg_lo:[1,0,0] neg_hi:[1,0,0]
    v_pk_fma_f32 v[16:17], v[32:33], s[20:21], v[40:41] op_sel:[1,0,0] op_sel_hi:[0,1,1] neg_hi:[1,0,0]
    v_pk_fma_f32 v[24:25], v[32:33], s[20:21], v[40:41] op_sel:[1,0,0] op_sel_hi:[0,1,1] neg_lo:[1,0,0]
    ds_write_b64 v100, v[10:11] offset:36864
    v_pk_mul_f32 v[28:29], v[12:13], v[60:61] op_sel_hi:[1,0]
    v_pk_fma_f32 v[12:13], v[12:13], v[60:61], v[28:29] op_sel:[1,1,0] op_sel_hi:[0,1,1] neg_lo:[1,0,0]
    ds_write_b64 v100, v[12:13] offset:37152
    v_pk_mul_f32 v[30:31], v[14:15], v[62:63] op_sel_hi:[1,0]
    v_pk_fma_f32 v[14:15], v[14:15], v[62:63], v[30:31] op_sel:[1,1,0] op_sel_hi:[0,1,1] neg_lo:[1,0,0]
    ds_write_b64 v100, v[14:15] offset:37440
    v_pk_mul_f32 v[32:33], v[16:17], v[64:65] op_sel_hi:[1,0]
    v_pk_fma_f32 v[16:17], v[16:17], v[64:65], v[32:33] op_sel:[1,1,0] op_sel_hi:[0,1,1] neg_lo:[1,0,0]
    ds_write_b64 v100, v[16:17] offset:37728
    v_pk_mul_f32 v[34:35], v[18:19], v[66:67] op_sel_hi:[1,0]
    v_pk_fma_f32 v[18:19], v[18:19], v[66:67], v[34:35] op_sel:[1,1,0] op_sel_hi:[0,1,1] neg_lo:[1,0,0]
    ds_write_b64 v100, v[18:19] offset:38016
    v_pk_mul_f32 v[36:37], v[20:21], v[68:69] op_sel_hi:[1,0]
    v_pk_fma_f32 v[20:21], v[20:21], v[68:69], v[36:37] op_sel:[1,1,0] op_sel_hi:[0,1,1] neg_lo:[1,0,0]
    ds_write_b64 v100, v[20:21] offset:38304
    v_pk_mul_f32 v[38:39], v[22:23], v[70:71] op_sel_hi:[1,0]
    v_pk_fma_f32 v[22:23], v[22:23], v[70:71], v[38:39] op_sel:[1,1,0] op_sel_hi:[0,1,1] neg_lo:[1,0,0]
    ds_write_b64 v100, v[22:23] offset:38592
    v_pk_mul_f32 v[40:41], v[24:25], v[72:73] op_sel_hi:[1,0]
    v_pk_fma_f32 v[24:25], v[24:25], v[72:73], v[40:41] op_sel:[1,1,0] op_sel_hi:[0,1,1] neg_lo:[1,0,0]
    ds_write_b64 v100, v[24:25] offset:38880
    ds_read_b64 v[10:11], v101 offset:36864
    ds_read_b64 v[18:19], v101 offset:36992
    ds_read_b64 v[12:13], v101 offset:36896
    ds_read_b64 v[20:21], v101 offset:37024
    ds_read_b64 v[14:15], v101 offset:36928
    ds_read_b64 v[22:23], v101 offset:37056
    ds_read_b64 v[16:17], v101 offset:36960
    ds_read_b64 v[24:25], v101 offset:37088
    s_waitcnt lgkmcnt(6)
    v_pk_add_f32 v[26:27], v[10:11], v[18:19]
    v_pk_add_f32 v[34:35], v[10:11], v[18:19] neg_lo:[0,1] neg_hi:[0,1]
    s_waitcnt lgkmcnt(4)
    v_pk_add_f32 v[28:29], v[12:13], v[20:21]
    v_pk_add_f32 v[36:37], v[12:13], v[20:21] neg_lo:[0,1] neg_hi:[0,1]
    s_waitcnt lgkmcnt(2)
    v_pk_add_f32 v[30:31], v[14:15], v[22:23]
    v_pk_add_f32 v[38:39], v[14:15], v[22:23] neg_lo:[0,1] neg_hi:[0,1]
    s_waitcnt lgkmcnt(0)
    v_pk_add_f32 v[32:33], v[16:17], v[24:25]
    v_pk_add_f32 v[40:41], v[16:17], v[24:25] neg_lo:[0,1] neg_hi:[0,1]
    v_pk_add_f32 v[12:13], v[26:27], v[30:31]
    v_pk_add_f32 v[16:17], v[26:27], v[30:31] neg_lo:[0,1] neg_hi:[0,1]
    v_pk_add_f32 v[20:21], v[28:29], v[32:33]
    v_pk_add_f32 v[24:25], v[28:29], v[32:33] neg_lo:[0,1] neg_hi:[0,1]
    v_pk_add_f32 v[10:11], v[12:13], v[20:21]
    v_pk_add_f32 v[18:19], v[12:13], v[20:21] neg_lo:[0,1] neg_hi:[0,1]
    v_pk_add_f32 v[14:15], v[16:17], v[24:25] op_sel:[0,1] op_sel_hi:[1,0] neg_hi:[0,1]
    v_pk_add_f32 v[22:23], v[16:17], v[24:25] op_sel:[0,1] op_sel_hi:[1,0] neg_lo:[0,1]
    v_pk_add_f32 v[26:27], v[36:37], v[36:37] op_sel:[0,1] op_sel_hi:[1,0] neg_hi:[0,1]
    v_pk_add_f32 v[28:29], v[40:41], v[40:41] op_sel:[0,1] op_sel_hi:[1,0] neg_lo:[1,0] neg_hi:[1,1]
    v_pk_add_f32 v[30:31], v[26:27], v[28:29]
    v_pk_add_f32 v[32:33], v[26:27], v[28:29] neg_lo:[0,1] neg_hi:[0,1]
    v_pk_add_f32 v[36:37], v[34:35], v[38:39] op_sel:[0,1] op_sel_hi:[1,0] neg_hi:[0,1]
    v_pk_add_f32 v[40:41], v[34:35], v[38:39] op_sel:[0,1] op_sel_hi:[1,0] neg_lo:[0,1]
    v_pk_fma_f32 v[12:13], v[30:31], s[20:21], v[36:37]
    v_pk_fma_f32 v[20:21], v[30:31], s[20:21], v[36:37] neg_lo:[1,0,0] neg_hi:[1,0,0]
    v_pk_fma_f32 v[16:17], v[32:33], s[20:21], v[40:41] op_sel:[1,0,0] op_sel_hi:[0,1,1] neg_hi:[1,0,0]
    v_pk_fma_f32 v[24:25], v[32:33], s[20:21], v[40:41] op_sel:[1,0,0] op_sel_hi:[0,1,1] neg_lo:[1,0,0]
    ds_write_b64 v102, v[10:11] offset:18432
    v_pk_mul_f32 v[28:29], v[12:13], v[76:77] op_sel_hi:[1,0]
    v_pk_fma_f32 v[12:13], v[12:13], v[76:77], v[28:29] op_sel:[1,1,0] op_sel_hi:[0,1,1] neg_lo:[1,0,0]
    ds_write_b64 v102, v[12:13] offset:20608
    v_pk_mul_f32 v[30:31], v[14:15], v[78:79] op_sel_hi:[1,0]
    v_pk_fma_f32 v[14:15], v[14:15], v[78:79], v[30:31] op_sel:[1,1,0] op_sel_hi:[0,1,1] neg_lo:[1,0,0]
    ds_write_b64 v102, v[14:15] offset:22784
    v_pk_mul_f32 v[32:33], v[16:17], v[80:81] op_sel_hi:[1,0]
    v_pk_fma_f32 v[16:17], v[16:17], v[80:81], v[32:33] op_sel:[1,1,0] op_sel_hi:[0,1,1] neg_lo:[1,0,0]
    ds_write_b64 v102, v[16:17] offset:24960
    v_pk_mul_f32 v[34:35], v[18:19], v[82:83] op_sel_hi:[1,0]
    v_pk_fma_f32 v[18:19], v[18:19], v[82:83], v[34:35] op_sel:[1,1,0] op_sel_hi:[0,1,1] neg_lo:[1,0,0]
    ds_write_b64 v102, v[18:19] offset:27136
    v_pk_mul_f32 v[36:37], v[20:21], v[84:85] op_sel_hi:[1,0]
    v_pk_fma_f32 v[20:21], v[20:21], v[84:85], v[36:37] op_sel:[1,1,0] op_sel_hi:[0,1,1] neg_lo:[1,0,0]
    ds_write_b64 v102, v[20:21] offset:29312
    v_pk_mul_f32 v[38:39], v[22:23], v[86:87] op_sel_hi:[1,0]
    v_pk_fma_f32 v[22:23], v[22:23], v[86:87], v[38:39] op_sel:[1,1,0] op_sel_hi:[0,1,1] neg_lo:[1,0,0]
    ds_write_b64 v102, v[22:23] offset:31488
    v_pk_mul_f32 v[40:41], v[24:25], v[88:89] op_sel_hi:[1,0]
    v_pk_fma_f32 v[24:25], v[24:25], v[88:89], v[40:41] op_sel:[1,1,0] op_sel_hi:[0,1,1] neg_lo:[1,0,0]
    ds_write_b64 v102, v[24:25] offset:33664
    s_waitcnt lgkmcnt(0)
    s_barrier
    ds_read_b64 v[10:11], v103 offset:18432
    ds_read_b64 v[14:15], v103 offset:18976
    ds_read_b64 v[18:19], v103 offset:19520
    ds_read_b64 v[22:23], v103 offset:20064
    ds_read_b64 v[12:13], v103 offset:27136
    ds_read_b64 v[16:17], v103 offset:27680
    ds_read_b64 v[20:21], v103 offset:28224
    ds_read_b64 v[24:25], v103 offset:28768
    s_waitcnt lgkmcnt(0)
    v_pk_add_f32 v[26:27], v[10:11], v[18:19]
    v_pk_add_f32 v[28:29], v[10:11], v[18:19] neg_lo:[0,1] neg_hi:[0,1]
    v_pk_add_f32 v[30:31], v[14:15], v[22:23]
    v_pk_add_f32 v[32:33], v[14:15], v[22:23] neg_lo:[0,1] neg_hi:[0,1]
    v_pk_add_f32 v[10:11], v[26:27], v[30:31]
    v_pk_add_f32 v[18:19], v[26:27], v[30:31] neg_lo:[0,1] neg_hi:[0,1]
    v_pk_add_f32 v[14:15], v[28:29], v[32:33] op_sel:[0,1] op_sel_hi:[1,0] neg_hi:[0,1]
    v_pk_add_f32 v[22:23], v[28:29], v[32:33] op_sel:[0,1] op_sel_hi:[1,0] neg_lo:[0,1]
    v_pk_add_f32 v[34:35], v[12:13], v[20:21]
    v_pk_add_f32 v[36:37], v[12:13], v[20:21] neg_lo:[0,1] neg_hi:[0,1]
    v_pk_add_f32 v[38:39], v[16:17], v[24:25]
    v_pk_add_f32 v[40:41], v[16:17], v[24:25] neg_lo:[0,1] neg_hi:[0,1]
    v_pk_add_f32 v[12:13], v[34:35], v[38:39]
    v_pk_add_f32 v[20:21], v[34:35], v[38:39] neg_lo:[0,1] neg_hi:[0,1]
    v_pk_add_f32 v[16:17], v[36:37], v[40:41] op_sel:[0,1] op_sel_hi:[1,0] neg_hi:[0,1]
    v_pk_add_f32 v[24:25], v[36:37], v[40:41] op_sel:[0,1] op_sel_hi:[1,0] neg_lo:[0,1]
    s_waitcnt vmcnt(0)
    v_lshlrev_b32 v28, 16, v90
    v_and_b32 v29, 0xffff0000, v90
    v_pk_mul_f32 v[26:27], v[10:11], v[28:29] op_sel_hi:[1,0]
    v_pk_fma_f32 v[10:11], v[10:11], v[28:29], v[26:27] op_sel:[1,1,0] op_sel_hi:[0,1,1] neg_lo:[1,0,0]
    v_lshlrev_b32 v26, 16, v91
    v_and_b32 v27, 0xffff0000, v91
    v_pk_mul_f32 v[28:29], v[12:13], v[26:27] op_sel_hi:[1,0]
    v_pk_fma_f32 v[12:13], v[12:13], v[26:27], v[28:29] op_sel:[1,1,0] op_sel_hi:[0,1,1] neg_lo:[1,0,0]
    v_lshlrev_b32 v32, 16, v92
    v_and_b32 v33, 0xffff0000, v92
    v_pk_mul_f32 v[30:31], v[14:15], v[32:33] op_sel_hi:[1,0]
    v_pk_fma_f32 v[14:15], v[14:15], v[32:33], v[30:31] op_sel:[1,1,0] op_sel_hi:[0,1,1] neg_lo:[1,0,0]
    v_lshlrev_b32 v30, 16, v93
    v_and_b32 v31, 0xffff0000, v93
    v_pk_mul_f32 v[32:33], v[16:17], v[30:31] op_sel_hi:[1,0]
    v_pk_fma_f32 v[16:17], v[16:17], v[30:31], v[32:33] op_sel:[1,1,0] op_sel_hi:[0,1,1] neg_lo:[1,0,0]
    v_lshlrev_b32 v36, 16, v94
    v_and_b32 v37, 0xffff0000, v94
    v_pk_mul_f32 v[34:35], v[18:19], v[36:37] op_sel_hi:[1,0]
    v_pk_fma_f32 v[18:19], v[18:19], v[36:37], v[34:35] op_sel:[1,1,0] op_sel_hi:[0,1,1] neg_lo:[1,0,0]
    v_lshlrev_b32 v34, 16, v95
    v_and_b32 v35, 0xffff0000, v95
    v_pk_mul_f32 v[36:37], v[20:21], v[34:35] op_sel_hi:[1,0]
    v_pk_fma_f32 v[20:21], v[20:21], v[34:35], v[36:37] op_sel:[1,1,0] op_sel_hi:[0,1,1] neg_lo:[1,0,0]
    v_lshlrev_b32 v40, 16, v96
    v_and_b32 v41, 0xffff0000, v96
    v_pk_mul_f32 v[38:39], v[22:23], v[40:41] op_sel_hi:[1,0]
    v_pk_fma_f32 v[22:23], v[22:23], v[40:41], v[38:39] op_sel:[1,1,0] op_sel_hi:[0,1,1] neg_lo:[1,0,0]
    v_lshlrev_b32 v38, 16, v97
    v_and_b32 v39, 0xffff0000, v97
    v_pk_mul_f32 v[40:41], v[24:25], v[38:39] op_sel_hi:[1,0]
    v_pk_fma_f32 v[24:25], v[24:25], v[38:39], v[40:41] op_sel:[1,1,0] op_sel_hi:[0,1,1] neg_lo:[1,0,0]
    v_pk_add_f32 v[26:27], v[10:11], v[18:19]
    v_pk_add_f32 v[34:35], v[10:11], v[18:19] neg_lo:[0,1] neg_hi:[0,1]
    v_pk_add_f32 v[28:29], v[12:13], v[20:21]
    v_pk_add_f32 v[36:37], v[12:13], v[20:21] neg_lo:[0,1] neg_hi:[0,1]
    v_pk_add_f32 v[30:31], v[14:15], v[22:23]
    v_pk_add_f32 v[38:39], v[14:15], v[22:23] neg_lo:[0,1] neg_hi:[0,1]
    v_pk_add_f32 v[32:33], v[16:17], v[24:25]
    v_pk_add_f32 v[40:41], v[16:17], v[24:25] neg_lo:[0,1] neg_hi:[0,1]
    v_pk_add_f32 v[12:13], v[26:27], v[30:31]
    v_pk_add_f32 v[16:17], v[26:27], v[30:31] neg_lo:[0,1] neg_hi:[0,1]
    v_pk_add_f32 v[20:21], v[28:29], v[32:33]
    v_pk_add_f32 v[24:25], v[28:29], v[32:33] neg_lo:[0,1] neg_hi:[0,1]
    v_pk_add_f32 v[10:11], v[12:13], v[20:21]
    v_pk_add_f32 v[18:19], v[12:13], v[20:21] neg_lo:[0,1] neg_hi:[0,1]
    v_pk_add_f32 v[14:15], v[16:17], v[24:25] op_sel:[0,1] op_sel_hi:[1,0] neg_lo:[0,1]
    v_pk_add_f32 v[22:23], v[16:17], v[24:25] op_sel:[0,1] op_sel_hi:[1,0] neg_hi:[0,1]
    v_pk_add_f32 v[26:27], v[36:37], v[36:37] op_sel:[0,1] op_sel_hi:[1,0] neg_lo:[0,1]
    v_pk_add_f32 v[28:29], v[40:41], v[40:41] op_sel:[0,1] op_sel_hi:[1,0] neg_lo:[1,1] neg_hi:[1,0]
    v_pk_add_f32 v[30:31], v[26:27], v[28:29]
    v_pk_add_f32 v[32:33], v[26:27], v[28:29] neg_lo:[0,1] neg_hi:[0,1]
    v_pk_add_f32 v[36:37], v[34:35], v[38:39] op_sel:[0,1] op_sel_hi:[1,0] neg_lo:[0,1]
    v_pk_add_f32 v[40:41], v[34:35], v[38:39] op_sel:[0,1] op_sel_hi:[1,0] neg_hi:[0,1]
    v_pk_fma_f32 v[12:13], v[30:31], s[20:21], v[36:37]
    v_pk_fma_f32 v[20:21], v[30:31], s[20:21], v[36:37] neg_lo:[1,0,0] neg_hi:[1,0,0]
    v_pk_fma_f32 v[16:17], v[32:33], s[20:21], v[40:41] op_sel:[1,0,0] op_sel_hi:[0,1,1] neg_lo:[1,0,0]
    v_pk_fma_f32 v[24:25], v[32:33], s[20:21], v[40:41] op_sel:[1,0,0] op_sel_hi:[0,1,1] neg_hi:[1,0,0]
    ds_write_b64 v98, v[10:11] offset:0
    v_pk_mul_f32 v[28:29], v[12:13], v[44:45] op_sel_hi:[1,0]
    v_pk_fma_f32 v[12:13], v[12:13], v[44:45], v[28:29] op_sel:[1,1,0] op_sel_hi:[0,1,1] neg_hi:[1,0,0]
    ds_write_b64 v98, v[12:13] offset:2048
    v_pk_mul_f32 v[30:31], v[14:15], v[46:47] op_sel_hi:[1,0]
    v_pk_fma_f32 v[14:15], v[14:15], v[46:47], v[30:31] op_sel:[1,1,0] op_sel_hi:[0,1,1] neg_hi:[1,0,0]
    ds_write_b64 v98, v[14:15] offset:4096
    v_pk_mul_f32 v[32:33], v[16:17], v[48:49] op_sel_hi:[1,0]
    v_pk_fma_f32 v[16:17], v[16:17], v[48:49], v[32:33] op_sel:[1,1,0] op_sel_hi:[0,1,1] neg_hi:[1,0,0]
    ds_write_b64 v98, v[16:17] offset:6144
    v_pk_mul_f32 v[34:35], v[18:19], v[50:51] op_sel_hi:[1,0]
    v_pk_fma_f32 v[18:19], v[18:19], v[50:51], v[34:35] op_sel:[1,1,0] op_sel_hi:[0,1,1] neg_hi:[1,0,0]
    ds_write_b64 v98, v[18:19] offset:8192
    v_pk_mul_f32 v[36:37], v[20:21], v[52:53] op_sel_hi:[1,0]
    v_pk_fma_f32 v[20:21], v[20:21], v[52:53], v[36:37] op_sel:[1,1,0] op_sel_hi:[0,1,1] neg_hi:[1,0,0]
    ds_write_b64 v98, v[20:21] offset:10240
    v_pk_mul_f32 v[38:39], v[22:23], v[54:55] op_sel_hi:[1,0]
    v_pk_fma_f32 v[22:23], v[22:23], v[54:55], v[38:39] op_sel:[1,1,0] op_sel_hi:[0,1,1] neg_hi:[1,0,0]
    ds_write_b64 v98, v[22:23] offset:12288
    v_pk_mul_f32 v[40:41], v[24:25], v[56:57] op_sel_hi:[1,0]
    v_pk_fma_f32 v[24:25], v[24:25], v[56:57], v[40:41] op_sel:[1,1,0] op_sel_hi:[0,1,1] neg_hi:[1,0,0]
    ds_write_b64 v98, v[24:25] offset:14336
    s_waitcnt lgkmcnt(0)
    s_barrier
    ds_read_b64 v[10:11], v99 offset:0
    ds_read_b64 v[18:19], v99 offset:1024
    ds_read_b64 v[12:13], v99 offset:256
    ds_read_b64 v[20:21], v99 offset:1280
    ds_read_b64 v[14:15], v99 offset:512
    ds_read_b64 v[22:23], v99 offset:1536
    ds_read_b64 v[16:17], v99 offset:768
    ds_read_b64 v[24:25], v99 offset:1792
    s_waitcnt lgkmcnt(6)
    v_pk_add_f32 v[26:27], v[10:11], v[18:19]
    v_pk_add_f32 v[34:35], v[10:11], v[18:19] neg_lo:[0,1] neg_hi:[0,1]
    s_waitcnt lgkmcnt(4)
    v_pk_add_f32 v[28:29], v[12:13], v[20:21]
    v_pk_add_f32 v[36:37], v[12:13], v[20:21] neg_lo:[0,1] neg_hi:[0,1]
    s_waitcnt lgkmcnt(2)
    v_pk_add_f32 v[30:31], v[14:15], v[22:23]
    v_pk_add_f32 v[38:39], v[14:15], v[22:23] neg_lo:[0,1] neg_hi:[0,1]
    s_waitcnt lgkmcnt(0)
    v_pk_add_f32 v[32:33], v[16:17], v[24:25]
    v_pk_add_f32 v[40:41], v[16:17], v[24:25] neg_lo:[0,1] neg_hi:[0,1]
    v_pk_add_f32 v[12:13], v[26:27], v[30:31]
    v_pk_add_f32 v[16:17], v[26:27], v[30:31] neg_lo:[0,1] neg_hi:[0,1]
    v_pk_add_f32 v[20:21], v[28:29], v[32:33]
    v_pk_add_f32 v[24:25], v[28:29], v[32:33] neg_lo:[0,1] neg_hi:[0,1]
    v_pk_add_f32 v[10:11], v[12:13], v[20:21]
    v_pk_add_f32 v[18:19], v[12:13], v[20:21] neg_lo:[0,1] neg_hi:[0,1]
    v_pk_add_f32 v[14:15], v[16:17], v[24:25] op_sel:[0,1] op_sel_hi:[1,0] neg_lo:[0,1]
    v_pk_add_f32 v[22:23], v[16:17], v[24:25] op_sel:[0,1] op_sel_hi:[1,0] neg_hi:[0,1]
    v_pk_add_f32 v[26:27], v[36:37], v[36:37] op_sel:[0,1] op_sel_hi:[1,0] neg_lo:[0,1]
    v_pk_add_f32 v[28:29], v[40:41], v[40:41] op_sel:[0,1] op_sel_hi:[1,0] neg_lo:[1,1] neg_hi:[1,0]
    v_pk_add_f32 v[30:31], v[26:27], v[28:29]
    v_pk_add_f32 v[32:33], v[26:27], v[28:29] neg_lo:[0,1] neg_hi:[0,1]
    v_pk_add_f32 v[36:37], v[34:35], v[38:39] op_sel:[0,1] op_sel_hi:[1,0] neg_lo:[0,1]
    v_pk_add_f32 v[40:41], v[34:35], v[38:39] op_sel:[0,1] op_sel_hi:[1,0] neg_hi:[0,1]
    v_pk_fma_f32 v[12:13], v[30:31], s[20:21], v[36:37]
    v_pk_fma_f32 v[20:21], v[30:31], s[20:21], v[36:37] neg_lo:[1,0,0] neg_hi:[1,0,0]
    v_pk_fma_f32 v[16:17], v[32:33], s[20:21], v[40:41] op_sel:[1,0,0] op_sel_hi:[0,1,1] neg_lo:[1,0,0]
    v_pk_fma_f32 v[24:25], v[32:33], s[20:21], v[40:41] op_sel:[1,0,0] op_sel_hi:[0,1,1] neg_hi:[1,0,0]
    ds_write_b64 v100, v[10:11] offset:36864
    v_pk_mul_f32 v[28:29], v[12:13], v[60:61] op_sel_hi:[1,0]
    v_pk_fma_f32 v[12:13], v[12:13], v[60:61], v[28:29] op_sel:[1,1,0] op_sel_hi:[0,1,1] neg_hi:[1,0,0]
    ds_write_b64 v100, v[12:13] offset:37152
    v_pk_mul_f32 v[30:31], v[14:15], v[62:63] op_sel_hi:[1,0]
    v_pk_fma_f32 v[14:15], v[14:15], v[62:63], v[30:31] op_sel:[1,1,0] op_sel_hi:[0,1,1] neg_hi:[1,0,0]
    ds_write_b64 v100, v[14:15] offset:37440
    v_pk_mul_f32 v[32:33], v[16:17], v[64:65] op_sel_hi:[1,0]
    v_pk_fma_f32 v[16:17], v[16:17], v[64:65], v[32:33] op_sel:[1,1,0] op_sel_hi:[0,1,1] neg_hi:[1,0,0]
    ds_write_b64 v100, v[16:17] offset:37728
    v_pk_mul_f32 v[34:35], v[18:19], v[66:67] op_sel_hi:[1,0]
    v_pk_fma_f32 v[18:19], v[18:19], v[66:67], v[34:35] op_sel:[1,1,0] op_sel_hi:[0,1,1] neg_hi:[1,0,0]
    ds_write_b64 v100, v[18:19] offset:38016
    v_pk_mul_f32 v[36:37], v[20:21], v[68:69] op_sel_hi:[1,0]
    v_pk_fma_f32 v[20:21], v[20:21], v[68:69], v[36:37] op_sel:[1,1,0] op_sel_hi:[0,1,1] neg_hi:[1,0,0]
    ds_write_b64 v100, v[20:21] offset:38304
    v_pk_mul_f32 v[38:39], v[22:23], v[70:71] op_sel_hi:[1,0]
    v_pk_fma_f32 v[22:23], v[22:23], v[70:71], v[38:39] op_sel:[1,1,0] op_sel_hi:[0,1,1] neg_hi:[1,0,0]
    ds_write_b64 v100, v[22:23] offset:38592
    v_pk_mul_f32 v[40:41], v[24:25], v[72:73] op_sel_hi:[1,0]
    v_pk_fma_f32 v[24:25], v[24:25], v[72:73], v[40:41] op_sel:[1,1,0] op_sel_hi:[0,1,1] neg_hi:[1,0,0]
    ds_write_b64 v100, v[24:25] offset:38880
    ds_read_b64 v[10:11], v101 offset:36864
    ds_read_b64 v[18:19], v101 offset:36992
    ds_read_b64 v[12:13], v101 offset:36896
    ds_read_b64 v[20:21], v101 offset:37024
    ds_read_b64 v[14:15], v101 offset:36928
    ds_read_b64 v[22:23], v101 offset:37056
    ds_read_b64 v[16:17], v101 offset:36960
    ds_read_b64 v[24:25], v101 offset:37088
    s_waitcnt lgkmcnt(6)
    v_pk_add_f32 v[26:27], v[10:11], v[18:19]
    v_pk_add_f32 v[34:35], v[10:11], v[18:19] neg_lo:[0,1] neg_hi:[0,1]
    s_waitcnt lgkmcnt(4)
    v_pk_add_f32 v[28:29], v[12:13], v[20:21]
    v_pk_add_f32 v[36:37], v[12:13], v[20:21] neg_lo:[0,1] neg_hi:[0,1]
    s_waitcnt lgkmcnt(2)
    v_pk_add_f32 v[30:31], v[14:15], v[22:23]
    v_pk_add_f32 v[38:39], v[14:15], v[22:23] neg_lo:[0,1] neg_hi:[0,1]
    s_waitcnt lgkmcnt(0)
    v_pk_add_f32 v[32:33], v[16:17], v[24:25]
    v_pk_add_f32 v[40:41], v[16:17], v[24:25] neg_lo:[0,1] neg_hi:[0,1]
    v_pk_add_f32 v[12:13], v[26:27], v[30:31]
    v_pk_add_f32 v[16:17], v[26:27], v[30:31] neg_lo:[0,1] neg_hi:[0,1]
    v_pk_add_f32 v[20:21], v[28:29], v[32:33]
    v_pk_add_f32 v[24:25], v[28:29], v[32:33] neg_lo:[0,1] neg_hi:[0,1]
    v_pk_add_f32 v[10:11], v[12:13], v[20:21]
    v_pk_add_f32 v[18:19], v[12:13], v[20:21] neg_lo:[0,1] neg_hi:[0,1]
    v_pk_add_f32 v[14:15], v[16:17], v[24:25] op_sel:[0,1] op_sel_hi:[1,0] neg_lo:[0,1]
    v_pk_add_f32 v[22:23], v[16:17], v[24:25] op_sel:[0,1] op_sel_hi:[1,0] neg_hi:[0,1]
    v_pk_add_f32 v[26:27], v[36:37], v[36:37] op_sel:[0,1] op_sel_hi:[1,0] neg_lo:[0,1]
    v_pk_add_f32 v[28:29], v[40:41], v[40:41] op_sel:[0,1] op_sel_hi:[1,0] neg_lo:[1,1] neg_hi:[1,0]
    v_pk_add_f32 v[30:31], v[26:27], v[28:29]
    v_pk_add_f32 v[32:33], v[26:27], v[28:29] neg_lo:[0,1] neg_hi:[0,1]
    v_pk_add_f32 v[36:37], v[34:35], v[38:39] op_sel:[0,1] op_sel_hi:[1,0] neg_lo:[0,1]
    v_pk_add_f32 v[40:41], v[34:35], v[38:39] op_sel:[0,1] op_sel_hi:[1,0] neg_hi:[0,1]
    v_pk_fma_f32 v[12:13], v[30:31], s[20:21], v[36:37]
    v_pk_fma_f32 v[20:21], v[30:31], s[20:21], v[36:37] neg_lo:[1,0,0] neg_hi:[1,0,0]
    v_pk_fma_f32 v[16:17], v[32:33], s[20:21], v[40:41] op_sel:[1,0,0] op_sel_hi:[0,1,1] neg_lo:[1,0,0]
    v_pk_fma_f32 v[24:25], v[32:33], s[20:21], v[40:41] op_sel:[1,0,0] op_sel_hi:[0,1,1] neg_hi:[1,0,0]
    ds_write_b64 v102, v[10:11] offset:18432
    v_pk_mul_f32 v[28:29], v[12:13], v[76:77] op_sel_hi:[1,0]
    v_pk_fma_f32 v[12:13], v[12:13], v[76:77], v[28:29] op_sel:[1,1,0] op_sel_hi:[0,1,1] neg_hi:[1,0,0]
    ds_write_b64 v102, v[12:13] offset:20608
    v_pk_mul_f32 v[30:31], v[14:15], v[78:79] op_sel_hi:[1,0]
    v_pk_fma_f32 v[14:15], v[14:15], v[78:79], v[30:31] op_sel:[1,1,0] op_sel_hi:[0,1,1] neg_hi:[1,0,0]
    ds_write_b64 v102, v[14:15] offset:22784
    v_pk_mul_f32 v[32:33], v[16:17], v[80:81] op_sel_hi:[1,0]
    v_pk_fma_f32 v[16:17], v[16:17], v[80:81], v[32:33] op_sel:[1,1,0] op_sel_hi:[0,1,1] neg_hi:[1,0,0]
    ds_write_b64 v102, v[16:17] offset:24960
    v_pk_mul_f32 v[34:35], v[18:19], v[82:83] op_sel_hi:[1,0]
    v_pk_fma_f32 v[18:19], v[18:19], v[82:83], v[34:35] op_sel:[1,1,0] op_sel_hi:[0,1,1] neg_hi:[1,0,0]
    ds_write_b64 v102, v[18:19] offset:27136
    v_pk_mul_f32 v[36:37], v[20:21], v[84:85] op_sel_hi:[1,0]
    v_pk_fma_f32 v[20:21], v[20:21], v[84:85], v[36:37] op_sel:[1,1,0] op_sel_hi:[0,1,1] neg_hi:[1,0,0]
    ds_write_b64 v102, v[20:21] offset:29312
    v_pk_mul_f32 v[38:39], v[22:23], v[86:87] op_sel_hi:[1,0]
    v_pk_fma_f32 v[22:23], v[22:23], v[86:87], v[38:39] op_sel:[1,1,0] op_sel_hi:[0,1,1] neg_hi:[1,0,0]
    ds_write_b64 v102, v[22:23] offset:31488
    v_pk_mul_f32 v[40:41], v[24:25], v[88:89] op_sel_hi:[1,0]
    v_pk_fma_f32 v[24:25], v[24:25], v[88:89], v[40:41] op_sel:[1,1,0] op_sel_hi:[0,1,1] neg_hi:[1,0,0]
    ds_write_b64 v102, v[24:25] offset:33664
    s_waitcnt lgkmcnt(0)
    s_barrier
    ds_read_b64 v[10:11], v103 offset:18432
    ds_read_b64 v[14:15], v103 offset:18976
    ds_read_b64 v[18:19], v103 offset:19520
    ds_read_b64 v[22:23], v103 offset:20064
    ds_read_b64 v[12:13], v103 offset:27136
    ds_read_b64 v[16:17], v103 offset:27680
    ds_read_b64 v[20:21], v103 offset:28224
    ds_read_b64 v[24:25], v103 offset:28768
    s_waitcnt lgkmcnt(0)
    v_pk_add_f32 v[26:27], v[10:11], v[18:19]
    v_pk_add_f32 v[28:29], v[10:11], v[18:19] neg_lo:[0,1] neg_hi:[0,1]
    v_pk_add_f32 v[30:31], v[14:15], v[22:23]
    v_pk_add_f32 v[32:33], v[14:15], v[22:23] neg_lo:[0,1] neg_hi:[0,1]
    v_pk_add_f32 v[10:11], v[26:27], v[30:31]
    v_pk_add_f32 v[18:19], v[26:27], v[30:31] neg_lo:[0,1] neg_hi:[0,1]
    v_pk_add_f32 v[14:15], v[28:29], v[32:33] op_sel:[0,1] op_sel_hi:[1,0] neg_lo:[0,1]
    v_pk_add_f32 v[22:23], v[28:29], v[32:33] op_sel:[0,1] op_sel_hi:[1,0] neg_hi:[0,1]
    v_pk_add_f32 v[34:35], v[12:13], v[20:21]
    v_pk_add_f32 v[36:37], v[12:13], v[20:21] neg_lo:[0,1] neg_hi:[0,1]
    v_pk_add_f32 v[38:39], v[16:17], v[24:25]
    v_pk_add_f32 v[40:41], v[16:17], v[24:25] neg_lo:[0,1] neg_hi:[0,1]
    v_pk_add_f32 v[12:13], v[34:35], v[38:39]
    v_pk_add_f32 v[20:21], v[34:35], v[38:39] neg_lo:[0,1] neg_hi:[0,1]
    v_pk_add_f32 v[16:17], v[36:37], v[40:41] op_sel:[0,1] op_sel_hi:[1,0] neg_lo:[0,1]
    v_pk_add_f32 v[24:25], v[36:37], v[40:41] op_sel:[0,1] op_sel_hi:[1,0] neg_hi:[0,1]
    v_lshrrev_b32 v4, 3, v0
    v_mul_u32_u24 v4, 16640, v4
    v_and_b32 v5, 7, v0
    v_lshl_add_u32 v4, v5, 3, v4
    s_lshl_b32 s28, s95, 6
    s_add_u32 s29, s28, 0x2000000
    buffer_store_dwordx2 v[10:11], v4, s[12:15], s29 offen sc1
    s_add_u32 s29, s28, 0x2082000
    buffer_store_dwordx2 v[12:13], v4, s[12:15], s29 offen sc1
    s_add_u32 s29, s28, 0x2104000
    buffer_store_dwordx2 v[14:15], v4, s[12:15], s29 offen sc1
    s_add_u32 s29, s28, 0x2186000
    buffer_store_dwordx2 v[16:17], v4, s[12:15], s29 offen sc1
    s_add_u32 s29, s28, 0x2208000
    buffer_store_dwordx2 v[18:19], v4, s[12:15], s29 offen sc1
    s_add_u32 s29, s28, 0x228a000
    buffer_store_dwordx2 v[20:21], v4, s[12:15], s29 offen sc1
    s_add_u32 s29, s28, 0x230c000
    buffer_store_dwordx2 v[22:23], v4, s[12:15], s29 offen sc1
    s_add_u32 s29, s28, 0x238e000
    buffer_store_dwordx2 v[24:25], v4, s[12:15], s29 offen sc1
    s_branch Ljoin_19
Lskip_18:
    v_subrev_u32 v0, 256, v0
    s_mov_b32 s36, s72
    s_and_b32 s37, s73, 0xffff
    s_mov_b32 s38, 0x1c0000
    s_mov_b32 s39, 0x00020000
    s_mov_b32 s40, s76
    s_and_b32 s41, s77, 0xffff
    s_mov_b32 s42, 0x1c0000
    s_mov_b32 s43, 0x00020000
    s_mul_i32 s29, s2, 7168
    v_lshlrev_b32 v3, 4, v0
    buffer_load_dwordx4 v[60:63], v3, s[36:39], s29 offen
    buffer_load_dwordx4 v[64:67], v3, s[40:43], s29 offen
    s_add_u32 s29, s29, 4096
    buffer_load_dwordx4 v[68:71], v3, s[36:39], s29 offen
    buffer_load_dwordx4 v[72:75], v3, s[40:43], s29 offen
    s_add_u32 s29, s29, 4096
    v_add_u32 v0, 256, v0
    s_barrier
    s_barrier
    s_barrier
    s_barrier
    s_barrier
Ljoin_19:
    s_branch Lspj_17
Lsp_16:
    s_cmp_ge_u32 s3, 4
    s_cbranch_scc1 Lskip_23
    s_getpc_b64 s[16:17]
Lpc_25:
    s_add_u32 s16, s16, tab_tw2048a-Lpc_25
    s_addc_u32 s17, s17, 0
    s_and_b32 s17, s17, 0xffff
    s_mov_b32 s18, 0x800
    s_mov_b32 s19, 0x00020000
    s_mov_b32 s20, 0x3f3504f3
    s_mov_b32 s21, s20
    s_mov_b64 s[6:7], s[84:85]
    s_mov_b32 s12, s6
    s_and_b32 s13, s7, 0xffff
    s_mov_b32 s14, 0x10000000
    s_mov_b32 s15, 0x00020000
    v_lshlrev_b32 v3, 3, v0
    buffer_load_dwordx2 v[44:45], v3, s[16:19], 0 offen
    v_and_b32 v5, 31, v0
    v_lshlrev_b32 v5, 6, v5
    buffer_load_dwordx2 v[60:61], v5, s[16:19], 0 offen
    v_and_b32 v5, 3, v0
    v_lshlrev_b32 v5, 9, v5
    buffer_load_dwordx2 v[76:77], v5, s[16:19], 0 offen
    v_lshlrev_b32 v98, 3, v0
    v_lshrrev_b32 v7, 5, v0
    v_and_b32 v8, 31, v0
    v_lshl_add_u32 v9, v7, 8, v8
    v_lshlrev_b32 v99, 3, v9
    v_mul_u32_u24 v9, 288, v7
    v_add_u32 v8, v9, v8
    v_lshlrev_b32 v100, 3, v8
    v_bfe_u32 v8, v0, 2, 3
    v_mul_u32_u24 v8, 36, v8
    v_add_u32 v9, v9, v8
    v_and_b32 v8, 3, v0
    v_add_u32 v9, v9, v8
    v_lshlrev_b32 v101, 3, v9
    v_lshlrev_b32 v9, 2, v7
    v_bfe_u32 v7, v0, 2, 2
    v_add_u32 v9, v9, v7
    v_bfe_u32 v7, v0, 4, 1
    v_lshl_add_u32 v9, v7, 5, v9
    v_mul_u32_u24 v8, 68, v8
    v_add_u32 v9, v9, v8
    v_lshlrev_b32 v102, 3, v9
    v_and_b32 v7, 7, v0
    v_lshlrev_b32 v9, 2, v7
    v_bfe_u32 v7, v0, 3, 2
    v_add_u32 v9, v9, v7
    v_bfe_u32 v7, v0, 5, 1
    v_lshl_add_u32 v9, v7, 5, v9
    v_lshrrev_b32 v7, 6, v0
    v_mul_u32_u24 v7, 272, v7
    v_add_u32 v9, v9, v7
    v_lshlrev_b32 v103, 3, v9
    s_cmp_lg_u32 s3, 0
    s_cbranch_scc1 Lpd_26
    s_lshr_b32 s92, s2, 4
    s_lshl_b32 s92, s92, 8
    s_add_u32 s92, s92, 36864
    v_mov_b32 v159, 0
    s_mov_b32 s93, 0
Lpl_27:
    v_mov_b32 v158, 0
    s_mov_b64 exec, 1
    buffer_atomic_add v158, v159, s[96:99], s92 offen sc0 sc1
    s_mov_b64 exec, -1
    s_waitcnt vmcnt(0)
    v_readfirstlane_b32 s94, v158
    s_add_u32 s93, s93, 1
    s_cmp_ge_u32 s94, 16
    s_cbranch_scc1 Lpd_26
    s_cmp_gt_u32 s93, 0x40000
    s_cbranch_scc1 Lpd_26
    s_sleep 2
    s_branch Lpl_27
Lpd_26:
    s_barrier
    s_mul_i32 s28, s95, 16640
    s_add_u32 s28, s28, 0x0
    s_add_u32 s36, s28, 0
    s_add_u32 s37, s28, 4096
    s_add_u32 s38, s28, 8192
    s_add_u32 s39, s28, 12288
    buffer_load_dwordx2 v[10:11], v3, s[12:15], s36 offen offset:0
    buffer_load_dwordx2 v[12:13], v3, s[12:15], s36 offen offset:2048
    buffer_load_dwordx2 v[14:15], v3, s[12:15], s37 offen offset:0
    buffer_load_dwordx2 v[16:17], v3, s[12:15], s37 offen offset:2048
    buffer_load_dwordx2 v[18:19], v3, s[12:15], s38 offen offset:0
    buffer_load_dwordx2 v[20:21], v3, s[12:15], s38 offen offset:2048
    buffer_load_dwordx2 v[22:23], v3, s[12:15], s39 offen offset:0
    buffer_load_dwordx2 v[24:25], v3, s[12:15], s39 offen offset:2048
    v_lshlrev_b32 v6, 2, v0
    v_sub_u32 v7, 2048, v0
    v_and_b32 v7, 2047, v7
    v_lshlrev_b32 v7, 2, v7
    s_mov_b32 s29, 0x420000
    buffer_load_dword v104, v6, s[12:15], s29 offen
    s_mov_b32 s29, 0x620000
    buffer_load_dword v105, v6, s[12:15], s29 offen
    s_mov_b32 s29, 0x420000
    buffer_load_dword v106, v7, s[12:15], s29 offen
    s_mov_b32 s29, 0x620000
    buffer_load_dword v107, v7, s[12:15], s29 offen
    v_sub_u32 v7, 1792, v0
    v_and_b32 v7, 2047, v7
    v_lshlrev_b32 v7, 2, v7
    s_mov_b32 s29, 0x420400
    buffer_load_dword v108, v6, s[12:15], s29 offen
    s_mov_b32 s29, 0x620400
    buffer_load_dword v109, v6, s[12:15], s29 offen
    s_mov_b32 s29, 0x420000
    buffer_load_dword v110, v7, s[12:15], s29 offen
    s_mov_b32 s29, 0x620000
    buffer_load_dword v111, v7, s[12:15], s29 offen
    v_sub_u32 v7, 1536, v0
    v_and_b32 v7, 2047, v7
    v_lshlrev_b32 v7, 2, v7
    s_mov_b32 s29, 0x420800
    buffer_load_dword v112, v6, s[12:15], s29 offen
    s_mov_b32 s29, 0x620800
    buffer_load_dword v113, v6, s[12:15], s29 offen
    s_mov_b32 s29, 0x420000
    buffer_load_dword v114, v7, s[12:15], s29 offen
    s_mov_b32 s29, 0x620000
    buffer_load_dword v115, v7, s[12:15], s29 offen
    v_sub_u32 v7, 1280, v0
    v_and_b32 v7, 2047, v7
    v_lshlrev_b32 v7, 2, v7
    s_mov_b32 s29, 0x420c00
    buffer_load_dword v116, v6, s[12:15], s29 offen
    s_mov_b32 s29, 0x620c00
    buffer_load_dword v117, v6, s[12:15], s29 offen
    s_mov_b32 s29, 0x420000
    buffer_load_dword v118, v7, s[12:15], s29 offen
    s_mov_b32 s29, 0x620000
    buffer_load_dword v119, v7, s[12:15], s29 offen
    v_sub_u32 v7, 1024, v0
    v_and_b32 v7, 2047, v7
    v_lshlrev_b32 v7, 2, v7
    s_mov_b32 s29, 0x421000
    buffer_load_dword v120, v6, s[12:15], s29 offen
    s_mov_b32 s29, 0x621000
    buffer_load_dword v121, v6, s[12:15], s29 offen
    s_mov_b32 s29, 0x420000
    buffer_load_dword v122, v7, s[12:15], s29 offen
    s_mov_b32 s29, 0x620000
    buffer_load_dword v123, v7, s[12:15], s29 offen
    v_sub_u32 v7, 768, v0
    v_and_b32 v7, 2047, v7
    v_lshlrev_b32 v7, 2, v7
    s_mov_b32 s29, 0x421400
    buffer_load_dword v124, v6, s[12:15], s29 offen
    s_mov_b32 s29, 0x621400
    buffer_load_dword v125, v6, s[12:15], s29 offen
    s_mov_b32 s29, 0x420000
    buffer_load_dword v126, v7, s[12:15], s29 offen
    s_mov_b32 s29, 0x620000
    buffer_load_dword v127, v7, s[12:15], s29 offen
    v_sub_u32 v7, 512, v0
    v_and_b32 v7, 2047, v7
    v_lshlrev_b32 v7, 2, v7
    s_mov_b32 s29, 0x421800
    buffer_load_dword v128, v6, s[12:15], s29 offen
    s_mov_b32 s29, 0x621800
    buffer_load_dword v129, v6, s[12:15], s29 offen
    s_mov_b32 s29, 0x420000
    buffer_load_dword v130, v7, s[12:15], s29 offen
    s_mov_b32 s29, 0x620000
    buffer_load_dword v131, v7, s[12:15], s29 offen
    v_sub_u32 v7, 256, v0
    v_and_b32 v7, 2047, v7
    v_lshlrev_b32 v7, 2, v7
    s_mov_b32 s29, 0x421c00
    buffer_load_dword v132, v6, s[12:15], s29 offen
    s_mov_b32 s29, 0x621c00
    buffer_load_dword v133, v6, s[12:15], s29 offen
    s_mov_b32 s29, 0x420000
    buffer_load_dword v134, v7, s[12:15], s29 offen
    s_mov_b32 s29, 0x620000
    buffer_load_dword v135, v7, s[12:15], s29 offen
    s_waitcnt vmcnt(40)
    v_pk_mul_f32 v[26:27], v[44:45], v[44:45] op_sel_hi:[1,0]
    v_pk_fma_f32 v[46:47], v[44:45], v[44:45], v[26:27] op_sel:[1,1,0] op_sel_hi:[0,1,1] neg_lo:[1,0,0]
    v_pk_mul_f32 v[28:29], v[46:47], v[44:45] op_sel_hi:[1,0]
    v_pk_fma_f32 v[48:49], v[46:47], v[44:45], v[28:29] op_sel:[1,1,0] op_sel_hi:[0,1,1] neg_lo:[1,0,0]
    v_pk_mul_f32 v[26:27], v[46:47], v[46:47] op_sel_hi:[1,0]
    v_pk_fma_f32 v[50:51], v[46:47], v[46:47], v[26:27] op_sel:[1,1,0] op_sel_hi:[0,1,1] neg_lo:[1,0,0]
    v_pk_mul_f32 v[28:29], v[50:51], v[44:45] op_sel_hi:[1,0]
    v_pk_fma_f32 v[52:53], v[50:51], v[44:45], v[28:29] op_sel:[1,1,0] op_sel_hi:[0,1,1] neg_lo:[1,0,0]
    v_pk_mul_f32 v[26:27], v[48:49], v[48:49] op_sel_hi:[1,0]
    v_pk_fma_f32 v[54:55], v[48:49], v[48:49], v[26:27] op_sel:[1,1,0] op_sel_hi:[0,1,1] neg_lo:[1,0,0]
    v_pk_mul_f32 v[28:29], v[50:51], v[48:49] op_sel_hi:[1,0]
    v_pk_fma_f32 v[56:57], v[50:51], v[48:49], v[28:29] op_sel:[1,1,0] op_sel_hi:[0,1,1] neg_lo:[1,0,0]
    v_pk_mul_f32 v[26:27], v[60:61], v[60:61] op_sel_hi:[1,0]
    v_pk_fma_f32 v[62:63], v[60:61], v[60:61], v[26:27] op_sel:[1,1,0] op_sel_hi:[0,1,1] neg_lo:[1,0,0]
    v_pk_mul_f32 v[28:29], v[62:63], v[60:61] op_sel_hi:[1,0]
    v_pk_fma_f32 v[64:65], v[62:63], v[60:61], v[28:29] op_sel:[1,1,0] op_sel_hi:[0,1,1] neg_lo:[1,0,0]
    v_pk_mul_f32 v[26:27], v[62:63], v[62:63] op_sel_hi:[1,0]
    v_pk_fma_f32 v[66:67], v[62:63], v[62:63], v[26:27] op_sel:[1,1,0] op_sel_hi:[0,1,1] neg_lo:[1,0,0]
    v_pk_mul_f32 v[28:29], v[66:67], v[60:61] op_sel_hi:[1,0]
    v_pk_fma_f32 v[68:69], v[66:67], v[60:61], v[28:29] op_sel:[1,1,0] op_sel_hi:[0,1,1] neg_lo:[1,0,0]
    v_pk_mul_f32 v[26:27], v[64:65], v[64:65] op_sel_hi:[1,0]
    v_pk_fma_f32 v[70:71], v[64:65], v[64:65], v[26:27] op_sel:[1,1,0] op_sel_hi:[0,1,1] neg_lo:[1,0,0]
    v_pk_mul_f32 v[28:29], v[66:67], v[64:65] op_sel_hi:[1,0]
    v_pk_fma_f32 v[72:73], v[66:67], v[64:65], v[28:29] op_sel:[1,1,0] op_sel_hi:[0,1,1] neg_lo:[1,0,0]
    v_pk_mul_f32 v[26:27], v[76:77], v[76:77] op_sel_hi:[1,0]
    v_pk_fma_f32 v[78:79], v[76:77], v[76:77], v[26:27] op_sel:[1,1,0] op_sel_hi:[0,1,1] neg_lo:[1,0,0]
    v_pk_mul_f32 v[28:29], v[78:79], v[76:77] op_sel_hi:[1,0]
    v_pk_fma_f32 v[80:81], v[78:79], v[76:77], v[28:29] op_sel:[1,1,0] op_sel_hi:[0,1,1] neg_lo:[1,0,0]
    v_pk_mul_f32 v[26:27], v[78:79], v[78:79] op_sel_hi:[1,0]
    v_pk_fma_f32 v[82:83], v[78:79], v[78:79], v[26:27] op_sel:[1,1,0] op_sel_hi:[0,1,1] neg_lo:[1,0,0]
    v_pk_mul_f32 v[28:29], v[82:83], v[76:77] op_sel_hi:[1,0]
    v_pk_fma_f32 v[84:85], v[82:83], v[76:77], v[28:29] op_sel:[1,1,0] op_sel_hi:[0,1,1] neg_lo:[1,0,0]
    v_pk_mul_f32 v[26:27], v[80:81], v[80:81] op_sel_hi:[1,0]
    v_pk_fma_f32 v[86:87], v[80:81], v[80:81], v[26:27] op_sel:[1,1,0] op_sel_hi:[0,1,1] neg_lo:[1,0,0]
    v_pk_mul_f32 v[28:29], v[82:83], v[80:81] op_sel_hi:[1,0]
    v_pk_fma_f32 v[88:89], v[82:83], v[80:81], v[28:29] op_sel:[1,1,0] op_sel_hi:[0,1,1] neg_lo:[1,0,0]
    s_waitcnt vmcnt(32)
    v_pk_add_f32 v[26:27], v[10:11], v[18:19]
    v_pk_add_f32 v[34:35], v[10:11], v[18:19] neg_lo:[0,1] neg_hi:[0,1]
    v_pk_add_f32 v[28:29], v[12:13], v[20:21]
    v_pk_add_f32 v[36:37], v[12:13], v[20:21] neg_lo:[0,1] neg_hi:[0,1]
    v_pk_add_f32 v[30:31], v[14:15], v[22:23]
    v_pk_add_f32 v[38:39], v[14:15], v[22:23] neg_lo:[0,1] neg_hi:[0,1]
    v_pk_add_f32 v[32:33], v[16:17], v[24:25]
    v_pk_add_f32 v[40:41], v[16:17], v[24:25] neg_lo:[0,1] neg_hi:[0,1]
    v_pk_add_f32 v[12:13], v[26:27], v[30:31]
    v_pk_add_f32 v[16:17], v[26:27], v[30:31] neg_lo:[0,1] neg_hi:[0,1]
    v_pk_add_f32 v[20:21], v[28:29], v[32:33]
    v_pk_add_f32 v[24:25], v[28:29], v[32:33] neg_lo:[0,1] neg_hi:[0,1]
    v_pk_add_f32 v[10:11], v[12:13], v[20:21]
    v_pk_add_f32 v[18:19], v[12:13], v[20:21] neg_lo:[0,1] neg_hi:[0,1]
    v_pk_add_f32 v[14:15], v[16:17], v[24:25] op_sel:[0,1] op_sel_hi:[1,0] neg_hi:[0,1]
    v_pk_add_f32 v[22:23], v[16:17], v[24:25] op_sel:[0,1] op_sel_hi:[1,0] neg_lo:[0,1]
    v_pk_add_f32 v[26:27], v[36:37], v[36:37] op_sel:[0,1] op_sel_hi:[1,0] neg_hi:[0,1]
    v_pk_add_f32 v[28:29], v[40:41], v[40:41] op_sel:[0,1] op_sel_hi:[1,0] neg_lo:[1,0] neg_hi:[1,1]
    v_pk_add_f32 v[30:31], v[26:27], v[28:29]
    v_pk_add_f32 v[32:33], v[26:27], v[28:29] neg_lo:[0,1] neg_hi:[0,1]
    v_pk_add_f32 v[36:37], v[34:35], v[38:39] op_sel:[0,1] op_sel_hi:[1,0] neg_hi:[0,1]
    v_pk_add_f32 v[40:41], v[34:35], v[38:39] op_sel:[0,1] op_sel_hi:[1,0] neg_lo:[0,1]
    v_pk_fma_f32 v[12:13], v[30:31], s[20:21], v[36:37]
    v_pk_fma_f32 v[20:21], v[30:31], s[20:21], v[36:37] neg_lo:[1,0,0] neg_hi:[1,0,0]
    v_pk_fma_f32 v[16:17], v[32:33], s[20:21], v[40:41] op_sel:[1,0,0] op_sel_hi:[0,1,1] neg_hi:[1,0,0]
    v_pk_fma_f32 v[24:25], v[32:33], s[20:21], v[40:41] op_sel:[1,0,0] op_sel_hi:[0,1,1] neg_lo:[1,0,0]
    ds_write_b64 v98, v[10:11] offset:0
    v_pk_mul_f32 v[28:29], v[12:13], v[44:45] op_sel_hi:[1,0]
    v_pk_fma_f32 v[12:13], v[12:13], v[44:45], v[28:29] op_sel:[1,1,0] op_sel_hi:[0,1,1] neg_lo:[1,0,0]
    ds_write_b64 v98, v[12:13] offset:2048
    v_pk_mul_f32 v[30:31], v[14:15], v[46:47] op_sel_hi:[1,0]
    v_pk_fma_f32 v[14:15], v[14:15], v[46:47], v[30:31] op_sel:[1,1,0] op_sel_hi:[0,1,1] neg_lo:[1,0,0]
    ds_write_b64 v98, v[14:15] offset:4096
    v_pk_mul_f32 v[32:33], v[16:17], v[48:49] op_sel_hi:[1,0]
    v_pk_fma_f32 v[16:17], v[16:17], v[48:49], v[32:33] op_sel:[1,1,0] op_sel_hi:[0,1,1] neg_lo:[1,0,0]
    ds_write_b64 v98, v[16:17] offset:6144
    v_pk_mul_f32 v[34:35], v[18:19], v[50:51] op_sel_hi:[1,0]
    v_pk_fma_f32 v[18:19], v[18:19], v[50:51], v[34:35] op_sel:[1,1,0] op_sel_hi:[0,1,1] neg_lo:[1,0,0]
    ds_write_b64 v98, v[18:19] offset:8192
    v_pk_mul_f32 v[36:37], v[20:21], v[52:53] op_sel_hi:[1,0]
    v_pk_fma_f32 v[20:21], v[20:21], v[52:53], v[36:37] op_sel:[1,1,0] op_sel_hi:[0,1,1] neg_lo:[1,0,0]
    ds_write_b64 v98, v[20:21] offset:10240
    v_pk_mul_f32 v[38:39], v[22:23], v[54:55] op_sel_hi:[1,0]
    v_pk_fma_f32 v[22:23], v[22:23], v[54:55], v[38:39] op_sel:[1,1,0] op_sel_hi:[0,1,1] neg_lo:[1,0,0]
    ds_write_b64 v98, v[22:23] offset:12288
    v_pk_mul_f32 v[40:41], v[24:25], v[56:57] op_sel_hi:[1,0]
    v_pk_fma_f32 v[24:25], v[24:25], v[56:57], v[40:41] op_sel:[1,1,0] op_sel_hi:[0,1,1] neg_lo:[1,0,0]
    ds_write_b64 v98, v[24:25] offset:14336
    s_waitcnt lgkmcnt(0)
    s_barrier
    ds_read_b64 v[10:11], v99 offset:0
    ds_read_b64 v[18:19], v99 offset:1024
    ds_read_b64 v[12:13], v99 offset:256
    ds_read_b64 v[20:21], v99 offset:1280
    ds_read_b64 v[14:15], v99 offset:512
    ds_read_b64 v[22:23], v99 offset:1536
    ds_read_b64 v[16:17], v99 offset:768
    ds_read_b64 v[24:25], v99 offset:1792
    s_waitcnt lgkmcnt(6)
    v_pk_add_f32 v[26:27], v[10:11], v[18:19]
    v_pk_add_f32 v[34:35], v[10:11], v[18:19] neg_lo:[0,1] neg_hi:[0,1]
    s_waitcnt lgkmcnt(4)
    v_pk_add_f32 v[28:29], v[12:13], v[20:21]
    v_pk_add_f32 v[36:37], v[12:13], v[20:21] neg_lo:[0,1] neg_hi:[0,1]
    s_waitcnt lgkmcnt(2)
    v_pk_add_f32 v[30:31], v[14:15], v[22:23]
    v_pk_add_f32 v[38:39], v[14:15], v[22:23] neg_lo:[0,1] neg_hi:[0,1]
    s_waitcnt lgkmcnt(0)
    v_pk_add_f32 v[32:33], v[16:17], v[24:25]
    v_pk_add_f32 v[40:41], v[16:17], v[24:25] neg_lo:[0,1] neg_hi:[0,1]
    v_pk_add_f32 v[12:13], v[26:27], v[30:31]
    v_pk_add_f32 v[16:17], v[26:27], v[30:31] neg_lo:[0,1] neg_hi:[0,1]
    v_pk_add_f32 v[20:21], v[28:29], v[32:33]
    v_pk_add_f32 v[24:25], v[28:29], v[32:33] neg_lo:[0,1] neg_hi:[0,1]
    v_pk_add_f32 v[10:11], v[12:13], v[20:21]
    v_pk_add_f32 v[18:19], v[12:13], v[20:21] neg_lo:[0,1] neg_hi:[0,1]
    v_pk_add_f32 v[14:15], v[16:17], v[24:25] op_sel:[0,1] op_sel_hi:[1,0] neg_hi:[0,1]
    v_pk_add_f32 v[22:23], v[16:17], v[24:25] op_sel:[0,1] op_sel_hi:[1,0] neg_lo:[0,1]
    v_pk_add_f32 v[26:27], v[36:37], v[36:37] op_sel:[0,1] op_sel_hi:[1,0] neg_hi:[0,1]
    v_pk_add_f32 v[28:29], v[40:41], v[40:41] op_sel:[0,1] op_sel_hi:[1,0] neg_lo:[1,0] neg_hi:[1,1]
    v_pk_add_f32 v[30:31], v[26:27], v[28:29]
    v_pk_add_f32 v[32:33], v[26:27], v[28:29] neg_lo:[0,1] neg_hi:[0,1]
    v_pk_add_f32 v[36:37], v[34:35], v[38:39] op_sel:[0,1] op_sel_hi:[1,0] neg_hi:[0,1]
    v_pk_add_f32 v[40:41], v[34:35], v[38:39] op_sel:[0,1] op_sel_hi:[1,0] neg_lo:[0,1]
    v_pk_fma_f32 v[12:13], v[30:31], s[20:21], v[36:37]
    v_pk_fma_f32 v[20:21], v[30:31], s[20:21], v[36:37] neg_lo:[1,0,0] neg_hi:[1,0,0]
    v_pk_fma_f32 v[16:17], v[32:33], s[20:21], v[40:41] op_sel:[1,0,0] op_sel_hi:[0,1,1] neg_hi:[1,0,0]
    v_pk_fma_f32 v[24:25], v[32:33], s[20:21], v[40:41] op_sel:[1,0,0] op_sel_hi:[0,1,1] neg_lo:[1,0,0]
    ds_write_b64 v100, v[10:11] offset:36864
    v_pk_mul_f32 v[28:29], v[12:13], v[60:61] op_sel_hi:[1,0]
    v_pk_fma_f32 v[12:13], v[12:13], v[60:61], v[28:29] op_sel:[1,1,0] op_sel_hi:[0,1,1] neg_lo:[1,0,0]
    ds_write_b64 v100, v[12:13] offset:37152
    v_pk_mul_f32 v[30:31], v[14:15], v[62:63] op_sel_hi:[1,0]
    v_pk_fma_f32 v[14:15], v[14:15], v[62:63], v[30:31] op_sel:[1,1,0] op_sel_hi:[0,1,1] neg_lo:[1,0,0]
    ds_write_b64 v100, v[14:15] offset:37440
    v_pk_mul_f32 v[32:33], v[16:17], v[64:65] op_sel_hi:[1,0]
    v_pk_fma_f32 v[16:17], v[16:17], v[64:65], v[32:33] op_sel:[1,1,0] op_sel_hi:[0,1,1] neg_lo:[1,0,0]
    ds_write_b64 v100, v[16:17] offset:37728
    v_pk_mul_f32 v[34:35], v[18:19], v[66:67] op_sel_hi:[1,0]
    v_pk_fma_f32 v[18:19], v[18:19], v[66:67], v[34:35] op_sel:[1,1,0] op_sel_hi:[0,1,1] neg_lo:[1,0,0]
    ds_write_b64 v100, v[18:19] offset:38016
    v_pk_mul_f32 v[36:37], v[20:21], v[68:69] op_sel_hi:[1,0]
    v_pk_fma_f32 v[20:21], v[20:21], v[68:69], v[36:37] op_sel:[1,1,0] op_sel_hi:[0,1,1] neg_lo:[1,0,0]
    ds_write_b64 v100, v[20:21] offset:38304
    v_pk_mul_f32 v[38:39], v[22:23], v[70:71] op_sel_hi:[1,0]
    v_pk_fma_f32 v[22:23], v[22:23], v[70:71], v[38:39] op_sel:[1,1,0] op_sel_hi:[0,1,1] neg_lo:[1,0,0]
    ds_write_b64 v100, v[22:23] offset:38592
    v_pk_mul_f32 v[40:41], v[24:25], v[72:73] op_sel_hi:[1,0]
    v_pk_fma_f32 v[24:25], v[24:25], v[72:73], v[40:41] op_sel:[1,1,0] op_sel_hi:[0,1,1] neg_lo:[1,0,0]
    ds_write_b64 v100, v[24:25] offset:38880
    ds_read_b64 v[10:11], v101 offset:36864
    ds_read_b64 v[18:19], v101 offset:36992
    ds_read_b64 v[12:13], v101 offset:36896
    ds_read_b64 v[20:21], v101 offset:37024
    ds_read_b64 v[14:15], v101 offset:36928
    ds_read_b64 v[22:23], v101 offset:37056
    ds_read_b64 v[16:17], v101 offset:36960
    ds_read_b64 v[24:25], v101 offset:37088
    s_waitcnt lgkmcnt(6)
    v_pk_add_f32 v[26:27], v[10:11], v[18:19]
    v_pk_add_f32 v[34:35], v[10:11], v[18:19] neg_lo:[0,1] neg_hi:[0,1]
    s_waitcnt lgkmcnt(4)
    v_pk_add_f32 v[28:29], v[12:13], v[20:21]
    v_pk_add_f32 v[36:37], v[12:13], v[20:21] neg_lo:[0,1] neg_hi:[0,1]
    s_waitcnt lgkmcnt(2)
    v_pk_add_f32 v[30:31], v[14:15], v[22:23]
    v_pk_add_f32 v[38:39], v[14:15], v[22:23] neg_lo:[0,1] neg_hi:[0,1]
    s_waitcnt lgkmcnt(0)
    v_pk_add_f32 v[32:33], v[16:17], v[24:25]
    v_pk_add_f32 v[40:41], v[16:17], v[24:25] neg_lo:[0,1] neg_hi:[0,1]
    v_pk_add_f32 v[12:13], v[26:27], v[30:31]
    v_pk_add_f32 v[16:17], v[26:27], v[30:31] neg_lo:[0,1] neg_hi:[0,1]
    v_pk_add_f32 v[20:21], v[28:29], v[32:33]
    v_pk_add_f32 v[24:25], v[28:29], v[32:33] neg_lo:[0,1] neg_hi:[0,1]
    v_pk_add_f32 v[10:11], v[12:13], v[20:21]
    v_pk_add_f32 v[18:19], v[12:13], v[20:21] neg_lo:[0,1] neg_hi:[0,1]
    v_pk_add_f32 v[14:15], v[16:17], v[24:25] op_sel:[0,1] op_sel_hi:[1,0] neg_hi:[0,1]
    v_pk_add_f32 v[22:23], v[16:17], v[24:25] op_sel:[0,1] op_sel_hi:[1,0] neg_lo:[0,1]
    v_pk_add_f32 v[26:27], v[36:37], v[36:37] op_sel:[0,1] op_sel_hi:[1,0] neg_hi:[0,1]
    v_pk_add_f32 v[28:29], v[40:41], v[40:41] op_sel:[0,1] op_sel_hi:[1,0] neg_lo:[1,0] neg_hi:[1,1]
    v_pk_add_f32 v[30:31], v[26:27], v[28:29]
    v_pk_add_f32 v[32:33], v[26:27], v[28:29] neg_lo:[0,1] neg_hi:[0,1]
    v_pk_add_f32 v[36:37], v[34:35], v[38:39] op_sel:[0,1] op_sel_hi:[1,0] neg_hi:[0,1]
    v_pk_add_f32 v[40:41], v[34:35], v[38:39] op_sel:[0,1] op_sel_hi:[1,0] neg_lo:[0,1]
    v_pk_fma_f32 v[12:13], v[30:31], s[20:21], v[36:37]
    v_pk_fma_f32 v[20:21], v[30:31], s[20:21], v[36:37] neg_lo:[1,0,0] neg_hi:[1,0,0]
    v_pk_fma_f32 v[16:17], v[32:33], s[20:21], v[40:41] op_sel:[1,0,0] op_sel_hi:[0,1,1] neg_hi:[1,0,0]
    v_pk_fma_f32 v[24:25], v[32:33], s[20:21], v[40:41] op_sel:[1,0,0] op_sel_hi:[0,1,1] neg_lo:[1,0,0]
    ds_write_b64 v102, v[10:11] offset:18432
    v_pk_mul_f32 v[28:29], v[12:13], v[76:77] op_sel_hi:[1,0]
    v_pk_fma_f32 v[12:13], v[12:13], v[76:77], v[28:29] op_sel:[1,1,0] op_sel_hi:[0,1,1] neg_lo:[1,0,0]
    ds_write_b64 v102, v[12:13] offset:20608
    v_pk_mul_f32 v[30:31], v[14:15], v[78:79] op_sel_hi:[1,0]
    v_pk_fma_f32 v[14:15], v[14:15], v[78:79], v[30:31] op_sel:[1,1,0] op_sel_hi:[0,1,1] neg_lo:[1,0,0]
    ds_write_b64 v102, v[14:15] offset:22784
    v_pk_mul_f32 v[32:33], v[16:17], v[80:81] op_sel_hi:[1,0]
    v_pk_fma_f32 v[16:17], v[16:17], v[80:81], v[32:33] op_sel:[1,1,0] op_sel_hi:[0,1,1] neg_lo:[1,0,0]
    ds_write_b64 v102, v[16:17] offset:24960
    v_pk_mul_f32 v[34:35], v[18:19], v[82:83] op_sel_hi:[1,0]
    v_pk_fma_f32 v[18:19], v[18:19], v[82:83], v[34:35] op_sel:[1,1,0] op_sel_hi:[0,1,1] neg_lo:[1,0,0]
    ds_write_b64 v102, v[18:19] offset:27136
    v_pk_mul_f32 v[36:37], v[20:21], v[84:85] op_sel_hi:[1,0]
    v_pk_fma_f32 v[20:21], v[20:21], v[84:85], v[36:37] op_sel:[1,1,0] op_sel_hi:[0,1,1] neg_lo:[1,0,0]
    ds_write_b64 v102, v[20:21] offset:29312
    v_pk_mul_f32 v[38:39], v[22:23], v[86:87] op_sel_hi:[1,0]
    v_pk_fma_f32 v[22:23], v[22:23], v[86:87], v[38:39] op_sel:[1,1,0] op_sel_hi:[0,1,1] neg_lo:[1,0,0]
    ds_write_b64 v102, v[22:23] offset:31488
    v_pk_mul_f32 v[40:41], v[24:25], v[88:89] op_sel_hi:[1,0]
    v_pk_fma_f32 v[24:25], v[24:25], v[88:89], v[40:41] op_sel:[1,1,0] op_sel_hi:[0,1,1] neg_lo:[1,0,0]
    ds_write_b64 v102, v[24:25] offset:33664
    s_waitcnt lgkmcnt(0)
    s_barrier
    ds_read_b64 v[10:11], v103 offset:18432
    ds_read_b64 v[14:15], v103 offset:18976
    ds_read_b64 v[18:19], v103 offset:19520
    ds_read_b64 v[22:23], v103 offset:20064
    ds_read_b64 v[12:13], v103 offset:27136
    ds_read_b64 v[16:17], v103 offset:27680
    ds_read_b64 v[20:21], v103 offset:28224
    ds_read_b64 v[24:25], v103 offset:28768
    s_waitcnt lgkmcnt(0)
    v_pk_add_f32 v[26:27], v[10:11], v[18:19]
    v_pk_add_f32 v[28:29], v[10:11], v[18:19] neg_lo:[0,1] neg_hi:[0,1]
    v_pk_add_f32 v[30:31], v[14:15], v[22:23]
    v_pk_add_f32 v[32:33], v[14:15], v[22:23] neg_lo:[0,1] neg_hi:[0,1]
    v_pk_add_f32 v[10:11], v[26:27], v[30:31]
    v_pk_add_f32 v[18:19], v[26:27], v[30:31] neg_lo:[0,1] neg_hi:[0,1]
    v_pk_add_f32 v[14:15], v[28:29], v[32:33] op_sel:[0,1] op_sel_hi:[1,0] neg_hi:[0,1]
    v_pk_add_f32 v[22:23], v[28:29], v[32:33] op_sel:[0,1] op_sel_hi:[1,0] neg_lo:[0,1]
    v_pk_add_f32 v[34:35], v[12:13], v[20:21]
    v_pk_add_f32 v[36:37], v[12:13], v[20:21] neg_lo:[0,1] neg_hi:[0,1]
    v_pk_add_f32 v[38:39], v[16:17], v[24:25]
    v_pk_add_f32 v[40:41], v[16:17], v[24:25] neg_lo:[0,1] neg_hi:[0,1]
    v_pk_add_f32 v[12:13], v[34:35], v[38:39]
    v_pk_add_f32 v[20:21], v[34:35], v[38:39] neg_lo:[0,1] neg_hi:[0,1]
    v_pk_add_f32 v[16:17], v[36:37], v[40:41] op_sel:[0,1] op_sel_hi:[1,0] neg_hi:[0,1]
    v_pk_add_f32 v[24:25], v[36:37], v[40:41] op_sel:[0,1] op_sel_hi:[1,0] neg_lo:[0,1]
    s_waitcnt vmcnt(0)
    ds_write_b64 v3, v[10:11] offset:36864
    ds_write_b64 v3, v[12:13] offset:38912
    ds_write_b64 v3, v[14:15] offset:40960
    ds_write_b64 v3, v[16:17] offset:43008
    ds_write_b64 v3, v[18:19] offset:45056
    ds_write_b64 v3, v[20:21] offset:47104
    ds_write_b64 v3, v[22:23] offset:49152
    ds_write_b64 v3, v[24:25] offset:51200
    s_waitcnt lgkmcnt(0)
    s_barrier
    v_sub_u32 v7, 2048, v0
    v_and_b32 v7, 2047, v7
    v_lshlrev_b32 v7, 3, v7
    ds_read_b64 v[136:137], v7 offset:36864
    v_sub_u32 v7, 1792, v0
    v_and_b32 v7, 2047, v7
    v_lshlrev_b32 v7, 3, v7
    ds_read_b64 v[138:139], v7 offset:36864
    v_sub_u32 v7, 1536, v0
    v_and_b32 v7, 2047, v7
    v_lshlrev_b32 v7, 3, v7
    ds_read_b64 v[140:141], v7 offset:36864
    v_sub_u32 v7, 1280, v0
    v_and_b32 v7, 2047, v7
    v_lshlrev_b32 v7, 3, v7
    ds_read_b64 v[142:143], v7 offset:36864
    v_sub_u32 v7, 1024, v0
    v_and_b32 v7, 2047, v7
    v_lshlrev_b32 v7, 3, v7
    ds_read_b64 v[144:145], v7 offset:36864
    v_sub_u32 v7, 768, v0
    v_and_b32 v7, 2047, v7
    v_lshlrev_b32 v7, 3, v7
    ds_read_b64 v[146:147], v7 offset:36864
    v_sub_u32 v7, 512, v0
    v_and_b32 v7, 2047, v7
    v_lshlrev_b32 v7, 3, v7
    ds_read_b64 v[148:149], v7 offset:36864
    v_sub_u32 v7, 256, v0
    v_and_b32 v7, 2047, v7
    v_lshlrev_b32 v7, 3, v7
    ds_read_b64 v[150:151], v7 offset:36864
    s_mov_b32 s22, 0.25
    s_mov_b32 s23, 0.25
    v_lshlrev_b32 v26, 16, v104
    v_and_b32 v27, 0xffff0000, v104
    v_lshlrev_b32 v28, 16, v105
    v_and_b32 v29, 0xffff0000, v105
    v_lshlrev_b32 v30, 16, v106
    v_and_b32 v31, 0xffff0000, v106
    v_lshlrev_b32 v32, 16, v107
    v_and_b32 v33, 0xffff0000, v107
    v_pk_add_f32 v[26:27], v[26:27], v[30:31] neg_hi:[0,1]
    v_pk_add_f32 v[28:29], v[28:29], v[32:33] neg_hi:[0,1]
    v_pk_add_f32 v[30:31], v[26:27], v[28:29]
    v_pk_add_f32 v[32:33], v[26:27], v[28:29] neg_lo:[0,1] neg_hi:[0,1]
    v_pk_mul_f32 v[104:105], v[30:31], s[22:23]
    v_pk_mul_f32 v[106:107], v[32:33], s[22:23]
    v_lshlrev_b32 v26, 16, v108
    v_and_b32 v27, 0xffff0000, v108
    v_lshlrev_b32 v28, 16, v109
    v_and_b32 v29, 0xffff0000, v109
    v_lshlrev_b32 v30, 16, v110
    v_and_b32 v31, 0xffff0000, v110
    v_lshlrev_b32 v32, 16, v111
    v_and_b32 v33, 0xffff0000, v111
    v_pk_add_f32 v[26:27], v[26:27], v[30:31] neg_hi:[0,1]
    v_pk_add_f32 v[28:29], v[28:29], v[32:33] neg_hi:[0,1]
    v_pk_add_f32 v[30:31], v[26:27], v[28:29]
    v_pk_add_f32 v[32:33], v[26:27], v[28:29] neg_lo:[0,1] neg_hi:[0,1]
    v_pk_mul_f32 v[108:109], v[30:31], s[22:23]
    v_pk_mul_f32 v[110:111], v[32:33], s[22:23]
    v_lshlrev_b32 v26, 16, v112
    v_and_b32 v27, 0xffff0000, v112
    v_lshlrev_b32 v28, 16, v113
    v_and_b32 v29, 0xffff0000, v113
    v_lshlrev_b32 v30, 16, v114
    v_and_b32 v31, 0xffff0000, v114
    v_lshlrev_b32 v32, 16, v115
    v_and_b32 v33, 0xffff0000, v115
    v_pk_add_f32 v[26:27], v[26:27], v[30:31] neg_hi:[0,1]
    v_pk_add_f32 v[28:29], v[28:29], v[32:33] neg_hi:[0,1]
    v_pk_add_f32 v[30:31], v[26:27], v[28:29]
    v_pk_add_f32 v[32:33], v[26:27], v[28:29] neg_lo:[0,1] neg_hi:[0,1]
    v_pk_mul_f32 v[112:113], v[30:31], s[22:23]
    v_pk_mul_f32 v[114:115], v[32:33], s[22:23]
    v_lshlrev_b32 v26, 16, v116
    v_and_b32 v27, 0xffff0000, v116
    v_lshlrev_b32 v28, 16, v117
    v_and_b32 v29, 0xffff0000, v117
    v_lshlrev_b32 v30, 16, v118
    v_and_b32 v31, 0xffff0000, v118
    v_lshlrev_b32 v32, 16, v119
    v_and_b32 v33, 0xffff0000, v119
    v_pk_add_f32 v[26:27], v[26:27], v[30:31] neg_hi:[0,1]
    v_pk_add_f32 v[28:29], v[28:29], v[32:33] neg_hi:[0,1]
    v_pk_add_f32 v[30:31], v[26:27], v[28:29]
    v_pk_add_f32 v[32:33], v[26:27], v[28:29] neg_lo:[0,1] neg_hi:[0,1]
    v_pk_mul_f32 v[116:117], v[30:31], s[22:23]
    v_pk_mul_f32 v[118:119], v[32:33], s[22:23]
    v_lshlrev_b32 v26, 16, v120
    v_and_b32 v27, 0xffff0000, v120
    v_lshlrev_b32 v28, 16, v121
    v_and_b32 v29, 0xffff0000, v121
    v_lshlrev_b32 v30, 16, v122
    v_and_b32 v31, 0xffff0000, v122
    v_lshlrev_b32 v32, 16, v123
    v_and_b32 v33, 0xffff0000, v123
    v_pk_add_f32 v[26:27], v[26:27], v[30:31] neg_hi:[0,1]
    v_pk_add_f32 v[28:29], v[28:29], v[32:33] neg_hi:[0,1]
    v_pk_add_f32 v[30:31], v[26:27], v[28:29]
    v_pk_add_f32 v[32:33], v[26:27], v[28:29] neg_lo:[0,1] neg_hi:[0,1]
    v_pk_mul_f32 v[120:121], v[30:31], s[22:23]
    v_pk_mul_f32 v[122:123], v[32:33], s[22:23]
    v_lshlrev_b32 v26, 16, v124
    v_and_b32 v27, 0xffff0000, v124
    v_lshlrev_b32 v28, 16, v125
    v_and_b32 v29, 0xffff0000, v125
    v_lshlrev_b32 v30, 16, v126
    v_and_b32 v31, 0xffff0000, v126
    v_lshlrev_b32 v32, 16, v127
    v_and_b32 v33, 0xffff0000, v127
    v_pk_add_f32 v[26:27], v[26:27], v[30:31] neg_hi:[0,1]
    v_pk_add_f32 v[28:29], v[28:29], v[32:33] neg_hi:[0,1]
    v_pk_add_f32 v[30:31], v[26:27], v[28:29]
    v_pk_add_f32 v[32:33], v[26:27], v[28:29] neg_lo:[0,1] neg_hi:[0,1]
    v_pk_mul_f32 v[124:125], v[30:31], s[22:23]
    v_pk_mul_f32 v[126:127], v[32:33], s[22:23]
    v_lshlrev_b32 v26, 16, v128
    v_and_b32 v27, 0xffff0000, v128
    v_lshlrev_b32 v28, 16, v129
    v_and_b32 v29, 0xffff0000, v129
    v_lshlrev_b32 v30, 16, v130
    v_and_b32 v31, 0xffff0000, v130
    v_lshlrev_b32 v32, 16, v131
    v_and_b32 v33, 0xffff0000, v131
    v_pk_add_f32 v[26:27], v[26:27], v[30:31] neg_hi:[0,1]
    v_pk_add_f32 v[28:29], v[28:29], v[32:33] neg_hi:[0,1]
    v_pk_add_f32 v[30:31], v[26:27], v[28:29]
    v_pk_add_f32 v[32:33], v[26:27], v[28:29] neg_lo:[0,1] neg_hi:[0,1]
    v_pk_mul_f32 v[128:129], v[30:31], s[22:23]
    v_pk_mul_f32 v[130:131], v[32:33], s[22:23]
    v_lshlrev_b32 v26, 16, v132
    v_and_b32 v27, 0xffff0000, v132
    v_lshlrev_b32 v28, 16, v133
    v_and_b32 v29, 0xffff0000, v133
    v_lshlrev_b32 v30, 16, v134
    v_and_b32 v31, 0xffff0000, v134
    v_lshlrev_b32 v32, 16, v135
    v_and_b32 v33, 0xffff0000, v135
    v_pk_add_f32 v[26:27], v[26:27], v[30:31] neg_hi:[0,1]
    v_pk_add_f32 v[28:29], v[28:29], v[32:33] neg_hi:[0,1]
    v_pk_add_f32 v[30:31], v[26:27], v[28:29]
    v_pk_add_f32 v[32:33], v[26:27], v[28:29] neg_lo:[0,1] neg_hi:[0,1]
    v_pk_mul_f32 v[132:133], v[30:31], s[22:23]
    v_pk_mul_f32 v[134:135], v[32:33], s[22:23]
    s_waitcnt lgkmcnt(0)
    v_pk_mul_f32 v[36:37], v[10:11], v[104:105] op_sel_hi:[1,0]
    v_pk_fma_f32 v[34:35], v[10:11], v[104:105], v[36:37] op_sel:[1,1,0] op_sel_hi:[0,1,1] neg_lo:[1,0,0]
    v_xor_b32 v137, 0x80000000, v137
    v_pk_mul_f32 v[40:41], v[136:137], v[106:107] op_sel_hi:[1,0]
    v_pk_fma_f32 v[38:39], v[136:137], v[106:107], v[40:41] op_sel:[1,1,0] op_sel_hi:[0,1,1] neg_lo:[1,0,0]
    v_pk_add_f32 v[10:11], v[34:35], v[38:39]
    v_pk_mul_f32 v[36:37], v[12:13], v[108:109] op_sel_hi:[1,0]
    v_pk_fma_f32 v[34:35], v[12:13], v[108:109], v[36:37] op_sel:[1,1,0] op_sel_hi:[0,1,1] neg_lo:[1,0,0]
    v_xor_b32 v139, 0x80000000, v139
    v_pk_mul_f32 v[40:41], v[138:139], v[110:111] op_sel_hi:[1,0]
    v_pk_fma_f32 v[38:39], v[138:139], v[110:111], v[40:41] op_sel:[1,1,0] op_sel_hi:[0,1,1] neg_lo:[1,0,0]
    v_pk_add_f32 v[12:13], v[34:35], v[38:39]
    v_pk_mul_f32 v[36:37], v[14:15], v[112:113] op_sel_hi:[1,0]
    v_pk_fma_f32 v[34:35], v[14:15], v[112:113], v[36:37] op_sel:[1,1,0] op_sel_hi:[0,1,1] neg_lo:[1,0,0]
    v_xor_b32 v141, 0x80000000, v141
    v_pk_mul_f32 v[40:41], v[140:141], v[114:115] op_sel_hi:[1,0]
    v_pk_fma_f32 v[38:39], v[140:141], v[114:115], v[40:41] op_sel:[1,1,0] op_sel_hi:[0,1,1] neg_lo:[1,0,0]
    v_pk_add_f32 v[14:15], v[34:35], v[38:39]
    v_pk_mul_f32 v[36:37], v[16:17], v[116:117] op_sel_hi:[1,0]
    v_pk_fma_f32 v[34:35], v[16:17], v[116:117], v[36:37] op_sel:[1,1,0] op_sel_hi:[0,1,1] neg_lo:[1,0,0]
    v_xor_b32 v143, 0x80000000, v143
    v_pk_mul_f32 v[40:41], v[142:143], v[118:119] op_sel_hi:[1,0]
    v_pk_fma_f32 v[38:39], v[142:143], v[118:119], v[40:41] op_sel:[1,1,0] op_sel_hi:[0,1,1] neg_lo:[1,0,0]
    v_pk_add_f32 v[16:17], v[34:35], v[38:39]
    v_pk_mul_f32 v[36:37], v[18:19], v[120:121] op_sel_hi:[1,0]
    v_pk_fma_f32 v[34:35], v[18:19], v[120:121], v[36:37] op_sel:[1,1,0] op_sel_hi:[0,1,1] neg_lo:[1,0,0]
    v_xor_b32 v145, 0x80000000, v145
    v_pk_mul_f32 v[40:41], v[144:145], v[122:123] op_sel_hi:[1,0]
    v_pk_fma_f32 v[38:39], v[144:145], v[122:123], v[40:41] op_sel:[1,1,0] op_sel_hi:[0,1,1] neg_lo:[1,0,0]
    v_pk_add_f32 v[18:19], v[34:35], v[38:39]
    v_pk_mul_f32 v[36:37], v[20:21], v[124:125] op_sel_hi:[1,0]
    v_pk_fma_f32 v[34:35], v[20:21], v[124:125], v[36:37] op_sel:[1,1,0] op_sel_hi:[0,1,1] neg_lo:[1,0,0]
    v_xor_b32 v147, 0x80000000, v147
    v_pk_mul_f32 v[40:41], v[146:147], v[126:127] op_sel_hi:[1,0]
    v_pk_fma_f32 v[38:39], v[146:147], v[126:127], v[40:41] op_sel:[1,1,0] op_sel_hi:[0,1,1] neg_lo:[1,0,0]
    v_pk_add_f32 v[20:21], v[34:35], v[38:39]
    v_pk_mul_f32 v[36:37], v[22:23], v[128:129] op_sel_hi:[1,0]
    v_pk_fma_f32 v[34:35], v[22:23], v[128:129], v[36:37] op_sel:[1,1,0] op_sel_hi:[0,1,1] neg_lo:[1,0,0]
    v_xor_b32 v149, 0x80000000, v149
    v_pk_mul_f32 v[40:41], v[148:149], v[130:131] op_sel_hi:[1,0]
    v_pk_fma_f32 v[38:39], v[148:149], v[130:131], v[40:41] op_sel:[1,1,0] op_sel_hi:[0,1,1] neg_lo:[1,0,0]
    v_pk_add_f32 v[22:23], v[34:35], v[38:39]
    v_pk_mul_f32 v[36:37], v[24:25], v[132:133] op_sel_hi:[1,0]
    v_pk_fma_f32 v[34:35], v[24:25], v[132:133], v[36:37] op_sel:[1,1,0] op_sel_hi:[0,1,1] neg_lo:[1,0,0]
    v_xor_b32 v151, 0x80000000, v151
    v_pk_mul_f32 v[40:41], v[150:151], v[134:135] op_sel_hi:[1,0]
    v_pk_fma_f32 v[38:39], v[150:151], v[134:135], v[40:41] op_sel:[1,1,0] op_sel_hi:[0,1,1] neg_lo:[1,0,0]
    v_pk_add_f32 v[24:25], v[34:35], v[38:39]
    v_pk_add_f32 v[26:27], v[10:11], v[18:19]
    v_pk_add_f32 v[34:35], v[10:11], v[18:19] neg_lo:[0,1] neg_hi:[0,1]
    v_pk_add_f32 v[28:29], v[12:13], v[20:21]
    v_pk_add_f32 v[36:37], v[12:13], v[20:21] neg_lo:[0,1] neg_hi:[0,1]
    v_pk_add_f32 v[30:31], v[14:15], v[22:23]
    v_pk_add_f32 v[38:39], v[14:15], v[22:23] neg_lo:[0,1] neg_hi:[0,1]
    v_pk_add_f32 v[32:33], v[16:17], v[24:25]
    v_pk_add_f32 v[40:41], v[16:17], v[24:25] neg_lo:[0,1] neg_hi:[0,1]
    v_pk_add_f32 v[12:13], v[26:27], v[30:31]
    v_pk_add_f32 v[16:17], v[26:27], v[30:31] neg_lo:[0,1] neg_hi:[0,1]
    v_pk_add_f32 v[20:21], v[28:29], v[32:33]
    v_pk_add_f32 v[24:25], v[28:29], v[32:33] neg_lo:[0,1] neg_hi:[0,1]
    v_pk_add_f32 v[10:11], v[12:13], v[20:21]
    v_pk_add_f32 v[18:19], v[12:13], v[20:21] neg_lo:[0,1] neg_hi:[0,1]
    v_pk_add_f32 v[14:15], v[16:17], v[24:25] op_sel:[0,1] op_sel_hi:[1,0] neg_lo:[0,1]
    v_pk_add_f32 v[22:23], v[16:17], v[24:25] op_sel:[0,1] op_sel_hi:[1,0] neg_hi:[0,1]
    v_pk_add_f32 v[26:27], v[36:37], v[36:37] op_sel:[0,1] op_sel_hi:[1,0] neg_lo:[0,1]
    v_pk_add_f32 v[28:29], v[40:41], v[40:41] op_sel:[0,1] op_sel_hi:[1,0] neg_lo:[1,1] neg_hi:[1,0]
    v_pk_add_f32 v[30:31], v[26:27], v[28:29]
    v_pk_add_f32 v[32:33], v[26:27], v[28:29] neg_lo:[0,1] neg_hi:[0,1]
    v_pk_add_f32 v[36:37], v[34:35], v[38:39] op_sel:[0,1] op_sel_hi:[1,0] neg_lo:[0,1]
    v_pk_add_f32 v[40:41], v[34:35], v[38:39] op_sel:[0,1] op_sel_hi:[1,0] neg_hi:[0,1]
    v_pk_fma_f32 v[12:13], v[30:31], s[20:21], v[36:37]
    v_pk_fma_f32 v[20:21], v[30:31], s[20:21], v[36:37] neg_lo:[1,0,0] neg_hi:[1,0,0]
    v_pk_fma_f32 v[16:17], v[32:33], s[20:21], v[40:41] op_sel:[1,0,0] op_sel_hi:[0,1,1] neg_lo:[1,0,0]
    v_pk_fma_f32 v[24:25], v[32:33], s[20:21], v[40:41] op_sel:[1,0,0] op_sel_hi:[0,1,1] neg_hi:[1,0,0]
    ds_write_b64 v98, v[10:11] offset:0
    v_pk_mul_f32 v[28:29], v[12:13], v[44:45] op_sel_hi:[1,0]
    v_pk_fma_f32 v[12:13], v[12:13], v[44:45], v[28:29] op_sel:[1,1,0] op_sel_hi:[0,1,1] neg_hi:[1,0,0]
    ds_write_b64 v98, v[12:13] offset:2048
    v_pk_mul_f32 v[30:31], v[14:15], v[46:47] op_sel_hi:[1,0]
    v_pk_fma_f32 v[14:15], v[14:15], v[46:47], v[30:31] op_sel:[1,1,0] op_sel_hi:[0,1,1] neg_hi:[1,0,0]
    ds_write_b64 v98, v[14:15] offset:4096
    v_pk_mul_f32 v[32:33], v[16:17], v[48:49] op_sel_hi:[1,0]
    v_pk_fma_f32 v[16:17], v[16:17], v[48:49], v[32:33] op_sel:[1,1,0] op_sel_hi:[0,1,1] neg_hi:[1,0,0]
    ds_write_b64 v98, v[16:17] offset:6144
    v_pk_mul_f32 v[34:35], v[18:19], v[50:51] op_sel_hi:[1,0]
    v_pk_fma_f32 v[18:19], v[18:19], v[50:51], v[34:35] op_sel:[1,1,0] op_sel_hi:[0,1,1] neg_hi:[1,0,0]
    ds_write_b64 v98, v[18:19] offset:8192
    v_pk_mul_f32 v[36:37], v[20:21], v[52:53] op_sel_hi:[1,0]
    v_pk_fma_f32 v[20:21], v[20:21], v[52:53], v[36:37] op_sel:[1,1,0] op_sel_hi:[0,1,1] neg_hi:[1,0,0]
    ds_write_b64 v98, v[20:21] offset:10240
    v_pk_mul_f32 v[38:39], v[22:23], v[54:55] op_sel_hi:[1,0]
    v_pk_fma_f32 v[22:23], v[22:23], v[54:55], v[38:39] op_sel:[1,1,0] op_sel_hi:[0,1,1] neg_hi:[1,0,0]
    ds_write_b64 v98, v[22:23] offset:12288
    v_pk_mul_f32 v[40:41], v[24:25], v[56:57] op_sel_hi:[1,0]
    v_pk_fma_f32 v[24:25], v[24:25], v[56:57], v[40:41] op_sel:[1,1,0] op_sel_hi:[0,1,1] neg_hi:[1,0,0]
    ds_write_b64 v98, v[24:25] offset:14336
    s_waitcnt lgkmcnt(0)
    s_barrier
    ds_read_b64 v[10:11], v99 offset:0
    ds_read_b64 v[18:19], v99 offset:1024
    ds_read_b64 v[12:13], v99 offset:256
    ds_read_b64 v[20:21], v99 offset:1280
    ds_read_b64 v[14:15], v99 offset:512
    ds_read_b64 v[22:23], v99 offset:1536
    ds_read_b64 v[16:17], v99 offset:768
    ds_read_b64 v[24:25], v99 offset:1792
    s_waitcnt lgkmcnt(6)
    v_pk_add_f32 v[26:27], v[10:11], v[18:19]
    v_pk_add_f32 v[34:35], v[10:11], v[18:19] neg_lo:[0,1] neg_hi:[0,1]
    s_waitcnt lgkmcnt(4)
    v_pk_add_f32 v[28:29], v[12:13], v[20:21]
    v_pk_add_f32 v[36:37], v[12:13], v[20:21] neg_lo:[0,1] neg_hi:[0,1]
    s_waitcnt lgkmcnt(2)
    v_pk_add_f32 v[30:31], v[14:15], v[22:23]
    v_pk_add_f32 v[38:39], v[14:15], v[22:23] neg_lo:[0,1] neg_hi:[0,1]
    s_waitcnt lgkmcnt(0)
    v_pk_add_f32 v[32:33], v[16:17], v[24:25]
    v_pk_add_f32 v[40:41], v[16:17], v[24:25] neg_lo:[0,1] neg_hi:[0,1]
    v_pk_add_f32 v[12:13], v[26:27], v[30:31]
    v_pk_add_f32 v[16:17], v[26:27], v[30:31] neg_lo:[0,1] neg_hi:[0,1]
    v_pk_add_f32 v[20:21], v[28:29], v[32:33]
    v_pk_add_f32 v[24:25], v[28:29], v[32:33] neg_lo:[0,1] neg_hi:[0,1]
    v_pk_add_f32 v[10:11], v[12:13], v[20:21]
    v_pk_add_f32 v[18:19], v[12:13], v[20:21] neg_lo:[0,1] neg_hi:[0,1]
    v_pk_add_f32 v[14:15], v[16:17], v[24:25] op_sel:[0,1] op_sel_hi:[1,0] neg_lo:[0,1]
    v_pk_add_f32 v[22:23], v[16:17], v[24:25] op_sel:[0,1] op_sel_hi:[1,0] neg_hi:[0,1]
    v_pk_add_f32 v[26:27], v[36:37], v[36:37] op_sel:[0,1] op_sel_hi:[1,0] neg_lo:[0,1]
    v_pk_add_f32 v[28:29], v[40:41], v[40:41] op_sel:[0,1] op_sel_hi:[1,0] neg_lo:[1,1] neg_hi:[1,0]
    v_pk_add_f32 v[30:31], v[26:27], v[28:29]
    v_pk_add_f32 v[32:33], v[26:27], v[28:29] neg_lo:[0,1] neg_hi:[0,1]
    v_pk_add_f32 v[36:37], v[34:35], v[38:39] op_sel:[0,1] op_sel_hi:[1,0] neg_lo:[0,1]
    v_pk_add_f32 v[40:41], v[34:35], v[38:39] op_sel:[0,1] op_sel_hi:[1,0] neg_hi:[0,1]
    v_pk_fma_f32 v[12:13], v[30:31], s[20:21], v[36:37]
    v_pk_fma_f32 v[20:21], v[30:31], s[20:21], v[36:37] neg_lo:[1,0,0] neg_hi:[1,0,0]
    v_pk_fma_f32 v[16:17], v[32:33], s[20:21], v[40:41] op_sel:[1,0,0] op_sel_hi:[0,1,1] neg_lo:[1,0,0]
    v_pk_fma_f32 v[24:25], v[32:33], s[20:21], v[40:41] op_sel:[1,0,0] op_sel_hi:[0,1,1] neg_hi:[1,0,0]
    ds_write_b64 v100, v[10:11] offset:36864
    v_pk_mul_f32 v[28:29], v[12:13], v[60:61] op_sel_hi:[1,0]
    v_pk_fma_f32 v[12:13], v[12:13], v[60:61], v[28:29] op_sel:[1,1,0] op_sel_hi:[0,1,1] neg_hi:[1,0,0]
    ds_write_b64 v100, v[12:13] offset:37152
    v_pk_mul_f32 v[30:31], v[14:15], v[62:63] op_sel_hi:[1,0]
    v_pk_fma_f32 v[14:15], v[14:15], v[62:63], v[30:31] op_sel:[1,1,0] op_sel_hi:[0,1,1] neg_hi:[1,0,0]
    ds_write_b64 v100, v[14:15] offset:37440
    v_pk_mul_f32 v[32:33], v[16:17], v[64:65] op_sel_hi:[1,0]
    v_pk_fma_f32 v[16:17], v[16:17], v[64:65], v[32:33] op_sel:[1,1,0] op_sel_hi:[0,1,1] neg_hi:[1,0,0]
    ds_write_b64 v100, v[16:17] offset:37728
    v_pk_mul_f32 v[34:35], v[18:19], v[66:67] op_sel_hi:[1,0]
    v_pk_fma_f32 v[18:19], v[18:19], v[66:67], v[34:35] op_sel:[1,1,0] op_sel_hi:[0,1,1] neg_hi:[1,0,0]
    ds_write_b64 v100, v[18:19] offset:38016
    v_pk_mul_f32 v[36:37], v[20:21], v[68:69] op_sel_hi:[1,0]
    v_pk_fma_f32 v[20:21], v[20:21], v[68:69], v[36:37] op_sel:[1,1,0] op_sel_hi:[0,1,1] neg_hi:[1,0,0]
    ds_write_b64 v100, v[20:21] offset:38304
    v_pk_mul_f32 v[38:39], v[22:23], v[70:71] op_sel_hi:[1,0]
    v_pk_fma_f32 v[22:23], v[22:23], v[70:71], v[38:39] op_sel:[1,1,0] op_sel_hi:[0,1,1] neg_hi:[1,0,0]
    ds_write_b64 v100, v[22:23] offset:38592
    v_pk_mul_f32 v[40:41], v[24:25], v[72:73] op_sel_hi:[1,0]
    v_pk_fma_f32 v[24:25], v[24:25], v[72:73], v[40:41] op_sel:[1,1,0] op_sel_hi:[0,1,1] neg_hi:[1,0,0]
    ds_write_b64 v100, v[24:25] offset:38880
    ds_read_b64 v[10:11], v101 offset:36864
    ds_read_b64 v[18:19], v101 offset:36992
    ds_read_b64 v[12:13], v101 offset:36896
    ds_read_b64 v[20:21], v101 offset:37024
    ds_read_b64 v[14:15], v101 offset:36928
    ds_read_b64 v[22:23], v101 offset:37056
    ds_read_b64 v[16:17], v101 offset:36960
    ds_read_b64 v[24:25], v101 offset:37088
    s_waitcnt lgkmcnt(6)
    v_pk_add_f32 v[26:27], v[10:11], v[18:19]
    v_pk_add_f32 v[34:35], v[10:11], v[18:19] neg_lo:[0,1] neg_hi:[0,1]
    s_waitcnt lgkmcnt(4)
    v_pk_add_f32 v[28:29], v[12:13], v[20:21]
    v_pk_add_f32 v[36:37], v[12:13], v[20:21] neg_lo:[0,1] neg_hi:[0,1]
    s_waitcnt lgkmcnt(2)
    v_pk_add_f32 v[30:31], v[14:15], v[22:23]
    v_pk_add_f32 v[38:39], v[14:15], v[22:23] neg_lo:[0,1] neg_hi:[0,1]
    s_waitcnt lgkmcnt(0)
    v_pk_add_f32 v[32:33], v[16:17], v[24:25]
    v_pk_add_f32 v[40:41], v[16:17], v[24:25] neg_lo:[0,1] neg_hi:[0,1]
    v_pk_add_f32 v[12:13], v[26:27], v[30:31]
    v_pk_add_f32 v[16:17], v[26:27], v[30:31] neg_lo:[0,1] neg_hi:[0,1]
    v_pk_add_f32 v[20:21], v[28:29], v[32:33]
    v_pk_add_f32 v[24:25], v[28:29], v[32:33] neg_lo:[0,1] neg_hi:[0,1]
    v_pk_add_f32 v[10:11], v[12:13], v[20:21]
    v_pk_add_f32 v[18:19], v[12:13], v[20:21] neg_lo:[0,1] neg_hi:[0,1]
    v_pk_add_f32 v[14:15], v[16:17], v[24:25] op_sel:[0,1] op_sel_hi:[1,0] neg_lo:[0,1]
    v_pk_add_f32 v[22:23], v[16:17], v[24:25] op_sel:[0,1] op_sel_hi:[1,0] neg_hi:[0,1]
    v_pk_add_f32 v[26:27], v[36:37], v[36:37] op_sel:[0,1] op_sel_hi:[1,0] neg_lo:[0,1]
    v_pk_add_f32 v[28:29], v[40:41], v[40:41] op_sel:[0,1] op_sel_hi:[1,0] neg_lo:[1,1] neg_hi:[1,0]
    v_pk_add_f32 v[30:31], v[26:27], v[28:29]
    v_pk_add_f32 v[32:33], v[26:27], v[28:29] neg_lo:[0,1] neg_hi:[0,1]
    v_pk_add_f32 v[36:37], v[34:35], v[38:39] op_sel:[0,1] op_sel_hi:[1,0] neg_lo:[0,1]
    v_pk_add_f32 v[40:41], v[34:35], v[38:39] op_sel:[0,1] op_sel_hi:[1,0] neg_hi:[0,1]
    v_pk_fma_f32 v[12:13], v[30:31], s[20:21], v[36:37]
    v_pk_fma_f32 v[20:21], v[30:31], s[20:21], v[36:37] neg_lo:[1,0,0] neg_hi:[1,0,0]
    v_pk_fma_f32 v[16:17], v[32:33], s[20:21], v[40:41] op_sel:[1,0,0] op_sel_hi:[0,1,1] neg_lo:[1,0,0]
    v_pk_fma_f32 v[24:25], v[32:33], s[20:21], v[40:41] op_sel:[1,0,0] op_sel_hi:[0,1,1] neg_hi:[1,0,0]
    ds_write_b64 v102, v[10:11] offset:18432
    v_pk_mul_f32 v[28:29], v[12:13], v[76:77] op_sel_hi:[1,0]
    v_pk_fma_f32 v[12:13], v[12:13], v[76:77], v[28:29] op_sel:[1,1,0] op_sel_hi:[0,1,1] neg_hi:[1,0,0]
    ds_write_b64 v102, v[12:13] offset:20608
    v_pk_mul_f32 v[30:31], v[14:15], v[78:79] op_sel_hi:[1,0]
    v_pk_fma_f32 v[14:15], v[14:15], v[78:79], v[30:31] op_sel:[1,1,0] op_sel_hi:[0,1,1] neg_hi:[1,0,0]
    ds_write_b64 v102, v[14:15] offset:22784
    v_pk_mul_f32 v[32:33], v[16:17], v[80:81] op_sel_hi:[1,0]
    v_pk_fma_f32 v[16:17], v[16:17], v[80:81], v[32:33] op_sel:[1,1,0] op_sel_hi:[0,1,1] neg_hi:[1,0,0]
    ds_write_b64 v102, v[16:17] offset:24960
    v_pk_mul_f32 v[34:35], v[18:19], v[82:83] op_sel_hi:[1,0]
    v_pk_fma_f32 v[18:19], v[18:19], v[82:83], v[34:35] op_sel:[1,1,0] op_sel_hi:[0,1,1] neg_hi:[1,0,0]
    ds_write_b64 v102, v[18:19] offset:27136
    v_pk_mul_f32 v[36:37], v[20:21], v[84:85] op_sel_hi:[1,0]
    v_pk_fma_f32 v[20:21], v[20:21], v[84:85], v[36:37] op_sel:[1,1,0] op_sel_hi:[0,1,1] neg_hi:[1,0,0]
    ds_write_b64 v102, v[20:21] offset:29312
    v_pk_mul_f32 v[38:39], v[22:23], v[86:87] op_sel_hi:[1,0]
    v_pk_fma_f32 v[22:23], v[22:23], v[86:87], v[38:39] op_sel:[1,1,0] op_sel_hi:[0,1,1] neg_hi:[1,0,0]
    ds_write_b64 v102, v[22:23] offset:31488
    v_pk_mul_f32 v[40:41], v[24:25], v[88:89] op_sel_hi:[1,0]
    v_pk_fma_f32 v[24:25], v[24:25], v[88:89], v[40:41] op_sel:[1,1,0] op_sel_hi:[0,1,1] neg_hi:[1,0,0]
    ds_write_b64 v102, v[24:25] offset:33664
    s_waitcnt lgkmcnt(0)
    s_barrier
    ds_read_b64 v[10:11], v103 offset:18432
    ds_read_b64 v[14:15], v103 offset:18976
    ds_read_b64 v[18:19], v103 offset:19520
    ds_read_b64 v[22:23], v103 offset:20064
    ds_read_b64 v[12:13], v103 offset:27136
    ds_read_b64 v[16:17], v103 offset:27680
    ds_read_b64 v[20:21], v103 offset:28224
    ds_read_b64 v[24:25], v103 offset:28768
    s_waitcnt lgkmcnt(0)
    v_pk_add_f32 v[26:27], v[10:11], v[18:19]
    v_pk_add_f32 v[28:29], v[10:11], v[18:19] neg_lo:[0,1] neg_hi:[0,1]
    v_pk_add_f32 v[30:31], v[14:15], v[22:23]
    v_pk_add_f32 v[32:33], v[14:15], v[22:23] neg_lo:[0,1] neg_hi:[0,1]
    v_pk_add_f32 v[10:11], v[26:27], v[30:31]
    v_pk_add_f32 v[18:19], v[26:27], v[30:31] neg_lo:[0,1] neg_hi:[0,1]
    v_pk_add_f32 v[14:15], v[28:29], v[32:33] op_sel:[0,1] op_sel_hi:[1,0] neg_lo:[0,1]
    v_pk_add_f32 v[22:23], v[28:29], v[32:33] op_sel:[0,1] op_sel_hi:[1,0] neg_hi:[0,1]
    v_pk_add_f32 v[34:35], v[12:13], v[20:21]
    v_pk_add_f32 v[36:37], v[12:13], v[20:21] neg_lo:[0,1] neg_hi:[0,1]
    v_pk_add_f32 v[38:39], v[16:17], v[24:25]
    v_pk_add_f32 v[40:41], v[16:17], v[24:25] neg_lo:[0,1] neg_hi:[0,1]
    v_pk_add_f32 v[12:13], v[34:35], v[38:39]
    v_pk_add_f32 v[20:21], v[34:35], v[38:39] neg_lo:[0,1] neg_hi:[0,1]
    v_pk_add_f32 v[16:17], v[36:37], v[40:41] op_sel:[0,1] op_sel_hi:[1,0] neg_lo:[0,1]
    v_pk_add_f32 v[24:25], v[36:37], v[40:41] op_sel:[0,1] op_sel_hi:[1,0] neg_hi:[0,1]
    v_lshrrev_b32 v4, 3, v0
    v_mul_u32_u24 v4, 16640, v4
    v_and_b32 v5, 7, v0
    v_lshl_add_u32 v4, v5, 3, v4
    s_lshl_b32 s28, s95, 6
    s_add_u32 s29, s28, 0x2000000
    buffer_store_dwordx2 v[10:11], v4, s[12:15], s29 offen sc1
    s_add_u32 s29, s28, 0x2082000
    buffer_store_dwordx2 v[12:13], v4, s[12:15], s29 offen sc1
    s_add_u32 s29, s28, 0x2104000
    buffer_store_dwordx2 v[14:15], v4, s[12:15], s29 offen sc1
    s_add_u32 s29, s28, 0x2186000
    buffer_store_dwordx2 v[16:17], v4, s[12:15], s29 offen sc1
    s_add_u32 s29, s28, 0x2208000
    buffer_store_dwordx2 v[18:19], v4, s[12:15], s29 offen sc1
    s_add_u32 s29, s28, 0x228a000
    buffer_store_dwordx2 v[20:21], v4, s[12:15], s29 offen sc1
    s_add_u32 s29, s28, 0x230c000
    buffer_store_dwordx2 v[22:23], v4, s[12:15], s29 offen sc1
    s_add_u32 s29, s28, 0x238e000
    buffer_store_dwordx2 v[24:25], v4, s[12:15], s29 offen sc1
    s_branch Ljoin_24
Lskip_23:
    v_subrev_u32 v0, 256, v0
    s_mov_b32 s36, s72
    s_and_b32 s37, s73, 0xffff
    s_mov_b32 s38, 0x1c0000
    s_mov_b32 s39, 0x00020000
    s_mov_b32 s40, s76
    s_and_b32 s41, s77, 0xffff
    s_mov_b32 s42, 0x1c0000
    s_mov_b32 s43, 0x00020000
    s_mul_i32 s29, s2, 7168
    v_lshlrev_b32 v3, 4, v0
    buffer_load_dwordx4 v[60:63], v3, s[36:39], s29 offen
    buffer_load_dwordx4 v[64:67], v3, s[40:43], s29 offen
    s_add_u32 s29, s29, 4096
    buffer_load_dwordx4 v[68:71], v3, s[36:39], s29 offen
    buffer_load_dwordx4 v[72:75], v3, s[40:43], s29 offen
    s_add_u32 s29, s29, 4096
    v_add_u32 v0, 256, v0
    s_barrier
    s_barrier
    s_barrier
    s_barrier
    s_barrier
    s_barrier
Ljoin_24:
Lspj_17:
    s_waitcnt vmcnt(0)
    s_barrier
    s_cmp_lg_u32 s3, 0
    s_cbranch_scc1 Lpub_28
    s_lshr_b32 s92, s2, 4
    s_lshl_b32 s92, s92, 8
    s_add_u32 s92, s92, 49152
    v_mov_b32 v158, 1
    v_mov_b32 v159, 0
    s_mov_b64 exec, 1
    buffer_atomic_add v158, v159, s[96:99], s92 offen sc0 sc1
    s_waitcnt vmcnt(0)
    v_readfirstlane_b32 s94, v158
    s_cmp_lg_u32 s94, 15
    s_cbranch_scc1 Lpub_28x
    s_mov_b64 exec, 0xffff
    v_mov_b32 v158, 1
    v_lshlrev_b32 v159, 8, v1
    s_mov_b32 s92, 53248
    buffer_atomic_add v158, v159, s[96:99], s92 offen sc1
Lpub_28x:
    s_mov_b64 exec, -1
Lpub_28:
    s_cmp_ge_u32 s3, 4
    s_cbranch_scc1 Lskip_29
    s_getpc_b64 s[16:17]
Lpc_32:
    s_add_u32 s16, s16, tab_tw2048a-Lpc_32
    s_addc_u32 s17, s17, 0
    s_and_b32 s17, s17, 0xffff
    s_mov_b32 s18, 0x800
    s_mov_b32 s19, 0x00020000
    s_mov_b32 s20, 0x3f3504f3
    s_mov_b32 s21, s20
    s_mov_b32 s22, 0x3b000000
    s_mov_b32 s23, s22
    s_mov_b32 s24, 0x35000000
    s_mov_b32 s25, s24
    s_waitcnt lgkmcnt(0)
    s_mov_b64 s[4:5], s[64:65]
    s_mov_b64 s[6:7], s[84:85]
    s_mov_b32 s8, s4
    s_and_b32 s9, s5, 0xffff
    s_mov_b32 s10, 0x200000
    s_mov_b32 s11, 0x00020000
    s_mov_b32 s12, s6
    s_and_b32 s13, s7, 0xffff
    s_mov_b32 s14, 0x10000000
    s_mov_b32 s15, 0x00020000
    v_lshrrev_b32 v7, 2, v0
    v_and_b32 v8, 3, v0
    s_cmp_lg_u32 s3, 0
    s_cbranch_scc1 Lpd_33
    s_lshr_b32 s92, s2, 4
    s_lshl_b32 s92, s92, 8
    s_add_u32 s92, s92, 53248
    v_mov_b32 v159, 0
    s_mov_b32 s93, 0
Lpl_34:
    v_mov_b32 v158, 0
    s_mov_b64 exec, 1
    buffer_atomic_add v158, v159, s[96:99], s92 offen sc0 sc1
    s_mov_b64 exec, -1
    s_waitcnt vmcnt(0)
    v_readfirstlane_b32 s94, v158
    s_add_u32 s93, s93, 1
    s_cmp_ge_u32 s94, 16
    s_cbranch_scc1 Lpd_33
    s_cmp_gt_u32 s93, 0x40000
    s_cbranch_scc1 Lpd_33
    s_sleep 2
    s_branch Lpl_34
Lpd_33:
    v_lshlrev_b32 v4, 5, v1
    buffer_load_dwordx2 v[52:53], v4, s[16:19], 0 offen
    v_and_b32 v5, 7, v1
    v_lshlrev_b32 v5, 8, v5
    buffer_load_dwordx2 v[68:69], v5, s[16:19], 0 offen
    s_barrier
    v_lshlrev_b32 v3, 4, v0
    s_mul_i32 s28, s2, 16640
    s_add_u32 s29, s28, 0x2000000
    buffer_load_dwordx4 v[104:107], v3, s[12:15], s29 offen
    s_add_u32 s29, s28, 0x2001000
    buffer_load_dwordx4 v[108:111], v3, s[12:15], s29 offen
    s_add_u32 s29, s28, 0x2002000
    buffer_load_dwordx4 v[112:115], v3, s[12:15], s29 offen
    s_add_u32 s29, s28, 0x2003000
    buffer_load_dwordx4 v[116:119], v3, s[12:15], s29 offen
    v_cmp_gt_u32 vcc, 4, v0
    s_and_saveexec_b64 s[34:35], vcc
    s_mov_b64 exec, s[34:35]
    s_lshl_b32 s28, s2, 13
    s_lshl_b32 s29, s3, 11
    s_add_u32 s28, s28, s29
    v_lshlrev_b32 v6, 4, v1
    v_add_u32 v6, s28, v6
    buffer_load_dwordx4 v[42:45], v6, s[8:11], 0 offen
    buffer_load_dwordx4 v[46:49], v6, s[8:11], 0 offen offset:1024
    s_mul_i32 s30, s3, 4768
    v_lshlrev_b32 v96, 3, v1
    v_add_u32 v96, s30, v96
    v_lshrrev_b32 v86, 3, v1
    v_mul_u32_u24 v97, 72, v86
    v_and_b32 v87, 7, v1
    v_add_u32 v97, v97, v87
    v_lshlrev_b32 v97, 3, v97
    v_add_u32 v97, s30, v97
    v_mul_u32_u24 v98, 66, v87
    v_add_u32 v98, v98, v86
    v_lshlrev_b32 v98, 3, v98
    v_add_u32 v98, s30, v98
    v_mul_u32_u24 v8, 4768, v8
    v_lshl_add_u32 v9, v7, 3, v8
    v_sub_u32 v7, 256, v7
    v_lshl_add_u32 v99, v7, 3, v8
    s_waitcnt vmcnt(2)
    v_pk_mul_f32 v[38:39], v[52:53], v[52:53] op_sel_hi:[1,0]
    v_pk_fma_f32 v[54:55], v[52:53], v[52:53], v[38:39] op_sel:[1,1,0] op_sel_hi:[0,1,1] neg_lo:[1,0,0]
    v_pk_mul_f32 v[40:41], v[54:55], v[52:53] op_sel_hi:[1,0]
    v_pk_fma_f32 v[56:57], v[54:55], v[52:53], v[40:41] op_sel:[1,1,0] op_sel_hi:[0,1,1] neg_lo:[1,0,0]
    v_pk_mul_f32 v[38:39], v[54:55], v[54:55] op_sel_hi:[1,0]
    v_pk_fma_f32 v[58:59], v[54:55], v[54:55], v[38:39] op_sel:[1,1,0] op_sel_hi:[0,1,1] neg_lo:[1,0,0]
    v_pk_mul_f32 v[40:41], v[58:59], v[52:53] op_sel_hi:[1,0]
    v_pk_fma_f32 v[60:61], v[58:59], v[52:53], v[40:41] op_sel:[1,1,0] op_sel_hi:[0,1,1] neg_lo:[1,0,0]
    v_pk_mul_f32 v[38:39], v[56:57], v[56:57] op_sel_hi:[1,0]
    v_pk_fma_f32 v[62:63], v[56:57], v[56:57], v[38:39] op_sel:[1,1,0] op_sel_hi:[0,1,1] neg_lo:[1,0,0]
    v_pk_mul_f32 v[40:41], v[58:59], v[56:57] op_sel_hi:[1,0]
    v_pk_fma_f32 v[64:65], v[58:59], v[56:57], v[40:41] op_sel:[1,1,0] op_sel_hi:[0,1,1] neg_lo:[1,0,0]
    v_pk_mul_f32 v[38:39], v[68:69], v[68:69] op_sel_hi:[1,0]
    v_pk_fma_f32 v[70:71], v[68:69], v[68:69], v[38:39] op_sel:[1,1,0] op_sel_hi:[0,1,1] neg_lo:[1,0,0]
    v_pk_mul_f32 v[40:41], v[70:71], v[68:69] op_sel_hi:[1,0]
    v_pk_fma_f32 v[72:73], v[70:71], v[68:69], v[40:41] op_sel:[1,1,0] op_sel_hi:[0,1,1] neg_lo:[1,0,0]
    v_pk_mul_f32 v[38:39], v[70:71], v[70:71] op_sel_hi:[1,0]
    v_pk_fma_f32 v[74:75], v[70:71], v[70:71], v[38:39] op_sel:[1,1,0] op_sel_hi:[0,1,1] neg_lo:[1,0,0]
    v_pk_mul_f32 v[40:41], v[74:75], v[68:69] op_sel_hi:[1,0]
    v_pk_fma_f32 v[76:77], v[74:75], v[68:69], v[40:41] op_sel:[1,1,0] op_sel_hi:[0,1,1] neg_lo:[1,0,0]
    v_pk_mul_f32 v[38:39], v[72:73], v[72:73] op_sel_hi:[1,0]
    v_pk_fma_f32 v[78:79], v[72:73], v[72:73], v[38:39] op_sel:[1,1,0] op_sel_hi:[0,1,1] neg_lo:[1,0,0]
    v_pk_mul_f32 v[40:41], v[74:75], v[72:73] op_sel_hi:[1,0]
    v_pk_fma_f32 v[80:81], v[74:75], v[72:73], v[40:41] op_sel:[1,1,0] op_sel_hi:[0,1,1] neg_lo:[1,0,0]
    s_mov_b64 exec, vcc
    v_mov_b32 v34, v105
    v_mov_b32 v35, v107
    v_mov_b32 v105, 0
    v_mov_b32 v107, 0
    ds_write_b64 v9, v[34:35] offset:2048
    s_mov_b64 exec, s[34:35]
    v_pk_add_f32 v[10:11], v[104:105], v[106:107] op_sel:[0,1] op_sel_hi:[1,0] neg_lo:[0,1]
    v_pk_add_f32 v[26:27], v[104:105], v[106:107] op_sel:[0,1] op_sel_hi:[1,0] neg_hi:[1,0]
    ds_write_b64 v9, v[10:11] offset:0
    ds_write_b64 v99, v[26:27] offset:2048
    v_pk_add_f32 v[12:13], v[108:109], v[110:111] op_sel:[0,1] op_sel_hi:[1,0] neg_lo:[0,1]
    v_pk_add_f32 v[28:29], v[108:109], v[110:111] op_sel:[0,1] op_sel_hi:[1,0] neg_hi:[1,0]
    ds_write_b64 v9, v[12:13] offset:512
    ds_write_b64 v99, v[28:29] offset:1536
    v_pk_add_f32 v[14:15], v[112:113], v[114:115] op_sel:[0,1] op_sel_hi:[1,0] neg_lo:[0,1]
    v_pk_add_f32 v[30:31], v[112:113], v[114:115] op_sel:[0,1] op_sel_hi:[1,0] neg_hi:[1,0]
    ds_write_b64 v9, v[14:15] offset:1024
    ds_write_b64 v99, v[30:31] offset:1024
    v_pk_add_f32 v[16:17], v[116:117], v[118:119] op_sel:[0,1] op_sel_hi:[1,0] neg_lo:[0,1]
    v_pk_add_f32 v[32:33], v[116:117], v[118:119] op_sel:[0,1] op_sel_hi:[1,0] neg_hi:[1,0]
    ds_write_b64 v9, v[16:17] offset:1536
    ds_write_b64 v99, v[32:33] offset:512
    s_waitcnt lgkmcnt(0)
    s_barrier
    ds_read_b64 v[10:11], v96 offset:0
    ds_read_b64 v[12:13], v96 offset:512
    ds_read_b64 v[14:15], v96 offset:1024
    ds_read_b64 v[16:17], v96 offset:1536
    ds_read_b64 v[18:19], v96 offset:2048
    ds_read_b64 v[20:21], v96 offset:2560
    ds_read_b64 v[22:23], v96 offset:3072
    ds_read_b64 v[24:25], v96 offset:3584
    s_waitcnt lgkmcnt(0)
    v_pk_add_f32 v[26:27], v[10:11], v[18:19]
    v_pk_add_f32 v[34:35], v[10:11], v[18:19] neg_lo:[0,1] neg_hi:[0,1]
    v_pk_add_f32 v[28:29], v[12:13], v[20:21]
    v_pk_add_f32 v[36:37], v[12:13], v[20:21] neg_lo:[0,1] neg_hi:[0,1]
    v_pk_add_f32 v[30:31], v[14:15], v[22:23]
    v_pk_add_f32 v[38:39], v[14:15], v[22:23] neg_lo:[0,1] neg_hi:[0,1]
    v_pk_add_f32 v[32:33], v[16:17], v[24:25]
    v_pk_add_f32 v[40:41], v[16:17], v[24:25] neg_lo:[0,1] neg_hi:[0,1]
    v_pk_add_f32 v[12:13], v[26:27], v[30:31]
    v_pk_add_f32 v[16:17], v[26:27], v[30:31] neg_lo:[0,1] neg_hi:[0,1]
    v_pk_add_f32 v[20:21], v[28:29], v[32:33]
    v_pk_add_f32 v[24:25], v[28:29], v[32:33] neg_lo:[0,1] neg_hi:[0,1]
    v_pk_add_f32 v[10:11], v[12:13], v[20:21]
    v_pk_add_f32 v[18:19], v[12:13], v[20:21] neg_lo:[0,1] neg_hi:[0,1]
    v_pk_add_f32 v[14:15], v[16:17], v[24:25] op_sel:[0,1] op_sel_hi:[1,0] neg_lo:[0,1]
    v_pk_add_f32 v[22:23], v[16:17], v[24:25] op_sel:[0,1] op_sel_hi:[1,0] neg_hi:[0,1]
    v_pk_add_f32 v[26:27], v[36:37], v[36:37] op_sel:[0,1] op_sel_hi:[1,0] neg_lo:[0,1]
    v_pk_add_f32 v[28:29], v[40:41], v[40:41] op_sel:[0,1] op_sel_hi:[1,0] neg_lo:[1,1] neg_hi:[1,0]
    v_pk_add_f32 v[30:31], v[26:27], v[28:29]
    v_pk_add_f32 v[32:33], v[26:27], v[28:29] neg_lo:[0,1] neg_hi:[0,1]
    v_pk_add_f32 v[36:37], v[34:35], v[38:39] op_sel:[0,1] op_sel_hi:[1,0] neg_lo:[0,1]
    v_pk_add_f32 v[40:41], v[34:35], v[38:39] op_sel:[0,1] op_sel_hi:[1,0] neg_hi:[0,1]
    v_pk_fma_f32 v[12:13], v[30:31], s[20:21], v[36:37]
    v_pk_fma_f32 v[20:21], v[30:31], s[20:21], v[36:37] neg_lo:[1,0,0] neg_hi:[1,0,0]
    v_pk_fma_f32 v[16:17], v[32:33], s[20:21], v[40:41] op_sel:[1,0,0] op_sel_hi:[0,1,1] neg_lo:[1,0,0]
    v_pk_fma_f32 v[24:25], v[32:33], s[20:21], v[40:41] op_sel:[1,0,0] op_sel_hi:[0,1,1] neg_hi:[1,0,0]
    ds_write_b64 v96, v[10:11] offset:0
    v_pk_mul_f32 v[28:29], v[12:13], v[52:53] op_sel_hi:[1,0]
    v_pk_fma_f32 v[12:13], v[12:13], v[52:53], v[28:29] op_sel:[1,1,0] op_sel_hi:[0,1,1] neg_hi:[1,0,0]
    ds_write_b64 v96, v[12:13] offset:576
    v_pk_mul_f32 v[30:31], v[14:15], v[54:55] op_sel_hi:[1,0]
    v_pk_fma_f32 v[14:15], v[14:15], v[54:55], v[30:31] op_sel:[1,1,0] op_sel_hi:[0,1,1] neg_hi:[1,0,0]
    ds_write_b64 v96, v[14:15] offset:1152
    v_pk_mul_f32 v[32:33], v[16:17], v[56:57] op_sel_hi:[1,0]
    v_pk_fma_f32 v[16:17], v[16:17], v[56:57], v[32:33] op_sel:[1,1,0] op_sel_hi:[0,1,1] neg_hi:[1,0,0]
    ds_write_b64 v96, v[16:17] offset:1728
    v_pk_mul_f32 v[34:35], v[18:19], v[58:59] op_sel_hi:[1,0]
    v_pk_fma_f32 v[18:19], v[18:19], v[58:59], v[34:35] op_sel:[1,1,0] op_sel_hi:[0,1,1] neg_hi:[1,0,0]
    ds_write_b64 v96, v[18:19] offset:2304
    v_pk_mul_f32 v[36:37], v[20:21], v[60:61] op_sel_hi:[1,0]
    v_pk_fma_f32 v[20:21], v[20:21], v[60:61], v[36:37] op_sel:[1,1,0] op_sel_hi:[0,1,1] neg_hi:[1,0,0]
    ds_write_b64 v96, v[20:21] offset:2880
    v_pk_mul_f32 v[38:39], v[22:23], v[62:63] op_sel_hi:[1,0]
    v_pk_fma_f32 v[22:23], v[22:23], v[62:63], v[38:39] op_sel:[1,1,0] op_sel_hi:[0,1,1] neg_hi:[1,0,0]
    ds_write_b64 v96, v[22:23] offset:3456
    v_pk_mul_f32 v[40:41], v[24:25], v[64:65] op_sel_hi:[1,0]
    v_pk_fma_f32 v[24:25], v[24:25], v[64:65], v[40:41] op_sel:[1,1,0] op_sel_hi:[0,1,1] neg_hi:[1,0,0]
    ds_write_b64 v96, v[24:25] offset:4032
    ds_read_b64 v[10:11], v97 offset:0
    ds_read_b64 v[18:19], v97 offset:256
    ds_read_b64 v[12:13], v97 offset:64
    ds_read_b64 v[20:21], v97 offset:320
    ds_read_b64 v[14:15], v97 offset:128
    ds_read_b64 v[22:23], v97 offset:384
    ds_read_b64 v[16:17], v97 offset:192
    ds_read_b64 v[24:25], v97 offset:448
    s_waitcnt lgkmcnt(6)
    v_pk_add_f32 v[26:27], v[10:11], v[18:19]
    v_pk_add_f32 v[34:35], v[10:11], v[18:19] neg_lo:[0,1] neg_hi:[0,1]
    s_waitcnt lgkmcnt(4)
    v_pk_add_f32 v[28:29], v[12:13], v[20:21]
    v_pk_add_f32 v[36:37], v[12:13], v[20:21] neg_lo:[0,1] neg_hi:[0,1]
    s_waitcnt lgkmcnt(2)
    v_pk_add_f32 v[30:31], v[14:15], v[22:23]
    v_pk_add_f32 v[38:39], v[14:15], v[22:23] neg_lo:[0,1] neg_hi:[0,1]
    s_waitcnt lgkmcnt(0)
    v_pk_add_f32 v[32:33], v[16:17], v[24:25]
    v_pk_add_f32 v[40:41], v[16:17], v[24:25] neg_lo:[0,1] neg_hi:[0,1]
    v_pk_add_f32 v[12:13], v[26:27], v[30:31]
    v_pk_add_f32 v[16:17], v[26:27], v[30:31] neg_lo:[0,1] neg_hi:[0,1]
    v_pk_add_f32 v[20:21], v[28:29], v[32:33]
    v_pk_add_f32 v[24:25], v[28:29], v[32:33] neg_lo:[0,1] neg_hi:[0,1]
    v_pk_add_f32 v[10:11], v[12:13], v[20:21]
    v_pk_add_f32 v[18:19], v[12:13], v[20:21] neg_lo:[0,1] neg_hi:[0,1]
    v_pk_add_f32 v[14:15], v[16:17], v[24:25] op_sel:[0,1] op_sel_hi:[1,0] neg_lo:[0,1]
    v_pk_add_f32 v[22:23], v[16:17], v[24:25] op_sel:[0,1] op_sel_hi:[1,0] neg_hi:[0,1]
    v_pk_add_f32 v[26:27], v[36:37], v[36:37] op_sel:[0,1] op_sel_hi:[1,0] neg_lo:[0,1]
    v_pk_add_f32 v[28:29], v[40:41], v[40:41] op_sel:[0,1] op_sel_hi:[1,0] neg_lo:[1,1] neg_hi:[1,0]
    v_pk_add_f32 v[30:31], v[26:27], v[28:29]
    v_pk_add_f32 v[32:33], v[26:27], v[28:29] neg_lo:[0,1] neg_hi:[0,1]
    v_pk_add_f32 v[36:37], v[34:35], v[38:39] op_sel:[0,1] op_sel_hi:[1,0] neg_lo:[0,1]
    v_pk_add_f32 v[40:41], v[34:35], v[38:39] op_sel:[0,1] op_sel_hi:[1,0] neg_hi:[0,1]
    v_pk_fma_f32 v[12:13], v[30:31], s[20:21], v[36:37]
    v_pk_fma_f32 v[20:21], v[30:31], s[20:21], v[36:37] neg_lo:[1,0,0] neg_hi:[1,0,0]
    v_pk_fma_f32 v[16:17], v[32:33], s[20:21], v[40:41] op_sel:[1,0,0] op_sel_hi:[0,1,1] neg_lo:[1,0,0]
    v_pk_fma_f32 v[24:25], v[32:33], s[20:21], v[40:41] op_sel:[1,0,0] op_sel_hi:[0,1,1] neg_hi:[1,0,0]
    ds_write_b64 v98, v[10:11] offset:0
    v_pk_mul_f32 v[28:29], v[12:13], v[68:69] op_sel_hi:[1,0]
    v_pk_fma_f32 v[12:13], v[12:13], v[68:69], v[28:29] op_sel:[1,1,0] op_sel_hi:[0,1,1] neg_hi:[1,0,0]
    ds_write_b64 v98, v[12:13] offset:64
    v_pk_mul_f32 v[30:31], v[14:15], v[70:71] op_sel_hi:[1,0]
    v_pk_fma_f32 v[14:15], v[14:15], v[70:71], v[30:31] op_sel:[1,1,0] op_sel_hi:[0,1,1] neg_hi:[1,0,0]
    ds_write_b64 v98, v[14:15] offset:128
    v_pk_mul_f32 v[32:33], v[16:17], v[72:73] op_sel_hi:[1,0]
    v_pk_fma_f32 v[16:17], v[16:17], v[72:73], v[32:33] op_sel:[1,1,0] op_sel_hi:[0,1,1] neg_hi:[1,0,0]
    ds_write_b64 v98, v[16:17] offset:192
    v_pk_mul_f32 v[34:35], v[18:19], v[74:75] op_sel_hi:[1,0]
    v_pk_fma_f32 v[18:19], v[18:19], v[74:75], v[34:35] op_sel:[1,1,0] op_sel_hi:[0,1,1] neg_hi:[1,0,0]
    ds_write_b64 v98, v[18:19] offset:256
    v_pk_mul_f32 v[36:37], v[20:21], v[76:77] op_sel_hi:[1,0]
    v_pk_fma_f32 v[20:21], v[20:21], v[76:77], v[36:37] op_sel:[1,1,0] op_sel_hi:[0,1,1] neg_hi:[1,0,0]
    ds_write_b64 v98, v[20:21] offset:320
    v_pk_mul_f32 v[38:39], v[22:23], v[78:79] op_sel_hi:[1,0]
    v_pk_fma_f32 v[22:23], v[22:23], v[78:79], v[38:39] op_sel:[1,1,0] op_sel_hi:[0,1,1] neg_hi:[1,0,0]
    ds_write_b64 v98, v[22:23] offset:384
    v_pk_mul_f32 v[40:41], v[24:25], v[80:81] op_sel_hi:[1,0]
    v_pk_fma_f32 v[24:25], v[24:25], v[80:81], v[40:41] op_sel:[1,1,0] op_sel_hi:[0,1,1] neg_hi:[1,0,0]
    ds_write_b64 v98, v[24:25] offset:448
    ds_read_b64 v[10:11], v96 offset:0
    ds_read_b64 v[18:19], v96 offset:2112
    ds_read_b64 v[12:13], v96 offset:528
    ds_read_b64 v[20:21], v96 offset:2640
    ds_read_b64 v[14:15], v96 offset:1056
    ds_read_b64 v[22:23], v96 offset:3168
    ds_read_b64 v[16:17], v96 offset:1584
    ds_read_b64 v[24:25], v96 offset:3696
    s_waitcnt lgkmcnt(6)
    v_pk_add_f32 v[26:27], v[10:11], v[18:19]
    v_pk_add_f32 v[34:35], v[10:11], v[18:19] neg_lo:[0,1] neg_hi:[0,1]
    s_waitcnt lgkmcnt(4)
    v_pk_add_f32 v[28:29], v[12:13], v[20:21]
    v_pk_add_f32 v[36:37], v[12:13], v[20:21] neg_lo:[0,1] neg_hi:[0,1]
    s_waitcnt lgkmcnt(2)
    v_pk_add_f32 v[30:31], v[14:15], v[22:23]
    v_pk_add_f32 v[38:39], v[14:15], v[22:23] neg_lo:[0,1] neg_hi:[0,1]
    s_waitcnt lgkmcnt(0)
    v_pk_add_f32 v[32:33], v[16:17], v[24:25]
    v_pk_add_f32 v[40:41], v[16:17], v[24:25] neg_lo:[0,1] neg_hi:[0,1]
    v_pk_add_f32 v[12:13], v[26:27], v[30:31]
    v_pk_add_f32 v[16:17], v[26:27], v[30:31] neg_lo:[0,1] neg_hi:[0,1]
    v_pk_add_f32 v[20:21], v[28:29], v[32:33]
    v_pk_add_f32 v[24:25], v[28:29], v[32:33] neg_lo:[0,1] neg_hi:[0,1]
    v_pk_add_f32 v[10:11], v[12:13], v[20:21]
    v_pk_add_f32 v[18:19], v[12:13], v[20:21] neg_lo:[0,1] neg_hi:[0,1]
    v_pk_add_f32 v[14:15], v[16:17], v[24:25] op_sel:[0,1] op_sel_hi:[1,0] neg_lo:[0,1]
    v_pk_add_f32 v[22:23], v[16:17], v[24:25] op_sel:[0,1] op_sel_hi:[1,0] neg_hi:[0,1]
    v_pk_add_f32 v[26:27], v[36:37], v[36:37] op_sel:[0,1] op_sel_hi:[1,0] neg_lo:[0,1]
    v_pk_add_f32 v[28:29], v[40:41], v[40:41] op_sel:[0,1] op_sel_hi:[1,0] neg_lo:[1,1] neg_hi:[1,0]
    v_pk_add_f32 v[30:31], v[26:27], v[28:29]
    v_pk_add_f32 v[32:33], v[26:27], v[28:29] neg_lo:[0,1] neg_hi:[0,1]
    v_pk_add_f32 v[36:37], v[34:35], v[38:39] op_sel:[0,1] op_sel_hi:[1,0] neg_lo:[0,1]
    v_pk_add_f32 v[40:41], v[34:35], v[38:39] op_sel:[0,1] op_sel_hi:[1,0] neg_hi:[0,1]
    v_pk_fma_f32 v[12:13], v[30:31], s[20:21], v[36:37]
    v_pk_fma_f32 v[20:21], v[30:31], s[20:21], v[36:37] neg_lo:[1,0,0] neg_hi:[1,0,0]
    v_pk_fma_f32 v[16:17], v[32:33], s[20:21], v[40:41] op_sel:[1,0,0] op_sel_hi:[0,1,1] neg_lo:[1,0,0]
    v_pk_fma_f32 v[24:25], v[32:33], s[20:21], v[40:41] op_sel:[1,0,0] op_sel_hi:[0,1,1] neg_hi:[1,0,0]
    v_bfe_u32 v86, v1, 1, 2
    v_lshrrev_b32 v87, 5, v1
    v_add3_u32 v86, v86, v87, 0
    v_and_b32 v86, 3, v86
    v_lshlrev_b32 v86, 4, v86
    v_lshrrev_b32 v87, 3, v1
    v_lshl_add_u32 v86, v87, 6, v86
    v_and_b32 v87, 1, v1
    v_lshl_add_u32 v86, v87, 3, v86
    v_add_u32 v100, s30, v86
    v_bfe_u32 v86, v1, 1, 2
    v_lshrrev_b32 v87, 5, v1
    v_add3_u32 v86, v86, v87, 2
    v_and_b32 v86, 3, v86
    v_lshlrev_b32 v86, 4, v86
    v_lshrrev_b32 v87, 3, v1
    v_lshl_add_u32 v86, v87, 6, v86
    v_and_b32 v87, 1, v1
    v_lshl_add_u32 v86, v87, 3, v86
    v_add_u32 v101, s30, v86
    ds_write_b64 v100, v[10:11] offset:0
    ds_write_b64 v101, v[12:13] offset:512
    ds_write_b64 v100, v[14:15] offset:1024
    ds_write_b64 v101, v[16:17] offset:1536
    ds_write_b64 v100, v[18:19] offset:2048
    ds_write_b64 v101, v[20:21] offset:2560
    ds_write_b64 v100, v[22:23] offset:3072
    ds_write_b64 v101, v[24:25] offset:3584
    v_lshrrev_b32 v86, 2, v1
    v_lshlrev_b32 v87, 6, v1
    v_add_u32 v87, s30, v87
    v_add_u32 v88, 0, v86
    v_and_b32 v88, 3, v88
    v_lshlrev_b32 v88, 4, v88
    v_add_u32 v26, v87, v88
    v_add_u32 v88, 1, v86
    v_and_b32 v88, 3, v88
    v_lshlrev_b32 v88, 4, v88
    v_add_u32 v28, v87, v88
    v_add_u32 v88, 2, v86
    v_and_b32 v88, 3, v88
    v_lshlrev_b32 v88, 4, v88
    v_add_u32 v30, v87, v88
    v_add_u32 v88, 3, v86
    v_and_b32 v88, 3, v88
    v_lshlrev_b32 v88, 4, v88
    v_add_u32 v32, v87, v88
    ds_read_b128 v[10:13], v26
    ds_read_b128 v[14:17], v28
    ds_read_b128 v[18:21], v30
    ds_read_b128 v[22:25], v32
    s_waitcnt vmcnt(0) lgkmcnt(0)
    v_pk_mul_f32 v[10:11], v[10:11], s[24:25]
    v_pk_mul_f32 v[12:13], v[12:13], s[24:25]
    v_pk_mul_f32 v[14:15], v[14:15], s[24:25]
    v_pk_mul_f32 v[16:17], v[16:17], s[24:25]
    v_pk_mul_f32 v[18:19], v[18:19], s[24:25]
    v_pk_mul_f32 v[20:21], v[20:21], s[24:25]
    v_pk_mul_f32 v[22:23], v[22:23], s[24:25]
    v_pk_mul_f32 v[24:25], v[24:25], s[24:25]
    v_cvt_pk_bf16_f32 v86, v10, v11
    v_cvt_pk_bf16_f32 v87, v12, v13
    v_cvt_pk_bf16_f32 v88, v14, v15
    v_cvt_pk_bf16_f32 v89, v16, v17
    v_cvt_pk_bf16_f32 v90, v18, v19
    v_cvt_pk_bf16_f32 v91, v20, v21
    v_cvt_pk_bf16_f32 v92, v22, v23
    v_cvt_pk_bf16_f32 v93, v24, v25
    v_lshlrev_b32 v10, 16, v86
    v_and_b32 v11, 0xffff0000, v86
    v_lshlrev_b32 v12, 16, v87
    v_and_b32 v13, 0xffff0000, v87
    v_lshlrev_b32 v14, 16, v88
    v_and_b32 v15, 0xffff0000, v88
    v_lshlrev_b32 v16, 16, v89
    v_and_b32 v17, 0xffff0000, v89
    v_lshlrev_b32 v18, 16, v90
    v_and_b32 v19, 0xffff0000, v90
    v_lshlrev_b32 v20, 16, v91
    v_and_b32 v21, 0xffff0000, v91
    v_lshlrev_b32 v22, 16, v92
    v_and_b32 v23, 0xffff0000, v92
    v_lshlrev_b32 v24, 16, v93
    v_and_b32 v25, 0xffff0000, v93
    v_lshlrev_b32 v26, 16, v42
    v_lshlrev_b32 v27, 16, v46
    v_and_b32 v28, 0xffff0000, v42
    v_and_b32 v29, 0xffff0000, v46
    v_lshlrev_b32 v30, 16, v43
    v_lshlrev_b32 v31, 16, v47
    v_and_b32 v32, 0xffff0000, v43
    v_and_b32 v33, 0xffff0000, v47
    v_lshlrev_b32 v34, 16, v44
    v_lshlrev_b32 v35, 16, v48
    v_and_b32 v36, 0xffff0000, v44
    v_and_b32 v37, 0xffff0000, v48
    v_lshlrev_b32 v38, 16, v45
    v_lshlrev_b32 v39, 16, v49
    v_and_b32 v40, 0xffff0000, v45
    v_and_b32 v41, 0xffff0000, v49
    v_pk_add_f32 v[10:11], v[10:11], v[26:27]
    v_pk_add_f32 v[12:13], v[12:13], v[28:29]
    v_pk_add_f32 v[14:15], v[14:15], v[30:31]
    v_pk_add_f32 v[16:17], v[16:17], v[32:33]
    v_pk_add_f32 v[18:19], v[18:19], v[34:35]
    v_pk_add_f32 v[20:21], v[20:21], v[36:37]
    v_pk_add_f32 v[22:23], v[22:23], v[38:39]
    v_pk_add_f32 v[24:25], v[24:25], v[40:41]
    v_cvt_pk_bf16_f32 v42, v10, v12
    v_cvt_pk_bf16_f32 v46, v11, v13
    v_cvt_pk_bf16_f32 v43, v14, v16
    v_cvt_pk_bf16_f32 v47, v15, v17
    v_cvt_pk_bf16_f32 v44, v18, v20
    v_cvt_pk_bf16_f32 v48, v19, v21
    v_cvt_pk_bf16_f32 v45, v22, v24
    v_cvt_pk_bf16_f32 v49, v23, v25
    s_mov_b32 s29, 0x640000
    buffer_store_dwordx4 v[42:45], v6, s[12:15], s29 offen sc1
    buffer_store_dwordx4 v[46:49], v6, s[12:15], s29 offen offset:1024 sc1
    v_lshlrev_b32 v10, 16, v42
    v_lshlrev_b32 v11, 16, v46
    v_and_b32 v12, 0xffff0000, v42
    v_and_b32 v13, 0xffff0000, v46
    v_lshlrev_b32 v14, 16, v43
    v_lshlrev_b32 v15, 16, v47
    v_and_b32 v16, 0xffff0000, v43
    v_and_b32 v17, 0xffff0000, v47
    v_lshlrev_b32 v18, 16, v44
    v_lshlrev_b32 v19, 16, v48
    v_and_b32 v20, 0xffff0000, v44
    v_and_b32 v21, 0xffff0000, v48
    v_lshlrev_b32 v22, 16, v45
    v_lshlrev_b32 v23, 16, v49
    v_and_b32 v24, 0xffff0000, v45
    v_and_b32 v25, 0xffff0000, v49
    v_readfirstlane_b32 s48, v10
    v_readfirstlane_b32 s49, v11
    s_nop 0
    v_pk_add_f32 v[86:87], v[10:11], s[48:49] neg_lo:[0,1] neg_hi:[0,1]
    v_pk_mul_f32 v[84:85], v[86:87], v[86:87]
    v_pk_add_f32 v[88:89], v[12:13], s[48:49] neg_lo:[0,1] neg_hi:[0,1]
    v_pk_fma_f32 v[84:85], v[88:89], v[88:89], v[84:85]
    v_pk_add_f32 v[82:83], v[86:87], v[88:89]
    v_pk_add_f32 v[86:87], v[14:15], s[48:49] neg_lo:[0,1] neg_hi:[0,1]
    v_pk_fma_f32 v[84:85], v[86:87], v[86:87], v[84:85]
    v_pk_add_f32 v[82:83], v[82:83], v[86:87]
    v_pk_add_f32 v[88:89], v[16:17], s[48:49] neg_lo:[0,1] neg_hi:[0,1]
    v_pk_fma_f32 v[84:85], v[88:89], v[88:89], v[84:85]
    v_pk_add_f32 v[82:83], v[82:83], v[88:89]
    v_pk_add_f32 v[86:87], v[18:19], s[48:49] neg_lo:[0,1] neg_hi:[0,1]
    v_pk_fma_f32 v[84:85], v[86:87], v[86:87], v[84:85]
    v_pk_add_f32 v[82:83], v[82:83], v[86:87]
    v_pk_add_f32 v[88:89], v[20:21], s[48:49] neg_lo:[0,1] neg_hi:[0,1]
    v_pk_fma_f32 v[84:85], v[88:89], v[88:89], v[84:85]
    v_pk_add_f32 v[82:83], v[82:83], v[88:89]
    v_pk_add_f32 v[86:87], v[22:23], s[48:49] neg_lo:[0,1] neg_hi:[0,1]
    v_pk_fma_f32 v[84:85], v[86:87], v[86:87], v[84:85]
    v_pk_add_f32 v[82:83], v[82:83], v[86:87]
    v_pk_add_f32 v[88:89], v[24:25], s[48:49] neg_lo:[0,1] neg_hi:[0,1]
    v_pk_fma_f32 v[84:85], v[88:89], v[88:89], v[84:85]
    v_pk_add_f32 v[82:83], v[82:83], v[88:89]
    v_pk_mul_f32 v[82:83], v[82:83], s[22:23]
    v_pk_mul_f32 v[84:85], v[84:85], s[22:23]
    s_nop 1
    v_add_f32_dpp v82, v82, v82 row_shr:1 row_mask:0xf bank_mask:0xf bound_ctrl:0
    v_add_f32_dpp v83, v83, v83 row_shr:1 row_mask:0xf bank_mask:0xf bound_ctrl:0
    v_add_f32_dpp v84, v84, v84 row_shr:1 row_mask:0xf bank_mask:0xf bound_ctrl:0
    v_add_f32_dpp v85, v85, v85 row_shr:1 row_mask:0xf bank_mask:0xf bound_ctrl:0
    v_add_f32_dpp v82, v82, v82 row_shr:2 row_mask:0xf bank_mask:0xf bound_ctrl:0
    v_add_f32_dpp v83, v83, v83 row_shr:2 row_mask:0xf bank_mask:0xf bound_ctrl:0
    v_add_f32_dpp v84, v84, v84 row_shr:2 row_mask:0xf bank_mask:0xf bound_ctrl:0
    v_add_f32_dpp v85, v85, v85 row_shr:2 row_mask:0xf bank_mask:0xf bound_ctrl:0
    v_add_f32_dpp v82, v82, v82 row_shr:4 row_mask:0xf bank_mask:0xf bound_ctrl:0
    v_add_f32_dpp v83, v83, v83 row_shr:4 row_mask:0xf bank_mask:0xf bound_ctrl:0
    v_add_f32_dpp v84, v84, v84 row_shr:4 row_mask:0xf bank_mask:0xf bound_ctrl:0
    v_add_f32_dpp v85, v85, v85 row_shr:4 row_mask:0xf bank_mask:0xf bound_ctrl:0
    v_add_f32_dpp v82, v82, v82 row_shr:8 row_mask:0xf bank_mask:0xf bound_ctrl:0
    v_add_f32_dpp v83, v83, v83 row_shr:8 row_mask:0xf bank_mask:0xf bound_ctrl:0
    v_add_f32_dpp v84, v84, v84 row_shr:8 row_mask:0xf bank_mask:0xf bound_ctrl:0
    v_add_f32_dpp v85, v85, v85 row_shr:8 row_mask:0xf bank_mask:0xf bound_ctrl:0
    v_add_f32_dpp v82, v82, v82 row_bcast:15 row_mask:0xa bank_mask:0xf
    v_add_f32_dpp v83, v83, v83 row_bcast:15 row_mask:0xa bank_mask:0xf
    v_add_f32_dpp v84, v84, v84 row_bcast:15 row_mask:0xa bank_mask:0xf
    v_add_f32_dpp v85, v85, v85 row_bcast:15 row_mask:0xa bank_mask:0xf
    v_add_f32_dpp v82, v82, v82 row_bcast:31 row_mask:0xc bank_mask:0xf
    v_add_f32_dpp v83, v83, v83 row_bcast:31 row_mask:0xc bank_mask:0xf
    v_add_f32_dpp v84, v84, v84 row_bcast:31 row_mask:0xc bank_mask:0xf
    v_add_f32_dpp v85, v85, v85 row_bcast:31 row_mask:0xc bank_mask:0xf
    s_nop 0
    v_readlane_b32 s44, v82, 63
    v_readlane_b32 s45, v83, 63
    v_readlane_b32 s46, v84, 63
    v_readlane_b32 s47, v85, 63
    s_nop 1
    v_mov_b32 v82, s44
    v_mov_b32 v83, s45
    v_mov_b32 v84, s46
    v_mov_b32 v85, s47
    v_pk_fma_f32 v[84:85], v[82:83], v[82:83], v[84:85] neg_lo:[1,0,0] neg_hi:[1,0,0]
    v_max_f32 v84, 0, v84
    v_max_f32 v85, 0, v85
    v_pk_add_f32 v[82:83], v[82:83], s[48:49]
    v_cvt_pk_bf16_f32 v90, v82, v83
    v_lshlrev_b32 v82, 16, v90
    v_and_b32 v83, 0xffff0000, v90
    v_cvt_pk_bf16_f32 v91, v84, v85
    v_lshlrev_b32 v84, 16, v91
    v_and_b32 v85, 0xffff0000, v91
    v_add_f32 v84, 0x3727c5ac, v84
    v_add_f32 v85, 0x3727c5ac, v85
    v_cvt_pk_bf16_f32 v91, v84, v85
    v_lshlrev_b32 v84, 16, v91
    v_and_b32 v85, 0xffff0000, v91
    v_sqrt_f32 v84, v84
    v_sqrt_f32 v85, v85
    v_pk_add_f32 v[10:11], v[10:11], v[82:83] neg_lo:[0,1] neg_hi:[0,1]
    v_pk_add_f32 v[12:13], v[12:13], v[82:83] neg_lo:[0,1] neg_hi:[0,1]
    v_pk_add_f32 v[14:15], v[14:15], v[82:83] neg_lo:[0,1] neg_hi:[0,1]
    v_pk_add_f32 v[16:17], v[16:17], v[82:83] neg_lo:[0,1] neg_hi:[0,1]
    v_pk_add_f32 v[18:19], v[18:19], v[82:83] neg_lo:[0,1] neg_hi:[0,1]
    v_pk_add_f32 v[20:21], v[20:21], v[82:83] neg_lo:[0,1] neg_hi:[0,1]
    v_pk_add_f32 v[22:23], v[22:23], v[82:83] neg_lo:[0,1] neg_hi:[0,1]
    v_pk_add_f32 v[24:25], v[24:25], v[82:83] neg_lo:[0,1] neg_hi:[0,1]
    v_cvt_pk_bf16_f32 v94, v84, v85
    v_lshlrev_b32 v84, 16, v94
    v_and_b32 v85, 0xffff0000, v94
    v_rcp_f32 v84, v84
    v_rcp_f32 v85, v85
    v_cvt_pk_bf16_f32 v86, v10, v11
    v_cvt_pk_bf16_f32 v87, v12, v13
    v_cvt_pk_bf16_f32 v88, v14, v15
    v_cvt_pk_bf16_f32 v89, v16, v17
    v_cvt_pk_bf16_f32 v90, v18, v19
    v_cvt_pk_bf16_f32 v91, v20, v21
    v_cvt_pk_bf16_f32 v92, v22, v23
    v_cvt_pk_bf16_f32 v93, v24, v25
    v_lshlrev_b32 v10, 16, v86
    v_and_b32 v11, 0xffff0000, v86
    v_lshlrev_b32 v12, 16, v87
    v_and_b32 v13, 0xffff0000, v87
    v_lshlrev_b32 v14, 16, v88
    v_and_b32 v15, 0xffff0000, v88
    v_lshlrev_b32 v16, 16, v89
    v_and_b32 v17, 0xffff0000, v89
    v_lshlrev_b32 v18, 16, v90
    v_and_b32 v19, 0xffff0000, v90
    v_lshlrev_b32 v20, 16, v91
    v_and_b32 v21, 0xffff0000, v91
    v_lshlrev_b32 v22, 16, v92
    v_and_b32 v23, 0xffff0000, v92
    v_lshlrev_b32 v24, 16, v93
    v_and_b32 v25, 0xffff0000, v93
    v_pk_mul_f32 v[10:11], v[10:11], v[84:85]
    v_pk_mul_f32 v[12:13], v[12:13], v[84:85]
    v_pk_mul_f32 v[14:15], v[14:15], v[84:85]
    v_pk_mul_f32 v[16:17], v[16:17], v[84:85]
    v_pk_mul_f32 v[18:19], v[18:19], v[84:85]
    v_pk_mul_f32 v[20:21], v[20:21], v[84:85]
    v_pk_mul_f32 v[22:23], v[22:23], v[84:85]
    v_pk_mul_f32 v[24:25], v[24:25], v[84:85]
    v_cvt_pk_bf16_f32 v86, v10, v11
    v_cvt_pk_bf16_f32 v87, v12, v13
    v_cvt_pk_bf16_f32 v88, v14, v15
    v_cvt_pk_bf16_f32 v89, v16, v17
    v_cvt_pk_bf16_f32 v90, v18, v19
    v_cvt_pk_bf16_f32 v91, v20, v21
    v_cvt_pk_bf16_f32 v92, v22, v23
    v_cvt_pk_bf16_f32 v93, v24, v25
    v_lshlrev_b32 v10, 16, v86
    v_and_b32 v11, 0xffff0000, v86
    v_lshlrev_b32 v12, 16, v87
    v_and_b32 v13, 0xffff0000, v87
    v_lshlrev_b32 v14, 16, v88
    v_and_b32 v15, 0xffff0000, v88
    v_lshlrev_b32 v16, 16, v89
    v_and_b32 v17, 0xffff0000, v89
    v_lshlrev_b32 v18, 16, v90
    v_and_b32 v19, 0xffff0000, v90
    v_lshlrev_b32 v20, 16, v91
    v_and_b32 v21, 0xffff0000, v91
    v_lshlrev_b32 v22, 16, v92
    v_and_b32 v23, 0xffff0000, v92
    v_lshlrev_b32 v24, 16, v93
    v_and_b32 v25, 0xffff0000, v93
    v_cvt_pk_bf16_f32 v26, v10, v12
    v_cvt_pk_bf16_f32 v30, v11, v13
    v_cvt_pk_bf16_f32 v27, v14, v16
    v_cvt_pk_bf16_f32 v31, v15, v17
    v_cvt_pk_bf16_f32 v28, v18, v20
    v_cvt_pk_bf16_f32 v32, v19, v21
    v_cvt_pk_bf16_f32 v29, v22, v24
    v_cvt_pk_bf16_f32 v33, v23, v25
    s_mov_b32 s29, 0x840000
    buffer_store_dwordx4 v[26:29], v6, s[12:15], s29 offen sc1
    buffer_store_dwordx4 v[30:33], v6, s[12:15], s29 offen offset:1024 sc1
    s_branch Ljoin_30
Lskip_29:
    s_barrier
    s_barrier
Ljoin_30:
    s_waitcnt vmcnt(0)
    s_barrier
    s_cmp_lg_u32 s3, 0
    s_cbranch_scc1 Lpub_35
    s_lshr_b32 s92, s2, 4
    s_lshl_b32 s92, s92, 8
    s_add_u32 s92, s92, 0
    v_mov_b32 v158, 1
    v_mov_b32 v159, 0
    s_mov_b64 exec, 1
    buffer_atomic_add v158, v159, s[96:99], s92 offen sc1
    s_mov_b64 exec, -1
Lpub_35:
    s_cmp_ge_u32 s2, 224
    s_cbranch_scc1 Lg1skip_36
    s_mov_b64 s[4:5], s[72:73]
    s_mov_b64 s[6:7], s[74:75]
    s_mov_b64 s[8:9], s[84:85]
    s_and_b32 s10, s2, 7
    s_lshr_b32 s11, s2, 3
    s_and_b32 s28, s11, 3
    s_lshr_b32 s11, s11, 2
    s_and_b32 s29, s10, 1
    s_mul_i32 s29, s29, 7
    s_add_u32 s11, s11, s29
    s_lshr_b32 s10, s10, 1
    s_lshl_b32 s10, s10, 2
    s_add_u32 s10, s10, s28
    v_lshrrev_b32 v6, 3, v1
    v_lshlrev_b32 v6, 10, v6
    v_and_b32 v7, 7, v1
    v_lshrrev_b32 v8, 4, v1
    v_xor_b32 v7, v7, v8
    v_lshl_add_u32 v3, v7, 4, v6
    v_xor_b32 v7, 4, v7
    v_lshl_add_u32 v4, v7, 4, v6
    s_lshl_b32 s28, s10, 17
    s_lshl_b32 s29, s3, 14
    s_add_u32 s28, s28, s29
    v_and_b32 v7, 15, v1
    v_lshlrev_b32 v9, 2, v8
    v_xor_b32 v7, v7, v9
    s_movk_i32 s30, 3584
    v_mul_lo_u32 v8, v8, s30
    v_lshl_add_u32 v5, v7, 4, v8
    s_lshl_b32 s31, s11, 8
    s_mul_i32 s29, s3, 28672
    s_add_u32 s31, s31, s29
    s_lshl_b32 s32, s3, 11
    s_waitcnt lgkmcnt(0)
    s_mov_b32 s12, s4
    s_and_b32 s13, s5, 0xffff
    s_mov_b32 s14, 0x1c0000
    s_mov_b32 s15, 0x00020000
    s_add_u32 s20, s8, 0x840000
    s_addc_u32 s21, s9, 0
    s_and_b32 s21, s21, 0xffff
    s_mov_b32 s22, 0x200000
    s_mov_b32 s23, 0x00020000
    s_cmp_lg_u32 s3, 0
    s_cbranch_scc1 Lpd_38
    s_lshl_b32 s92, s10, 8
    s_add_u32 s92, s92, 0
    v_mov_b32 v159, 0
    s_mov_b32 s93, 0
Lpl_39:
    v_mov_b32 v158, 0
    s_mov_b64 exec, 1
    buffer_atomic_add v158, v159, s[96:99], s92 offen sc0 sc1
    s_mov_b64 exec, -1
    s_waitcnt vmcnt(0)
    v_readfirstlane_b32 s94, v158
    s_add_u32 s93, s93, 1
    s_cmp_ge_u32 s94, 16
    s_cbranch_scc1 Lpd_38
    s_cmp_gt_u32 s93, 0x40000
    s_cbranch_scc1 Lpd_38
    s_sleep 2
    s_branch Lpl_39
Lpd_38:
    s_add_u32 m0, s32, 16384
    s_add_u32 s33, s31, 0
    buffer_load_dwordx4 v5, s[12:15], s33 offen lds
    s_add_u32 m0, s32, 17408
    s_add_u32 s33, s31, 14336
    buffer_load_dwordx4 v5, s[12:15], s33 offen lds
    s_add_u32 m0, s32, 49152
    s_add_u32 s33, s31, 229376
    buffer_load_dwordx4 v5, s[12:15], s33 offen lds
    s_add_u32 m0, s32, 50176
    s_add_u32 s33, s31, 243712
    buffer_load_dwordx4 v5, s[12:15], s33 offen lds
    s_add_u32 m0, s32, 81920
    s_add_u32 s33, s31, 458752
    buffer_load_dwordx4 v5, s[12:15], s33 offen lds
    s_add_u32 m0, s32, 82944
    s_add_u32 s33, s31, 473088
    buffer_load_dwordx4 v5, s[12:15], s33 offen lds
    s_add_u32 m0, s32, 114688
    s_add_u32 s33, s31, 688128
    buffer_load_dwordx4 v5, s[12:15], s33 offen lds
    s_add_u32 m0, s32, 115712
    s_add_u32 s33, s31, 702464
    buffer_load_dwordx4 v5, s[12:15], s33 offen lds
    s_mov_b32 s16, s6
    s_and_b32 s17, s7, 0xffff
    s_mov_b32 s18, 0xe00
    s_mov_b32 s19, 0x00020000
    s_add_u32 s24, s8, 0xa40000
    s_addc_u32 s25, s9, 0
    s_and_b32 s25, s25, 0xffff
    s_mov_b32 s26, 0x700000
    s_mov_b32 s27, 0x00020000
    s_lshr_b32 s34, s3, 1
    s_and_b32 s35, s3, 1
    v_and_b32 v6, 31, v1
    v_lshlrev_b32 v6, 7, v6
    s_lshl_b32 s37, s35, 13
    v_add_u32 v6, s37, v6
    v_lshrrev_b32 v7, 5, v1
    v_bfe_u32 v8, v1, 1, 3
    v_xor_b32 v7, v7, v8
    v_lshl_add_u32 v6, v7, 4, v6
    v_xor_b32 v26, 0, v6
    v_add_u32 v30, 0x10000, v26
    v_xor_b32 v27, 32, v6
    v_add_u32 v31, 0x10000, v27
    v_xor_b32 v28, 64, v6
    v_add_u32 v32, 0x10000, v28
    v_xor_b32 v29, 96, v6
    v_add_u32 v33, 0x10000, v29
    v_lshrrev_b32 v6, 5, v1
    v_lshlrev_b32 v6, 3, v6
    v_bfe_u32 v7, v1, 2, 2
    v_add_u32 v6, v6, v7
    v_lshlrev_b32 v6, 8, v6
    v_bfe_u32 v8, v1, 4, 1
    v_lshlrev_b32 v8, 1, v8
    v_bfe_u32 v9, v1, 1, 1
    v_add_u32 v8, v8, v9
    s_lshl_b32 s37, s34, 2
    v_add_u32 v8, s37, v8
    v_lshlrev_b32 v7, 2, v7
    v_xor_b32 v8, v8, v7
    v_lshl_add_u32 v6, v8, 4, v6
    v_and_b32 v9, 1, v1
    v_lshl_add_u32 v6, v9, 3, v6
    v_add_u32 v34, 16384, v6
    v_add_u32 v35, 0x10000, v34
    v_add_u32 v36, 0x1c000, v34
    v_mov_b32 v64, 0
    v_mov_b32 v65, 0
    v_mov_b32 v66, 0
    v_mov_b32 v67, 0
    v_mov_b32 v68, 0
    v_mov_b32 v69, 0
    v_mov_b32 v70, 0
    v_mov_b32 v71, 0
    v_mov_b32 v72, 0
    v_mov_b32 v73, 0
    v_mov_b32 v74, 0
    v_mov_b32 v75, 0
    v_mov_b32 v76, 0
    v_mov_b32 v77, 0
    v_mov_b32 v78, 0
    v_mov_b32 v79, 0
    v_mov_b32 v80, 0
    v_mov_b32 v81, 0
    v_mov_b32 v82, 0
    v_mov_b32 v83, 0
    v_mov_b32 v84, 0
    v_mov_b32 v85, 0
    v_mov_b32 v86, 0
    v_mov_b32 v87, 0
    v_mov_b32 v88, 0
    v_mov_b32 v89, 0
    v_mov_b32 v90, 0
    v_mov_b32 v91, 0
    v_mov_b32 v92, 0
    v_mov_b32 v93, 0
    v_mov_b32 v94, 0
    v_mov_b32 v95, 0
    s_barrier
    s_add_u32 m0, s32, 0
    s_add_u32 s33, s28, 0
    buffer_load_dwordx4 v3, s[20:23], s33 offen lds
    s_add_u32 m0, s32, 1024
    s_add_u32 s33, s28, 8192
    buffer_load_dwordx4 v4, s[20:23], s33 offen lds
    s_add_u32 m0, s32, 32768
    s_add_u32 s33, s28, 128
    buffer_load_dwordx4 v3, s[20:23], s33 offen lds
    s_add_u32 m0, s32, 33792
    s_add_u32 s33, s28, 8320
    buffer_load_dwordx4 v4, s[20:23], s33 offen lds
    s_add_u32 m0, s32, 65536
    s_add_u32 s33, s28, 256
    buffer_load_dwordx4 v3, s[20:23], s33 offen lds
    s_add_u32 m0, s32, 66560
    s_add_u32 s33, s28, 8448
    buffer_load_dwordx4 v4, s[20:23], s33 offen lds
    s_add_u32 m0, s32, 98304
    s_add_u32 s33, s28, 384
    buffer_load_dwordx4 v3, s[20:23], s33 offen lds
    s_add_u32 m0, s32, 99328
    s_add_u32 s33, s28, 8576
    buffer_load_dwordx4 v4, s[20:23], s33 offen lds
    v_lshrrev_b32 v6, 5, v1
    v_lshlrev_b32 v6, 3, v6
    s_lshl_b32 s36, s11, 8
    s_lshl_b32 s37, s34, 6
    s_add_u32 s36, s36, s37
    buffer_load_dwordx2 v[10:11], v6, s[16:19], s36 offen offset:0
    buffer_load_dwordx2 v[12:13], v6, s[16:19], s36 offen offset:16
    buffer_load_dwordx2 v[14:15], v6, s[16:19], s36 offen offset:32
    buffer_load_dwordx2 v[16:17], v6, s[16:19], s36 offen offset:48
    s_waitcnt vmcnt(10)
    s_barrier
    ds_read_b64_tr_b16 v[96:97], v34 offset:0
    ds_read_b64_tr_b16 v[98:99], v34 offset:1024
    ds_read_b128 v[100:103], v26 offset:0
    ds_read_b128 v[104:107], v26 offset:4096
    s_waitcnt lgkmcnt(1)
    v_mfma_f32_32x32x16_bf16 v[64:79], v[96:99], v[100:103], v[64:79]
    ds_read_b64_tr_b16 v[108:109], v34 offset:4096
    ds_read_b64_tr_b16 v[110:111], v34 offset:5120
    s_waitcnt lgkmcnt(2)
    v_mfma_f32_32x32x16_bf16 v[80:95], v[96:99], v[104:107], v[80:95]
    ds_read_b128 v[112:115], v27 offset:0
    ds_read_b128 v[116:119], v27 offset:4096
    s_waitcnt lgkmcnt(1)
    v_mfma_f32_32x32x16_bf16 v[64:79], v[108:111], v[112:115], v[64:79]
    ds_read_b64_tr_b16 v[96:97], v34 offset:8192
    ds_read_b64_tr_b16 v[98:99], v34 offset:9216
    s_waitcnt lgkmcnt(2)
    v_mfma_f32_32x32x16_bf16 v[80:95], v[108:111], v[116:119], v[80:95]
    ds_read_b128 v[100:103], v28 offset:0
    ds_read_b128 v[104:107], v28 offset:4096
    s_waitcnt lgkmcnt(1)
    v_mfma_f32_32x32x16_bf16 v[64:79], v[96:99], v[100:103], v[64:79]
    ds_read_b64_tr_b16 v[108:109], v34 offset:12288
    ds_read_b64_tr_b16 v[110:111], v34 offset:13312
    s_waitcnt lgkmcnt(2)
    v_mfma_f32_32x32x16_bf16 v[80:95], v[96:99], v[104:107], v[80:95]
    ds_read_b128 v[112:115], v29 offset:0
    ds_read_b128 v[116:119], v29 offset:4096
    s_waitcnt lgkmcnt(1)
    v_mfma_f32_32x32x16_bf16 v[64:79], v[108:111], v[112:115], v[64:79]
    s_waitcnt vmcnt(8) lgkmcnt(0)
    s_barrier
    ds_read_b64_tr_b16 v[96:97], v34 offset:32768
    ds_read_b64_tr_b16 v[98:99], v34 offset:33792
    ds_read_b128 v[100:103], v26 offset:32768
    ds_read_b128 v[104:107], v26 offset:36864
    v_mfma_f32_32x32x16_bf16 v[80:95], v[108:111], v[116:119], v[80:95]
    s_add_u32 m0, s32, 0
    s_add_u32 s33, s28, 512
    buffer_load_dwordx4 v3, s[20:23], s33 offen lds
    s_add_u32 m0, s32, 1024
    s_add_u32 s33, s28, 8704
    buffer_load_dwordx4 v4, s[20:23], s33 offen lds
    s_add_u32 m0, s32, 16384
    s_add_u32 s33, s31, 917504
    buffer_load_dwordx4 v5, s[12:15], s33 offen lds
    s_add_u32 m0, s32, 17408
    s_add_u32 s33, s31, 931840
    buffer_load_dwordx4 v5, s[12:15], s33 offen lds
    s_waitcnt lgkmcnt(1)
    v_mfma_f32_32x32x16_bf16 v[64:79], v[96:99], v[100:103], v[64:79]
    ds_read_b64_tr_b16 v[108:109], v34 offset:36864
    ds_read_b64_tr_b16 v[110:111], v34 offset:37888
    s_waitcnt lgkmcnt(2)
    v_mfma_f32_32x32x16_bf16 v[80:95], v[96:99], v[104:107], v[80:95]
    ds_read_b128 v[112:115], v27 offset:32768
    ds_read_b128 v[116:119], v27 offset:36864
    s_waitcnt lgkmcnt(1)
    v_mfma_f32_32x32x16_bf16 v[64:79], v[108:111], v[112:115], v[64:79]
    ds_read_b64_tr_b16 v[96:97], v34 offset:40960
    ds_read_b64_tr_b16 v[98:99], v34 offset:41984
    s_waitcnt lgkmcnt(2)
    v_mfma_f32_32x32x16_bf16 v[80:95], v[108:111], v[116:119], v[80:95]
    ds_read_b128 v[100:103], v28 offset:32768
    ds_read_b128 v[104:107], v28 offset:36864
    s_waitcnt lgkmcnt(1)
    v_mfma_f32_32x32x16_bf16 v[64:79], v[96:99], v[100:103], v[64:79]
    ds_read_b64_tr_b16 v[108:109], v34 offset:45056
    ds_read_b64_tr_b16 v[110:111], v34 offset:46080
    s_waitcnt lgkmcnt(2)
    v_mfma_f32_32x32x16_bf16 v[80:95], v[96:99], v[104:107], v[80:95]
    ds_read_b128 v[112:115], v29 offset:32768
    ds_read_b128 v[116:119], v29 offset:36864
    s_waitcnt lgkmcnt(1)
    v_mfma_f32_32x32x16_bf16 v[64:79], v[108:111], v[112:115], v[64:79]
    s_waitcnt vmcnt(10) lgkmcnt(0)
    s_barrier
    ds_read_b64_tr_b16 v[96:97], v35 offset:0
    ds_read_b64_tr_b16 v[98:99], v35 offset:1024
    ds_read_b128 v[100:103], v30 offset:0
    ds_read_b128 v[104:107], v30 offset:4096
    v_mfma_f32_32x32x16_bf16 v[80:95], v[108:111], v[116:119], v[80:95]
    s_add_u32 m0, s32, 32768
    s_add_u32 s33, s28, 640
    buffer_load_dwordx4 v3, s[20:23], s33 offen lds
    s_add_u32 m0, s32, 33792
    s_add_u32 s33, s28, 8832
    buffer_load_dwordx4 v4, s[20:23], s33 offen lds
    s_add_u32 m0, s32, 49152
    s_add_u32 s33, s31, 1146880
    buffer_load_dwordx4 v5, s[12:15], s33 offen lds
    s_add_u32 m0, s32, 50176
    s_add_u32 s33, s31, 1161216
    buffer_load_dwordx4 v5, s[12:15], s33 offen lds
    s_waitcnt lgkmcnt(1)
    v_mfma_f32_32x32x16_bf16 v[64:79], v[96:99], v[100:103], v[64:79]
    ds_read_b64_tr_b16 v[108:109], v35 offset:4096
    ds_read_b64_tr_b16 v[110:111], v35 offset:5120
    s_waitcnt lgkmcnt(2)
    v_mfma_f32_32x32x16_bf16 v[80:95], v[96:99], v[104:107], v[80:95]
    ds_read_b128 v[112:115], v31 offset:0
    ds_read_b128 v[116:119], v31 offset:4096
    s_waitcnt lgkmcnt(1)
    v_mfma_f32_32x32x16_bf16 v[64:79], v[108:111], v[112:115], v[64:79]
    ds_read_b64_tr_b16 v[96:97], v35 offset:8192
    ds_read_b64_tr_b16 v[98:99], v35 offset:9216
    s_waitcnt lgkmcnt(2)
    v_mfma_f32_32x32x16_bf16 v[80:95], v[108:111], v[116:119], v[80:95]
    ds_read_b128 v[100:103], v32 offset:0
    ds_read_b128 v[104:107], v32 offset:4096
    s_waitcnt lgkmcnt(1)
    v_mfma_f32_32x32x16_bf16 v[64:79], v[96:99], v[100:103], v[64:79]
    ds_read_b64_tr_b16 v[108:109], v35 offset:12288
    ds_read_b64_tr_b16 v[110:111], v35 offset:13312
    s_waitcnt lgkmcnt(2)
    v_mfma_f32_32x32x16_bf16 v[80:95], v[96:99], v[104:107], v[80:95]
    ds_read_b128 v[112:115], v33 offset:0
    ds_read_b128 v[116:119], v33 offset:4096
    s_waitcnt lgkmcnt(1)
    v_mfma_f32_32x32x16_bf16 v[64:79], v[108:111], v[112:115], v[64:79]
    s_waitcnt vmcnt(12) lgkmcnt(0)
    s_barrier
    ds_read_b64_tr_b16 v[96:97], v35 offset:32768
    ds_read_b64_tr_b16 v[98:99], v35 offset:33792
    ds_read_b128 v[100:103], v30 offset:32768
    ds_read_b128 v[104:107], v30 offset:36864
    v_mfma_f32_32x32x16_bf16 v[80:95], v[108:111], v[116:119], v[80:95]
    s_add_u32 m0, s32, 65536
    s_add_u32 s33, s28, 768
    buffer_load_dwordx4 v3, s[20:23], s33 offen lds
    s_add_u32 m0, s32, 66560
    s_add_u32 s33, s28, 8960
    buffer_load_dwordx4 v4, s[20:23], s33 offen lds
    s_add_u32 m0, s32, 81920
    s_add_u32 s33, s31, 1376256
    buffer_load_dwordx4 v5, s[12:15], s33 offen lds
    s_add_u32 m0, s32, 82944
    s_add_u32 s33, s31, 1390592
    buffer_load_dwordx4 v5, s[12:15], s33 offen lds
    s_waitcnt lgkmcnt(1)
    v_mfma_f32_32x32x16_bf16 v[64:79], v[96:99], v[100:103], v[64:79]
    ds_read_b64_tr_b16 v[108:109], v35 offset:36864
    ds_read_b64_tr_b16 v[110:111], v35 offset:37888
    s_waitcnt lgkmcnt(2)
    v_mfma_f32_32x32x16_bf16 v[80:95], v[96:99], v[104:107], v[80:95]
    ds_read_b128 v[112:115], v31 offset:32768
    ds_read_b128 v[116:119], v31 offset:36864
    s_waitcnt lgkmcnt(1)
    v_mfma_f32_32x32x16_bf16 v[64:79], v[108:111], v[112:115], v[64:79]
    ds_read_b64_tr_b16 v[96:97], v35 offset:40960
    ds_read_b64_tr_b16 v[98:99], v35 offset:41984
    s_waitcnt lgkmcnt(2)
    v_mfma_f32_32x32x16_bf16 v[80:95], v[108:111], v[116:119], v[80:95]
    ds_read_b128 v[100:103], v32 offset:32768
    ds_read_b128 v[104:107], v32 offset:36864
    s_waitcnt lgkmcnt(1)
    v_mfma_f32_32x32x16_bf16 v[64:79], v[96:99], v[100:103], v[64:79]
    ds_read_b64_tr_b16 v[108:109], v35 offset:45056
    ds_read_b64_tr_b16 v[110:111], v35 offset:46080
    s_waitcnt lgkmcnt(2)
    v_mfma_f32_32x32x16_bf16 v[80:95], v[96:99], v[104:107], v[80:95]
    ds_read_b128 v[112:115], v33 offset:32768
    ds_read_b128 v[116:119], v33 offset:36864
    s_waitcnt lgkmcnt(1)
    v_mfma_f32_32x32x16_bf16 v[64:79], v[108:111], v[112:115], v[64:79]
    s_waitcnt vmcnt(8) lgkmcnt(0)
    s_barrier
    ds_read_b64_tr_b16 v[96:97], v34 offset:0
    ds_read_b64_tr_b16 v[98:99], v34 offset:1024
    ds_read_b128 v[100:103], v26 offset:0
    ds_read_b128 v[104:107], v26 offset:4096
    v_mfma_f32_32x32x16_bf16 v[80:95], v[108:111], v[116:119], v[80:95]
    s_add_u32 m0, s32, 98304
    s_add_u32 s33, s28, 896
    buffer_load_dwordx4 v3, s[20:23], s33 offen lds
    s_add_u32 m0, s32, 99328
    s_add_u32 s33, s28, 9088
    buffer_load_dwordx4 v4, s[20:23], s33 offen lds
    s_add_u32 m0, s32, 114688
    s_add_u32 s33, s31, 1605632
    buffer_load_dwordx4 v5, s[12:15], s33 offen lds
    s_add_u32 m0, s32, 115712
    s_add_u32 s33, s31, 1619968
    buffer_load_dwordx4 v5, s[12:15], s33 offen lds
    s_waitcnt lgkmcnt(1)
    v_mfma_f32_32x32x16_bf16 v[64:79], v[96:99], v[100:103], v[64:79]
    ds_read_b64_tr_b16 v[108:109], v34 offset:4096
    ds_read_b64_tr_b16 v[110:111], v34 offset:5120
    s_waitcnt lgkmcnt(2)
    v_mfma_f32_32x32x16_bf16 v[80:95], v[96:99], v[104:107], v[80:95]
    ds_read_b128 v[112:115], v27 offset:0
    ds_read_b128 v[116:119], v27 offset:4096
    s_waitcnt lgkmcnt(1)
    v_mfma_f32_32x32x16_bf16 v[64:79], v[108:111], v[112:115], v[64:79]
    ds_read_b64_tr_b16 v[96:97], v34 offset:8192
    ds_read_b64_tr_b16 v[98:99], v34 offset:9216
    s_waitcnt lgkmcnt(2)
    v_mfma_f32_32x32x16_bf16 v[80:95], v[108:111], v[116:119], v[80:95]
    ds_read_b128 v[100:103], v28 offset:0
    ds_read_b128 v[104:107], v28 offset:4096
    s_waitcnt lgkmcnt(1)
    v_mfma_f32_32x32x16_bf16 v[64:79], v[96:99], v[100:103], v[64:79]
    ds_read_b64_tr_b16 v[108:109], v34 offset:12288
    ds_read_b64_tr_b16 v[110:111], v34 offset:13312
    s_waitcnt lgkmcnt(2)
    v_mfma_f32_32x32x16_bf16 v[80:95], v[96:99], v[104:107], v[80:95]
    ds_read_b128 v[112:115], v29 offset:0
    ds_read_b128 v[116:119], v29 offset:4096
    s_waitcnt lgkmcnt(1)
    v_mfma_f32_32x32x16_bf16 v[64:79], v[108:111], v[112:115], v[64:79]
    s_waitcnt vmcnt(8) lgkmcnt(0)
    s_barrier
    ds_read_b64_tr_b16 v[96:97], v34 offset:32768
    ds_read_b64_tr_b16 v[98:99], v34 offset:33792
    ds_read_b128 v[100:103], v26 offset:32768
    ds_read_b128 v[104:107], v26 offset:36864
    v_mfma_f32_32x32x16_bf16 v[80:95], v[108:111], v[116:119], v[80:95]
    s_waitcnt lgkmcnt(1)
    v_mfma_f32_32x32x16_bf16 v[64:79], v[96:99], v[100:103], v[64:79]
    ds_read_b64_tr_b16 v[108:109], v34 offset:36864
    ds_read_b64_tr_b16 v[110:111], v34 offset:37888
    s_waitcnt lgkmcnt(2)
    v_mfma_f32_32x32x16_bf16 v[80:95], v[96:99], v[104:107], v[80:95]
    ds_read_b128 v[112:115], v27 offset:32768
    ds_read_b128 v[116:119], v27 offset:36864
    s_waitcnt lgkmcnt(1)
    v_mfma_f32_32x32x16_bf16 v[64:79], v[108:111], v[112:115], v[64:79]
    ds_read_b64_tr_b16 v[96:97], v34 offset:40960
    ds_read_b64_tr_b16 v[98:99], v34 offset:41984
    s_waitcnt lgkmcnt(2)
    v_mfma_f32_32x32x16_bf16 v[80:95], v[108:111], v[116:119], v[80:95]
    ds_read_b128 v[100:103], v28 offset:32768
    ds_read_b128 v[104:107], v28 offset:36864
    s_waitcnt lgkmcnt(1)
    v_mfma_f32_32x32x16_bf16 v[64:79], v[96:99], v[100:103], v[64:79]
    ds_read_b64_tr_b16 v[108:109], v34 offset:45056
    ds_read_b64_tr_b16 v[110:111], v34 offset:46080
    s_waitcnt lgkmcnt(2)
    v_mfma_f32_32x32x16_bf16 v[80:95], v[96:99], v[104:107], v[80:95]
    ds_read_b128 v[112:115], v29 offset:32768
    ds_read_b128 v[116:119], v29 offset:36864
    s_waitcnt lgkmcnt(1)
    v_mfma_f32_32x32x16_bf16 v[64:79], v[108:111], v[112:115], v[64:79]
    s_waitcnt vmcnt(4) lgkmcnt(0)
    s_barrier
    ds_read_b64_tr_b16 v[96:97], v35 offset:0
    ds_read_b64_tr_b16 v[98:99], v35 offset:1024
    ds_read_b128 v[100:103], v30 offset:0
    ds_read_b128 v[104:107], v30 offset:4096
    v_mfma_f32_32x32x16_bf16 v[80:95], v[108:111], v[116:119], v[80:95]
    s_waitcnt lgkmcnt(1)
    v_mfma_f32_32x32x16_bf16 v[64:79], v[96:99], v[100:103], v[64:79]
    ds_read_b64_tr_b16 v[108:109], v35 offset:4096
    ds_read_b64_tr_b16 v[110:111], v35 offset:5120
    s_waitcnt lgkmcnt(2)
    v_mfma_f32_32x32x16_bf16 v[80:95], v[96:99], v[104:107], v[80:95]
    ds_read_b128 v[112:115], v31 offset:0
    ds_read_b128 v[116:119], v31 offset:4096
    s_waitcnt lgkmcnt(1)
    v_mfma_f32_32x32x16_bf16 v[64:79], v[108:111], v[112:115], v[64:79]
    ds_read_b64_tr_b16 v[96:97], v35 offset:8192
    ds_read_b64_tr_b16 v[98:99], v35 offset:9216
    s_waitcnt lgkmcnt(2)
    v_mfma_f32_32x32x16_bf16 v[80:95], v[108:111], v[116:119], v[80:95]
    ds_read_b128 v[100:103], v32 offset:0
    ds_read_b128 v[104:107], v32 offset:4096
    s_waitcnt lgkmcnt(1)
    v_mfma_f32_32x32x16_bf16 v[64:79], v[96:99], v[100:103], v[64:79]
    ds_read_b64_tr_b16 v[108:109], v35 offset:12288
    ds_read_b64_tr_b16 v[110:111], v35 offset:13312
    s_waitcnt lgkmcnt(2)
    v_mfma_f32_32x32x16_bf16 v[80:95], v[96:99], v[104:107], v[80:95]
    ds_read_b128 v[112:115], v33 offset:0
    ds_read_b128 v[116:119], v33 offset:4096
    s_waitcnt lgkmcnt(1)
    v_mfma_f32_32x32x16_bf16 v[64:79], v[108:111], v[112:115], v[64:79]
    s_waitcnt vmcnt(0) lgkmcnt(0)
    s_barrier
    ds_read_b64_tr_b16 v[96:97], v35 offset:32768
    ds_read_b64_tr_b16 v[98:99], v35 offset:33792
    ds_read_b128 v[100:103], v30 offset:32768
    ds_read_b128 v[104:107], v30 offset:36864
    v_mfma_f32_32x32x16_bf16 v[80:95], v[108:111], v[116:119], v[80:95]
    s_waitcnt lgkmcnt(1)
    v_mfma_f32_32x32x16_bf16 v[64:79], v[96:99], v[100:103], v[64:79]
    ds_read_b64_tr_b16 v[108:109], v35 offset:36864
    ds_read_b64_tr_b16 v[110:111], v35 offset:37888
    s_waitcnt lgkmcnt(2)
    v_mfma_f32_32x32x16_bf16 v[80:95], v[96:99], v[104:107], v[80:95]
    ds_read_b128 v[112:115], v31 offset:32768
    ds_read_b128 v[116:119], v31 offset:36864
    s_waitcnt lgkmcnt(1)
    v_mfma_f32_32x32x16_bf16 v[64:79], v[108:111], v[112:115], v[64:79]
    ds_read_b64_tr_b16 v[96:97], v35 offset:40960
    ds_read_b64_tr_b16 v[98:99], v35 offset:41984
    s_waitcnt lgkmcnt(2)
    v_mfma_f32_32x32x16_bf16 v[80:95], v[108:111], v[116:119], v[80:95]
    ds_read_b128 v[100:103], v32 offset:32768
    ds_read_b128 v[104:107], v32 offset:36864
    s_waitcnt lgkmcnt(1)
    v_mfma_f32_32x32x16_bf16 v[64:79], v[96:99], v[100:103], v[64:79]
    ds_read_b64_tr_b16 v[108:109], v35 offset:45056
    ds_read_b64_tr_b16 v[110:111], v35 offset:46080
    s_waitcnt lgkmcnt(2)
    v_mfma_f32_32x32x16_bf16 v[80:95], v[96:99], v[104:107], v[80:95]
    ds_read_b128 v[112:115], v33 offset:32768
    ds_read_b128 v[116:119], v33 offset:36864
    s_waitcnt lgkmcnt(1)
    v_mfma_f32_32x32x16_bf16 v[64:79], v[108:111], v[112:115], v[64:79]
    s_waitcnt lgkmcnt(0)
    v_mfma_f32_32x32x16_bf16 v[80:95], v[108:111], v[116:119], v[80:95]
    s_waitcnt vmcnt(0)
    v_mov_b32 v38, 0xc0135761
    v_mov_b32 v39, 0xc0135761
    s_mov_b32 s42, 0xbdd2d3e8
    s_mov_b32 s43, s42
    s_mov_b32 s44, 1.0
    s_mov_b32 s45, 1.0
    v_lshlrev_b32 v96, 16, v10
    v_and_b32 v97, 0xffff0000, v10
    v_lshlrev_b32 v98, 16, v11
    v_and_b32 v99, 0xffff0000, v11
    v_lshlrev_b32 v100, 16, v12
    v_and_b32 v101, 0xffff0000, v12
    v_lshlrev_b32 v102, 16, v13
    v_and_b32 v103, 0xffff0000, v13
    v_lshlrev_b32 v104, 16, v14
    v_and_b32 v105, 0xffff0000, v14
    v_lshlrev_b32 v106, 16, v15
    v_and_b32 v107, 0xffff0000, v15
    v_lshlrev_b32 v108, 16, v16
    v_and_b32 v109, 0xffff0000, v16
    v_lshlrev_b32 v110, 16, v17
    v_and_b32 v111, 0xffff0000, v17
    s_lshr_b32 s37, s34, 1
    s_lshl_b32 s37, s37, 1
    s_add_u32 s37, s37, s35
    s_lshl_b32 s37, s37, 13
    v_and_b32 v6, 31, v1
    v_lshlrev_b32 v7, 7, v6
    v_add_u32 v7, s37, v7
    v_lshrrev_b32 v8, 5, v1
    v_lshl_add_u32 v7, v8, 3, v7
    v_and_b32 v8, 7, v1
    v_lshl_add_u32 v7, v8, 4, v7
    s_and_b32 s38, s34, 1
    s_lshl_b32 s38, s38, 6
    v_xor_b32 v7, s38, v7
    v_cvt_pk_bf16_f32 v40, v64, v65
    v_cvt_pk_bf16_f32 v41, v66, v67
    v_lshlrev_b32 v64, 16, v40
    v_and_b32 v65, 0xffff0000, v40
    v_lshlrev_b32 v66, 16, v41
    v_and_b32 v67, 0xffff0000, v41
    v_pk_add_f32 v[64:65], v[64:65], v[96:97]
    v_pk_add_f32 v[66:67], v[66:67], v[98:99]
    v_cvt_pk_bf16_f32 v40, v64, v65
    v_cvt_pk_bf16_f32 v41, v66, v67
    v_lshlrev_b32 v64, 16, v40
    v_and_b32 v65, 0xffff0000, v40
    v_lshlrev_b32 v66, 16, v41
    v_and_b32 v67, 0xffff0000, v41
    v_pk_mul_f32 v[40:41], v[64:65], v[64:65]
    v_pk_mul_f32 v[42:43], v[66:67], v[66:67]
    v_pk_fma_f32 v[40:41], v[40:41], s[42:43], v[38:39]
    v_pk_fma_f32 v[42:43], v[42:43], s[42:43], v[38:39]
    v_pk_mul_f32 v[40:41], v[40:41], v[64:65]
    v_pk_mul_f32 v[42:43], v[42:43], v[66:67]
    v_exp_f32 v40, v40
    v_exp_f32 v41, v41
    v_exp_f32 v42, v42
    v_exp_f32 v43, v43
    v_pk_add_f32 v[40:41], v[40:41], s[44:45]
    v_pk_add_f32 v[42:43], v[42:43], s[44:45]
    v_rcp_f32 v40, v40
    v_rcp_f32 v41, v41
    v_rcp_f32 v42, v42
    v_rcp_f32 v43, v43
    v_pk_mul_f32 v[64:65], v[64:65], v[40:41]
    v_pk_mul_f32 v[66:67], v[66:67], v[42:43]
    v_cvt_pk_bf16_f32 v44, v64, v65
    v_cvt_pk_bf16_f32 v45, v66, v67
    v_xor_b32 v46, 0, v7
    ds_write_b64 v46, v[44:45] offset:0
    v_cvt_pk_bf16_f32 v48, v68, v69
    v_cvt_pk_bf16_f32 v49, v70, v71
    v_lshlrev_b32 v68, 16, v48
    v_and_b32 v69, 0xffff0000, v48
    v_lshlrev_b32 v70, 16, v49
    v_and_b32 v71, 0xffff0000, v49
    v_pk_add_f32 v[68:69], v[68:69], v[100:101]
    v_pk_add_f32 v[70:71], v[70:71], v[102:103]
    v_cvt_pk_bf16_f32 v48, v68, v69
    v_cvt_pk_bf16_f32 v49, v70, v71
    v_lshlrev_b32 v68, 16, v48
    v_and_b32 v69, 0xffff0000, v48
    v_lshlrev_b32 v70, 16, v49
    v_and_b32 v71, 0xffff0000, v49
    v_pk_mul_f32 v[48:49], v[68:69], v[68:69]
    v_pk_mul_f32 v[50:51], v[70:71], v[70:71]
    v_pk_fma_f32 v[48:49], v[48:49], s[42:43], v[38:39]
    v_pk_fma_f32 v[50:51], v[50:51], s[42:43], v[38:39]
    v_pk_mul_f32 v[48:49], v[48:49], v[68:69]
    v_pk_mul_f32 v[50:51], v[50:51], v[70:71]
    v_exp_f32 v48, v48
    v_exp_f32 v49, v49
    v_exp_f32 v50, v50
    v_exp_f32 v51, v51
    v_pk_add_f32 v[48:49], v[48:49], s[44:45]
    v_pk_add_f32 v[50:51], v[50:51], s[44:45]
    v_rcp_f32 v48, v48
    v_rcp_f32 v49, v49
    v_rcp_f32 v50, v50
    v_rcp_f32 v51, v51
    v_pk_mul_f32 v[68:69], v[68:69], v[48:49]
    v_pk_mul_f32 v[70:71], v[70:71], v[50:51]
    v_cvt_pk_bf16_f32 v52, v68, v69
    v_cvt_pk_bf16_f32 v53, v70, v71
    v_xor_b32 v54, 16, v7
    ds_write_b64 v54, v[52:53] offset:0
    v_cvt_pk_bf16_f32 v40, v72, v73
    v_cvt_pk_bf16_f32 v41, v74, v75
    v_lshlrev_b32 v72, 16, v40
    v_and_b32 v73, 0xffff0000, v40
    v_lshlrev_b32 v74, 16, v41
    v_and_b32 v75, 0xffff0000, v41
    v_pk_add_f32 v[72:73], v[72:73], v[104:105]
    v_pk_add_f32 v[74:75], v[74:75], v[106:107]
    v_cvt_pk_bf16_f32 v40, v72, v73
    v_cvt_pk_bf16_f32 v41, v74, v75
    v_lshlrev_b32 v72, 16, v40
    v_and_b32 v73, 0xffff0000, v40
    v_lshlrev_b32 v74, 16, v41
    v_and_b32 v75, 0xffff0000, v41
    v_pk_mul_f32 v[40:41], v[72:73], v[72:73]
    v_pk_mul_f32 v[42:43], v[74:75], v[74:75]
    v_pk_fma_f32 v[40:41], v[40:41], s[42:43], v[38:39]
    v_pk_fma_f32 v[42:43], v[42:43], s[42:43], v[38:39]
    v_pk_mul_f32 v[40:41], v[40:41], v[72:73]
    v_pk_mul_f32 v[42:43], v[42:43], v[74:75]
    v_exp_f32 v40, v40
    v_exp_f32 v41, v41
    v_exp_f32 v42, v42
    v_exp_f32 v43, v43
    v_pk_add_f32 v[40:41], v[40:41], s[44:45]
    v_pk_add_f32 v[42:43], v[42:43], s[44:45]
    v_rcp_f32 v40, v40
    v_rcp_f32 v41, v41
    v_rcp_f32 v42, v42
    v_rcp_f32 v43, v43
    v_pk_mul_f32 v[72:73], v[72:73], v[40:41]
    v_pk_mul_f32 v[74:75], v[74:75], v[42:43]
    v_cvt_pk_bf16_f32 v44, v72, v73
    v_cvt_pk_bf16_f32 v45, v74, v75
    v_xor_b32 v46, 32, v7
    ds_write_b64 v46, v[44:45] offset:0
    v_cvt_pk_bf16_f32 v48, v76, v77
    v_cvt_pk_bf16_f32 v49, v78, v79
    v_lshlrev_b32 v76, 16, v48
    v_and_b32 v77, 0xffff0000, v48
    v_lshlrev_b32 v78, 16, v49
    v_and_b32 v79, 0xffff0000, v49
    v_pk_add_f32 v[76:77], v[76:77], v[108:109]
    v_pk_add_f32 v[78:79], v[78:79], v[110:111]
    v_cvt_pk_bf16_f32 v48, v76, v77
    v_cvt_pk_bf16_f32 v49, v78, v79
    v_lshlrev_b32 v76, 16, v48
    v_and_b32 v77, 0xffff0000, v48
    v_lshlrev_b32 v78, 16, v49
    v_and_b32 v79, 0xffff0000, v49
    v_pk_mul_f32 v[48:49], v[76:77], v[76:77]
    v_pk_mul_f32 v[50:51], v[78:79], v[78:79]
    v_pk_fma_f32 v[48:49], v[48:49], s[42:43], v[38:39]
    v_pk_fma_f32 v[50:51], v[50:51], s[42:43], v[38:39]
    v_pk_mul_f32 v[48:49], v[48:49], v[76:77]
    v_pk_mul_f32 v[50:51], v[50:51], v[78:79]
    v_exp_f32 v48, v48
    v_exp_f32 v49, v49
    v_exp_f32 v50, v50
    v_exp_f32 v51, v51
    v_pk_add_f32 v[48:49], v[48:49], s[44:45]
    v_pk_add_f32 v[50:51], v[50:51], s[44:45]
    v_rcp_f32 v48, v48
    v_rcp_f32 v49, v49
    v_rcp_f32 v50, v50
    v_rcp_f32 v51, v51
    v_pk_mul_f32 v[76:77], v[76:77], v[48:49]
    v_pk_mul_f32 v[78:79], v[78:79], v[50:51]
    v_cvt_pk_bf16_f32 v52, v76, v77
    v_cvt_pk_bf16_f32 v53, v78, v79
    v_xor_b32 v54, 48, v7
    ds_write_b64 v54, v[52:53] offset:0
    v_cvt_pk_bf16_f32 v40, v80, v81
    v_cvt_pk_bf16_f32 v41, v82, v83
    v_lshlrev_b32 v80, 16, v40
    v_and_b32 v81, 0xffff0000, v40
    v_lshlrev_b32 v82, 16, v41
    v_and_b32 v83, 0xffff0000, v41
    v_pk_add_f32 v[80:81], v[80:81], v[96:97]
    v_pk_add_f32 v[82:83], v[82:83], v[98:99]
    v_cvt_pk_bf16_f32 v40, v80, v81
    v_cvt_pk_bf16_f32 v41, v82, v83
    v_lshlrev_b32 v80, 16, v40
    v_and_b32 v81, 0xffff0000, v40
    v_lshlrev_b32 v82, 16, v41
    v_and_b32 v83, 0xffff0000, v41
    v_pk_mul_f32 v[40:41], v[80:81], v[80:81]
    v_pk_mul_f32 v[42:43], v[82:83], v[82:83]
    v_pk_fma_f32 v[40:41], v[40:41], s[42:43], v[38:39]
    v_pk_fma_f32 v[42:43], v[42:43], s[42:43], v[38:39]
    v_pk_mul_f32 v[40:41], v[40:41], v[80:81]
    v_pk_mul_f32 v[42:43], v[42:43], v[82:83]
    v_exp_f32 v40, v40
    v_exp_f32 v41, v41
    v_exp_f32 v42, v42
    v_exp_f32 v43, v43
    v_pk_add_f32 v[40:41], v[40:41], s[44:45]
    v_pk_add_f32 v[42:43], v[42:43], s[44:45]
    v_rcp_f32 v40, v40
    v_rcp_f32 v41, v41
    v_rcp_f32 v42, v42
    v_rcp_f32 v43, v43
    v_pk_mul_f32 v[80:81], v[80:81], v[40:41]
    v_pk_mul_f32 v[82:83], v[82:83], v[42:43]
    v_cvt_pk_bf16_f32 v44, v80, v81
    v_cvt_pk_bf16_f32 v45, v82, v83
    v_xor_b32 v46, 0, v7
    ds_write_b64 v46, v[44:45] offset:4096
    v_cvt_pk_bf16_f32 v48, v84, v85
    v_cvt_pk_bf16_f32 v49, v86, v87
    v_lshlrev_b32 v84, 16, v48
    v_and_b32 v85, 0xffff0000, v48
    v_lshlrev_b32 v86, 16, v49
    v_and_b32 v87, 0xffff0000, v49
    v_pk_add_f32 v[84:85], v[84:85], v[100:101]
    v_pk_add_f32 v[86:87], v[86:87], v[102:103]
    v_cvt_pk_bf16_f32 v48, v84, v85
    v_cvt_pk_bf16_f32 v49, v86, v87
    v_lshlrev_b32 v84, 16, v48
    v_and_b32 v85, 0xffff0000, v48
    v_lshlrev_b32 v86, 16, v49
    v_and_b32 v87, 0xffff0000, v49
    v_pk_mul_f32 v[48:49], v[84:85], v[84:85]
    v_pk_mul_f32 v[50:51], v[86:87], v[86:87]
    v_pk_fma_f32 v[48:49], v[48:49], s[42:43], v[38:39]
    v_pk_fma_f32 v[50:51], v[50:51], s[42:43], v[38:39]
    v_pk_mul_f32 v[48:49], v[48:49], v[84:85]
    v_pk_mul_f32 v[50:51], v[50:51], v[86:87]
    v_exp_f32 v48, v48
    v_exp_f32 v49, v49
    v_exp_f32 v50, v50
    v_exp_f32 v51, v51
    v_pk_add_f32 v[48:49], v[48:49], s[44:45]
    v_pk_add_f32 v[50:51], v[50:51], s[44:45]
    v_rcp_f32 v48, v48
    v_rcp_f32 v49, v49
    v_rcp_f32 v50, v50
    v_rcp_f32 v51, v51
    v_pk_mul_f32 v[84:85], v[84:85], v[48:49]
    v_pk_mul_f32 v[86:87], v[86:87], v[50:51]
    v_cvt_pk_bf16_f32 v52, v84, v85
    v_cvt_pk_bf16_f32 v53, v86, v87
    v_xor_b32 v54, 16, v7
    ds_write_b64 v54, v[52:53] offset:4096
    v_cvt_pk_bf16_f32 v40, v88, v89
    v_cvt_pk_bf16_f32 v41, v90, v91
    v_lshlrev_b32 v88, 16, v40
    v_and_b32 v89, 0xffff0000, v40
    v_lshlrev_b32 v90, 16, v41
    v_and_b32 v91, 0xffff0000, v41
    v_pk_add_f32 v[88:89], v[88:89], v[104:105]
    v_pk_add_f32 v[90:91], v[90:91], v[106:107]
    v_cvt_pk_bf16_f32 v40, v88, v89
    v_cvt_pk_bf16_f32 v41, v90, v91
    v_lshlrev_b32 v88, 16, v40
    v_and_b32 v89, 0xffff0000, v40
    v_lshlrev_b32 v90, 16, v41
    v_and_b32 v91, 0xffff0000, v41
    v_pk_mul_f32 v[40:41], v[88:89], v[88:89]
    v_pk_mul_f32 v[42:43], v[90:91], v[90:91]
    v_pk_fma_f32 v[40:41], v[40:41], s[42:43], v[38:39]
    v_pk_fma_f32 v[42:43], v[42:43], s[42:43], v[38:39]
    v_pk_mul_f32 v[40:41], v[40:41], v[88:89]
    v_pk_mul_f32 v[42:43], v[42:43], v[90:91]
    v_exp_f32 v40, v40
    v_exp_f32 v41, v41
    v_exp_f32 v42, v42
    v_exp_f32 v43, v43
    v_pk_add_f32 v[40:41], v[40:41], s[44:45]
    v_pk_add_f32 v[42:43], v[42:43], s[44:45]
    v_rcp_f32 v40, v40
    v_rcp_f32 v41, v41
    v_rcp_f32 v42, v42
    v_rcp_f32 v43, v43
    v_pk_mul_f32 v[88:89], v[88:89], v[40:41]
    v_pk_mul_f32 v[90:91], v[90:91], v[42:43]
    v_cvt_pk_bf16_f32 v44, v88, v89
    v_cvt_pk_bf16_f32 v45, v90, v91
    v_xor_b32 v46, 32, v7
    ds_write_b64 v46, v[44:45] offset:4096
    v_cvt_pk_bf16_f32 v48, v92, v93
    v_cvt_pk_bf16_f32 v49, v94, v95
    v_lshlrev_b32 v92, 16, v48
    v_and_b32 v93, 0xffff0000, v48
    v_lshlrev_b32 v94, 16, v49
    v_and_b32 v95, 0xffff0000, v49
    v_pk_add_f32 v[92:93], v[92:93], v[108:109]
    v_pk_add_f32 v[94:95], v[94:95], v[110:111]
    v_cvt_pk_bf16_f32 v48, v92, v93
    v_cvt_pk_bf16_f32 v49, v94, v95
    v_lshlrev_b32 v92, 16, v48
    v_and_b32 v93, 0xffff0000, v48
    v_lshlrev_b32 v94, 16, v49
    v_and_b32 v95, 0xffff0000, v49
    v_pk_mul_f32 v[48:49], v[92:93], v[92:93]
    v_pk_mul_f32 v[50:51], v[94:95], v[94:95]
    v_pk_fma_f32 v[48:49], v[48:49], s[42:43], v[38:39]
    v_pk_fma_f32 v[50:51], v[50:51], s[42:43], v[38:39]
    v_pk_mul_f32 v[48:49], v[48:49], v[92:93]
    v_pk_mul_f32 v[50:51], v[50:51], v[94:95]
    v_exp_f32 v48, v48
    v_exp_f32 v49, v49
    v_exp_f32 v50, v50
    v_exp_f32 v51, v51
    v_pk_add_f32 v[48:49], v[48:49], s[44:45]
    v_pk_add_f32 v[50:51], v[50:51], s[44:45]
    v_rcp_f32 v48, v48
    v_rcp_f32 v49, v49
    v_rcp_f32 v50, v50
    v_rcp_f32 v51, v51
    v_pk_mul_f32 v[92:93], v[92:93], v[48:49]
    v_pk_mul_f32 v[94:95], v[94:95], v[50:51]
    v_cvt_pk_bf16_f32 v52, v92, v93
    v_cvt_pk_bf16_f32 v53, v94, v95
    v_xor_b32 v54, 48, v7
    ds_write_b64 v54, v[52:53] offset:4096
    v_lshlrev_b32 v6, 4, v1
    s_and_b32 s38, s34, 1
    s_lshl_b32 s39, s38, 12
    s_add_u32 s39, s39, s37
    v_add_u32 v6, s39, v6
    v_lshrrev_b32 v8, 3, v1
    v_and_b32 v9, 7, v1
    v_xor_b32 v9, v9, v8
    v_mul_lo_u32 v8, v8, s30
    v_lshl_add_u32 v8, v9, 4, v8
    s_lshl_b32 s38, s38, 5
    s_lshl_b32 s39, s10, 7
    s_add_u32 s38, s38, s39
    s_lshl_b32 s39, s35, 6
    s_add_u32 s38, s38, s39
    s_mul_i32 s38, s38, 3584
    s_lshl_b32 s39, s11, 8
    s_add_u32 s38, s38, s39
    s_lshr_b32 s39, s34, 1
    s_lshl_b32 s39, s39, 7
    s_add_u32 s38, s38, s39
    s_waitcnt lgkmcnt(0)
    s_barrier
    ds_read_b128 v[64:67], v6 offset:0
    ds_read_b128 v[68:71], v6 offset:1024
    ds_read_b128 v[72:75], v6 offset:2048
    ds_read_b128 v[76:79], v6 offset:3072
    s_waitcnt lgkmcnt(3)
    buffer_store_dwordx4 v[64:67], v8, s[24:27], s38 offen sc1
    s_add_u32 s38, s38, 28672
    s_waitcnt lgkmcnt(2)
    buffer_store_dwordx4 v[68:71], v8, s[24:27], s38 offen sc1
    s_add_u32 s38, s38, 28672
    s_waitcnt lgkmcnt(1)
    buffer_store_dwordx4 v[72:75], v8, s[24:27], s38 offen sc1
    s_add_u32 s38, s38, 28672
    s_waitcnt lgkmcnt(0)
    buffer_store_dwordx4 v[76:79], v8, s[24:27], s38 offen sc1
    s_add_u32 s38, s38, 28672
    s_waitcnt vmcnt(0)
    s_barrier
    s_cmp_lg_u32 s3, 0
    s_cbranch_scc1 Lpub_40
    s_lshl_b32 s92, s10, 8
    s_add_u32 s92, s92, 4096
    v_mov_b32 v158, 1
    v_mov_b32 v159, 0
    s_mov_b64 exec, 1
    buffer_atomic_add v158, v159, s[96:99], s92 offen sc1
    s_mov_b64 exec, -1
Lpub_40:
Lg1skip_36:
    s_cmp_ge_u32 s3, 4
    s_cbranch_scc1 Lskip_41
    s_mov_b64 s[4:5], s[76:77]
    s_mov_b64 s[6:7], s[78:79]
    s_mov_b64 s[8:9], s[84:85]
    s_mov_b64 s[40:41], s[84:85]
    s_and_b32 s10, s2, 7
    s_lshr_b32 s11, s2, 3
    s_and_b32 s28, s11, 3
    s_lshl_b32 s10, s10, 2
    s_add_u32 s10, s10, s28
    s_lshr_b32 s11, s11, 2
    s_waitcnt lgkmcnt(0)
    s_mov_b32 s12, s4
    s_and_b32 s13, s5, 0xffff
    s_mov_b32 s14, 0x1c0000
    s_mov_b32 s15, 0x00020000
    s_mov_b32 s16, s6
    s_and_b32 s17, s7, 0xffff
    s_mov_b32 s18, 0x400
    s_mov_b32 s19, 0x00020000
    s_add_u32 s20, s8, 0xa40000
    s_addc_u32 s21, s9, 0
    s_and_b32 s21, s21, 0xffff
    s_mov_b32 s22, 0x700000
    s_mov_b32 s23, 0x00020000
    s_add_u32 s24, s8, 0x640000
    s_addc_u32 s25, s9, 0
    s_and_b32 s25, s25, 0xffff
    s_mov_b32 s26, 0x200000
    s_mov_b32 s27, 0x00020000
    s_add_u32 s44, s40, 0x1140000
    s_addc_u32 s45, s41, 0
    s_and_b32 s45, s45, 0xffff
    s_mov_b32 s46, 0x200000
    s_mov_b32 s47, 0x00020000
    v_lshrrev_b32 v6, 3, v1
    s_movk_i32 s30, 3584
    v_mul_lo_u32 v6, v6, s30
    v_and_b32 v7, 7, v1
    v_lshrrev_b32 v8, 4, v1
    v_xor_b32 v7, v7, v8
    v_lshl_add_u32 v3, v7, 4, v6
    v_xor_b32 v7, 4, v7
    v_lshl_add_u32 v4, v7, 4, v6
    s_lshl_b32 s28, s10, 6
    s_mul_i32 s28, s28, 3584
    s_mul_i32 s29, s3, 896
    s_add_u32 s28, s28, s29
    v_lshrrev_b32 v6, 3, v1
    v_lshlrev_b32 v6, 10, v6
    v_and_b32 v7, 7, v1
    v_bfe_u32 v8, v1, 4, 1
    v_lshlrev_b32 v8, 2, v8
    v_xor_b32 v7, v7, v8
    v_lshl_add_u32 v5, v7, 4, v6
    s_mul_i32 s31, s3, 458752
    s_lshl_b32 s29, s11, 7
    s_add_u32 s31, s31, s29
    s_mul_i32 s32, s3, 40960
    s_cmp_lg_u32 s3, 0
    s_cbranch_scc1 Lpd_44
    s_lshr_b32 s92, s10, 1
    s_lshl_b32 s92, s92, 8
    s_add_u32 s92, s92, 4096
    v_mov_b32 v159, 0
    s_mov_b32 s93, 0
Lpl_45:
    v_mov_b32 v158, 0
    s_mov_b64 exec, 1
    buffer_atomic_add v158, v159, s[96:99], s92 offen sc0 sc1
    s_mov_b64 exec, -1
    s_waitcnt vmcnt(0)
    v_readfirstlane_b32 s94, v158
    s_add_u32 s93, s93, 1
    s_cmp_ge_u32 s94, 14
    s_cbranch_scc1 Lpd_44
    s_cmp_gt_u32 s93, 0x40000
    s_cbranch_scc1 Lpd_44
    s_sleep 2
    s_branch Lpl_45
Lpd_44:
    s_add_u32 m0, s32, 8192
    s_add_u32 s33, s31, 0
    buffer_load_dwordx4 v5, s[12:15], s33 offen lds
    s_add_u32 m0, s32, 9216
    s_add_u32 s33, s31, 8192
    buffer_load_dwordx4 v5, s[12:15], s33 offen lds
    s_add_u32 m0, s32, 10240
    s_add_u32 s33, s31, 16384
    buffer_load_dwordx4 v5, s[12:15], s33 offen lds
    s_add_u32 m0, s32, 11264
    s_add_u32 s33, s31, 24576
    buffer_load_dwordx4 v5, s[12:15], s33 offen lds
    s_add_u32 m0, s32, 12288
    s_add_u32 s33, s31, 32768
    buffer_load_dwordx4 v5, s[12:15], s33 offen lds
    s_add_u32 m0, s32, 13312
    s_add_u32 s33, s31, 40960
    buffer_load_dwordx4 v5, s[12:15], s33 offen lds
    s_add_u32 m0, s32, 14336
    s_add_u32 s33, s31, 49152
    buffer_load_dwordx4 v5, s[12:15], s33 offen lds
    s_add_u32 m0, s32, 15360
    s_add_u32 s33, s31, 57344
    buffer_load_dwordx4 v5, s[12:15], s33 offen lds
    s_add_u32 m0, s32, 24576
    s_add_u32 s33, s31, 65536
    buffer_load_dwordx4 v5, s[12:15], s33 offen lds
    s_add_u32 m0, s32, 25600
    s_add_u32 s33, s31, 73728
    buffer_load_dwordx4 v5, s[12:15], s33 offen lds
    s_add_u32 m0, s32, 26624
    s_add_u32 s33, s31, 81920
    buffer_load_dwordx4 v5, s[12:15], s33 offen lds
    s_add_u32 m0, s32, 27648
    s_add_u32 s33, s31, 90112
    buffer_load_dwordx4 v5, s[12:15], s33 offen lds
    s_add_u32 m0, s32, 28672
    s_add_u32 s33, s31, 98304
    buffer_load_dwordx4 v5, s[12:15], s33 offen lds
    s_add_u32 m0, s32, 29696
    s_add_u32 s33, s31, 106496
    buffer_load_dwordx4 v5, s[12:15], s33 offen lds
    s_add_u32 m0, s32, 30720
    s_add_u32 s33, s31, 114688
    buffer_load_dwordx4 v5, s[12:15], s33 offen lds
    s_add_u32 m0, s32, 31744
    s_add_u32 s33, s31, 122880
    buffer_load_dwordx4 v5, s[12:15], s33 offen lds
    v_and_b32 v6, 31, v1
    v_lshlrev_b32 v6, 7, v6
    v_add_u32 v6, s32, v6
    v_lshrrev_b32 v7, 5, v1
    v_bfe_u32 v8, v1, 1, 3
    v_xor_b32 v7, v7, v8
    v_lshl_add_u32 v6, v7, 4, v6
    v_xor_b32 v10, 0, v6
    v_xor_b32 v11, 32, v6
    v_xor_b32 v12, 64, v6
    v_xor_b32 v13, 96, v6
    v_lshrrev_b32 v6, 5, v1
    v_lshlrev_b32 v6, 3, v6
    v_bfe_u32 v7, v1, 2, 2
    v_add_u32 v6, v6, v7
    v_lshlrev_b32 v6, 7, v6
    v_bfe_u32 v8, v1, 4, 1
    v_lshlrev_b32 v8, 1, v8
    v_bfe_u32 v9, v1, 1, 1
    v_add_u32 v8, v8, v9
    v_bfe_u32 v7, v1, 3, 1
    v_lshlrev_b32 v7, 2, v7
    v_xor_b32 v8, v8, v7
    v_lshl_add_u32 v6, v8, 4, v6
    v_and_b32 v9, 1, v1
    v_lshl_add_u32 v6, v9, 3, v6
    v_add_u32 v14, s32, v6
    v_xor_b32 v15, 64, v14
    v_mov_b32 v64, 0
    v_mov_b32 v65, 0
    v_mov_b32 v66, 0
    v_mov_b32 v67, 0
    v_mov_b32 v68, 0
    v_mov_b32 v69, 0
    v_mov_b32 v70, 0
    v_mov_b32 v71, 0
    v_mov_b32 v72, 0
    v_mov_b32 v73, 0
    v_mov_b32 v74, 0
    v_mov_b32 v75, 0
    v_mov_b32 v76, 0
    v_mov_b32 v77, 0
    v_mov_b32 v78, 0
    v_mov_b32 v79, 0
    v_mov_b32 v80, 0
    v_mov_b32 v81, 0
    v_mov_b32 v82, 0
    v_mov_b32 v83, 0
    v_mov_b32 v84, 0
    v_mov_b32 v85, 0
    v_mov_b32 v86, 0
    v_mov_b32 v87, 0
    v_mov_b32 v88, 0
    v_mov_b32 v89, 0
    v_mov_b32 v90, 0
    v_mov_b32 v91, 0
    v_mov_b32 v92, 0
    v_mov_b32 v93, 0
    v_mov_b32 v94, 0
    v_mov_b32 v95, 0
    v_mov_b32 v96, 0
    v_mov_b32 v97, 0
    v_mov_b32 v98, 0
    v_mov_b32 v99, 0
    v_mov_b32 v100, 0
    v_mov_b32 v101, 0
    v_mov_b32 v102, 0
    v_mov_b32 v103, 0
    v_mov_b32 v104, 0
    v_mov_b32 v105, 0
    v_mov_b32 v106, 0
    v_mov_b32 v107, 0
    v_mov_b32 v108, 0
    v_mov_b32 v109, 0
    v_mov_b32 v110, 0
    v_mov_b32 v111, 0
    v_mov_b32 v112, 0
    v_mov_b32 v113, 0
    v_mov_b32 v114, 0
    v_mov_b32 v115, 0
    v_mov_b32 v116, 0
    v_mov_b32 v117, 0
    v_mov_b32 v118, 0
    v_mov_b32 v119, 0
    v_mov_b32 v120, 0
    v_mov_b32 v121, 0
    v_mov_b32 v122, 0
    v_mov_b32 v123, 0
    v_mov_b32 v124, 0
    v_mov_b32 v125, 0
    v_mov_b32 v126, 0
    v_mov_b32 v127, 0
    s_barrier
    s_add_u32 m0, s32, 0
    s_add_u32 s33, s28, 0
    buffer_load_dwordx4 v3, s[20:23], s33 offen lds
    s_add_u32 m0, s32, 1024
    s_add_u32 s33, s28, 28672
    buffer_load_dwordx4 v4, s[20:23], s33 offen lds
    s_add_u32 m0, s32, 2048
    s_add_u32 s33, s28, 57344
    buffer_load_dwordx4 v3, s[20:23], s33 offen lds
    s_add_u32 m0, s32, 3072
    s_add_u32 s33, s28, 86016
    buffer_load_dwordx4 v4, s[20:23], s33 offen lds
    s_add_u32 m0, s32, 4096
    s_add_u32 s33, s28, 114688
    buffer_load_dwordx4 v3, s[20:23], s33 offen lds
    s_add_u32 m0, s32, 5120
    s_add_u32 s33, s28, 143360
    buffer_load_dwordx4 v4, s[20:23], s33 offen lds
    s_add_u32 m0, s32, 6144
    s_add_u32 s33, s28, 172032
    buffer_load_dwordx4 v3, s[20:23], s33 offen lds
    s_add_u32 m0, s32, 7168
    s_add_u32 s33, s28, 200704
    buffer_load_dwordx4 v4, s[20:23], s33 offen lds
    s_add_u32 m0, s32, 16384
    s_add_u32 s33, s28, 128
    buffer_load_dwordx4 v3, s[20:23], s33 offen lds
    s_add_u32 m0, s32, 17408
    s_add_u32 s33, s28, 28800
    buffer_load_dwordx4 v4, s[20:23], s33 offen lds
    s_add_u32 m0, s32, 18432
    s_add_u32 s33, s28, 57472
    buffer_load_dwordx4 v3, s[20:23], s33 offen lds
    s_add_u32 m0, s32, 19456
    s_add_u32 s33, s28, 86144
    buffer_load_dwordx4 v4, s[20:23], s33 offen lds
    s_add_u32 m0, s32, 20480
    s_add_u32 s33, s28, 114816
    buffer_load_dwordx4 v3, s[20:23], s33 offen lds
    s_add_u32 m0, s32, 21504
    s_add_u32 s33, s28, 143488
    buffer_load_dwordx4 v4, s[20:23], s33 offen lds
    s_add_u32 m0, s32, 22528
    s_add_u32 s33, s28, 172160
    buffer_load_dwordx4 v3, s[20:23], s33 offen lds
    s_add_u32 m0, s32, 23552
    s_add_u32 s33, s28, 200832
    buffer_load_dwordx4 v4, s[20:23], s33 offen lds
    s_add_u32 m0, s32, 32768
    s_add_u32 s33, s28, 256
    buffer_load_dwordx4 v3, s[20:23], s33 offen lds
    s_add_u32 m0, s32, 33792
    s_add_u32 s33, s28, 28928
    buffer_load_dwordx4 v4, s[20:23], s33 offen lds
    s_add_u32 m0, s32, 34816
    s_add_u32 s33, s28, 57600
    buffer_load_dwordx4 v3, s[20:23], s33 offen lds
    s_add_u32 m0, s32, 35840
    s_add_u32 s33, s28, 86272
    buffer_load_dwordx4 v4, s[20:23], s33 offen lds
    s_add_u32 m0, s32, 36864
    s_add_u32 s33, s28, 114944
    buffer_load_dwordx4 v3, s[20:23], s33 offen lds
    s_add_u32 m0, s32, 37888
    s_add_u32 s33, s28, 143616
    buffer_load_dwordx4 v4, s[20:23], s33 offen lds
    s_add_u32 m0, s32, 38912
    s_add_u32 s33, s28, 172288
    buffer_load_dwordx4 v3, s[20:23], s33 offen lds
    s_add_u32 m0, s32, 39936
    s_add_u32 s33, s28, 200960
    buffer_load_dwordx4 v4, s[20:23], s33 offen lds
    v_lshrrev_b32 v28, 3, v1
    v_lshlrev_b32 v28, 10, v28
    v_and_b32 v29, 7, v1
    v_lshl_add_u32 v28, v29, 4, v28
    s_lshl_b32 s34, s10, 16
    s_lshl_b32 s35, s3, 14
    s_add_u32 s34, s34, s35
    s_lshl_b32 s35, s11, 7
    s_add_u32 s34, s34, s35
    buffer_load_dwordx4 v[16:19], v28, s[24:27], s34 offen
    s_add_u32 s36, s34, 8192
    buffer_load_dwordx4 v[20:23], v28, s[24:27], s36 offen
    v_lshlrev_b32 v30, 4, v29
    buffer_load_dwordx4 v[24:27], v30, s[16:19], s35 offen
    s_waitcnt vmcnt(19)
    ds_read_b64_tr_b16 v[128:129], v14 offset:8192
    ds_read_b64_tr_b16 v[130:131], v14 offset:8704
    ds_read_b128 v[136:139], v10 offset:0
    ds_read_b128 v[140:143], v10 offset:4096
    ds_read_b64_tr_b16 v[132:133], v15 offset:8192
    ds_read_b64_tr_b16 v[134:135], v15 offset:8704
    s_waitcnt lgkmcnt(3)
    v_mfma_f32_32x32x16_bf16 v[64:79], v[128:131], v[136:139], v[64:79]
    ds_read_b64_tr_b16 v[144:145], v14 offset:10240
    ds_read_b64_tr_b16 v[146:147], v14 offset:10752
    s_waitcnt lgkmcnt(4)
    v_mfma_f32_32x32x16_bf16 v[80:95], v[128:131], v[140:143], v[80:95]
    ds_read_b128 v[152:155], v11 offset:0
    ds_read_b128 v[156:159], v11 offset:4096
    s_waitcnt lgkmcnt(4)
    v_mfma_f32_32x32x16_bf16 v[96:111], v[132:135], v[136:139], v[96:111]
    ds_read_b64_tr_b16 v[148:149], v15 offset:10240
    ds_read_b64_tr_b16 v[150:151], v15 offset:10752
    v_mfma_f32_32x32x16_bf16 v[112:127], v[132:135], v[140:143], v[112:127]
    s_waitcnt lgkmcnt(3)
    v_mfma_f32_32x32x16_bf16 v[64:79], v[144:147], v[152:155], v[64:79]
    ds_read_b64_tr_b16 v[128:129], v14 offset:12288
    ds_read_b64_tr_b16 v[130:131], v14 offset:12800
    s_waitcnt lgkmcnt(4)
    v_mfma_f32_32x32x16_bf16 v[80:95], v[144:147], v[156:159], v[80:95]
    ds_read_b128 v[136:139], v12 offset:0
    ds_read_b128 v[140:143], v12 offset:4096
    s_waitcnt lgkmcnt(4)
    v_mfma_f32_32x32x16_bf16 v[96:111], v[148:151], v[152:155], v[96:111]
    ds_read_b64_tr_b16 v[132:133], v15 offset:12288
    ds_read_b64_tr_b16 v[134:135], v15 offset:12800
    v_mfma_f32_32x32x16_bf16 v[112:127], v[148:151], v[156:159], v[112:127]
    s_waitcnt lgkmcnt(3)
    v_mfma_f32_32x32x16_bf16 v[64:79], v[128:131], v[136:139], v[64:79]
    ds_read_b64_tr_b16 v[144:145], v14 offset:14336
    ds_read_b64_tr_b16 v[146:147], v14 offset:14848
    s_waitcnt lgkmcnt(4)
    v_mfma_f32_32x32x16_bf16 v[80:95], v[128:131], v[140:143], v[80:95]
    ds_read_b128 v[152:155], v13 offset:0
    ds_read_b128 v[156:159], v13 offset:4096
    s_waitcnt lgkmcnt(4)
    v_mfma_f32_32x32x16_bf16 v[96:111], v[132:135], v[136:139], v[96:111]
    ds_read_b64_tr_b16 v[148:149], v15 offset:14336
    ds_read_b64_tr_b16 v[150:151], v15 offset:14848
    v_mfma_f32_32x32x16_bf16 v[112:127], v[132:135], v[140:143], v[112:127]
    s_waitcnt lgkmcnt(3)
    v_mfma_f32_32x32x16_bf16 v[64:79], v[144:147], v[152:155], v[64:79]
    s_waitcnt lgkmcnt(2)
    v_mfma_f32_32x32x16_bf16 v[80:95], v[144:147], v[156:159], v[80:95]
    s_waitcnt vmcnt(11) lgkmcnt(0)
    ds_read_b64_tr_b16 v[128:129], v14 offset:24576
    ds_read_b64_tr_b16 v[130:131], v14 offset:25088
    ds_read_b128 v[136:139], v10 offset:16384
    ds_read_b128 v[140:143], v10 offset:20480
    v_mfma_f32_32x32x16_bf16 v[96:111], v[148:151], v[152:155], v[96:111]
    ds_read_b64_tr_b16 v[132:133], v15 offset:24576
    ds_read_b64_tr_b16 v[134:135], v15 offset:25088
    v_mfma_f32_32x32x16_bf16 v[112:127], v[148:151], v[156:159], v[112:127]
    s_add_u32 m0, s32, 0
    s_add_u32 s33, s31, 131072
    buffer_load_dwordx4 v5, s[12:15], s33 offen lds
    s_add_u32 m0, s32, 1024
    s_add_u32 s33, s31, 139264
    buffer_load_dwordx4 v5, s[12:15], s33 offen lds
    s_add_u32 m0, s32, 2048
    s_add_u32 s33, s31, 147456
    buffer_load_dwordx4 v5, s[12:15], s33 offen lds
    s_add_u32 m0, s32, 3072
    s_add_u32 s33, s31, 155648
    buffer_load_dwordx4 v5, s[12:15], s33 offen lds
    s_add_u32 m0, s32, 4096
    s_add_u32 s33, s31, 163840
    buffer_load_dwordx4 v5, s[12:15], s33 offen lds
    s_add_u32 m0, s32, 5120
    s_add_u32 s33, s31, 172032
    buffer_load_dwordx4 v5, s[12:15], s33 offen lds
    s_add_u32 m0, s32, 6144
    s_add_u32 s33, s31, 180224
    buffer_load_dwordx4 v5, s[12:15], s33 offen lds
    s_add_u32 m0, s32, 7168
    s_add_u32 s33, s31, 188416
    buffer_load_dwordx4 v5, s[12:15], s33 offen lds
    s_add_u32 m0, s32, 8192
    s_add_u32 s33, s28, 384
    buffer_load_dwordx4 v3, s[20:23], s33 offen lds
    s_add_u32 m0, s32, 9216
    s_add_u32 s33, s28, 29056
    buffer_load_dwordx4 v4, s[20:23], s33 offen lds
    s_add_u32 m0, s32, 10240
    s_add_u32 s33, s28, 57728
    buffer_load_dwordx4 v3, s[20:23], s33 offen lds
    s_add_u32 m0, s32, 11264
    s_add_u32 s33, s28, 86400
    buffer_load_dwordx4 v4, s[20:23], s33 offen lds
    s_add_u32 m0, s32, 12288
    s_add_u32 s33, s28, 115072
    buffer_load_dwordx4 v3, s[20:23], s33 offen lds
    s_add_u32 m0, s32, 13312
    s_add_u32 s33, s28, 143744
    buffer_load_dwordx4 v4, s[20:23], s33 offen lds
    s_add_u32 m0, s32, 14336
    s_add_u32 s33, s28, 172416
    buffer_load_dwordx4 v3, s[20:23], s33 offen lds
    s_add_u32 m0, s32, 15360
    s_add_u32 s33, s28, 201088
    buffer_load_dwordx4 v4, s[20:23], s33 offen lds
    s_waitcnt lgkmcnt(3)
    v_mfma_f32_32x32x16_bf16 v[64:79], v[128:131], v[136:139], v[64:79]
    ds_read_b64_tr_b16 v[144:145], v14 offset:26624
    ds_read_b64_tr_b16 v[146:147], v14 offset:27136
    s_waitcnt lgkmcnt(4)
    v_mfma_f32_32x32x16_bf16 v[80:95], v[128:131], v[140:143], v[80:95]
    ds_read_b128 v[152:155], v11 offset:16384
    ds_read_b128 v[156:159], v11 offset:20480
    s_waitcnt lgkmcnt(4)
    v_mfma_f32_32x32x16_bf16 v[96:111], v[132:135], v[136:139], v[96:111]
    ds_read_b64_tr_b16 v[148:149], v15 offset:26624
    ds_read_b64_tr_b16 v[150:151], v15 offset:27136
    v_mfma_f32_32x32x16_bf16 v[112:127], v[132:135], v[140:143], v[112:127]
    s_waitcnt lgkmcnt(3)
    v_mfma_f32_32x32x16_bf16 v[64:79], v[144:147], v[152:155], v[64:79]
    ds_read_b64_tr_b16 v[128:129], v14 offset:28672
    ds_read_b64_tr_b16 v[130:131], v14 offset:29184
    s_waitcnt lgkmcnt(4)
    v_mfma_f32_32x32x16_bf16 v[80:95], v[144:147], v[156:159], v[80:95]
    ds_read_b128 v[136:139], v12 offset:16384
    ds_read_b128 v[140:143], v12 offset:20480
    s_waitcnt lgkmcnt(4)
    v_mfma_f32_32x32x16_bf16 v[96:111], v[148:151], v[152:155], v[96:111]
    ds_read_b64_tr_b16 v[132:133], v15 offset:28672
    ds_read_b64_tr_b16 v[134:135], v15 offset:29184
    v_mfma_f32_32x32x16_bf16 v[112:127], v[148:151], v[156:159], v[112:127]
    s_waitcnt lgkmcnt(3)
    v_mfma_f32_32x32x16_bf16 v[64:79], v[128:131], v[136:139], v[64:79]
    ds_read_b64_tr_b16 v[144:145], v14 offset:30720
    ds_read_b64_tr_b16 v[146:147], v14 offset:31232
    s_waitcnt lgkmcnt(4)
    v_mfma_f32_32x32x16_bf16 v[80:95], v[128:131], v[140:143], v[80:95]
    ds_read_b128 v[152:155], v13 offset:16384
    ds_read_b128 v[156:159], v13 offset:20480
    s_waitcnt lgkmcnt(4)
    v_mfma_f32_32x32x16_bf16 v[96:111], v[132:135], v[136:139], v[96:111]
    ds_read_b64_tr_b16 v[148:149], v15 offset:30720
    ds_read_b64_tr_b16 v[150:151], v15 offset:31232
    v_mfma_f32_32x32x16_bf16 v[112:127], v[132:135], v[140:143], v[112:127]
    s_waitcnt lgkmcnt(3)
    v_mfma_f32_32x32x16_bf16 v[64:79], v[144:147], v[152:155], v[64:79]
    s_waitcnt lgkmcnt(2)
    v_mfma_f32_32x32x16_bf16 v[80:95], v[144:147], v[156:159], v[80:95]
    s_waitcnt vmcnt(8) lgkmcnt(0)
    ds_read_b64_tr_b16 v[128:129], v14 offset:0
    ds_read_b64_tr_b16 v[130:131], v14 offset:512
    ds_read_b128 v[136:139], v10 offset:32768
    ds_read_b128 v[140:143], v10 offset:36864
    v_mfma_f32_32x32x16_bf16 v[96:111], v[148:151], v[152:155], v[96:111]
    ds_read_b64_tr_b16 v[132:133], v15 offset:0
    ds_read_b64_tr_b16 v[134:135], v15 offset:512
    v_mfma_f32_32x32x16_bf16 v[112:127], v[148:151], v[156:159], v[112:127]
    s_add_u32 m0, s32, 16384
    s_add_u32 s33, s31, 196608
    buffer_load_dwordx4 v5, s[12:15], s33 offen lds
    s_add_u32 m0, s32, 17408
    s_add_u32 s33, s31, 204800
    buffer_load_dwordx4 v5, s[12:15], s33 offen lds
    s_add_u32 m0, s32, 18432
    s_add_u32 s33, s31, 212992
    buffer_load_dwordx4 v5, s[12:15], s33 offen lds
    s_add_u32 m0, s32, 19456
    s_add_u32 s33, s31, 221184
    buffer_load_dwordx4 v5, s[12:15], s33 offen lds
    s_add_u32 m0, s32, 20480
    s_add_u32 s33, s31, 229376
    buffer_load_dwordx4 v5, s[12:15], s33 offen lds
    s_add_u32 m0, s32, 21504
    s_add_u32 s33, s31, 237568
    buffer_load_dwordx4 v5, s[12:15], s33 offen lds
    s_add_u32 m0, s32, 22528
    s_add_u32 s33, s31, 245760
    buffer_load_dwordx4 v5, s[12:15], s33 offen lds
    s_add_u32 m0, s32, 23552
    s_add_u32 s33, s31, 253952
    buffer_load_dwordx4 v5, s[12:15], s33 offen lds
    s_add_u32 m0, s32, 24576
    s_add_u32 s33, s28, 512
    buffer_load_dwordx4 v3, s[20:23], s33 offen lds
    s_add_u32 m0, s32, 25600
    s_add_u32 s33, s28, 29184
    buffer_load_dwordx4 v4, s[20:23], s33 offen lds
    s_add_u32 m0, s32, 26624
    s_add_u32 s33, s28, 57856
    buffer_load_dwordx4 v3, s[20:23], s33 offen lds
    s_add_u32 m0, s32, 27648
    s_add_u32 s33, s28, 86528
    buffer_load_dwordx4 v4, s[20:23], s33 offen lds
    s_add_u32 m0, s32, 28672
    s_add_u32 s33, s28, 115200
    buffer_load_dwordx4 v3, s[20:23], s33 offen lds
    s_add_u32 m0, s32, 29696
    s_add_u32 s33, s28, 143872
    buffer_load_dwordx4 v4, s[20:23], s33 offen lds
    s_add_u32 m0, s32, 30720
    s_add_u32 s33, s28, 172544
    buffer_load_dwordx4 v3, s[20:23], s33 offen lds
    s_add_u32 m0, s32, 31744
    s_add_u32 s33, s28, 201216
    buffer_load_dwordx4 v4, s[20:23], s33 offen lds
    s_waitcnt lgkmcnt(3)
    v_mfma_f32_32x32x16_bf16 v[64:79], v[128:131], v[136:139], v[64:79]
    ds_read_b64_tr_b16 v[144:145], v14 offset:2048
    ds_read_b64_tr_b16 v[146:147], v14 offset:2560
    s_waitcnt lgkmcnt(4)
    v_mfma_f32_32x32x16_bf16 v[80:95], v[128:131], v[140:143], v[80:95]
    ds_read_b128 v[152:155], v11 offset:32768
    ds_read_b128 v[156:159], v11 offset:36864
    s_waitcnt lgkmcnt(4)
    v_mfma_f32_32x32x16_bf16 v[96:111], v[132:135], v[136:139], v[96:111]
    ds_read_b64_tr_b16 v[148:149], v15 offset:2048
    ds_read_b64_tr_b16 v[150:151], v15 offset:2560
    v_mfma_f32_32x32x16_bf16 v[112:127], v[132:135], v[140:143], v[112:127]
    s_waitcnt lgkmcnt(3)
    v_mfma_f32_32x32x16_bf16 v[64:79], v[144:147], v[152:155], v[64:79]
    ds_read_b64_tr_b16 v[128:129], v14 offset:4096
    ds_read_b64_tr_b16 v[130:131], v14 offset:4608
    s_waitcnt lgkmcnt(4)
    v_mfma_f32_32x32x16_bf16 v[80:95], v[144:147], v[156:159], v[80:95]
    ds_read_b128 v[136:139], v12 offset:32768
    ds_read_b128 v[140:143], v12 offset:36864
    s_waitcnt lgkmcnt(4)
    v_mfma_f32_32x32x16_bf16 v[96:111], v[148:151], v[152:155], v[96:111]
    ds_read_b64_tr_b16 v[132:133], v15 offset:4096
    ds_read_b64_tr_b16 v[134:135], v15 offset:4608
    v_mfma_f32_32x32x16_bf16 v[112:127], v[148:151], v[156:159], v[112:127]
    s_waitcnt lgkmcnt(3)
    v_mfma_f32_32x32x16_bf16 v[64:79], v[128:131], v[136:139], v[64:79]
    ds_read_b64_tr_b16 v[144:145], v14 offset:6144
    ds_read_b64_tr_b16 v[146:147], v14 offset:6656
    s_waitcnt lgkmcnt(4)
    v_mfma_f32_32x32x16_bf16 v[80:95], v[128:131], v[140:143], v[80:95]
    ds_read_b128 v[152:155], v13 offset:32768
    ds_read_b128 v[156:159], v13 offset:36864
    s_waitcnt lgkmcnt(4)
    v_mfma_f32_32x32x16_bf16 v[96:111], v[132:135], v[136:139], v[96:111]
    ds_read_b64_tr_b16 v[148:149], v15 offset:6144
    ds_read_b64_tr_b16 v[150:151], v15 offset:6656
    v_mfma_f32_32x32x16_bf16 v[112:127], v[132:135], v[140:143], v[112:127]
    s_waitcnt lgkmcnt(3)
    v_mfma_f32_32x32x16_bf16 v[64:79], v[144:147], v[152:155], v[64:79]
    s_waitcnt lgkmcnt(2)
    v_mfma_f32_32x32x16_bf16 v[80:95], v[144:147], v[156:159], v[80:95]
    s_waitcnt vmcnt(8) lgkmcnt(0)
    ds_read_b64_tr_b16 v[128:129], v14 offset:16384
    ds_read_b64_tr_b16 v[130:131], v14 offset:16896
    ds_read_b128 v[136:139], v10 offset:8192
    ds_read_b128 v[140:143], v10 offset:12288
    v_mfma_f32_32x32x16_bf16 v[96:111], v[148:151], v[152:155], v[96:111]
    ds_read_b64_tr_b16 v[132:133], v15 offset:16384
    ds_read_b64_tr_b16 v[134:135], v15 offset:16896
    v_mfma_f32_32x32x16_bf16 v[112:127], v[148:151], v[156:159], v[112:127]
    s_add_u32 m0, s32, 32768
    s_add_u32 s33, s31, 262144
    buffer_load_dwordx4 v5, s[12:15], s33 offen lds
    s_add_u32 m0, s32, 33792
    s_add_u32 s33, s31, 270336
    buffer_load_dwordx4 v5, s[12:15], s33 offen lds
    s_add_u32 m0, s32, 34816
    s_add_u32 s33, s31, 278528
    buffer_load_dwordx4 v5, s[12:15], s33 offen lds
    s_add_u32 m0, s32, 35840
    s_add_u32 s33, s31, 286720
    buffer_load_dwordx4 v5, s[12:15], s33 offen lds
    s_add_u32 m0, s32, 36864
    s_add_u32 s33, s31, 294912
    buffer_load_dwordx4 v5, s[12:15], s33 offen lds
    s_add_u32 m0, s32, 37888
    s_add_u32 s33, s31, 303104
    buffer_load_dwordx4 v5, s[12:15], s33 offen lds
    s_add_u32 m0, s32, 38912
    s_add_u32 s33, s31, 311296
    buffer_load_dwordx4 v5, s[12:15], s33 offen lds
    s_add_u32 m0, s32, 39936
    s_add_u32 s33, s31, 319488
    buffer_load_dwordx4 v5, s[12:15], s33 offen lds
    s_add_u32 m0, s32, 0
    s_add_u32 s33, s28, 640
    buffer_load_dwordx4 v3, s[20:23], s33 offen lds
    s_add_u32 m0, s32, 1024
    s_add_u32 s33, s28, 29312
    buffer_load_dwordx4 v4, s[20:23], s33 offen lds
    s_add_u32 m0, s32, 2048
    s_add_u32 s33, s28, 57984
    buffer_load_dwordx4 v3, s[20:23], s33 offen lds
    s_add_u32 m0, s32, 3072
    s_add_u32 s33, s28, 86656
    buffer_load_dwordx4 v4, s[20:23], s33 offen lds
    s_add_u32 m0, s32, 4096
    s_add_u32 s33, s28, 115328
    buffer_load_dwordx4 v3, s[20:23], s33 offen lds
    s_add_u32 m0, s32, 5120
    s_add_u32 s33, s28, 144000
    buffer_load_dwordx4 v4, s[20:23], s33 offen lds
    s_add_u32 m0, s32, 6144
    s_add_u32 s33, s28, 172672
    buffer_load_dwordx4 v3, s[20:23], s33 offen lds
    s_add_u32 m0, s32, 7168
    s_add_u32 s33, s28, 201344
    buffer_load_dwordx4 v4, s[20:23], s33 offen lds
    s_waitcnt lgkmcnt(3)
    v_mfma_f32_32x32x16_bf16 v[64:79], v[128:131], v[136:139], v[64:79]
    ds_read_b64_tr_b16 v[144:145], v14 offset:18432
    ds_read_b64_tr_b16 v[146:147], v14 offset:18944
    s_waitcnt lgkmcnt(4)
    v_mfma_f32_32x32x16_bf16 v[80:95], v[128:131], v[140:143], v[80:95]
    ds_read_b128 v[152:155], v11 offset:8192
    ds_read_b128 v[156:159], v11 offset:12288
    s_waitcnt lgkmcnt(4)
    v_mfma_f32_32x32x16_bf16 v[96:111], v[132:135], v[136:139], v[96:111]
    ds_read_b64_tr_b16 v[148:149], v15 offset:18432
    ds_read_b64_tr_b16 v[150:151], v15 offset:18944
    v_mfma_f32_32x32x16_bf16 v[112:127], v[132:135], v[140:143], v[112:127]
    s_waitcnt lgkmcnt(3)
    v_mfma_f32_32x32x16_bf16 v[64:79], v[144:147], v[152:155], v[64:79]
    ds_read_b64_tr_b16 v[128:129], v14 offset:20480
    ds_read_b64_tr_b16 v[130:131], v14 offset:20992
    s_waitcnt lgkmcnt(4)
    v_mfma_f32_32x32x16_bf16 v[80:95], v[144:147], v[156:159], v[80:95]
    ds_read_b128 v[136:139], v12 offset:8192
    ds_read_b128 v[140:143], v12 offset:12288
    s_waitcnt lgkmcnt(4)
    v_mfma_f32_32x32x16_bf16 v[96:111], v[148:151], v[152:155], v[96:111]
    ds_read_b64_tr_b16 v[132:133], v15 offset:20480
    ds_read_b64_tr_b16 v[134:135], v15 offset:20992
    v_mfma_f32_32x32x16_bf16 v[112:127], v[148:151], v[156:159], v[112:127]
    s_waitcnt lgkmcnt(3)
    v_mfma_f32_32x32x16_bf16 v[64:79], v[128:131], v[136:139], v[64:79]
    ds_read_b64_tr_b16 v[144:145], v14 offset:22528
    ds_read_b64_tr_b16 v[146:147], v14 offset:23040
    s_waitcnt lgkmcnt(4)
    v_mfma_f32_32x32x16_bf16 v[80:95], v[128:131], v[140:143], v[80:95]
    ds_read_b128 v[152:155], v13 offset:8192
    ds_read_b128 v[156:159], v13 offset:12288
    s_waitcnt lgkmcnt(4)
    v_mfma_f32_32x32x16_bf16 v[96:111], v[132:135], v[136:139], v[96:111]
    ds_read_b64_tr_b16 v[148:149], v15 offset:22528
    ds_read_b64_tr_b16 v[150:151], v15 offset:23040
    v_mfma_f32_32x32x16_bf16 v[112:127], v[132:135], v[140:143], v[112:127]
    s_waitcnt lgkmcnt(3)
    v_mfma_f32_32x32x16_bf16 v[64:79], v[144:147], v[152:155], v[64:79]
    s_waitcnt lgkmcnt(2)
    v_mfma_f32_32x32x16_bf16 v[80:95], v[144:147], v[156:159], v[80:95]
    s_waitcnt vmcnt(8) lgkmcnt(0)
    ds_read_b64_tr_b16 v[128:129], v14 offset:32768
    ds_read_b64_tr_b16 v[130:131], v14 offset:33280
    ds_read_b128 v[136:139], v10 offset:24576
    ds_read_b128 v[140:143], v10 offset:28672
    v_mfma_f32_32x32x16_bf16 v[96:111], v[148:151], v[152:155], v[96:111]
    ds_read_b64_tr_b16 v[132:133], v15 offset:32768
    ds_read_b64_tr_b16 v[134:135], v15 offset:33280
    v_mfma_f32_32x32x16_bf16 v[112:127], v[148:151], v[156:159], v[112:127]
    s_add_u32 m0, s32, 8192
    s_add_u32 s33, s31, 327680
    buffer_load_dwordx4 v5, s[12:15], s33 offen lds
    s_add_u32 m0, s32, 9216
    s_add_u32 s33, s31, 335872
    buffer_load_dwordx4 v5, s[12:15], s33 offen lds
    s_add_u32 m0, s32, 10240
    s_add_u32 s33, s31, 344064
    buffer_load_dwordx4 v5, s[12:15], s33 offen lds
    s_add_u32 m0, s32, 11264
    s_add_u32 s33, s31, 352256
    buffer_load_dwordx4 v5, s[12:15], s33 offen lds
    s_add_u32 m0, s32, 12288
    s_add_u32 s33, s31, 360448
    buffer_load_dwordx4 v5, s[12:15], s33 offen lds
    s_add_u32 m0, s32, 13312
    s_add_u32 s33, s31, 368640
    buffer_load_dwordx4 v5, s[12:15], s33 offen lds
    s_add_u32 m0, s32, 14336
    s_add_u32 s33, s31, 376832
    buffer_load_dwordx4 v5, s[12:15], s33 offen lds
    s_add_u32 m0, s32, 15360
    s_add_u32 s33, s31, 385024
    buffer_load_dwordx4 v5, s[12:15], s33 offen lds
    s_add_u32 m0, s32, 16384
    s_add_u32 s33, s28, 768
    buffer_load_dwordx4 v3, s[20:23], s33 offen lds
    s_add_u32 m0, s32, 17408
    s_add_u32 s33, s28, 29440
    buffer_load_dwordx4 v4, s[20:23], s33 offen lds
    s_add_u32 m0, s32, 18432
    s_add_u32 s33, s28, 58112
    buffer_load_dwordx4 v3, s[20:23], s33 offen lds
    s_add_u32 m0, s32, 19456
    s_add_u32 s33, s28, 86784
    buffer_load_dwordx4 v4, s[20:23], s33 offen lds
    s_add_u32 m0, s32, 20480
    s_add_u32 s33, s28, 115456
    buffer_load_dwordx4 v3, s[20:23], s33 offen lds
    s_add_u32 m0, s32, 21504
    s_add_u32 s33, s28, 144128
    buffer_load_dwordx4 v4, s[20:23], s33 offen lds
    s_add_u32 m0, s32, 22528
    s_add_u32 s33, s28, 172800
    buffer_load_dwordx4 v3, s[20:23], s33 offen lds
    s_add_u32 m0, s32, 23552
    s_add_u32 s33, s28, 201472
    buffer_load_dwordx4 v4, s[20:23], s33 offen lds
    s_waitcnt lgkmcnt(3)
    v_mfma_f32_32x32x16_bf16 v[64:79], v[128:131], v[136:139], v[64:79]
    ds_read_b64_tr_b16 v[144:145], v14 offset:34816
    ds_read_b64_tr_b16 v[146:147], v14 offset:35328
    s_waitcnt lgkmcnt(4)
    v_mfma_f32_32x32x16_bf16 v[80:95], v[128:131], v[140:143], v[80:95]
    ds_read_b128 v[152:155], v11 offset:24576
    ds_read_b128 v[156:159], v11 offset:28672
    s_waitcnt lgkmcnt(4)
    v_mfma_f32_32x32x16_bf16 v[96:111], v[132:135], v[136:139], v[96:111]
    ds_read_b64_tr_b16 v[148:149], v15 offset:34816
    ds_read_b64_tr_b16 v[150:151], v15 offset:35328
    v_mfma_f32_32x32x16_bf16 v[112:127], v[132:135], v[140:143], v[112:127]
    s_waitcnt lgkmcnt(3)
    v_mfma_f32_32x32x16_bf16 v[64:79], v[144:147], v[152:155], v[64:79]
    ds_read_b64_tr_b16 v[128:129], v14 offset:36864
    ds_read_b64_tr_b16 v[130:131], v14 offset:37376
    s_waitcnt lgkmcnt(4)
    v_mfma_f32_32x32x16_bf16 v[80:95], v[144:147], v[156:159], v[80:95]
    ds_read_b128 v[136:139], v12 offset:24576
    ds_read_b128 v[140:143], v12 offset:28672
    s_waitcnt lgkmcnt(4)
    v_mfma_f32_32x32x16_bf16 v[96:111], v[148:151], v[152:155], v[96:111]
    ds_read_b64_tr_b16 v[132:133], v15 offset:36864
    ds_read_b64_tr_b16 v[134:135], v15 offset:37376
    v_mfma_f32_32x32x16_bf16 v[112:127], v[148:151], v[156:159], v[112:127]
    s_waitcnt lgkmcnt(3)
    v_mfma_f32_32x32x16_bf16 v[64:79], v[128:131], v[136:139], v[64:79]
    ds_read_b64_tr_b16 v[144:145], v14 offset:38912
    ds_read_b64_tr_b16 v[146:147], v14 offset:39424
    s_waitcnt lgkmcnt(4)
    v_mfma_f32_32x32x16_bf16 v[80:95], v[128:131], v[140:143], v[80:95]
    ds_read_b128 v[152:155], v13 offset:24576
    ds_read_b128 v[156:159], v13 offset:28672
    s_waitcnt lgkmcnt(4)
    v_mfma_f32_32x32x16_bf16 v[96:111], v[132:135], v[136:139], v[96:111]
    ds_read_b64_tr_b16 v[148:149], v15 offset:38912
    ds_read_b64_tr_b16 v[150:151], v15 offset:39424
    v_mfma_f32_32x32x16_bf16 v[112:127], v[132:135], v[140:143], v[112:127]
    s_waitcnt lgkmcnt(3)
    v_mfma_f32_32x32x16_bf16 v[64:79], v[144:147], v[152:155], v[64:79]
    s_waitcnt lgkmcnt(2)
    v_mfma_f32_32x32x16_bf16 v[80:95], v[144:147], v[156:159], v[80:95]
    s_waitcnt vmcnt(8) lgkmcnt(0)
    ds_read_b64_tr_b16 v[128:129], v14 offset:8192
    ds_read_b64_tr_b16 v[130:131], v14 offset:8704
    ds_read_b128 v[136:139], v10 offset:0
    ds_read_b128 v[140:143], v10 offset:4096
    v_mfma_f32_32x32x16_bf16 v[96:111], v[148:151], v[152:155], v[96:111]
    ds_read_b64_tr_b16 v[132:133], v15 offset:8192
    ds_read_b64_tr_b16 v[134:135], v15 offset:8704
    v_mfma_f32_32x32x16_bf16 v[112:127], v[148:151], v[156:159], v[112:127]
    s_add_u32 m0, s32, 24576
    s_add_u32 s33, s31, 393216
    buffer_load_dwordx4 v5, s[12:15], s33 offen lds
    s_add_u32 m0, s32, 25600
    s_add_u32 s33, s31, 401408
    buffer_load_dwordx4 v5, s[12:15], s33 offen lds
    s_add_u32 m0, s32, 26624
    s_add_u32 s33, s31, 409600
    buffer_load_dwordx4 v5, s[12:15], s33 offen lds
    s_add_u32 m0, s32, 27648
    s_add_u32 s33, s31, 417792
    buffer_load_dwordx4 v5, s[12:15], s33 offen lds
    s_add_u32 m0, s32, 28672
    s_add_u32 s33, s31, 425984
    buffer_load_dwordx4 v5, s[12:15], s33 offen lds
    s_add_u32 m0, s32, 29696
    s_add_u32 s33, s31, 434176
    buffer_load_dwordx4 v5, s[12:15], s33 offen lds
    s_add_u32 m0, s32, 30720
    s_add_u32 s33, s31, 442368
    buffer_load_dwordx4 v5, s[12:15], s33 offen lds
    s_add_u32 m0, s32, 31744
    s_add_u32 s33, s31, 450560
    buffer_load_dwordx4 v5, s[12:15], s33 offen lds
    s_waitcnt lgkmcnt(3)
    v_mfma_f32_32x32x16_bf16 v[64:79], v[128:131], v[136:139], v[64:79]
    ds_read_b64_tr_b16 v[144:145], v14 offset:10240
    ds_read_b64_tr_b16 v[146:147], v14 offset:10752
    s_waitcnt lgkmcnt(4)
    v_mfma_f32_32x32x16_bf16 v[80:95], v[128:131], v[140:143], v[80:95]
    ds_read_b128 v[152:155], v11 offset:0
    ds_read_b128 v[156:159], v11 offset:4096
    s_waitcnt lgkmcnt(4)
    v_mfma_f32_32x32x16_bf16 v[96:111], v[132:135], v[136:139], v[96:111]
    ds_read_b64_tr_b16 v[148:149], v15 offset:10240
    ds_read_b64_tr_b16 v[150:151], v15 offset:10752
    v_mfma_f32_32x32x16_bf16 v[112:127], v[132:135], v[140:143], v[112:127]
    s_waitcnt lgkmcnt(3)
    v_mfma_f32_32x32x16_bf16 v[64:79], v[144:147], v[152:155], v[64:79]
    ds_read_b64_tr_b16 v[128:129], v14 offset:12288
    ds_read_b64_tr_b16 v[130:131], v14 offset:12800
    s_waitcnt lgkmcnt(4)
    v_mfma_f32_32x32x16_bf16 v[80:95], v[144:147], v[156:159], v[80:95]
    ds_read_b128 v[136:139], v12 offset:0
    ds_read_b128 v[140:143], v12 offset:4096
    s_waitcnt lgkmcnt(4)
    v_mfma_f32_32x32x16_bf16 v[96:111], v[148:151], v[152:155], v[96:111]
    ds_read_b64_tr_b16 v[132:133], v15 offset:12288
    ds_read_b64_tr_b16 v[134:135], v15 offset:12800
    v_mfma_f32_32x32x16_bf16 v[112:127], v[148:151], v[156:159], v[112:127]
    s_waitcnt lgkmcnt(3)
    v_mfma_f32_32x32x16_bf16 v[64:79], v[128:131], v[136:139], v[64:79]
    ds_read_b64_tr_b16 v[144:145], v14 offset:14336
    ds_read_b64_tr_b16 v[146:147], v14 offset:14848
    s_waitcnt lgkmcnt(4)
    v_mfma_f32_32x32x16_bf16 v[80:95], v[128:131], v[140:143], v[80:95]
    ds_read_b128 v[152:155], v13 offset:0
    ds_read_b128 v[156:159], v13 offset:4096
    s_waitcnt lgkmcnt(4)
    v_mfma_f32_32x32x16_bf16 v[96:111], v[132:135], v[136:139], v[96:111]
    ds_read_b64_tr_b16 v[148:149], v15 offset:14336
    ds_read_b64_tr_b16 v[150:151], v15 offset:14848
    v_mfma_f32_32x32x16_bf16 v[112:127], v[132:135], v[140:143], v[112:127]
    s_waitcnt lgkmcnt(3)
    v_mfma_f32_32x32x16_bf16 v[64:79], v[144:147], v[152:155], v[64:79]
    s_waitcnt lgkmcnt(2)
    v_mfma_f32_32x32x16_bf16 v[80:95], v[144:147], v[156:159], v[80:95]
    s_waitcnt vmcnt(0) lgkmcnt(0)
    ds_read_b64_tr_b16 v[128:129], v14 offset:24576
    ds_read_b64_tr_b16 v[130:131], v14 offset:25088
    ds_read_b128 v[136:139], v10 offset:16384
    ds_read_b128 v[140:143], v10 offset:20480
    v_mfma_f32_32x32x16_bf16 v[96:111], v[148:151], v[152:155], v[96:111]
    ds_read_b64_tr_b16 v[132:133], v15 offset:24576
    ds_read_b64_tr_b16 v[134:135], v15 offset:25088
    v_mfma_f32_32x32x16_bf16 v[112:127], v[148:151], v[156:159], v[112:127]
    s_waitcnt lgkmcnt(3)
    v_mfma_f32_32x32x16_bf16 v[64:79], v[128:131], v[136:139], v[64:79]
    ds_read_b64_tr_b16 v[144:145], v14 offset:26624
    ds_read_b64_tr_b16 v[146:147], v14 offset:27136
    s_waitcnt lgkmcnt(4)
    v_mfma_f32_32x32x16_bf16 v[80:95], v[128:131], v[140:143], v[80:95]
    ds_read_b128 v[152:155], v11 offset:16384
    ds_read_b128 v[156:159], v11 offset:20480
    s_waitcnt lgkmcnt(4)
    v_mfma_f32_32x32x16_bf16 v[96:111], v[132:135], v[136:139], v[96:111]
    ds_read_b64_tr_b16 v[148:149], v15 offset:26624
    ds_read_b64_tr_b16 v[150:151], v15 offset:27136
    v_mfma_f32_32x32x16_bf16 v[112:127], v[132:135], v[140:143], v[112:127]
    s_waitcnt lgkmcnt(3)
    v_mfma_f32_32x32x16_bf16 v[64:79], v[144:147], v[152:155], v[64:79]
    ds_read_b64_tr_b16 v[128:129], v14 offset:28672
    ds_read_b64_tr_b16 v[130:131], v14 offset:29184
    s_waitcnt lgkmcnt(4)
    v_mfma_f32_32x32x16_bf16 v[80:95], v[144:147], v[156:159], v[80:95]
    ds_read_b128 v[136:139], v12 offset:16384
    ds_read_b128 v[140:143], v12 offset:20480
    s_waitcnt lgkmcnt(4)
    v_mfma_f32_32x32x16_bf16 v[96:111], v[148:151], v[152:155], v[96:111]
    ds_read_b64_tr_b16 v[132:133], v15 offset:28672
    ds_read_b64_tr_b16 v[134:135], v15 offset:29184
    v_mfma_f32_32x32x16_bf16 v[112:127], v[148:151], v[156:159], v[112:127]
    s_waitcnt lgkmcnt(3)
    v_mfma_f32_32x32x16_bf16 v[64:79], v[128:131], v[136:139], v[64:79]
    ds_read_b64_tr_b16 v[144:145], v14 offset:30720
    ds_read_b64_tr_b16 v[146:147], v14 offset:31232
    s_waitcnt lgkmcnt(4)
    v_mfma_f32_32x32x16_bf16 v[80:95], v[128:131], v[140:143], v[80:95]
    ds_read_b128 v[152:155], v13 offset:16384
    ds_read_b128 v[156:159], v13 offset:20480
    s_waitcnt lgkmcnt(4)
    v_mfma_f32_32x32x16_bf16 v[96:111], v[132:135], v[136:139], v[96:111]
    ds_read_b64_tr_b16 v[148:149], v15 offset:30720
    ds_read_b64_tr_b16 v[150:151], v15 offset:31232
    v_mfma_f32_32x32x16_bf16 v[112:127], v[132:135], v[140:143], v[112:127]
    s_waitcnt lgkmcnt(3)
    v_mfma_f32_32x32x16_bf16 v[64:79], v[144:147], v[152:155], v[64:79]
    s_waitcnt lgkmcnt(2)
    v_mfma_f32_32x32x16_bf16 v[80:95], v[144:147], v[156:159], v[80:95]
    s_waitcnt lgkmcnt(0)
    v_mfma_f32_32x32x16_bf16 v[96:111], v[148:151], v[152:155], v[96:111]
    v_mfma_f32_32x32x16_bf16 v[112:127], v[148:151], v[156:159], v[112:127]
    v_mov_b32 v6, v28
    v_and_b32 v7, 7, v1
    s_barrier
    s_mul_i32 s37, s3, 17408
    v_and_b32 v9, 31, v1
    v_mul_u32_u24 v9, 272, v9
    v_lshrrev_b32 v10, 5, v1
    v_lshl_add_u32 v9, v10, 4, v9
    v_add_u32 v9, s37, v9
    s_nop 7
    ds_write_b128 v9, v[64:67] offset:0
    ds_write_b128 v9, v[68:71] offset:32
    ds_write_b128 v9, v[72:75] offset:64
    ds_write_b128 v9, v[76:79] offset:96
    ds_write_b128 v9, v[80:83] offset:8704
    ds_write_b128 v9, v[84:87] offset:8736
    ds_write_b128 v9, v[88:91] offset:8768
    ds_write_b128 v9, v[92:95] offset:8800
    ds_write_b128 v9, v[96:99] offset:128
    ds_write_b128 v9, v[100:103] offset:160
    ds_write_b128 v9, v[104:107] offset:192
    ds_write_b128 v9, v[108:111] offset:224
    ds_write_b128 v9, v[112:115] offset:8832
    ds_write_b128 v9, v[116:119] offset:8864
    ds_write_b128 v9, v[120:123] offset:8896
    ds_write_b128 v9, v[124:127] offset:8928
    s_waitcnt lgkmcnt(0)
    s_barrier
    v_lshrrev_b32 v9, 3, v1
    v_mul_u32_u24 v9, 272, v9
    v_lshl_add_u32 v9, v7, 5, v9
    s_mul_i32 s37, s3, 4352
    v_add_u32 v9, s37, v9
    ds_read_b128 v[64:67], v9 offset:0
    ds_read_b128 v[68:71], v9 offset:16
    ds_read_b128 v[72:75], v9 offset:17408
    ds_read_b128 v[76:79], v9 offset:17424
    ds_read_b128 v[80:83], v9 offset:34816
    ds_read_b128 v[84:87], v9 offset:34832
    ds_read_b128 v[88:91], v9 offset:52224
    ds_read_b128 v[92:95], v9 offset:52240
    ds_read_b128 v[96:99], v9 offset:2176
    ds_read_b128 v[100:103], v9 offset:2192
    ds_read_b128 v[104:107], v9 offset:19584
    ds_read_b128 v[108:111], v9 offset:19600
    ds_read_b128 v[112:115], v9 offset:36992
    ds_read_b128 v[116:119], v9 offset:37008
    ds_read_b128 v[120:123], v9 offset:54400
    ds_read_b128 v[124:127], v9 offset:54416
    s_waitcnt vmcnt(0)
    v_lshlrev_b32 v28, 16, v24
    v_and_b32 v29, 0xffff0000, v24
    v_lshlrev_b32 v30, 16, v25
    v_and_b32 v31, 0xffff0000, v25
    v_lshlrev_b32 v32, 16, v26
    v_and_b32 v33, 0xffff0000, v26
    v_lshlrev_b32 v34, 16, v27
    v_and_b32 v35, 0xffff0000, v27
    s_waitcnt lgkmcnt(0)
    v_pk_add_f32 v[64:65], v[64:65], v[72:73]
    v_pk_add_f32 v[80:81], v[80:81], v[88:89]
    v_pk_add_f32 v[66:67], v[66:67], v[74:75]
    v_pk_add_f32 v[82:83], v[82:83], v[90:91]
    v_pk_add_f32 v[68:69], v[68:69], v[76:77]
    v_pk_add_f32 v[84:85], v[84:85], v[92:93]
    v_pk_add_f32 v[70:71], v[70:71], v[78:79]
    v_pk_add_f32 v[86:87], v[86:87], v[94:95]
    v_pk_add_f32 v[64:65], v[64:65], v[80:81]
    v_pk_add_f32 v[66:67], v[66:67], v[82:83]
    v_pk_add_f32 v[68:69], v[68:69], v[84:85]
    v_pk_add_f32 v[70:71], v[70:71], v[86:87]
    v_cvt_pk_bf16_f32 v36, v64, v65
    v_lshlrev_b32 v64, 16, v36
    v_and_b32 v65, 0xffff0000, v36
    v_cvt_pk_bf16_f32 v37, v66, v67
    v_lshlrev_b32 v66, 16, v37
    v_and_b32 v67, 0xffff0000, v37
    v_cvt_pk_bf16_f32 v38, v68, v69
    v_lshlrev_b32 v68, 16, v38
    v_and_b32 v69, 0xffff0000, v38
    v_cvt_pk_bf16_f32 v39, v70, v71
    v_lshlrev_b32 v70, 16, v39
    v_and_b32 v71, 0xffff0000, v39
    v_pk_add_f32 v[64:65], v[64:65], v[28:29]
    v_pk_add_f32 v[66:67], v[66:67], v[30:31]
    v_pk_add_f32 v[68:69], v[68:69], v[32:33]
    v_pk_add_f32 v[70:71], v[70:71], v[34:35]
    v_cvt_pk_bf16_f32 v36, v64, v65
    v_lshlrev_b32 v64, 16, v36
    v_and_b32 v65, 0xffff0000, v36
    v_cvt_pk_bf16_f32 v37, v66, v67
    v_lshlrev_b32 v66, 16, v37
    v_and_b32 v67, 0xffff0000, v37
    v_cvt_pk_bf16_f32 v38, v68, v69
    v_lshlrev_b32 v68, 16, v38
    v_and_b32 v69, 0xffff0000, v38
    v_cvt_pk_bf16_f32 v39, v70, v71
    v_lshlrev_b32 v70, 16, v39
    v_and_b32 v71, 0xffff0000, v39
    v_lshlrev_b32 v72, 16, v16
    v_and_b32 v73, 0xffff0000, v16
    v_lshlrev_b32 v74, 16, v17
    v_and_b32 v75, 0xffff0000, v17
    v_lshlrev_b32 v76, 16, v18
    v_and_b32 v77, 0xffff0000, v18
    v_lshlrev_b32 v78, 16, v19
    v_and_b32 v79, 0xffff0000, v19
    v_pk_add_f32 v[64:65], v[64:65], v[72:73]
    v_pk_add_f32 v[66:67], v[66:67], v[74:75]
    v_pk_add_f32 v[68:69], v[68:69], v[76:77]
    v_pk_add_f32 v[70:71], v[70:71], v[78:79]
    v_cvt_pk_bf16_f32 v40, v64, v65
    v_cvt_pk_bf16_f32 v41, v66, v67
    v_cvt_pk_bf16_f32 v42, v68, v69
    v_cvt_pk_bf16_f32 v43, v70, v71
    v_pk_add_f32 v[96:97], v[96:97], v[104:105]
    v_pk_add_f32 v[112:113], v[112:113], v[120:121]
    v_pk_add_f32 v[98:99], v[98:99], v[106:107]
    v_pk_add_f32 v[114:115], v[114:115], v[122:123]
    v_pk_add_f32 v[100:101], v[100:101], v[108:109]
    v_pk_add_f32 v[116:117], v[116:117], v[124:125]
    v_pk_add_f32 v[102:103], v[102:103], v[110:111]
    v_pk_add_f32 v[118:119], v[118:119], v[126:127]
    v_pk_add_f32 v[96:97], v[96:97], v[112:113]
    v_pk_add_f32 v[98:99], v[98:99], v[114:115]
    v_pk_add_f32 v[100:101], v[100:101], v[116:117]
    v_pk_add_f32 v[102:103], v[102:103], v[118:119]
    v_cvt_pk_bf16_f32 v36, v96, v97
    v_lshlrev_b32 v96, 16, v36
    v_and_b32 v97, 0xffff0000, v36
    v_cvt_pk_bf16_f32 v37, v98, v99
    v_lshlrev_b32 v98, 16, v37
    v_and_b32 v99, 0xffff0000, v37
    v_cvt_pk_bf16_f32 v38, v100, v101
    v_lshlrev_b32 v100, 16, v38
    v_and_b32 v101, 0xffff0000, v38
    v_cvt_pk_bf16_f32 v39, v102, v103
    v_lshlrev_b32 v102, 16, v39
    v_and_b32 v103, 0xffff0000, v39
    v_pk_add_f32 v[96:97], v[96:97], v[28:29]
    v_pk_add_f32 v[98:99], v[98:99], v[30:31]
    v_pk_add_f32 v[100:101], v[100:101], v[32:33]
    v_pk_add_f32 v[102:103], v[102:103], v[34:35]
    v_cvt_pk_bf16_f32 v36, v96, v97
    v_lshlrev_b32 v96, 16, v36
    v_and_b32 v97, 0xffff0000, v36
    v_cvt_pk_bf16_f32 v37, v98, v99
    v_lshlrev_b32 v98, 16, v37
    v_and_b32 v99, 0xffff0000, v37
    v_cvt_pk_bf16_f32 v38, v100, v101
    v_lshlrev_b32 v100, 16, v38
    v_and_b32 v101, 0xffff0000, v38
    v_cvt_pk_bf16_f32 v39, v102, v103
    v_lshlrev_b32 v102, 16, v39
    v_and_b32 v103, 0xffff0000, v39
    v_lshlrev_b32 v104, 16, v20
    v_and_b32 v105, 0xffff0000, v20
    v_lshlrev_b32 v106, 16, v21
    v_and_b32 v107, 0xffff0000, v21
    v_lshlrev_b32 v108, 16, v22
    v_and_b32 v109, 0xffff0000, v22
    v_lshlrev_b32 v110, 16, v23
    v_and_b32 v111, 0xffff0000, v23
    v_pk_add_f32 v[96:97], v[96:97], v[104:105]
    v_pk_add_f32 v[98:99], v[98:99], v[106:107]
    v_pk_add_f32 v[100:101], v[100:101], v[108:109]
    v_pk_add_f32 v[102:103], v[102:103], v[110:111]
    v_cvt_pk_bf16_f32 v44, v96, v97
    v_cvt_pk_bf16_f32 v45, v98, v99
    v_cvt_pk_bf16_f32 v46, v100, v101
    v_cvt_pk_bf16_f32 v47, v102, v103
    buffer_store_dwordx4 v[40:43], v6, s[44:47], s34 offen sc1
    buffer_store_dwordx4 v[44:47], v6, s[44:47], s36 offen sc1
    s_branch Ljoin_42
Lskip_41:
    s_barrier
    s_barrier
    s_barrier
Ljoin_42:
    s_waitcnt vmcnt(0)
    s_barrier
    s_cmp_lg_u32 s3, 0
    s_cbranch_scc1 Lpub_46
    s_lshl_b32 s92, s10, 8
    s_add_u32 s92, s92, 8192
    v_mov_b32 v158, 1
    v_mov_b32 v159, 0
    s_mov_b64 exec, 1
    buffer_atomic_add v158, v159, s[96:99], s92 offen sc1
    s_mov_b64 exec, -1
Lpub_46:
    s_cmp_ge_u32 s3, 4
    s_cbranch_scc1 Lskip_47
    s_getpc_b64 s[16:17]
Lpc_51:
    s_add_u32 s16, s16, tab_tw2048a-Lpc_51
    s_addc_u32 s17, s17, 0
    s_and_b32 s17, s17, 0xffff
    s_mov_b32 s18, 0x800
    s_mov_b32 s19, 0x00020000
    s_mov_b32 s20, 0x3f3504f3
    s_mov_b32 s21, s20
    s_mov_b32 s22, 0x3b000000
    s_mov_b32 s23, s22
    s_waitcnt lgkmcnt(0)
    s_mov_b64 s[4:5], s[84:85]
    s_mov_b64 s[6:7], s[84:85]
    s_add_u32 s8, s4, 0x1140000
    s_addc_u32 s9, s5, 0
    s_and_b32 s9, s9, 0xffff
    s_mov_b32 s10, 0x200000
    s_mov_b32 s11, 0x00020000
    s_mov_b32 s12, s6
    s_and_b32 s13, s7, 0xffff
    s_mov_b32 s14, 0x10000000
    s_mov_b32 s15, 0x00020000
    s_lshl_b32 s28, s2, 13
    s_lshl_b32 s29, s3, 11
    s_add_u32 s28, s28, s29
    v_lshlrev_b32 v3, 4, v1
    v_add_u32 v3, s28, v3
    s_cmp_lg_u32 s3, 0
    s_cbranch_scc1 Lpd_52
    s_lshr_b32 s92, s2, 3
    s_lshl_b32 s92, s92, 8
    s_add_u32 s92, s92, 8192
    v_mov_b32 v159, 0
    s_mov_b32 s93, 0
Lpl_53:
    v_mov_b32 v158, 0
    s_mov_b64 exec, 1
    buffer_atomic_add v158, v159, s[96:99], s92 offen sc0 sc1
    s_mov_b64 exec, -1
    s_waitcnt vmcnt(0)
    v_readfirstlane_b32 s94, v158
    s_add_u32 s93, s93, 1
    s_cmp_ge_u32 s94, 8
    s_cbranch_scc1 Lpd_52
    s_cmp_gt_u32 s93, 0x40000
    s_cbranch_scc1 Lpd_52
    s_sleep 2
    s_branch Lpl_53
Lpd_52:
    v_lshlrev_b32 v4, 5, v1
    buffer_load_dwordx2 v[52:53], v4, s[16:19], 0 offen
    v_and_b32 v5, 7, v1
    v_lshlrev_b32 v5, 8, v5
    buffer_load_dwordx2 v[68:69], v5, s[16:19], 0 offen
    s_barrier
    buffer_load_dwordx4 v[42:45], v3, s[8:11], 0 offen sc1
    buffer_load_dwordx4 v[46:49], v3, s[8:11], 0 offen offset:1024 sc1
    s_mul_i32 s30, s3, 4768
    v_lshlrev_b32 v96, 3, v1
    v_add_u32 v96, s30, v96
    v_lshrrev_b32 v86, 3, v1
    v_mul_u32_u24 v97, 72, v86
    v_and_b32 v87, 7, v1
    v_add_u32 v97, v97, v87
    v_lshlrev_b32 v97, 3, v97
    v_add_u32 v97, s30, v97
    v_mul_u32_u24 v98, 66, v87
    v_add_u32 v98, v98, v86
    v_lshlrev_b32 v98, 3, v98
    v_add_u32 v98, s30, v98
    v_lshrrev_b32 v86, 1, v1
    v_lshlrev_b32 v87, 6, v1
    v_add_u32 v87, s30, v87
    v_add_u32 v88, 0, v86
    v_and_b32 v88, 3, v88
    v_lshlrev_b32 v88, 4, v88
    v_add_u32 v102, v87, v88
    v_add_u32 v88, 1, v86
    v_and_b32 v88, 3, v88
    v_lshlrev_b32 v88, 4, v88
    v_add_u32 v103, v87, v88
    v_add_u32 v88, 2, v86
    v_and_b32 v88, 3, v88
    v_lshlrev_b32 v88, 4, v88
    v_add_u32 v104, v87, v88
    v_add_u32 v88, 3, v86
    v_and_b32 v88, 3, v88
    v_lshlrev_b32 v88, 4, v88
    v_add_u32 v105, v87, v88
    v_lshrrev_b32 v86, 3, v1
    v_lshlrev_b32 v86, 6, v86
    v_bfe_u32 v87, v1, 1, 2
    v_lshrrev_b32 v88, 4, v1
    v_add_u32 v87, v87, v88
    v_and_b32 v87, 3, v87
    v_lshlrev_b32 v87, 4, v87
    v_and_b32 v88, 1, v1
    v_lshlrev_b32 v88, 3, v88
    v_add3_u32 v101, v86, v87, v88
    v_add_u32 v101, s30, v101
    s_waitcnt vmcnt(0)
    v_pk_mul_f32 v[26:27], v[52:53], v[52:53] op_sel_hi:[1,0]
    v_pk_fma_f32 v[54:55], v[52:53], v[52:53], v[26:27] op_sel:[1,1,0] op_sel_hi:[0,1,1] neg_lo:[1,0,0]
    v_pk_mul_f32 v[28:29], v[54:55], v[52:53] op_sel_hi:[1,0]
    v_pk_fma_f32 v[56:57], v[54:55], v[52:53], v[28:29] op_sel:[1,1,0] op_sel_hi:[0,1,1] neg_lo:[1,0,0]
    v_pk_mul_f32 v[26:27], v[54:55], v[54:55] op_sel_hi:[1,0]
    v_pk_fma_f32 v[58:59], v[54:55], v[54:55], v[26:27] op_sel:[1,1,0] op_sel_hi:[0,1,1] neg_lo:[1,0,0]
    v_pk_mul_f32 v[28:29], v[58:59], v[52:53] op_sel_hi:[1,0]
    v_pk_fma_f32 v[60:61], v[58:59], v[52:53], v[28:29] op_sel:[1,1,0] op_sel_hi:[0,1,1] neg_lo:[1,0,0]
    v_pk_mul_f32 v[26:27], v[56:57], v[56:57] op_sel_hi:[1,0]
    v_pk_fma_f32 v[62:63], v[56:57], v[56:57], v[26:27] op_sel:[1,1,0] op_sel_hi:[0,1,1] neg_lo:[1,0,0]
    v_pk_mul_f32 v[28:29], v[58:59], v[56:57] op_sel_hi:[1,0]
    v_pk_fma_f32 v[64:65], v[58:59], v[56:57], v[28:29] op_sel:[1,1,0] op_sel_hi:[0,1,1] neg_lo:[1,0,0]
    v_pk_mul_f32 v[26:27], v[68:69], v[68:69] op_sel_hi:[1,0]
    v_pk_fma_f32 v[70:71], v[68:69], v[68:69], v[26:27] op_sel:[1,1,0] op_sel_hi:[0,1,1] neg_lo:[1,0,0]
    v_pk_mul_f32 v[28:29], v[70:71], v[68:69] op_sel_hi:[1,0]
    v_pk_fma_f32 v[72:73], v[70:71], v[68:69], v[28:29] op_sel:[1,1,0] op_sel_hi:[0,1,1] neg_lo:[1,0,0]
    v_pk_mul_f32 v[26:27], v[70:71], v[70:71] op_sel_hi:[1,0]
    v_pk_fma_f32 v[74:75], v[70:71], v[70:71], v[26:27] op_sel:[1,1,0] op_sel_hi:[0,1,1] neg_lo:[1,0,0]
    v_pk_mul_f32 v[28:29], v[74:75], v[68:69] op_sel_hi:[1,0]
    v_pk_fma_f32 v[76:77], v[74:75], v[68:69], v[28:29] op_sel:[1,1,0] op_sel_hi:[0,1,1] neg_lo:[1,0,0]
    v_pk_mul_f32 v[26:27], v[72:73], v[72:73] op_sel_hi:[1,0]
    v_pk_fma_f32 v[78:79], v[72:73], v[72:73], v[26:27] op_sel:[1,1,0] op_sel_hi:[0,1,1] neg_lo:[1,0,0]
    v_pk_mul_f32 v[28:29], v[74:75], v[72:73] op_sel_hi:[1,0]
    v_pk_fma_f32 v[80:81], v[74:75], v[72:73], v[28:29] op_sel:[1,1,0] op_sel_hi:[0,1,1] neg_lo:[1,0,0]
    v_lshlrev_b32 v10, 16, v42
    v_lshlrev_b32 v11, 16, v46
    v_and_b32 v12, 0xffff0000, v42
    v_and_b32 v13, 0xffff0000, v46
    v_lshlrev_b32 v14, 16, v43
    v_lshlrev_b32 v15, 16, v47
    v_and_b32 v16, 0xffff0000, v43
    v_and_b32 v17, 0xffff0000, v47
    v_lshlrev_b32 v18, 16, v44
    v_lshlrev_b32 v19, 16, v48
    v_and_b32 v20, 0xffff0000, v44
    v_and_b32 v21, 0xffff0000, v48
    v_lshlrev_b32 v22, 16, v45
    v_lshlrev_b32 v23, 16, v49
    v_and_b32 v24, 0xffff0000, v45
    v_and_b32 v25, 0xffff0000, v49
    v_readfirstlane_b32 s48, v10
    v_readfirstlane_b32 s49, v11
    s_nop 0
    v_pk_add_f32 v[86:87], v[10:11], s[48:49] neg_lo:[0,1] neg_hi:[0,1]
    v_pk_mul_f32 v[84:85], v[86:87], v[86:87]
    v_pk_add_f32 v[88:89], v[12:13], s[48:49] neg_lo:[0,1] neg_hi:[0,1]
    v_pk_fma_f32 v[84:85], v[88:89], v[88:89], v[84:85]
    v_pk_add_f32 v[82:83], v[86:87], v[88:89]
    v_pk_add_f32 v[86:87], v[14:15], s[48:49] neg_lo:[0,1] neg_hi:[0,1]
    v_pk_fma_f32 v[84:85], v[86:87], v[86:87], v[84:85]
    v_pk_add_f32 v[82:83], v[82:83], v[86:87]
    v_pk_add_f32 v[88:89], v[16:17], s[48:49] neg_lo:[0,1] neg_hi:[0,1]
    v_pk_fma_f32 v[84:85], v[88:89], v[88:89], v[84:85]
    v_pk_add_f32 v[82:83], v[82:83], v[88:89]
    v_pk_add_f32 v[86:87], v[18:19], s[48:49] neg_lo:[0,1] neg_hi:[0,1]
    v_pk_fma_f32 v[84:85], v[86:87], v[86:87], v[84:85]
    v_pk_add_f32 v[82:83], v[82:83], v[86:87]
    v_pk_add_f32 v[88:89], v[20:21], s[48:49] neg_lo:[0,1] neg_hi:[0,1]
    v_pk_fma_f32 v[84:85], v[88:89], v[88:89], v[84:85]
    v_pk_add_f32 v[82:83], v[82:83], v[88:89]
    v_pk_add_f32 v[86:87], v[22:23], s[48:49] neg_lo:[0,1] neg_hi:[0,1]
    v_pk_fma_f32 v[84:85], v[86:87], v[86:87], v[84:85]
    v_pk_add_f32 v[82:83], v[82:83], v[86:87]
    v_pk_add_f32 v[88:89], v[24:25], s[48:49] neg_lo:[0,1] neg_hi:[0,1]
    v_pk_fma_f32 v[84:85], v[88:89], v[88:89], v[84:85]
    v_pk_add_f32 v[82:83], v[82:83], v[88:89]
    v_pk_mul_f32 v[82:83], v[82:83], s[22:23]
    v_pk_mul_f32 v[84:85], v[84:85], s[22:23]
    s_nop 1
    v_add_f32_dpp v82, v82, v82 row_shr:1 row_mask:0xf bank_mask:0xf bound_ctrl:0
    v_add_f32_dpp v83, v83, v83 row_shr:1 row_mask:0xf bank_mask:0xf bound_ctrl:0
    v_add_f32_dpp v84, v84, v84 row_shr:1 row_mask:0xf bank_mask:0xf bound_ctrl:0
    v_add_f32_dpp v85, v85, v85 row_shr:1 row_mask:0xf bank_mask:0xf bound_ctrl:0
    v_add_f32_dpp v82, v82, v82 row_shr:2 row_mask:0xf bank_mask:0xf bound_ctrl:0
    v_add_f32_dpp v83, v83, v83 row_shr:2 row_mask:0xf bank_mask:0xf bound_ctrl:0
    v_add_f32_dpp v84, v84, v84 row_shr:2 row_mask:0xf bank_mask:0xf bound_ctrl:0
    v_add_f32_dpp v85, v85, v85 row_shr:2 row_mask:0xf bank_mask:0xf bound_ctrl:0
    v_add_f32_dpp v82, v82, v82 row_shr:4 row_mask:0xf bank_mask:0xf bound_ctrl:0
    v_add_f32_dpp v83, v83, v83 row_shr:4 row_mask:0xf bank_mask:0xf bound_ctrl:0
    v_add_f32_dpp v84, v84, v84 row_shr:4 row_mask:0xf bank_mask:0xf bound_ctrl:0
    v_add_f32_dpp v85, v85, v85 row_shr:4 row_mask:0xf bank_mask:0xf bound_ctrl:0
    v_add_f32_dpp v82, v82, v82 row_shr:8 row_mask:0xf bank_mask:0xf bound_ctrl:0
    v_add_f32_dpp v83, v83, v83 row_shr:8 row_mask:0xf bank_mask:0xf bound_ctrl:0
    v_add_f32_dpp v84, v84, v84 row_shr:8 row_mask:0xf bank_mask:0xf bound_ctrl:0
    v_add_f32_dpp v85, v85, v85 row_shr:8 row_mask:0xf bank_mask:0xf bound_ctrl:0
    v_add_f32_dpp v82, v82, v82 row_bcast:15 row_mask:0xa bank_mask:0xf
    v_add_f32_dpp v83, v83, v83 row_bcast:15 row_mask:0xa bank_mask:0xf
    v_add_f32_dpp v84, v84, v84 row_bcast:15 row_mask:0xa bank_mask:0xf
    v_add_f32_dpp v85, v85, v85 row_bcast:15 row_mask:0xa bank_mask:0xf
    v_add_f32_dpp v82, v82, v82 row_bcast:31 row_mask:0xc bank_mask:0xf
    v_add_f32_dpp v83, v83, v83 row_bcast:31 row_mask:0xc bank_mask:0xf
    v_add_f32_dpp v84, v84, v84 row_bcast:31 row_mask:0xc bank_mask:0xf
    v_add_f32_dpp v85, v85, v85 row_bcast:31 row_mask:0xc bank_mask:0xf
    s_nop 0
    v_readlane_b32 s44, v82, 63
    v_readlane_b32 s45, v83, 63
    v_readlane_b32 s46, v84, 63
    v_readlane_b32 s47, v85, 63
    s_nop 1
    v_mov_b32 v82, s44
    v_mov_b32 v83, s45
    v_mov_b32 v84, s46
    v_mov_b32 v85, s47
    v_pk_fma_f32 v[84:85], v[82:83], v[82:83], v[84:85] neg_lo:[1,0,0] neg_hi:[1,0,0]
    v_max_f32 v84, 0, v84
    v_max_f32 v85, 0, v85
    v_pk_add_f32 v[82:83], v[82:83], s[48:49]
    v_cvt_pk_bf16_f32 v90, v82, v83
    v_lshlrev_b32 v82, 16, v90
    v_and_b32 v83, 0xffff0000, v90
    v_cvt_pk_bf16_f32 v91, v84, v85
    v_lshlrev_b32 v84, 16, v91
    v_and_b32 v85, 0xffff0000, v91
    v_add_f32 v84, 0x3727c5ac, v84
    v_add_f32 v85, 0x3727c5ac, v85
    v_cvt_pk_bf16_f32 v91, v84, v85
    v_lshlrev_b32 v84, 16, v91
    v_and_b32 v85, 0xffff0000, v91
    v_sqrt_f32 v84, v84
    v_sqrt_f32 v85, v85
    v_pk_add_f32 v[10:11], v[10:11], v[82:83] neg_lo:[0,1] neg_hi:[0,1]
    v_pk_add_f32 v[12:13], v[12:13], v[82:83] neg_lo:[0,1] neg_hi:[0,1]
    v_pk_add_f32 v[14:15], v[14:15], v[82:83] neg_lo:[0,1] neg_hi:[0,1]
    v_pk_add_f32 v[16:17], v[16:17], v[82:83] neg_lo:[0,1] neg_hi:[0,1]
    v_pk_add_f32 v[18:19], v[18:19], v[82:83] neg_lo:[0,1] neg_hi:[0,1]
    v_pk_add_f32 v[20:21], v[20:21], v[82:83] neg_lo:[0,1] neg_hi:[0,1]
    v_pk_add_f32 v[22:23], v[22:23], v[82:83] neg_lo:[0,1] neg_hi:[0,1]
    v_pk_add_f32 v[24:25], v[24:25], v[82:83] neg_lo:[0,1] neg_hi:[0,1]
    v_cvt_pk_bf16_f32 v94, v84, v85
    v_lshlrev_b32 v84, 16, v94
    v_and_b32 v85, 0xffff0000, v94
    v_rcp_f32 v84, v84
    v_rcp_f32 v85, v85
    v_cvt_pk_bf16_f32 v86, v10, v11
    v_cvt_pk_bf16_f32 v87, v12, v13
    v_cvt_pk_bf16_f32 v88, v14, v15
    v_cvt_pk_bf16_f32 v89, v16, v17
    v_cvt_pk_bf16_f32 v90, v18, v19
    v_cvt_pk_bf16_f32 v91, v20, v21
    v_cvt_pk_bf16_f32 v92, v22, v23
    v_cvt_pk_bf16_f32 v93, v24, v25
    v_lshlrev_b32 v10, 16, v86
    v_and_b32 v11, 0xffff0000, v86
    v_lshlrev_b32 v12, 16, v87
    v_and_b32 v13, 0xffff0000, v87
    v_lshlrev_b32 v14, 16, v88
    v_and_b32 v15, 0xffff0000, v88
    v_lshlrev_b32 v16, 16, v89
    v_and_b32 v17, 0xffff0000, v89
    v_lshlrev_b32 v18, 16, v90
    v_and_b32 v19, 0xffff0000, v90
    v_lshlrev_b32 v20, 16, v91
    v_and_b32 v21, 0xffff0000, v91
    v_lshlrev_b32 v22, 16, v92
    v_and_b32 v23, 0xffff0000, v92
    v_lshlrev_b32 v24, 16, v93
    v_and_b32 v25, 0xffff0000, v93
    v_pk_mul_f32 v[10:11], v[10:11], v[84:85]
    v_pk_mul_f32 v[12:13], v[12:13], v[84:85]
    v_pk_mul_f32 v[14:15], v[14:15], v[84:85]
    v_pk_mul_f32 v[16:17], v[16:17], v[84:85]
    v_pk_mul_f32 v[18:19], v[18:19], v[84:85]
    v_pk_mul_f32 v[20:21], v[20:21], v[84:85]
    v_pk_mul_f32 v[22:23], v[22:23], v[84:85]
    v_pk_mul_f32 v[24:25], v[24:25], v[84:85]
    v_cvt_pk_bf16_f32 v86, v10, v11
    v_cvt_pk_bf16_f32 v87, v12, v13
    v_cvt_pk_bf16_f32 v88, v14, v15
    v_cvt_pk_bf16_f32 v89, v16, v17
    v_cvt_pk_bf16_f32 v90, v18, v19
    v_cvt_pk_bf16_f32 v91, v20, v21
    v_cvt_pk_bf16_f32 v92, v22, v23
    v_cvt_pk_bf16_f32 v93, v24, v25
    v_lshlrev_b32 v10, 16, v86
    v_and_b32 v11, 0xffff0000, v86
    v_lshlrev_b32 v12, 16, v87
    v_and_b32 v13, 0xffff0000, v87
    v_lshlrev_b32 v14, 16, v88
    v_and_b32 v15, 0xffff0000, v88
    v_lshlrev_b32 v16, 16, v89
    v_and_b32 v17, 0xffff0000, v89
    v_lshlrev_b32 v18, 16, v90
    v_and_b32 v19, 0xffff0000, v90
    v_lshlrev_b32 v20, 16, v91
    v_and_b32 v21, 0xffff0000, v91
    v_lshlrev_b32 v22, 16, v92
    v_and_b32 v23, 0xffff0000, v92
    v_lshlrev_b32 v24, 16, v93
    v_and_b32 v25, 0xffff0000, v93
    ds_write_b128 v102, v[10:13]
    ds_write_b128 v103, v[14:17]
    ds_write_b128 v104, v[18:21]
    ds_write_b128 v105, v[22:25]
    ds_read_b64 v[10:11], v101 offset:0
    ds_read_b64 v[12:13], v101 offset:512
    ds_read_b64 v[14:15], v101 offset:1024
    ds_read_b64 v[16:17], v101 offset:1536
    ds_read_b64 v[18:19], v101 offset:2048
    ds_read_b64 v[20:21], v101 offset:2560
    ds_read_b64 v[22:23], v101 offset:3072
    ds_read_b64 v[24:25], v101 offset:3584
    s_waitcnt vmcnt(0) lgkmcnt(0)
    v_pk_add_f32 v[26:27], v[10:11], v[18:19]
    v_pk_add_f32 v[34:35], v[10:11], v[18:19] neg_lo:[0,1] neg_hi:[0,1]
    v_pk_add_f32 v[28:29], v[12:13], v[20:21]
    v_pk_add_f32 v[36:37], v[12:13], v[20:21] neg_lo:[0,1] neg_hi:[0,1]
    v_pk_add_f32 v[30:31], v[14:15], v[22:23]
    v_pk_add_f32 v[38:39], v[14:15], v[22:23] neg_lo:[0,1] neg_hi:[0,1]
    v_pk_add_f32 v[32:33], v[16:17], v[24:25]
    v_pk_add_f32 v[40:41], v[16:17], v[24:25] neg_lo:[0,1] neg_hi:[0,1]
    v_pk_add_f32 v[12:13], v[26:27], v[30:31]
    v_pk_add_f32 v[16:17], v[26:27], v[30:31] neg_lo:[0,1] neg_hi:[0,1]
    v_pk_add_f32 v[20:21], v[28:29], v[32:33]
    v_pk_add_f32 v[24:25], v[28:29], v[32:33] neg_lo:[0,1] neg_hi:[0,1]
    v_pk_add_f32 v[10:11], v[12:13], v[20:21]
    v_pk_add_f32 v[18:19], v[12:13], v[20:21] neg_lo:[0,1] neg_hi:[0,1]
    v_pk_add_f32 v[14:15], v[16:17], v[24:25] op_sel:[0,1] op_sel_hi:[1,0] neg_hi:[0,1]
    v_pk_add_f32 v[22:23], v[16:17], v[24:25] op_sel:[0,1] op_sel_hi:[1,0] neg_lo:[0,1]
    v_pk_add_f32 v[26:27], v[36:37], v[36:37] op_sel:[0,1] op_sel_hi:[1,0] neg_hi:[0,1]
    v_pk_add_f32 v[28:29], v[40:41], v[40:41] op_sel:[0,1] op_sel_hi:[1,0] neg_lo:[1,0] neg_hi:[1,1]
    v_pk_add_f32 v[30:31], v[26:27], v[28:29]
    v_pk_add_f32 v[32:33], v[26:27], v[28:29] neg_lo:[0,1] neg_hi:[0,1]
    v_pk_add_f32 v[36:37], v[34:35], v[38:39] op_sel:[0,1] op_sel_hi:[1,0] neg_hi:[0,1]
    v_pk_add_f32 v[40:41], v[34:35], v[38:39] op_sel:[0,1] op_sel_hi:[1,0] neg_lo:[0,1]
    v_pk_fma_f32 v[12:13], v[30:31], s[20:21], v[36:37]
    v_pk_fma_f32 v[20:21], v[30:31], s[20:21], v[36:37] neg_lo:[1,0,0] neg_hi:[1,0,0]
    v_pk_fma_f32 v[16:17], v[32:33], s[20:21], v[40:41] op_sel:[1,0,0] op_sel_hi:[0,1,1] neg_hi:[1,0,0]
    v_pk_fma_f32 v[24:25], v[32:33], s[20:21], v[40:41] op_sel:[1,0,0] op_sel_hi:[0,1,1] neg_lo:[1,0,0]
    ds_write_b64 v96, v[10:11] offset:0
    v_pk_mul_f32 v[28:29], v[12:13], v[52:53] op_sel_hi:[1,0]
    v_pk_fma_f32 v[12:13], v[12:13], v[52:53], v[28:29] op_sel:[1,1,0] op_sel_hi:[0,1,1] neg_lo:[1,0,0]
    ds_write_b64 v96, v[12:13] offset:576
    v_pk_mul_f32 v[30:31], v[14:15], v[54:55] op_sel_hi:[1,0]
    v_pk_fma_f32 v[14:15], v[14:15], v[54:55], v[30:31] op_sel:[1,1,0] op_sel_hi:[0,1,1] neg_lo:[1,0,0]
    ds_write_b64 v96, v[14:15] offset:1152
    v_pk_mul_f32 v[32:33], v[16:17], v[56:57] op_sel_hi:[1,0]
    v_pk_fma_f32 v[16:17], v[16:17], v[56:57], v[32:33] op_sel:[1,1,0] op_sel_hi:[0,1,1] neg_lo:[1,0,0]
    ds_write_b64 v96, v[16:17] offset:1728
    v_pk_mul_f32 v[34:35], v[18:19], v[58:59] op_sel_hi:[1,0]
    v_pk_fma_f32 v[18:19], v[18:19], v[58:59], v[34:35] op_sel:[1,1,0] op_sel_hi:[0,1,1] neg_lo:[1,0,0]
    ds_write_b64 v96, v[18:19] offset:2304
    v_pk_mul_f32 v[36:37], v[20:21], v[60:61] op_sel_hi:[1,0]
    v_pk_fma_f32 v[20:21], v[20:21], v[60:61], v[36:37] op_sel:[1,1,0] op_sel_hi:[0,1,1] neg_lo:[1,0,0]
    ds_write_b64 v96, v[20:21] offset:2880
    v_pk_mul_f32 v[38:39], v[22:23], v[62:63] op_sel_hi:[1,0]
    v_pk_fma_f32 v[22:23], v[22:23], v[62:63], v[38:39] op_sel:[1,1,0] op_sel_hi:[0,1,1] neg_lo:[1,0,0]
    ds_write_b64 v96, v[22:23] offset:3456
    v_pk_mul_f32 v[40:41], v[24:25], v[64:65] op_sel_hi:[1,0]
    v_pk_fma_f32 v[24:25], v[24:25], v[64:65], v[40:41] op_sel:[1,1,0] op_sel_hi:[0,1,1] neg_lo:[1,0,0]
    ds_write_b64 v96, v[24:25] offset:4032
    ds_read_b64 v[10:11], v97 offset:0
    ds_read_b64 v[18:19], v97 offset:256
    ds_read_b64 v[12:13], v97 offset:64
    ds_read_b64 v[20:21], v97 offset:320
    ds_read_b64 v[14:15], v97 offset:128
    ds_read_b64 v[22:23], v97 offset:384
    ds_read_b64 v[16:17], v97 offset:192
    ds_read_b64 v[24:25], v97 offset:448
    s_waitcnt lgkmcnt(6)
    v_pk_add_f32 v[26:27], v[10:11], v[18:19]
    v_pk_add_f32 v[34:35], v[10:11], v[18:19] neg_lo:[0,1] neg_hi:[0,1]
    s_waitcnt lgkmcnt(4)
    v_pk_add_f32 v[28:29], v[12:13], v[20:21]
    v_pk_add_f32 v[36:37], v[12:13], v[20:21] neg_lo:[0,1] neg_hi:[0,1]
    s_waitcnt lgkmcnt(2)
    v_pk_add_f32 v[30:31], v[14:15], v[22:23]
    v_pk_add_f32 v[38:39], v[14:15], v[22:23] neg_lo:[0,1] neg_hi:[0,1]
    s_waitcnt lgkmcnt(0)
    v_pk_add_f32 v[32:33], v[16:17], v[24:25]
    v_pk_add_f32 v[40:41], v[16:17], v[24:25] neg_lo:[0,1] neg_hi:[0,1]
    v_pk_add_f32 v[12:13], v[26:27], v[30:31]
    v_pk_add_f32 v[16:17], v[26:27], v[30:31] neg_lo:[0,1] neg_hi:[0,1]
    v_pk_add_f32 v[20:21], v[28:29], v[32:33]
    v_pk_add_f32 v[24:25], v[28:29], v[32:33] neg_lo:[0,1] neg_hi:[0,1]
    v_pk_add_f32 v[10:11], v[12:13], v[20:21]
    v_pk_add_f32 v[18:19], v[12:13], v[20:21] neg_lo:[0,1] neg_hi:[0,1]
    v_pk_add_f32 v[14:15], v[16:17], v[24:25] op_sel:[0,1] op_sel_hi:[1,0] neg_hi:[0,1]
    v_pk_add_f32 v[22:23], v[16:17], v[24:25] op_sel:[0,1] op_sel_hi:[1,0] neg_lo:[0,1]
    v_pk_add_f32 v[26:27], v[36:37], v[36:37] op_sel:[0,1] op_sel_hi:[1,0] neg_hi:[0,1]
    v_pk_add_f32 v[28:29], v[40:41], v[40:41] op_sel:[0,1] op_sel_hi:[1,0] neg_lo:[1,0] neg_hi:[1,1]
    v_pk_add_f32 v[30:31], v[26:27], v[28:29]
    v_pk_add_f32 v[32:33], v[26:27], v[28:29] neg_lo:[0,1] neg_hi:[0,1]
    v_pk_add_f32 v[36:37], v[34:35], v[38:39] op_sel:[0,1] op_sel_hi:[1,0] neg_hi:[0,1]
    v_pk_add_f32 v[40:41], v[34:35], v[38:39] op_sel:[0,1] op_sel_hi:[1,0] neg_lo:[0,1]
    v_pk_fma_f32 v[12:13], v[30:31], s[20:21], v[36:37]
    v_pk_fma_f32 v[20:21], v[30:31], s[20:21], v[36:37] neg_lo:[1,0,0] neg_hi:[1,0,0]
    v_pk_fma_f32 v[16:17], v[32:33], s[20:21], v[40:41] op_sel:[1,0,0] op_sel_hi:[0,1,1] neg_hi:[1,0,0]
    v_pk_fma_f32 v[24:25], v[32:33], s[20:21], v[40:41] op_sel:[1,0,0] op_sel_hi:[0,1,1] neg_lo:[1,0,0]
    ds_write_b64 v98, v[10:11] offset:0
    v_pk_mul_f32 v[28:29], v[12:13], v[68:69] op_sel_hi:[1,0]
    v_pk_fma_f32 v[12:13], v[12:13], v[68:69], v[28:29] op_sel:[1,1,0] op_sel_hi:[0,1,1] neg_lo:[1,0,0]
    ds_write_b64 v98, v[12:13] offset:64
    v_pk_mul_f32 v[30:31], v[14:15], v[70:71] op_sel_hi:[1,0]
    v_pk_fma_f32 v[14:15], v[14:15], v[70:71], v[30:31] op_sel:[1,1,0] op_sel_hi:[0,1,1] neg_lo:[1,0,0]
    ds_write_b64 v98, v[14:15] offset:128
    v_pk_mul_f32 v[32:33], v[16:17], v[72:73] op_sel_hi:[1,0]
    v_pk_fma_f32 v[16:17], v[16:17], v[72:73], v[32:33] op_sel:[1,1,0] op_sel_hi:[0,1,1] neg_lo:[1,0,0]
    ds_write_b64 v98, v[16:17] offset:192
    v_pk_mul_f32 v[34:35], v[18:19], v[74:75] op_sel_hi:[1,0]
    v_pk_fma_f32 v[18:19], v[18:19], v[74:75], v[34:35] op_sel:[1,1,0] op_sel_hi:[0,1,1] neg_lo:[1,0,0]
    ds_write_b64 v98, v[18:19] offset:256
    v_pk_mul_f32 v[36:37], v[20:21], v[76:77] op_sel_hi:[1,0]
    v_pk_fma_f32 v[20:21], v[20:21], v[76:77], v[36:37] op_sel:[1,1,0] op_sel_hi:[0,1,1] neg_lo:[1,0,0]
    ds_write_b64 v98, v[20:21] offset:320
    v_pk_mul_f32 v[38:39], v[22:23], v[78:79] op_sel_hi:[1,0]
    v_pk_fma_f32 v[22:23], v[22:23], v[78:79], v[38:39] op_sel:[1,1,0] op_sel_hi:[0,1,1] neg_lo:[1,0,0]
    ds_write_b64 v98, v[22:23] offset:384
    v_pk_mul_f32 v[40:41], v[24:25], v[80:81] op_sel_hi:[1,0]
    v_pk_fma_f32 v[24:25], v[24:25], v[80:81], v[40:41] op_sel:[1,1,0] op_sel_hi:[0,1,1] neg_lo:[1,0,0]
    ds_write_b64 v98, v[24:25] offset:448
    ds_read_b64 v[10:11], v96 offset:0
    ds_read_b64 v[18:19], v96 offset:2112
    ds_read_b64 v[12:13], v96 offset:528
    ds_read_b64 v[20:21], v96 offset:2640
    ds_read_b64 v[14:15], v96 offset:1056
    ds_read_b64 v[22:23], v96 offset:3168
    ds_read_b64 v[16:17], v96 offset:1584
    ds_read_b64 v[24:25], v96 offset:3696
    s_waitcnt lgkmcnt(6)
    v_pk_add_f32 v[26:27], v[10:11], v[18:19]
    v_pk_add_f32 v[34:35], v[10:11], v[18:19] neg_lo:[0,1] neg_hi:[0,1]
    s_waitcnt lgkmcnt(4)
    v_pk_add_f32 v[28:29], v[12:13], v[20:21]
    v_pk_add_f32 v[36:37], v[12:13], v[20:21] neg_lo:[0,1] neg_hi:[0,1]
    s_waitcnt lgkmcnt(2)
    v_pk_add_f32 v[30:31], v[14:15], v[22:23]
    v_pk_add_f32 v[38:39], v[14:15], v[22:23] neg_lo:[0,1] neg_hi:[0,1]
    s_waitcnt lgkmcnt(0)
    v_pk_add_f32 v[32:33], v[16:17], v[24:25]
    v_pk_add_f32 v[40:41], v[16:17], v[24:25] neg_lo:[0,1] neg_hi:[0,1]
    v_pk_add_f32 v[12:13], v[26:27], v[30:31]
    v_pk_add_f32 v[16:17], v[26:27], v[30:31] neg_lo:[0,1] neg_hi:[0,1]
    v_pk_add_f32 v[20:21], v[28:29], v[32:33]
    v_pk_add_f32 v[24:25], v[28:29], v[32:33] neg_lo:[0,1] neg_hi:[0,1]
    v_pk_add_f32 v[10:11], v[12:13], v[20:21]
    v_pk_add_f32 v[18:19], v[12:13], v[20:21] neg_lo:[0,1] neg_hi:[0,1]
    v_pk_add_f32 v[14:15], v[16:17], v[24:25] op_sel:[0,1] op_sel_hi:[1,0] neg_hi:[0,1]
    v_pk_add_f32 v[22:23], v[16:17], v[24:25] op_sel:[0,1] op_sel_hi:[1,0] neg_lo:[0,1]
    v_pk_add_f32 v[26:27], v[36:37], v[36:37] op_sel:[0,1] op_sel_hi:[1,0] neg_hi:[0,1]
    v_pk_add_f32 v[28:29], v[40:41], v[40:41] op_sel:[0,1] op_sel_hi:[1,0] neg_lo:[1,0] neg_hi:[1,1]
    v_pk_add_f32 v[30:31], v[26:27], v[28:29]
    v_pk_add_f32 v[32:33], v[26:27], v[28:29] neg_lo:[0,1] neg_hi:[0,1]
    v_pk_add_f32 v[36:37], v[34:35], v[38:39] op_sel:[0,1] op_sel_hi:[1,0] neg_hi:[0,1]
    v_pk_add_f32 v[40:41], v[34:35], v[38:39] op_sel:[0,1] op_sel_hi:[1,0] neg_lo:[0,1]
    v_pk_fma_f32 v[12:13], v[30:31], s[20:21], v[36:37]
    v_pk_fma_f32 v[20:21], v[30:31], s[20:21], v[36:37] neg_lo:[1,0,0] neg_hi:[1,0,0]
    v_pk_fma_f32 v[16:17], v[32:33], s[20:21], v[40:41] op_sel:[1,0,0] op_sel_hi:[0,1,1] neg_hi:[1,0,0]
    v_pk_fma_f32 v[24:25], v[32:33], s[20:21], v[40:41] op_sel:[1,0,0] op_sel_hi:[0,1,1] neg_lo:[1,0,0]
    ds_write_b64 v96, v[10:11] offset:0
    ds_write_b64 v96, v[12:13] offset:512
    ds_write_b64 v96, v[14:15] offset:1024
    ds_write_b64 v96, v[16:17] offset:1536
    ds_write_b64 v96, v[18:19] offset:2048
    ds_write_b64 v96, v[20:21] offset:2560
    ds_write_b64 v96, v[22:23] offset:3072
    ds_write_b64 v96, v[24:25] offset:3584
    v_cmp_eq_u32 vcc, 0, v1
    s_and_saveexec_b64 s[34:35], vcc
    ds_write_b64 v96, v[10:11] offset:4096
    s_mov_b64 exec, s[34:35]
    v_lshrrev_b32 v5, 2, v0
    v_and_b32 v6, 3, v0
    v_mul_u32_u24 v4, 4768, v6
    v_lshl_add_u32 v3, v5, 3, v4
    v_sub_u32 v7, 256, v5
    v_lshl_add_u32 v99, v7, 3, v4
    v_lshlrev_b32 v6, 4, v6
    v_mul_u32_u24 v5, 16640, v5
    v_add_u32 v6, v5, v6
    s_lshl_b32 s28, s2, 6
    s_waitcnt lgkmcnt(0)
    s_barrier
    ds_read_b64 v[10:11], v3 offset:0
    ds_read_b64 v[26:27], v99 offset:2048
    ds_read_b64 v[12:13], v3 offset:512
    ds_read_b64 v[28:29], v99 offset:1536
    ds_read_b64 v[14:15], v3 offset:1024
    ds_read_b64 v[30:31], v99 offset:1024
    ds_read_b64 v[16:17], v3 offset:1536
    ds_read_b64 v[32:33], v99 offset:512
    ds_read_b64 v[18:19], v3 offset:2048
    ds_read_b64 v[34:35], v99 offset:0
    v_cmp_gt_u32 vcc, 4, v0
    s_waitcnt lgkmcnt(0)
    v_pk_add_f32 v[50:51], v[10:11], v[26:27] neg_hi:[0,1]
    v_pk_add_f32 v[52:53], v[10:11], v[26:27] op_sel:[1,1] op_sel_hi:[0,0] neg_hi:[1,0]
    v_pk_add_f32 v[54:55], v[12:13], v[28:29] neg_hi:[0,1]
    v_pk_add_f32 v[56:57], v[12:13], v[28:29] op_sel:[1,1] op_sel_hi:[0,0] neg_hi:[1,0]
    s_add_u32 s29, s28, 0x2604000
    buffer_store_dwordx4 v[54:57], v6, s[12:15], s29 offen sc1
    v_pk_add_f32 v[58:59], v[14:15], v[30:31] neg_hi:[0,1]
    v_pk_add_f32 v[60:61], v[14:15], v[30:31] op_sel:[1,1] op_sel_hi:[0,0] neg_hi:[1,0]
    s_add_u32 s29, s28, 0x2708000
    buffer_store_dwordx4 v[58:61], v6, s[12:15], s29 offen sc1
    v_pk_add_f32 v[62:63], v[16:17], v[32:33] neg_hi:[0,1]
    v_pk_add_f32 v[64:65], v[16:17], v[32:33] op_sel:[1,1] op_sel_hi:[0,0] neg_hi:[1,0]
    s_add_u32 s29, s28, 0x280c000
    buffer_store_dwordx4 v[62:65], v6, s[12:15], s29 offen sc1
    v_pk_add_f32 v[66:67], v[18:19], v[34:35] neg_hi:[0,1]
    v_pk_add_f32 v[68:69], v[18:19], v[34:35] op_sel:[1,1] op_sel_hi:[0,0] neg_hi:[1,0]
    v_cndmask_b32 v51, v51, v66, vcc
    v_cndmask_b32 v53, v53, v68, vcc
    s_add_u32 s29, s28, 0x2500000
    buffer_store_dwordx4 v[50:53], v6, s[12:15], s29 offen sc1
Lsk_54:
    s_mov_b64 exec, -1
    s_branch Ljoin_48
Lskip_47:
    s_barrier
    s_barrier
Ljoin_48:
    s_waitcnt vmcnt(0)
    s_barrier
    s_cmp_lg_u32 s3, 0
    s_cbranch_scc1 Lpub_55
    s_lshr_b32 s92, s2, 4
    s_lshl_b32 s92, s92, 8
    s_add_u32 s92, s92, 65536
    v_mov_b32 v158, 1
    v_mov_b32 v159, 0
    s_mov_b64 exec, 1
    buffer_atomic_add v158, v159, s[96:99], s92 offen sc0 sc1
    s_waitcnt vmcnt(0)
    v_readfirstlane_b32 s94, v158
    s_cmp_lg_u32 s94, 15
    s_cbranch_scc1 Lpub_55x
    s_mov_b64 exec, 0xffff
    v_mov_b32 v158, 1
    v_lshlrev_b32 v159, 8, v1
    s_mov_b32 s92, 69632
    buffer_atomic_add v158, v159, s[96:99], s92 offen sc1
Lpub_55x:
    s_mov_b64 exec, -1
Lpub_55:
    s_cmp_eq_u32 s2, 200
    s_cbranch_scc1 Lsp_56
    s_cmp_ge_u32 s3, 4
    s_cbranch_scc1 Lskip_58
    s_getpc_b64 s[16:17]
Lpc_60:
    s_add_u32 s16, s16, tab_tw2048a-Lpc_60
    s_addc_u32 s17, s17, 0
    s_and_b32 s17, s17, 0xffff
    s_mov_b32 s18, 0x800
    s_mov_b32 s19, 0x00020000
    s_mov_b32 s20, 0x3f3504f3
    s_mov_b32 s21, s20
    s_mov_b64 s[6:7], s[84:85]
    s_mov_b32 s12, s6
    s_and_b32 s13, s7, 0xffff
    s_mov_b32 s14, 0x10000000
    s_mov_b32 s15, 0x00020000
    v_lshlrev_b32 v3, 3, v0
    buffer_load_dwordx2 v[44:45], v3, s[16:19], 0 offen
    v_and_b32 v5, 31, v0
    v_lshlrev_b32 v5, 6, v5
    buffer_load_dwordx2 v[60:61], v5, s[16:19], 0 offen
    v_and_b32 v5, 3, v0
    v_lshlrev_b32 v5, 9, v5
    buffer_load_dwordx2 v[76:77], v5, s[16:19], 0 offen
    v_lshlrev_b32 v6, 2, v0
    s_lshl_b32 s29, s95, 13
    s_add_u32 s29, s29, 0x420000
    s_add_u32 s30, s29, 4096
    buffer_load_dword v90, v6, s[12:15], s29 offen offset:0
    buffer_load_dword v91, v6, s[12:15], s29 offen offset:1024
    buffer_load_dword v92, v6, s[12:15], s29 offen offset:2048
    buffer_load_dword v93, v6, s[12:15], s29 offen offset:3072
    buffer_load_dword v94, v6, s[12:15], s30 offen offset:0
    buffer_load_dword v95, v6, s[12:15], s30 offen offset:1024
    buffer_load_dword v96, v6, s[12:15], s30 offen offset:2048
    buffer_load_dword v97, v6, s[12:15], s30 offen offset:3072
    v_lshlrev_b32 v98, 3, v0
    v_lshrrev_b32 v7, 5, v0
    v_and_b32 v8, 31, v0
    v_lshl_add_u32 v9, v7, 8, v8
    v_lshlrev_b32 v99, 3, v9
    v_mul_u32_u24 v9, 288, v7
    v_add_u32 v8, v9, v8
    v_lshlrev_b32 v100, 3, v8
    v_bfe_u32 v8, v0, 2, 3
    v_mul_u32_u24 v8, 36, v8
    v_add_u32 v9, v9, v8
    v_and_b32 v8, 3, v0
    v_add_u32 v9, v9, v8
    v_lshlrev_b32 v101, 3, v9
    v_lshlrev_b32 v9, 2, v7
    v_bfe_u32 v7, v0, 2, 2
    v_add_u32 v9, v9, v7
    v_bfe_u32 v7, v0, 4, 1
    v_lshl_add_u32 v9, v7, 5, v9
    v_mul_u32_u24 v8, 68, v8
    v_add_u32 v9, v9, v8
    v_lshlrev_b32 v102, 3, v9
    v_and_b32 v7, 7, v0
    v_lshlrev_b32 v9, 2, v7
    v_bfe_u32 v7, v0, 3, 2
    v_add_u32 v9, v9, v7
    v_bfe_u32 v7, v0, 5, 1
    v_lshl_add_u32 v9, v7, 5, v9
    v_lshrrev_b32 v7, 6, v0
    v_mul_u32_u24 v7, 272, v7
    v_add_u32 v9, v9, v7
    v_lshlrev_b32 v103, 3, v9
    s_cmp_lg_u32 s3, 0
    s_cbranch_scc1 Lpd_61
    s_lshr_b32 s92, s2, 4
    s_lshl_b32 s92, s92, 8
    s_add_u32 s92, s92, 69632
    v_mov_b32 v159, 0
    s_mov_b32 s93, 0
Lpl_62:
    v_mov_b32 v158, 0
    s_mov_b64 exec, 1
    buffer_atomic_add v158, v159, s[96:99], s92 offen sc0 sc1
    s_mov_b64 exec, -1
    s_waitcnt vmcnt(0)
    v_readfirstlane_b32 s94, v158
    s_add_u32 s93, s93, 1
    s_cmp_ge_u32 s94, 16
    s_cbranch_scc1 Lpd_61
    s_cmp_gt_u32 s93, 0x40000
    s_cbranch_scc1 Lpd_61
    s_sleep 2
    s_branch Lpl_62
Lpd_61:
    s_barrier
    s_mul_i32 s28, s95, 16640
    s_add_u32 s28, s28, 0x2500000
    s_add_u32 s36, s28, 0
    s_add_u32 s37, s28, 4096
    s_add_u32 s38, s28, 8192
    s_add_u32 s39, s28, 12288
    buffer_load_dwordx2 v[10:11], v3, s[12:15], s36 offen offset:0
    buffer_load_dwordx2 v[12:13], v3, s[12:15], s36 offen offset:2048
    buffer_load_dwordx2 v[14:15], v3, s[12:15], s37 offen offset:0
    buffer_load_dwordx2 v[16:17], v3, s[12:15], s37 offen offset:2048
    buffer_load_dwordx2 v[18:19], v3, s[12:15], s38 offen offset:0
    buffer_load_dwordx2 v[20:21], v3, s[12:15], s38 offen offset:2048
    buffer_load_dwordx2 v[22:23], v3, s[12:15], s39 offen offset:0
    buffer_load_dwordx2 v[24:25], v3, s[12:15], s39 offen offset:2048
    s_waitcnt vmcnt(8)
    v_pk_mul_f32 v[26:27], v[44:45], v[44:45] op_sel_hi:[1,0]
    v_pk_fma_f32 v[46:47], v[44:45], v[44:45], v[26:27] op_sel:[1,1,0] op_sel_hi:[0,1,1] neg_lo:[1,0,0]
    v_pk_mul_f32 v[28:29], v[46:47], v[44:45] op_sel_hi:[1,0]
    v_pk_fma_f32 v[48:49], v[46:47], v[44:45], v[28:29] op_sel:[1,1,0] op_sel_hi:[0,1,1] neg_lo:[1,0,0]
    v_pk_mul_f32 v[26:27], v[46:47], v[46:47] op_sel_hi:[1,0]
    v_pk_fma_f32 v[50:51], v[46:47], v[46:47], v[26:27] op_sel:[1,1,0] op_sel_hi:[0,1,1] neg_lo:[1,0,0]
    v_pk_mul_f32 v[28:29], v[50:51], v[44:45] op_sel_hi:[1,0]
    v_pk_fma_f32 v[52:53], v[50:51], v[44:45], v[28:29] op_sel:[1,1,0] op_sel_hi:[0,1,1] neg_lo:[1,0,0]
    v_pk_mul_f32 v[26:27], v[48:49], v[48:49] op_sel_hi:[1,0]
    v_pk_fma_f32 v[54:55], v[48:49], v[48:49], v[26:27] op_sel:[1,1,0] op_sel_hi:[0,1,1] neg_lo:[1,0,0]
    v_pk_mul_f32 v[28:29], v[50:51], v[48:49] op_sel_hi:[1,0]
    v_pk_fma_f32 v[56:57], v[50:51], v[48:49], v[28:29] op_sel:[1,1,0] op_sel_hi:[0,1,1] neg_lo:[1,0,0]
    v_pk_mul_f32 v[26:27], v[60:61], v[60:61] op_sel_hi:[1,0]
    v_pk_fma_f32 v[62:63], v[60:61], v[60:61], v[26:27] op_sel:[1,1,0] op_sel_hi:[0,1,1] neg_lo:[1,0,0]
    v_pk_mul_f32 v[28:29], v[62:63], v[60:61] op_sel_hi:[1,0]
    v_pk_fma_f32 v[64:65], v[62:63], v[60:61], v[28:29] op_sel:[1,1,0] op_sel_hi:[0,1,1] neg_lo:[1,0,0]
    v_pk_mul_f32 v[26:27], v[62:63], v[62:63] op_sel_hi:[1,0]
    v_pk_fma_f32 v[66:67], v[62:63], v[62:63], v[26:27] op_sel:[1,1,0] op_sel_hi:[0,1,1] neg_lo:[1,0,0]
    v_pk_mul_f32 v[28:29], v[66:67], v[60:61] op_sel_hi:[1,0]
    v_pk_fma_f32 v[68:69], v[66:67], v[60:61], v[28:29] op_sel:[1,1,0] op_sel_hi:[0,1,1] neg_lo:[1,0,0]
    v_pk_mul_f32 v[26:27], v[64:65], v[64:65] op_sel_hi:[1,0]
    v_pk_fma_f32 v[70:71], v[64:65], v[64:65], v[26:27] op_sel:[1,1,0] op_sel_hi:[0,1,1] neg_lo:[1,0,0]
    v_pk_mul_f32 v[28:29], v[66:67], v[64:65] op_sel_hi:[1,0]
    v_pk_fma_f32 v[72:73], v[66:67], v[64:65], v[28:29] op_sel:[1,1,0] op_sel_hi:[0,1,1] neg_lo:[1,0,0]
    v_pk_mul_f32 v[26:27], v[76:77], v[76:77] op_sel_hi:[1,0]
    v_pk_fma_f32 v[78:79], v[76:77], v[76:77], v[26:27] op_sel:[1,1,0] op_sel_hi:[0,1,1] neg_lo:[1,0,0]
    v_pk_mul_f32 v[28:29], v[78:79], v[76:77] op_sel_hi:[1,0]
    v_pk_fma_f32 v[80:81], v[78:79], v[76:77], v[28:29] op_sel:[1,1,0] op_sel_hi:[0,1,1] neg_lo:[1,0,0]
    v_pk_mul_f32 v[26:27], v[78:79], v[78:79] op_sel_hi:[1,0]
    v_pk_fma_f32 v[82:83], v[78:79], v[78:79], v[26:27] op_sel:[1,1,0] op_sel_hi:[0,1,1] neg_lo:[1,0,0]
    v_pk_mul_f32 v[28:29], v[82:83], v[76:77] op_sel_hi:[1,0]
    v_pk_fma_f32 v[84:85], v[82:83], v[76:77], v[28:29] op_sel:[1,1,0] op_sel_hi:[0,1,1] neg_lo:[1,0,0]
    v_pk_mul_f32 v[26:27], v[80:81], v[80:81] op_sel_hi:[1,0]
    v_pk_fma_f32 v[86:87], v[80:81], v[80:81], v[26:27] op_sel:[1,1,0] op_sel_hi:[0,1,1] neg_lo:[1,0,0]
    v_pk_mul_f32 v[28:29], v[82:83], v[80:81] op_sel_hi:[1,0]
    v_pk_fma_f32 v[88:89], v[82:83], v[80:81], v[28:29] op_sel:[1,1,0] op_sel_hi:[0,1,1] neg_lo:[1,0,0]
    s_waitcnt vmcnt(0)
    v_pk_add_f32 v[26:27], v[10:11], v[18:19]
    v_pk_add_f32 v[34:35], v[10:11], v[18:19] neg_lo:[0,1] neg_hi:[0,1]
    v_pk_add_f32 v[28:29], v[12:13], v[20:21]
    v_pk_add_f32 v[36:37], v[12:13], v[20:21] neg_lo:[0,1] neg_hi:[0,1]
    v_pk_add_f32 v[30:31], v[14:15], v[22:23]
    v_pk_add_f32 v[38:39], v[14:15], v[22:23] neg_lo:[0,1] neg_hi:[0,1]
    v_pk_add_f32 v[32:33], v[16:17], v[24:25]
    v_pk_add_f32 v[40:41], v[16:17], v[24:25] neg_lo:[0,1] neg_hi:[0,1]
    v_pk_add_f32 v[12:13], v[26:27], v[30:31]
    v_pk_add_f32 v[16:17], v[26:27], v[30:31] neg_lo:[0,1] neg_hi:[0,1]
    v_pk_add_f32 v[20:21], v[28:29], v[32:33]
    v_pk_add_f32 v[24:25], v[28:29], v[32:33] neg_lo:[0,1] neg_hi:[0,1]
    v_pk_add_f32 v[10:11], v[12:13], v[20:21]
    v_pk_add_f32 v[18:19], v[12:13], v[20:21] neg_lo:[0,1] neg_hi:[0,1]
    v_pk_add_f32 v[14:15], v[16:17], v[24:25] op_sel:[0,1] op_sel_hi:[1,0] neg_hi:[0,1]
    v_pk_add_f32 v[22:23], v[16:17], v[24:25] op_sel:[0,1] op_sel_hi:[1,0] neg_lo:[0,1]
    v_pk_add_f32 v[26:27], v[36:37], v[36:37] op_sel:[0,1] op_sel_hi:[1,0] neg_hi:[0,1]
    v_pk_add_f32 v[28:29], v[40:41], v[40:41] op_sel:[0,1] op_sel_hi:[1,0] neg_lo:[1,0] neg_hi:[1,1]
    v_pk_add_f32 v[30:31], v[26:27], v[28:29]
    v_pk_add_f32 v[32:33], v[26:27], v[28:29] neg_lo:[0,1] neg_hi:[0,1]
    v_pk_add_f32 v[36:37], v[34:35], v[38:39] op_sel:[0,1] op_sel_hi:[1,0] neg_hi:[0,1]
    v_pk_add_f32 v[40:41], v[34:35], v[38:39] op_sel:[0,1] op_sel_hi:[1,0] neg_lo:[0,1]
    v_pk_fma_f32 v[12:13], v[30:31], s[20:21], v[36:37]
    v_pk_fma_f32 v[20:21], v[30:31], s[20:21], v[36:37] neg_lo:[1,0,0] neg_hi:[1,0,0]
    v_pk_fma_f32 v[16:17], v[32:33], s[20:21], v[40:41] op_sel:[1,0,0] op_sel_hi:[0,1,1] neg_hi:[1,0,0]
    v_pk_fma_f32 v[24:25], v[32:33], s[20:21], v[40:41] op_sel:[1,0,0] op_sel_hi:[0,1,1] neg_lo:[1,0,0]
    ds_write_b64 v98, v[10:11] offset:0
    v_pk_mul_f32 v[28:29], v[12:13], v[44:45] op_sel_hi:[1,0]
    v_pk_fma_f32 v[12:13], v[12:13], v[44:45], v[28:29] op_sel:[1,1,0] op_sel_hi:[0,1,1] neg_lo:[1,0,0]
    ds_write_b64 v98, v[12:13] offset:2048
    v_pk_mul_f32 v[30:31], v[14:15], v[46:47] op_sel_hi:[1,0]
    v_pk_fma_f32 v[14:15], v[14:15], v[46:47], v[30:31] op_sel:[1,1,0] op_sel_hi:[0,1,1] neg_lo:[1,0,0]
    ds_write_b64 v98, v[14:15] offset:4096
    v_pk_mul_f32 v[32:33], v[16:17], v[48:49] op_sel_hi:[1,0]
    v_pk_fma_f32 v[16:17], v[16:17], v[48:49], v[32:33] op_sel:[1,1,0] op_sel_hi:[0,1,1] neg_lo:[1,0,0]
    ds_write_b64 v98, v[16:17] offset:6144
    v_pk_mul_f32 v[34:35], v[18:19], v[50:51] op_sel_hi:[1,0]
    v_pk_fma_f32 v[18:19], v[18:19], v[50:51], v[34:35] op_sel:[1,1,0] op_sel_hi:[0,1,1] neg_lo:[1,0,0]
    ds_write_b64 v98, v[18:19] offset:8192
    v_pk_mul_f32 v[36:37], v[20:21], v[52:53] op_sel_hi:[1,0]
    v_pk_fma_f32 v[20:21], v[20:21], v[52:53], v[36:37] op_sel:[1,1,0] op_sel_hi:[0,1,1] neg_lo:[1,0,0]
    ds_write_b64 v98, v[20:21] offset:10240
    v_pk_mul_f32 v[38:39], v[22:23], v[54:55] op_sel_hi:[1,0]
    v_pk_fma_f32 v[22:23], v[22:23], v[54:55], v[38:39] op_sel:[1,1,0] op_sel_hi:[0,1,1] neg_lo:[1,0,0]
    ds_write_b64 v98, v[22:23] offset:12288
    v_pk_mul_f32 v[40:41], v[24:25], v[56:57] op_sel_hi:[1,0]
    v_pk_fma_f32 v[24:25], v[24:25], v[56:57], v[40:41] op_sel:[1,1,0] op_sel_hi:[0,1,1] neg_lo:[1,0,0]
    ds_write_b64 v98, v[24:25] offset:14336
    s_waitcnt lgkmcnt(0)
    s_barrier
    ds_read_b64 v[10:11], v99 offset:0
    ds_read_b64 v[18:19], v99 offset:1024
    ds_read_b64 v[12:13], v99 offset:256
    ds_read_b64 v[20:21], v99 offset:1280
    ds_read_b64 v[14:15], v99 offset:512
    ds_read_b64 v[22:23], v99 offset:1536
    ds_read_b64 v[16:17], v99 offset:768
    ds_read_b64 v[24:25], v99 offset:1792
    s_waitcnt lgkmcnt(6)
    v_pk_add_f32 v[26:27], v[10:11], v[18:19]
    v_pk_add_f32 v[34:35], v[10:11], v[18:19] neg_lo:[0,1] neg_hi:[0,1]
    s_waitcnt lgkmcnt(4)
    v_pk_add_f32 v[28:29], v[12:13], v[20:21]
    v_pk_add_f32 v[36:37], v[12:13], v[20:21] neg_lo:[0,1] neg_hi:[0,1]
    s_waitcnt lgkmcnt(2)
    v_pk_add_f32 v[30:31], v[14:15], v[22:23]
    v_pk_add_f32 v[38:39], v[14:15], v[22:23] neg_lo:[0,1] neg_hi:[0,1]
    s_waitcnt lgkmcnt(0)
    v_pk_add_f32 v[32:33], v[16:17], v[24:25]
    v_pk_add_f32 v[40:41], v[16:17], v[24:25] neg_lo:[0,1] neg_hi:[0,1]
    v_pk_add_f32 v[12:13], v[26:27], v[30:31]
    v_pk_add_f32 v[16:17], v[26:27], v[30:31] neg_lo:[0,1] neg_hi:[0,1]
    v_pk_add_f32 v[20:21], v[28:29], v[32:33]
    v_pk_add_f32 v[24:25], v[28:29], v[32:33] neg_lo:[0,1] neg_hi:[0,1]
    v_pk_add_f32 v[10:11], v[12:13], v[20:21]
    v_pk_add_f32 v[18:19], v[12:13], v[20:21] neg_lo:[0,1] neg_hi:[0,1]
    v_pk_add_f32 v[14:15], v[16:17], v[24:25] op_sel:[0,1] op_sel_hi:[1,0] neg_hi:[0,1]
    v_pk_add_f32 v[22:23], v[16:17], v[24:25] op_sel:[0,1] op_sel_hi:[1,0] neg_lo:[0,1]
    v_pk_add_f32 v[26:27], v[36:37], v[36:37] op_sel:[0,1] op_sel_hi:[1,0] neg_hi:[0,1]
    v_pk_add_f32 v[28:29], v[40:41], v[40:41] op_sel:[0,1] op_sel_hi:[1,0] neg_lo:[1,0] neg_hi:[1,1]
    v_pk_add_f32 v[30:31], v[26:27], v[28:29]
    v_pk_add_f32 v[32:33], v[26:27], v[28:29] neg_lo:[0,1] neg_hi:[0,1]
    v_pk_add_f32 v[36:37], v[34:35], v[38:39] op_sel:[0,1] op_sel_hi:[1,0] neg_hi:[0,1]
    v_pk_add_f32 v[40:41], v[34:35], v[38:39] op_sel:[0,1] op_sel_hi:[1,0] neg_lo:[0,1]
    v_pk_fma_f32 v[12:13], v[30:31], s[20:21], v[36:37]
    v_pk_fma_f32 v[20:21], v[30:31], s[20:21], v[36:37] neg_lo:[1,0,0] neg_hi:[1,0,0]
    v_pk_fma_f32 v[16:17], v[32:33], s[20:21], v[40:41] op_sel:[1,0,0] op_sel_hi:[0,1,1] neg_hi:[1,0,0]
    v_pk_fma_f32 v[24:25], v[32:33], s[20:21], v[40:41] op_sel:[1,0,0] op_sel_hi:[0,1,1] neg_lo:[1,0,0]
    ds_write_b64 v100, v[10:11] offset:36864
    v_pk_mul_f32 v[28:29], v[12:13], v[60:61] op_sel_hi:[1,0]
    v_pk_fma_f32 v[12:13], v[12:13], v[60:61], v[28:29] op_sel:[1,1,0] op_sel_hi:[0,1,1] neg_lo:[1,0,0]
    ds_write_b64 v100, v[12:13] offset:37152
    v_pk_mul_f32 v[30:31], v[14:15], v[62:63] op_sel_hi:[1,0]
    v_pk_fma_f32 v[14:15], v[14:15], v[62:63], v[30:31] op_sel:[1,1,0] op_sel_hi:[0,1,1] neg_lo:[1,0,0]
    ds_write_b64 v100, v[14:15] offset:37440
    v_pk_mul_f32 v[32:33], v[16:17], v[64:65] op_sel_hi:[1,0]
    v_pk_fma_f32 v[16:17], v[16:17], v[64:65], v[32:33] op_sel:[1,1,0] op_sel_hi:[0,1,1] neg_lo:[1,0,0]
    ds_write_b64 v100, v[16:17] offset:37728
    v_pk_mul_f32 v[34:35], v[18:19], v[66:67] op_sel_hi:[1,0]
    v_pk_fma_f32 v[18:19], v[18:19], v[66:67], v[34:35] op_sel:[1,1,0] op_sel_hi:[0,1,1] neg_lo:[1,0,0]
    ds_write_b64 v100, v[18:19] offset:38016
    v_pk_mul_f32 v[36:37], v[20:21], v[68:69] op_sel_hi:[1,0]
    v_pk_fma_f32 v[20:21], v[20:21], v[68:69], v[36:37] op_sel:[1,1,0] op_sel_hi:[0,1,1] neg_lo:[1,0,0]
    ds_write_b64 v100, v[20:21] offset:38304
    v_pk_mul_f32 v[38:39], v[22:23], v[70:71] op_sel_hi:[1,0]
    v_pk_fma_f32 v[22:23], v[22:23], v[70:71], v[38:39] op_sel:[1,1,0] op_sel_hi:[0,1,1] neg_lo:[1,0,0]
    ds_write_b64 v100, v[22:23] offset:38592
    v_pk_mul_f32 v[40:41], v[24:25], v[72:73] op_sel_hi:[1,0]
    v_pk_fma_f32 v[24:25], v[24:25], v[72:73], v[40:41] op_sel:[1,1,0] op_sel_hi:[0,1,1] neg_lo:[1,0,0]
    ds_write_b64 v100, v[24:25] offset:38880
    ds_read_b64 v[10:11], v101 offset:36864
    ds_read_b64 v[18:19], v101 offset:36992
    ds_read_b64 v[12:13], v101 offset:36896
    ds_read_b64 v[20:21], v101 offset:37024
    ds_read_b64 v[14:15], v101 offset:36928
    ds_read_b64 v[22:23], v101 offset:37056
    ds_read_b64 v[16:17], v101 offset:36960
    ds_read_b64 v[24:25], v101 offset:37088
    s_waitcnt lgkmcnt(6)
    v_pk_add_f32 v[26:27], v[10:11], v[18:19]
    v_pk_add_f32 v[34:35], v[10:11], v[18:19] neg_lo:[0,1] neg_hi:[0,1]
    s_waitcnt lgkmcnt(4)
    v_pk_add_f32 v[28:29], v[12:13], v[20:21]
    v_pk_add_f32 v[36:37], v[12:13], v[20:21] neg_lo:[0,1] neg_hi:[0,1]
    s_waitcnt lgkmcnt(2)
    v_pk_add_f32 v[30:31], v[14:15], v[22:23]
    v_pk_add_f32 v[38:39], v[14:15], v[22:23] neg_lo:[0,1] neg_hi:[0,1]
    s_waitcnt lgkmcnt(0)
    v_pk_add_f32 v[32:33], v[16:17], v[24:25]
    v_pk_add_f32 v[40:41], v[16:17], v[24:25] neg_lo:[0,1] neg_hi:[0,1]
    v_pk_add_f32 v[12:13], v[26:27], v[30:31]
    v_pk_add_f32 v[16:17], v[26:27], v[30:31] neg_lo:[0,1] neg_hi:[0,1]
    v_pk_add_f32 v[20:21], v[28:29], v[32:33]
    v_pk_add_f32 v[24:25], v[28:29], v[32:33] neg_lo:[0,1] neg_hi:[0,1]
    v_pk_add_f32 v[10:11], v[12:13], v[20:21]
    v_pk_add_f32 v[18:19], v[12:13], v[20:21] neg_lo:[0,1] neg_hi:[0,1]
    v_pk_add_f32 v[14:15], v[16:17], v[24:25] op_sel:[0,1] op_sel_hi:[1,0] neg_hi:[0,1]
    v_pk_add_f32 v[22:23], v[16:17], v[24:25] op_sel:[0,1] op_sel_hi:[1,0] neg_lo:[0,1]
    v_pk_add_f32 v[26:27], v[36:37], v[36:37] op_sel:[0,1] op_sel_hi:[1,0] neg_hi:[0,1]
    v_pk_add_f32 v[28:29], v[40:41], v[40:41] op_sel:[0,1] op_sel_hi:[1,0] neg_lo:[1,0] neg_hi:[1,1]
    v_pk_add_f32 v[30:31], v[26:27], v[28:29]
    v_pk_add_f32 v[32:33], v[26:27], v[28:29] neg_lo:[0,1] neg_hi:[0,1]
    v_pk_add_f32 v[36:37], v[34:35], v[38:39] op_sel:[0,1] op_sel_hi:[1,0] neg_hi:[0,1]
    v_pk_add_f32 v[40:41], v[34:35], v[38:39] op_sel:[0,1] op_sel_hi:[1,0] neg_lo:[0,1]
    v_pk_fma_f32 v[12:13], v[30:31], s[20:21], v[36:37]
    v_pk_fma_f32 v[20:21], v[30:31], s[20:21], v[36:37] neg_lo:[1,0,0] neg_hi:[1,0,0]
    v_pk_fma_f32 v[16:17], v[32:33], s[20:21], v[40:41] op_sel:[1,0,0] op_sel_hi:[0,1,1] neg_hi:[1,0,0]
    v_pk_fma_f32 v[24:25], v[32:33], s[20:21], v[40:41] op_sel:[1,0,0] op_sel_hi:[0,1,1] neg_lo:[1,0,0]
    ds_write_b64 v102, v[10:11] offset:18432
    v_pk_mul_f32 v[28:29], v[12:13], v[76:77] op_sel_hi:[1,0]
    v_pk_fma_f32 v[12:13], v[12:13], v[76:77], v[28:29] op_sel:[1,1,0] op_sel_hi:[0,1,1] neg_lo:[1,0,0]
    ds_write_b64 v102, v[12:13] offset:20608
    v_pk_mul_f32 v[30:31], v[14:15], v[78:79] op_sel_hi:[1,0]
    v_pk_fma_f32 v[14:15], v[14:15], v[78:79], v[30:31] op_sel:[1,1,0] op_sel_hi:[0,1,1] neg_lo:[1,0,0]
    ds_write_b64 v102, v[14:15] offset:22784
    v_pk_mul_f32 v[32:33], v[16:17], v[80:81] op_sel_hi:[1,0]
    v_pk_fma_f32 v[16:17], v[16:17], v[80:81], v[32:33] op_sel:[1,1,0] op_sel_hi:[0,1,1] neg_lo:[1,0,0]
    ds_write_b64 v102, v[16:17] offset:24960
    v_pk_mul_f32 v[34:35], v[18:19], v[82:83] op_sel_hi:[1,0]
    v_pk_fma_f32 v[18:19], v[18:19], v[82:83], v[34:35] op_sel:[1,1,0] op_sel_hi:[0,1,1] neg_lo:[1,0,0]
    ds_write_b64 v102, v[18:19] offset:27136
    v_pk_mul_f32 v[36:37], v[20:21], v[84:85] op_sel_hi:[1,0]
    v_pk_fma_f32 v[20:21], v[20:21], v[84:85], v[36:37] op_sel:[1,1,0] op_sel_hi:[0,1,1] neg_lo:[1,0,0]
    ds_write_b64 v102, v[20:21] offset:29312
    v_pk_mul_f32 v[38:39], v[22:23], v[86:87] op_sel_hi:[1,0]
    v_pk_fma_f32 v[22:23], v[22:23], v[86:87], v[38:39] op_sel:[1,1,0] op_sel_hi:[0,1,1] neg_lo:[1,0,0]
    ds_write_b64 v102, v[22:23] offset:31488
    v_pk_mul_f32 v[40:41], v[24:25], v[88:89] op_sel_hi:[1,0]
    v_pk_fma_f32 v[24:25], v[24:25], v[88:89], v[40:41] op_sel:[1,1,0] op_sel_hi:[0,1,1] neg_lo:[1,0,0]
    ds_write_b64 v102, v[24:25] offset:33664
    s_waitcnt lgkmcnt(0)
    s_barrier
    ds_read_b64 v[10:11], v103 offset:18432
    ds_read_b64 v[14:15], v103 offset:18976
    ds_read_b64 v[18:19], v103 offset:19520
    ds_read_b64 v[22:23], v103 offset:20064
    ds_read_b64 v[12:13], v103 offset:27136
    ds_read_b64 v[16:17], v103 offset:27680
    ds_read_b64 v[20:21], v103 offset:28224
    ds_read_b64 v[24:25], v103 offset:28768
    s_waitcnt lgkmcnt(0)
    v_pk_add_f32 v[26:27], v[10:11], v[18:19]
    v_pk_add_f32 v[28:29], v[10:11], v[18:19] neg_lo:[0,1] neg_hi:[0,1]
    v_pk_add_f32 v[30:31], v[14:15], v[22:23]
    v_pk_add_f32 v[32:33], v[14:15], v[22:23] neg_lo:[0,1] neg_hi:[0,1]
    v_pk_add_f32 v[10:11], v[26:27], v[30:31]
    v_pk_add_f32 v[18:19], v[26:27], v[30:31] neg_lo:[0,1] neg_hi:[0,1]
    v_pk_add_f32 v[14:15], v[28:29], v[32:33] op_sel:[0,1] op_sel_hi:[1,0] neg_hi:[0,1]
    v_pk_add_f32 v[22:23], v[28:29], v[32:33] op_sel:[0,1] op_sel_hi:[1,0] neg_lo:[0,1]
    v_pk_add_f32 v[34:35], v[12:13], v[20:21]
    v_pk_add_f32 v[36:37], v[12:13], v[20:21] neg_lo:[0,1] neg_hi:[0,1]
    v_pk_add_f32 v[38:39], v[16:17], v[24:25]
    v_pk_add_f32 v[40:41], v[16:17], v[24:25] neg_lo:[0,1] neg_hi:[0,1]
    v_pk_add_f32 v[12:13], v[34:35], v[38:39]
    v_pk_add_f32 v[20:21], v[34:35], v[38:39] neg_lo:[0,1] neg_hi:[0,1]
    v_pk_add_f32 v[16:17], v[36:37], v[40:41] op_sel:[0,1] op_sel_hi:[1,0] neg_hi:[0,1]
    v_pk_add_f32 v[24:25], v[36:37], v[40:41] op_sel:[0,1] op_sel_hi:[1,0] neg_lo:[0,1]
    s_waitcnt vmcnt(0)
    v_lshlrev_b32 v28, 16, v90
    v_and_b32 v29, 0xffff0000, v90
    v_pk_mul_f32 v[26:27], v[10:11], v[28:29] op_sel_hi:[1,0]
    v_pk_fma_f32 v[10:11], v[10:11], v[28:29], v[26:27] op_sel:[1,1,0] op_sel_hi:[0,1,1] neg_lo:[1,0,0]
    v_lshlrev_b32 v26, 16, v91
    v_and_b32 v27, 0xffff0000, v91
    v_pk_mul_f32 v[28:29], v[12:13], v[26:27] op_sel_hi:[1,0]
    v_pk_fma_f32 v[12:13], v[12:13], v[26:27], v[28:29] op_sel:[1,1,0] op_sel_hi:[0,1,1] neg_lo:[1,0,0]
    v_lshlrev_b32 v32, 16, v92
    v_and_b32 v33, 0xffff0000, v92
    v_pk_mul_f32 v[30:31], v[14:15], v[32:33] op_sel_hi:[1,0]
    v_pk_fma_f32 v[14:15], v[14:15], v[32:33], v[30:31] op_sel:[1,1,0] op_sel_hi:[0,1,1] neg_lo:[1,0,0]
    v_lshlrev_b32 v30, 16, v93
    v_and_b32 v31, 0xffff0000, v93
    v_pk_mul_f32 v[32:33], v[16:17], v[30:31] op_sel_hi:[1,0]
    v_pk_fma_f32 v[16:17], v[16:17], v[30:31], v[32:33] op_sel:[1,1,0] op_sel_hi:[0,1,1] neg_lo:[1,0,0]
    v_lshlrev_b32 v36, 16, v94
    v_and_b32 v37, 0xffff0000, v94
    v_pk_mul_f32 v[34:35], v[18:19], v[36:37] op_sel_hi:[1,0]
    v_pk_fma_f32 v[18:19], v[18:19], v[36:37], v[34:35] op_sel:[1,1,0] op_sel_hi:[0,1,1] neg_lo:[1,0,0]
    v_lshlrev_b32 v34, 16, v95
    v_and_b32 v35, 0xffff0000, v95
    v_pk_mul_f32 v[36:37], v[20:21], v[34:35] op_sel_hi:[1,0]
    v_pk_fma_f32 v[20:21], v[20:21], v[34:35], v[36:37] op_sel:[1,1,0] op_sel_hi:[0,1,1] neg_lo:[1,0,0]
    v_lshlrev_b32 v40, 16, v96
    v_and_b32 v41, 0xffff0000, v96
    v_pk_mul_f32 v[38:39], v[22:23], v[40:41] op_sel_hi:[1,0]
    v_pk_fma_f32 v[22:23], v[22:23], v[40:41], v[38:39] op_sel:[1,1,0] op_sel_hi:[0,1,1] neg_lo:[1,0,0]
    v_lshlrev_b32 v38, 16, v97
    v_and_b32 v39, 0xffff0000, v97
    v_pk_mul_f32 v[40:41], v[24:25], v[38:39] op_sel_hi:[1,0]
    v_pk_fma_f32 v[24:25], v[24:25], v[38:39], v[40:41] op_sel:[1,1,0] op_sel_hi:[0,1,1] neg_lo:[1,0,0]
    v_pk_add_f32 v[26:27], v[10:11], v[18:19]
    v_pk_add_f32 v[34:35], v[10:11], v[18:19] neg_lo:[0,1] neg_hi:[0,1]
    v_pk_add_f32 v[28:29], v[12:13], v[20:21]
    v_pk_add_f32 v[36:37], v[12:13], v[20:21] neg_lo:[0,1] neg_hi:[0,1]
    v_pk_add_f32 v[30:31], v[14:15], v[22:23]
    v_pk_add_f32 v[38:39], v[14:15], v[22:23] neg_lo:[0,1] neg_hi:[0,1]
    v_pk_add_f32 v[32:33], v[16:17], v[24:25]
    v_pk_add_f32 v[40:41], v[16:17], v[24:25] neg_lo:[0,1] neg_hi:[0,1]
    v_pk_add_f32 v[12:13], v[26:27], v[30:31]
    v_pk_add_f32 v[16:17], v[26:27], v[30:31] neg_lo:[0,1] neg_hi:[0,1]
    v_pk_add_f32 v[20:21], v[28:29], v[32:33]
    v_pk_add_f32 v[24:25], v[28:29], v[32:33] neg_lo:[0,1] neg_hi:[0,1]
    v_pk_add_f32 v[10:11], v[12:13], v[20:21]
    v_pk_add_f32 v[18:19], v[12:13], v[20:21] neg_lo:[0,1] neg_hi:[0,1]
    v_pk_add_f32 v[14:15], v[16:17], v[24:25] op_sel:[0,1] op_sel_hi:[1,0] neg_lo:[0,1]
    v_pk_add_f32 v[22:23], v[16:17], v[24:25] op_sel:[0,1] op_sel_hi:[1,0] neg_hi:[0,1]
    v_pk_add_f32 v[26:27], v[36:37], v[36:37] op_sel:[0,1] op_sel_hi:[1,0] neg_lo:[0,1]
    v_pk_add_f32 v[28:29], v[40:41], v[40:41] op_sel:[0,1] op_sel_hi:[1,0] neg_lo:[1,1] neg_hi:[1,0]
    v_pk_add_f32 v[30:31], v[26:27], v[28:29]
    v_pk_add_f32 v[32:33], v[26:27], v[28:29] neg_lo:[0,1] neg_hi:[0,1]
    v_pk_add_f32 v[36:37], v[34:35], v[38:39] op_sel:[0,1] op_sel_hi:[1,0] neg_lo:[0,1]
    v_pk_add_f32 v[40:41], v[34:35], v[38:39] op_sel:[0,1] op_sel_hi:[1,0] neg_hi:[0,1]
    v_pk_fma_f32 v[12:13], v[30:31], s[20:21], v[36:37]
    v_pk_fma_f32 v[20:21], v[30:31], s[20:21], v[36:37] neg_lo:[1,0,0] neg_hi:[1,0,0]
    v_pk_fma_f32 v[16:17], v[32:33], s[20:21], v[40:41] op_sel:[1,0,0] op_sel_hi:[0,1,1] neg_lo:[1,0,0]
    v_pk_fma_f32 v[24:25], v[32:33], s[20:21], v[40:41] op_sel:[1,0,0] op_sel_hi:[0,1,1] neg_hi:[1,0,0]
    ds_write_b64 v98, v[10:11] offset:0
    v_pk_mul_f32 v[28:29], v[12:13], v[44:45] op_sel_hi:[1,0]
    v_pk_fma_f32 v[12:13], v[12:13], v[44:45], v[28:29] op_sel:[1,1,0] op_sel_hi:[0,1,1] neg_hi:[1,0,0]
    ds_write_b64 v98, v[12:13] offset:2048
    v_pk_mul_f32 v[30:31], v[14:15], v[46:47] op_sel_hi:[1,0]
    v_pk_fma_f32 v[14:15], v[14:15], v[46:47], v[30:31] op_sel:[1,1,0] op_sel_hi:[0,1,1] neg_hi:[1,0,0]
    ds_write_b64 v98, v[14:15] offset:4096
    v_pk_mul_f32 v[32:33], v[16:17], v[48:49] op_sel_hi:[1,0]
    v_pk_fma_f32 v[16:17], v[16:17], v[48:49], v[32:33] op_sel:[1,1,0] op_sel_hi:[0,1,1] neg_hi:[1,0,0]
    ds_write_b64 v98, v[16:17] offset:6144
    v_pk_mul_f32 v[34:35], v[18:19], v[50:51] op_sel_hi:[1,0]
    v_pk_fma_f32 v[18:19], v[18:19], v[50:51], v[34:35] op_sel:[1,1,0] op_sel_hi:[0,1,1] neg_hi:[1,0,0]
    ds_write_b64 v98, v[18:19] offset:8192
    v_pk_mul_f32 v[36:37], v[20:21], v[52:53] op_sel_hi:[1,0]
    v_pk_fma_f32 v[20:21], v[20:21], v[52:53], v[36:37] op_sel:[1,1,0] op_sel_hi:[0,1,1] neg_hi:[1,0,0]
    ds_write_b64 v98, v[20:21] offset:10240
    v_pk_mul_f32 v[38:39], v[22:23], v[54:55] op_sel_hi:[1,0]
    v_pk_fma_f32 v[22:23], v[22:23], v[54:55], v[38:39] op_sel:[1,1,0] op_sel_hi:[0,1,1] neg_hi:[1,0,0]
    ds_write_b64 v98, v[22:23] offset:12288
    v_pk_mul_f32 v[40:41], v[24:25], v[56:57] op_sel_hi:[1,0]
    v_pk_fma_f32 v[24:25], v[24:25], v[56:57], v[40:41] op_sel:[1,1,0] op_sel_hi:[0,1,1] neg_hi:[1,0,0]
    ds_write_b64 v98, v[24:25] offset:14336
    s_waitcnt lgkmcnt(0)
    s_barrier
    ds_read_b64 v[10:11], v99 offset:0
    ds_read_b64 v[18:19], v99 offset:1024
    ds_read_b64 v[12:13], v99 offset:256
    ds_read_b64 v[20:21], v99 offset:1280
    ds_read_b64 v[14:15], v99 offset:512
    ds_read_b64 v[22:23], v99 offset:1536
    ds_read_b64 v[16:17], v99 offset:768
    ds_read_b64 v[24:25], v99 offset:1792
    s_waitcnt lgkmcnt(6)
    v_pk_add_f32 v[26:27], v[10:11], v[18:19]
    v_pk_add_f32 v[34:35], v[10:11], v[18:19] neg_lo:[0,1] neg_hi:[0,1]
    s_waitcnt lgkmcnt(4)
    v_pk_add_f32 v[28:29], v[12:13], v[20:21]
    v_pk_add_f32 v[36:37], v[12:13], v[20:21] neg_lo:[0,1] neg_hi:[0,1]
    s_waitcnt lgkmcnt(2)
    v_pk_add_f32 v[30:31], v[14:15], v[22:23]
    v_pk_add_f32 v[38:39], v[14:15], v[22:23] neg_lo:[0,1] neg_hi:[0,1]
    s_waitcnt lgkmcnt(0)
    v_pk_add_f32 v[32:33], v[16:17], v[24:25]
    v_pk_add_f32 v[40:41], v[16:17], v[24:25] neg_lo:[0,1] neg_hi:[0,1]
    v_pk_add_f32 v[12:13], v[26:27], v[30:31]
    v_pk_add_f32 v[16:17], v[26:27], v[30:31] neg_lo:[0,1] neg_hi:[0,1]
    v_pk_add_f32 v[20:21], v[28:29], v[32:33]
    v_pk_add_f32 v[24:25], v[28:29], v[32:33] neg_lo:[0,1] neg_hi:[0,1]
    v_pk_add_f32 v[10:11], v[12:13], v[20:21]
    v_pk_add_f32 v[18:19], v[12:13], v[20:21] neg_lo:[0,1] neg_hi:[0,1]
    v_pk_add_f32 v[14:15], v[16:17], v[24:25] op_sel:[0,1] op_sel_hi:[1,0] neg_lo:[0,1]
    v_pk_add_f32 v[22:23], v[16:17], v[24:25] op_sel:[0,1] op_sel_hi:[1,0] neg_hi:[0,1]
    v_pk_add_f32 v[26:27], v[36:37], v[36:37] op_sel:[0,1] op_sel_hi:[1,0] neg_lo:[0,1]
    v_pk_add_f32 v[28:29], v[40:41], v[40:41] op_sel:[0,1] op_sel_hi:[1,0] neg_lo:[1,1] neg_hi:[1,0]
    v_pk_add_f32 v[30:31], v[26:27], v[28:29]
    v_pk_add_f32 v[32:33], v[26:27], v[28:29] neg_lo:[0,1] neg_hi:[0,1]
    v_pk_add_f32 v[36:37], v[34:35], v[38:39] op_sel:[0,1] op_sel_hi:[1,0] neg_lo:[0,1]
    v_pk_add_f32 v[40:41], v[34:35], v[38:39] op_sel:[0,1] op_sel_hi:[1,0] neg_hi:[0,1]
    v_pk_fma_f32 v[12:13], v[30:31], s[20:21], v[36:37]
    v_pk_fma_f32 v[20:21], v[30:31], s[20:21], v[36:37] neg_lo:[1,0,0] neg_hi:[1,0,0]
    v_pk_fma_f32 v[16:17], v[32:33], s[20:21], v[40:41] op_sel:[1,0,0] op_sel_hi:[0,1,1] neg_lo:[1,0,0]
    v_pk_fma_f32 v[24:25], v[32:33], s[20:21], v[40:41] op_sel:[1,0,0] op_sel_hi:[0,1,1] neg_hi:[1,0,0]
    ds_write_b64 v100, v[10:11] offset:36864
    v_pk_mul_f32 v[28:29], v[12:13], v[60:61] op_sel_hi:[1,0]
    v_pk_fma_f32 v[12:13], v[12:13], v[60:61], v[28:29] op_sel:[1,1,0] op_sel_hi:[0,1,1] neg_hi:[1,0,0]
    ds_write_b64 v100, v[12:13] offset:37152
    v_pk_mul_f32 v[30:31], v[14:15], v[62:63] op_sel_hi:[1,0]
    v_pk_fma_f32 v[14:15], v[14:15], v[62:63], v[30:31] op_sel:[1,1,0] op_sel_hi:[0,1,1] neg_hi:[1,0,0]
    ds_write_b64 v100, v[14:15] offset:37440
    v_pk_mul_f32 v[32:33], v[16:17], v[64:65] op_sel_hi:[1,0]
    v_pk_fma_f32 v[16:17], v[16:17], v[64:65], v[32:33] op_sel:[1,1,0] op_sel_hi:[0,1,1] neg_hi:[1,0,0]
    ds_write_b64 v100, v[16:17] offset:37728
    v_pk_mul_f32 v[34:35], v[18:19], v[66:67] op_sel_hi:[1,0]
    v_pk_fma_f32 v[18:19], v[18:19], v[66:67], v[34:35] op_sel:[1,1,0] op_sel_hi:[0,1,1] neg_hi:[1,0,0]
    ds_write_b64 v100, v[18:19] offset:38016
    v_pk_mul_f32 v[36:37], v[20:21], v[68:69] op_sel_hi:[1,0]
    v_pk_fma_f32 v[20:21], v[20:21], v[68:69], v[36:37] op_sel:[1,1,0] op_sel_hi:[0,1,1] neg_hi:[1,0,0]
    ds_write_b64 v100, v[20:21] offset:38304
    v_pk_mul_f32 v[38:39], v[22:23], v[70:71] op_sel_hi:[1,0]
    v_pk_fma_f32 v[22:23], v[22:23], v[70:71], v[38:39] op_sel:[1,1,0] op_sel_hi:[0,1,1] neg_hi:[1,0,0]
    ds_write_b64 v100, v[22:23] offset:38592
    v_pk_mul_f32 v[40:41], v[24:25], v[72:73] op_sel_hi:[1,0]
    v_pk_fma_f32 v[24:25], v[24:25], v[72:73], v[40:41] op_sel:[1,1,0] op_sel_hi:[0,1,1] neg_hi:[1,0,0]
    ds_write_b64 v100, v[24:25] offset:38880
    ds_read_b64 v[10:11], v101 offset:36864
    ds_read_b64 v[18:19], v101 offset:36992
    ds_read_b64 v[12:13], v101 offset:36896
    ds_read_b64 v[20:21], v101 offset:37024
    ds_read_b64 v[14:15], v101 offset:36928
    ds_read_b64 v[22:23], v101 offset:37056
    ds_read_b64 v[16:17], v101 offset:36960
    ds_read_b64 v[24:25], v101 offset:37088
    s_waitcnt lgkmcnt(6)
    v_pk_add_f32 v[26:27], v[10:11], v[18:19]
    v_pk_add_f32 v[34:35], v[10:11], v[18:19] neg_lo:[0,1] neg_hi:[0,1]
    s_waitcnt lgkmcnt(4)
    v_pk_add_f32 v[28:29], v[12:13], v[20:21]
    v_pk_add_f32 v[36:37], v[12:13], v[20:21] neg_lo:[0,1] neg_hi:[0,1]
    s_waitcnt lgkmcnt(2)
    v_pk_add_f32 v[30:31], v[14:15], v[22:23]
    v_pk_add_f32 v[38:39], v[14:15], v[22:23] neg_lo:[0,1] neg_hi:[0,1]
    s_waitcnt lgkmcnt(0)
    v_pk_add_f32 v[32:33], v[16:17], v[24:25]
    v_pk_add_f32 v[40:41], v[16:17], v[24:25] neg_lo:[0,1] neg_hi:[0,1]
    v_pk_add_f32 v[12:13], v[26:27], v[30:31]
    v_pk_add_f32 v[16:17], v[26:27], v[30:31] neg_lo:[0,1] neg_hi:[0,1]
    v_pk_add_f32 v[20:21], v[28:29], v[32:33]
    v_pk_add_f32 v[24:25], v[28:29], v[32:33] neg_lo:[0,1] neg_hi:[0,1]
    v_pk_add_f32 v[10:11], v[12:13], v[20:21]
    v_pk_add_f32 v[18:19], v[12:13], v[20:21] neg_lo:[0,1] neg_hi:[0,1]
    v_pk_add_f32 v[14:15], v[16:17], v[24:25] op_sel:[0,1] op_sel_hi:[1,0] neg_lo:[0,1]
    v_pk_add_f32 v[22:23], v[16:17], v[24:25] op_sel:[0,1] op_sel_hi:[1,0] neg_hi:[0,1]
    v_pk_add_f32 v[26:27], v[36:37], v[36:37] op_sel:[0,1] op_sel_hi:[1,0] neg_lo:[0,1]
    v_pk_add_f32 v[28:29], v[40:41], v[40:41] op_sel:[0,1] op_sel_hi:[1,0] neg_lo:[1,1] neg_hi:[1,0]
    v_pk_add_f32 v[30:31], v[26:27], v[28:29]
    v_pk_add_f32 v[32:33], v[26:27], v[28:29] neg_lo:[0,1] neg_hi:[0,1]
    v_pk_add_f32 v[36:37], v[34:35], v[38:39] op_sel:[0,1] op_sel_hi:[1,0] neg_lo:[0,1]
    v_pk_add_f32 v[40:41], v[34:35], v[38:39] op_sel:[0,1] op_sel_hi:[1,0] neg_hi:[0,1]
    v_pk_fma_f32 v[12:13], v[30:31], s[20:21], v[36:37]
    v_pk_fma_f32 v[20:21], v[30:31], s[20:21], v[36:37] neg_lo:[1,0,0] neg_hi:[1,0,0]
    v_pk_fma_f32 v[16:17], v[32:33], s[20:21], v[40:41] op_sel:[1,0,0] op_sel_hi:[0,1,1] neg_lo:[1,0,0]
    v_pk_fma_f32 v[24:25], v[32:33], s[20:21], v[40:41] op_sel:[1,0,0] op_sel_hi:[0,1,1] neg_hi:[1,0,0]
    ds_write_b64 v102, v[10:11] offset:18432
    v_pk_mul_f32 v[28:29], v[12:13], v[76:77] op_sel_hi:[1,0]
    v_pk_fma_f32 v[12:13], v[12:13], v[76:77], v[28:29] op_sel:[1,1,0] op_sel_hi:[0,1,1] neg_hi:[1,0,0]
    ds_write_b64 v102, v[12:13] offset:20608
    v_pk_mul_f32 v[30:31], v[14:15], v[78:79] op_sel_hi:[1,0]
    v_pk_fma_f32 v[14:15], v[14:15], v[78:79], v[30:31] op_sel:[1,1,0] op_sel_hi:[0,1,1] neg_hi:[1,0,0]
    ds_write_b64 v102, v[14:15] offset:22784
    v_pk_mul_f32 v[32:33], v[16:17], v[80:81] op_sel_hi:[1,0]
    v_pk_fma_f32 v[16:17], v[16:17], v[80:81], v[32:33] op_sel:[1,1,0] op_sel_hi:[0,1,1] neg_hi:[1,0,0]
    ds_write_b64 v102, v[16:17] offset:24960
    v_pk_mul_f32 v[34:35], v[18:19], v[82:83] op_sel_hi:[1,0]
    v_pk_fma_f32 v[18:19], v[18:19], v[82:83], v[34:35] op_sel:[1,1,0] op_sel_hi:[0,1,1] neg_hi:[1,0,0]
    ds_write_b64 v102, v[18:19] offset:27136
    v_pk_mul_f32 v[36:37], v[20:21], v[84:85] op_sel_hi:[1,0]
    v_pk_fma_f32 v[20:21], v[20:21], v[84:85], v[36:37] op_sel:[1,1,0] op_sel_hi:[0,1,1] neg_hi:[1,0,0]
    ds_write_b64 v102, v[20:21] offset:29312
    v_pk_mul_f32 v[38:39], v[22:23], v[86:87] op_sel_hi:[1,0]
    v_pk_fma_f32 v[22:23], v[22:23], v[86:87], v[38:39] op_sel:[1,1,0] op_sel_hi:[0,1,1] neg_hi:[1,0,0]
    ds_write_b64 v102, v[22:23] offset:31488
    v_pk_mul_f32 v[40:41], v[24:25], v[88:89] op_sel_hi:[1,0]
    v_pk_fma_f32 v[24:25], v[24:25], v[88:89], v[40:41] op_sel:[1,1,0] op_sel_hi:[0,1,1] neg_hi:[1,0,0]
    ds_write_b64 v102, v[24:25] offset:33664
    s_waitcnt lgkmcnt(0)
    s_barrier
    ds_read_b64 v[10:11], v103 offset:18432
    ds_read_b64 v[14:15], v103 offset:18976
    ds_read_b64 v[18:19], v103 offset:19520
    ds_read_b64 v[22:23], v103 offset:20064
    ds_read_b64 v[12:13], v103 offset:27136
    ds_read_b64 v[16:17], v103 offset:27680
    ds_read_b64 v[20:21], v103 offset:28224
    ds_read_b64 v[24:25], v103 offset:28768
    s_waitcnt lgkmcnt(0)
    v_pk_add_f32 v[26:27], v[10:11], v[18:19]
    v_pk_add_f32 v[28:29], v[10:11], v[18:19] neg_lo:[0,1] neg_hi:[0,1]
    v_pk_add_f32 v[30:31], v[14:15], v[22:23]
    v_pk_add_f32 v[32:33], v[14:15], v[22:23] neg_lo:[0,1] neg_hi:[0,1]
    v_pk_add_f32 v[10:11], v[26:27], v[30:31]
    v_pk_add_f32 v[18:19], v[26:27], v[30:31] neg_lo:[0,1] neg_hi:[0,1]
    v_pk_add_f32 v[14:15], v[28:29], v[32:33] op_sel:[0,1] op_sel_hi:[1,0] neg_lo:[0,1]
    v_pk_add_f32 v[22:23], v[28:29], v[32:33] op_sel:[0,1] op_sel_hi:[1,0] neg_hi:[0,1]
    v_pk_add_f32 v[34:35], v[12:13], v[20:21]
    v_pk_add_f32 v[36:37], v[12:13], v[20:21] neg_lo:[0,1] neg_hi:[0,1]
    v_pk_add_f32 v[38:39], v[16:17], v[24:25]
    v_pk_add_f32 v[40:41], v[16:17], v[24:25] neg_lo:[0,1] neg_hi:[0,1]
    v_pk_add_f32 v[12:13], v[34:35], v[38:39]
    v_pk_add_f32 v[20:21], v[34:35], v[38:39] neg_lo:[0,1] neg_hi:[0,1]
    v_pk_add_f32 v[16:17], v[36:37], v[40:41] op_sel:[0,1] op_sel_hi:[1,0] neg_lo:[0,1]
    v_pk_add_f32 v[24:25], v[36:37], v[40:41] op_sel:[0,1] op_sel_hi:[1,0] neg_hi:[0,1]
    v_lshrrev_b32 v4, 3, v0
    v_mul_u32_u24 v4, 16640, v4
    v_and_b32 v5, 7, v0
    v_lshl_add_u32 v4, v5, 3, v4
    s_lshl_b32 s28, s95, 6
    s_add_u32 s29, s28, 0x2a00000
    buffer_store_dwordx2 v[10:11], v4, s[12:15], s29 offen sc1
    s_add_u32 s29, s28, 0x2a82000
    buffer_store_dwordx2 v[12:13], v4, s[12:15], s29 offen sc1
    s_add_u32 s29, s28, 0x2b04000
    buffer_store_dwordx2 v[14:15], v4, s[12:15], s29 offen sc1
    s_add_u32 s29, s28, 0x2b86000
    buffer_store_dwordx2 v[16:17], v4, s[12:15], s29 offen sc1
    s_add_u32 s29, s28, 0x2c08000
    buffer_store_dwordx2 v[18:19], v4, s[12:15], s29 offen sc1
    s_add_u32 s29, s28, 0x2c8a000
    buffer_store_dwordx2 v[20:21], v4, s[12:15], s29 offen sc1
    s_add_u32 s29, s28, 0x2d0c000
    buffer_store_dwordx2 v[22:23], v4, s[12:15], s29 offen sc1
    s_add_u32 s29, s28, 0x2d8e000
    buffer_store_dwordx2 v[24:25], v4, s[12:15], s29 offen sc1
    s_branch Ljoin_59
Lskip_58:
    s_barrier
    s_barrier
    s_barrier
    s_barrier
    s_barrier
Ljoin_59:
    s_branch Lspj_57
Lsp_56:
    s_cmp_ge_u32 s3, 4
    s_cbranch_scc1 Lskip_63
    s_getpc_b64 s[16:17]
Lpc_65:
    s_add_u32 s16, s16, tab_tw2048a-Lpc_65
    s_addc_u32 s17, s17, 0
    s_and_b32 s17, s17, 0xffff
    s_mov_b32 s18, 0x800
    s_mov_b32 s19, 0x00020000
    s_mov_b32 s20, 0x3f3504f3
    s_mov_b32 s21, s20
    s_mov_b64 s[6:7], s[84:85]
    s_mov_b32 s12, s6
    s_and_b32 s13, s7, 0xffff
    s_mov_b32 s14, 0x10000000
    s_mov_b32 s15, 0x00020000
    v_lshlrev_b32 v3, 3, v0
    buffer_load_dwordx2 v[44:45], v3, s[16:19], 0 offen
    v_and_b32 v5, 31, v0
    v_lshlrev_b32 v5, 6, v5
    buffer_load_dwordx2 v[60:61], v5, s[16:19], 0 offen
    v_and_b32 v5, 3, v0
    v_lshlrev_b32 v5, 9, v5
    buffer_load_dwordx2 v[76:77], v5, s[16:19], 0 offen
    v_lshlrev_b32 v6, 2, v0
    v_sub_u32 v7, 2048, v0
    v_and_b32 v7, 2047, v7
    v_lshlrev_b32 v7, 2, v7
    s_mov_b32 s29, 0x420000
    buffer_load_dword v104, v6, s[12:15], s29 offen
    s_mov_b32 s29, 0x620000
    buffer_load_dword v105, v6, s[12:15], s29 offen
    s_mov_b32 s29, 0x420000
    buffer_load_dword v106, v7, s[12:15], s29 offen
    s_mov_b32 s29, 0x620000
    buffer_load_dword v107, v7, s[12:15], s29 offen
    v_sub_u32 v7, 1792, v0
    v_and_b32 v7, 2047, v7
    v_lshlrev_b32 v7, 2, v7
    s_mov_b32 s29, 0x420400
    buffer_load_dword v108, v6, s[12:15], s29 offen
    s_mov_b32 s29, 0x620400
    buffer_load_dword v109, v6, s[12:15], s29 offen
    s_mov_b32 s29, 0x420000
    buffer_load_dword v110, v7, s[12:15], s29 offen
    s_mov_b32 s29, 0x620000
    buffer_load_dword v111, v7, s[12:15], s29 offen
    v_sub_u32 v7, 1536, v0
    v_and_b32 v7, 2047, v7
    v_lshlrev_b32 v7, 2, v7
    s_mov_b32 s29, 0x420800
    buffer_load_dword v112, v6, s[12:15], s29 offen
    s_mov_b32 s29, 0x620800
    buffer_load_dword v113, v6, s[12:15], s29 offen
    s_mov_b32 s29, 0x420000
    buffer_load_dword v114, v7, s[12:15], s29 offen
    s_mov_b32 s29, 0x620000
    buffer_load_dword v115, v7, s[12:15], s29 offen
    v_sub_u32 v7, 1280, v0
    v_and_b32 v7, 2047, v7
    v_lshlrev_b32 v7, 2, v7
    s_mov_b32 s29, 0x420c00
    buffer_load_dword v116, v6, s[12:15], s29 offen
    s_mov_b32 s29, 0x620c00
    buffer_load_dword v117, v6, s[12:15], s29 offen
    s_mov_b32 s29, 0x420000
    buffer_load_dword v118, v7, s[12:15], s29 offen
    s_mov_b32 s29, 0x620000
    buffer_load_dword v119, v7, s[12:15], s29 offen
    v_sub_u32 v7, 1024, v0
    v_and_b32 v7, 2047, v7
    v_lshlrev_b32 v7, 2, v7
    s_mov_b32 s29, 0x421000
    buffer_load_dword v120, v6, s[12:15], s29 offen
    s_mov_b32 s29, 0x621000
    buffer_load_dword v121, v6, s[12:15], s29 offen
    s_mov_b32 s29, 0x420000
    buffer_load_dword v122, v7, s[12:15], s29 offen
    s_mov_b32 s29, 0x620000
    buffer_load_dword v123, v7, s[12:15], s29 offen
    v_sub_u32 v7, 768, v0
    v_and_b32 v7, 2047, v7
    v_lshlrev_b32 v7, 2, v7
    s_mov_b32 s29, 0x421400
    buffer_load_dword v124, v6, s[12:15], s29 offen
    s_mov_b32 s29, 0x621400
    buffer_load_dword v125, v6, s[12:15], s29 offen
    s_mov_b32 s29, 0x420000
    buffer_load_dword v126, v7, s[12:15], s29 offen
    s_mov_b32 s29, 0x620000
    buffer_load_dword v127, v7, s[12:15], s29 offen
    v_sub_u32 v7, 512, v0
    v_and_b32 v7, 2047, v7
    v_lshlrev_b32 v7, 2, v7
    s_mov_b32 s29, 0x421800
    buffer_load_dword v128, v6, s[12:15], s29 offen
    s_mov_b32 s29, 0x621800
    buffer_load_dword v129, v6, s[12:15], s29 offen
    s_mov_b32 s29, 0x420000
    buffer_load_dword v130, v7, s[12:15], s29 offen
    s_mov_b32 s29, 0x620000
    buffer_load_dword v131, v7, s[12:15], s29 offen
    v_sub_u32 v7, 256, v0
    v_and_b32 v7, 2047, v7
    v_lshlrev_b32 v7, 2, v7
    s_mov_b32 s29, 0x421c00
    buffer_load_dword v132, v6, s[12:15], s29 offen
    s_mov_b32 s29, 0x621c00
    buffer_load_dword v133, v6, s[12:15], s29 offen
    s_mov_b32 s29, 0x420000
    buffer_load_dword v134, v7, s[12:15], s29 offen
    s_mov_b32 s29, 0x620000
    buffer_load_dword v135, v7, s[12:15], s29 offen
    s_waitcnt vmcnt(0)
    s_mov_b32 s22, 0.25
    s_mov_b32 s23, 0.25
    v_lshlrev_b32 v26, 16, v104
    v_and_b32 v27, 0xffff0000, v104
    v_lshlrev_b32 v28, 16, v105
    v_and_b32 v29, 0xffff0000, v105
    v_lshlrev_b32 v30, 16, v106
    v_and_b32 v31, 0xffff0000, v106
    v_lshlrev_b32 v32, 16, v107
    v_and_b32 v33, 0xffff0000, v107
    v_pk_add_f32 v[26:27], v[26:27], v[30:31] neg_hi:[0,1]
    v_pk_add_f32 v[28:29], v[28:29], v[32:33] neg_hi:[0,1]
    v_pk_add_f32 v[30:31], v[26:27], v[28:29]
    v_pk_add_f32 v[32:33], v[26:27], v[28:29] neg_lo:[0,1] neg_hi:[0,1]
    v_pk_mul_f32 v[104:105], v[30:31], s[22:23]
    v_pk_mul_f32 v[106:107], v[32:33], s[22:23]
    v_lshlrev_b32 v26, 16, v108
    v_and_b32 v27, 0xffff0000, v108
    v_lshlrev_b32 v28, 16, v109
    v_and_b32 v29, 0xffff0000, v109
    v_lshlrev_b32 v30, 16, v110
    v_and_b32 v31, 0xffff0000, v110
    v_lshlrev_b32 v32, 16, v111
    v_and_b32 v33, 0xffff0000, v111
    v_pk_add_f32 v[26:27], v[26:27], v[30:31] neg_hi:[0,1]
    v_pk_add_f32 v[28:29], v[28:29], v[32:33] neg_hi:[0,1]
    v_pk_add_f32 v[30:31], v[26:27], v[28:29]
    v_pk_add_f32 v[32:33], v[26:27], v[28:29] neg_lo:[0,1] neg_hi:[0,1]
    v_pk_mul_f32 v[108:109], v[30:31], s[22:23]
    v_pk_mul_f32 v[110:111], v[32:33], s[22:23]
    v_lshlrev_b32 v26, 16, v112
    v_and_b32 v27, 0xffff0000, v112
    v_lshlrev_b32 v28, 16, v113
    v_and_b32 v29, 0xffff0000, v113
    v_lshlrev_b32 v30, 16, v114
    v_and_b32 v31, 0xffff0000, v114
    v_lshlrev_b32 v32, 16, v115
    v_and_b32 v33, 0xffff0000, v115
    v_pk_add_f32 v[26:27], v[26:27], v[30:31] neg_hi:[0,1]
    v_pk_add_f32 v[28:29], v[28:29], v[32:33] neg_hi:[0,1]
    v_pk_add_f32 v[30:31], v[26:27], v[28:29]
    v_pk_add_f32 v[32:33], v[26:27], v[28:29] neg_lo:[0,1] neg_hi:[0,1]
    v_pk_mul_f32 v[112:113], v[30:31], s[22:23]
    v_pk_mul_f32 v[114:115], v[32:33], s[22:23]
    v_lshlrev_b32 v26, 16, v116
    v_and_b32 v27, 0xffff0000, v116
    v_lshlrev_b32 v28, 16, v117
    v_and_b32 v29, 0xffff0000, v117
    v_lshlrev_b32 v30, 16, v118
    v_and_b32 v31, 0xffff0000, v118
    v_lshlrev_b32 v32, 16, v119
    v_and_b32 v33, 0xffff0000, v119
    v_pk_add_f32 v[26:27], v[26:27], v[30:31] neg_hi:[0,1]
    v_pk_add_f32 v[28:29], v[28:29], v[32:33] neg_hi:[0,1]
    v_pk_add_f32 v[30:31], v[26:27], v[28:29]
    v_pk_add_f32 v[32:33], v[26:27], v[28:29] neg_lo:[0,1] neg_hi:[0,1]
    v_pk_mul_f32 v[116:117], v[30:31], s[22:23]
    v_pk_mul_f32 v[118:119], v[32:33], s[22:23]
    v_lshlrev_b32 v26, 16, v120
    v_and_b32 v27, 0xffff0000, v120
    v_lshlrev_b32 v28, 16, v121
    v_and_b32 v29, 0xffff0000, v121
    v_lshlrev_b32 v30, 16, v122
    v_and_b32 v31, 0xffff0000, v122
    v_lshlrev_b32 v32, 16, v123
    v_and_b32 v33, 0xffff0000, v123
    v_pk_add_f32 v[26:27], v[26:27], v[30:31] neg_hi:[0,1]
    v_pk_add_f32 v[28:29], v[28:29], v[32:33] neg_hi:[0,1]
    v_pk_add_f32 v[30:31], v[26:27], v[28:29]
    v_pk_add_f32 v[32:33], v[26:27], v[28:29] neg_lo:[0,1] neg_hi:[0,1]
    v_pk_mul_f32 v[120:121], v[30:31], s[22:23]
    v_pk_mul_f32 v[122:123], v[32:33], s[22:23]
    v_lshlrev_b32 v26, 16, v124
    v_and_b32 v27, 0xffff0000, v124
    v_lshlrev_b32 v28, 16, v125
    v_and_b32 v29, 0xffff0000, v125
    v_lshlrev_b32 v30, 16, v126
    v_and_b32 v31, 0xffff0000, v126
    v_lshlrev_b32 v32, 16, v127
    v_and_b32 v33, 0xffff0000, v127
    v_pk_add_f32 v[26:27], v[26:27], v[30:31] neg_hi:[0,1]
    v_pk_add_f32 v[28:29], v[28:29], v[32:33] neg_hi:[0,1]
    v_pk_add_f32 v[30:31], v[26:27], v[28:29]
    v_pk_add_f32 v[32:33], v[26:27], v[28:29] neg_lo:[0,1] neg_hi:[0,1]
    v_pk_mul_f32 v[124:125], v[30:31], s[22:23]
    v_pk_mul_f32 v[126:127], v[32:33], s[22:23]
    v_lshlrev_b32 v26, 16, v128
    v_and_b32 v27, 0xffff0000, v128
    v_lshlrev_b32 v28, 16, v129
    v_and_b32 v29, 0xffff0000, v129
    v_lshlrev_b32 v30, 16, v130
    v_and_b32 v31, 0xffff0000, v130
    v_lshlrev_b32 v32, 16, v131
    v_and_b32 v33, 0xffff0000, v131
    v_pk_add_f32 v[26:27], v[26:27], v[30:31] neg_hi:[0,1]
    v_pk_add_f32 v[28:29], v[28:29], v[32:33] neg_hi:[0,1]
    v_pk_add_f32 v[30:31], v[26:27], v[28:29]
    v_pk_add_f32 v[32:33], v[26:27], v[28:29] neg_lo:[0,1] neg_hi:[0,1]
    v_pk_mul_f32 v[128:129], v[30:31], s[22:23]
    v_pk_mul_f32 v[130:131], v[32:33], s[22:23]
    v_lshlrev_b32 v26, 16, v132
    v_and_b32 v27, 0xffff0000, v132
    v_lshlrev_b32 v28, 16, v133
    v_and_b32 v29, 0xffff0000, v133
    v_lshlrev_b32 v30, 16, v134
    v_and_b32 v31, 0xffff0000, v134
    v_lshlrev_b32 v32, 16, v135
    v_and_b32 v33, 0xffff0000, v135
    v_pk_add_f32 v[26:27], v[26:27], v[30:31] neg_hi:[0,1]
    v_pk_add_f32 v[28:29], v[28:29], v[32:33] neg_hi:[0,1]
    v_pk_add_f32 v[30:31], v[26:27], v[28:29]
    v_pk_add_f32 v[32:33], v[26:27], v[28:29] neg_lo:[0,1] neg_hi:[0,1]
    v_pk_mul_f32 v[132:133], v[30:31], s[22:23]
    v_pk_mul_f32 v[134:135], v[32:33], s[22:23]
    v_lshlrev_b32 v98, 3, v0
    v_lshrrev_b32 v7, 5, v0
    v_and_b32 v8, 31, v0
    v_lshl_add_u32 v9, v7, 8, v8
    v_lshlrev_b32 v99, 3, v9
    v_mul_u32_u24 v9, 288, v7
    v_add_u32 v8, v9, v8
    v_lshlrev_b32 v100, 3, v8
    v_bfe_u32 v8, v0, 2, 3
    v_mul_u32_u24 v8, 36, v8
    v_add_u32 v9, v9, v8
    v_and_b32 v8, 3, v0
    v_add_u32 v9, v9, v8
    v_lshlrev_b32 v101, 3, v9
    v_lshlrev_b32 v9, 2, v7
    v_bfe_u32 v7, v0, 2, 2
    v_add_u32 v9, v9, v7
    v_bfe_u32 v7, v0, 4, 1
    v_lshl_add_u32 v9, v7, 5, v9
    v_mul_u32_u24 v8, 68, v8
    v_add_u32 v9, v9, v8
    v_lshlrev_b32 v102, 3, v9
    v_and_b32 v7, 7, v0
    v_lshlrev_b32 v9, 2, v7
    v_bfe_u32 v7, v0, 3, 2
    v_add_u32 v9, v9, v7
    v_bfe_u32 v7, v0, 5, 1
    v_lshl_add_u32 v9, v7, 5, v9
    v_lshrrev_b32 v7, 6, v0
    v_mul_u32_u24 v7, 272, v7
    v_add_u32 v9, v9, v7
    v_lshlrev_b32 v103, 3, v9
    s_cmp_lg_u32 s3, 0
    s_cbranch_scc1 Lpd_66
    s_lshr_b32 s92, s2, 4
    s_lshl_b32 s92, s92, 8
    s_add_u32 s92, s92, 69632
    v_mov_b32 v159, 0
    s_mov_b32 s93, 0
Lpl_67:
    v_mov_b32 v158, 0
    s_mov_b64 exec, 1
    buffer_atomic_add v158, v159, s[96:99], s92 offen sc0 sc1
    s_mov_b64 exec, -1
    s_waitcnt vmcnt(0)
    v_readfirstlane_b32 s94, v158
    s_add_u32 s93, s93, 1
    s_cmp_ge_u32 s94, 16
    s_cbranch_scc1 Lpd_66
    s_cmp_gt_u32 s93, 0x40000
    s_cbranch_scc1 Lpd_66
    s_sleep 2
    s_branch Lpl_67
Lpd_66:
    s_barrier
    s_mul_i32 s28, s95, 16640
    s_add_u32 s28, s28, 0x2500000
    s_add_u32 s36, s28, 0
    s_add_u32 s37, s28, 4096
    s_add_u32 s38, s28, 8192
    s_add_u32 s39, s28, 12288
    buffer_load_dwordx2 v[10:11], v3, s[12:15], s36 offen offset:0
    buffer_load_dwordx2 v[12:13], v3, s[12:15], s36 offen offset:2048
    buffer_load_dwordx2 v[14:15], v3, s[12:15], s37 offen offset:0
    buffer_load_dwordx2 v[16:17], v3, s[12:15], s37 offen offset:2048
    buffer_load_dwordx2 v[18:19], v3, s[12:15], s38 offen offset:0
    buffer_load_dwordx2 v[20:21], v3, s[12:15], s38 offen offset:2048
    buffer_load_dwordx2 v[22:23], v3, s[12:15], s39 offen offset:0
    buffer_load_dwordx2 v[24:25], v3, s[12:15], s39 offen offset:2048
    s_waitcnt vmcnt(8)
    v_pk_mul_f32 v[26:27], v[44:45], v[44:45] op_sel_hi:[1,0]
    v_pk_fma_f32 v[46:47], v[44:45], v[44:45], v[26:27] op_sel:[1,1,0] op_sel_hi:[0,1,1] neg_lo:[1,0,0]
    v_pk_mul_f32 v[28:29], v[46:47], v[44:45] op_sel_hi:[1,0]
    v_pk_fma_f32 v[48:49], v[46:47], v[44:45], v[28:29] op_sel:[1,1,0] op_sel_hi:[0,1,1] neg_lo:[1,0,0]
    v_pk_mul_f32 v[26:27], v[46:47], v[46:47] op_sel_hi:[1,0]
    v_pk_fma_f32 v[50:51], v[46:47], v[46:47], v[26:27] op_sel:[1,1,0] op_sel_hi:[0,1,1] neg_lo:[1,0,0]
    v_pk_mul_f32 v[28:29], v[50:51], v[44:45] op_sel_hi:[1,0]
    v_pk_fma_f32 v[52:53], v[50:51], v[44:45], v[28:29] op_sel:[1,1,0] op_sel_hi:[0,1,1] neg_lo:[1,0,0]
    v_pk_mul_f32 v[26:27], v[48:49], v[48:49] op_sel_hi:[1,0]
    v_pk_fma_f32 v[54:55], v[48:49], v[48:49], v[26:27] op_sel:[1,1,0] op_sel_hi:[0,1,1] neg_lo:[1,0,0]
    v_pk_mul_f32 v[28:29], v[50:51], v[48:49] op_sel_hi:[1,0]
    v_pk_fma_f32 v[56:57], v[50:51], v[48:49], v[28:29] op_sel:[1,1,0] op_sel_hi:[0,1,1] neg_lo:[1,0,0]
    v_pk_mul_f32 v[26:27], v[60:61], v[60:61] op_sel_hi:[1,0]
    v_pk_fma_f32 v[62:63], v[60:61], v[60:61], v[26:27] op_sel:[1,1,0] op_sel_hi:[0,1,1] neg_lo:[1,0,0]
    v_pk_mul_f32 v[28:29], v[62:63], v[60:61] op_sel_hi:[1,0]
    v_pk_fma_f32 v[64:65], v[62:63], v[60:61], v[28:29] op_sel:[1,1,0] op_sel_hi:[0,1,1] neg_lo:[1,0,0]
    v_pk_mul_f32 v[26:27], v[62:63], v[62:63] op_sel_hi:[1,0]
    v_pk_fma_f32 v[66:67], v[62:63], v[62:63], v[26:27] op_sel:[1,1,0] op_sel_hi:[0,1,1] neg_lo:[1,0,0]
    v_pk_mul_f32 v[28:29], v[66:67], v[60:61] op_sel_hi:[1,0]
    v_pk_fma_f32 v[68:69], v[66:67], v[60:61], v[28:29] op_sel:[1,1,0] op_sel_hi:[0,1,1] neg_lo:[1,0,0]
    v_pk_mul_f32 v[26:27], v[64:65], v[64:65] op_sel_hi:[1,0]
    v_pk_fma_f32 v[70:71], v[64:65], v[64:65], v[26:27] op_sel:[1,1,0] op_sel_hi:[0,1,1] neg_lo:[1,0,0]
    v_pk_mul_f32 v[28:29], v[66:67], v[64:65] op_sel_hi:[1,0]
    v_pk_fma_f32 v[72:73], v[66:67], v[64:65], v[28:29] op_sel:[1,1,0] op_sel_hi:[0,1,1] neg_lo:[1,0,0]
    v_pk_mul_f32 v[26:27], v[76:77], v[76:77] op_sel_hi:[1,0]
    v_pk_fma_f32 v[78:79], v[76:77], v[76:77], v[26:27] op_sel:[1,1,0] op_sel_hi:[0,1,1] neg_lo:[1,0,0]
    v_pk_mul_f32 v[28:29], v[78:79], v[76:77] op_sel_hi:[1,0]
    v_pk_fma_f32 v[80:81], v[78:79], v[76:77], v[28:29] op_sel:[1,1,0] op_sel_hi:[0,1,1] neg_lo:[1,0,0]
    v_pk_mul_f32 v[26:27], v[78:79], v[78:79] op_sel_hi:[1,0]
    v_pk_fma_f32 v[82:83], v[78:79], v[78:79], v[26:27] op_sel:[1,1,0] op_sel_hi:[0,1,1] neg_lo:[1,0,0]
    v_pk_mul_f32 v[28:29], v[82:83], v[76:77] op_sel_hi:[1,0]
    v_pk_fma_f32 v[84:85], v[82:83], v[76:77], v[28:29] op_sel:[1,1,0] op_sel_hi:[0,1,1] neg_lo:[1,0,0]
    v_pk_mul_f32 v[26:27], v[80:81], v[80:81] op_sel_hi:[1,0]
    v_pk_fma_f32 v[86:87], v[80:81], v[80:81], v[26:27] op_sel:[1,1,0] op_sel_hi:[0,1,1] neg_lo:[1,0,0]
    v_pk_mul_f32 v[28:29], v[82:83], v[80:81] op_sel_hi:[1,0]
    v_pk_fma_f32 v[88:89], v[82:83], v[80:81], v[28:29] op_sel:[1,1,0] op_sel_hi:[0,1,1] neg_lo:[1,0,0]
    s_waitcnt vmcnt(0)
    v_pk_add_f32 v[26:27], v[10:11], v[18:19]
    v_pk_add_f32 v[34:35], v[10:11], v[18:19] neg_lo:[0,1] neg_hi:[0,1]
    v_pk_add_f32 v[28:29], v[12:13], v[20:21]
    v_pk_add_f32 v[36:37], v[12:13], v[20:21] neg_lo:[0,1] neg_hi:[0,1]
    v_pk_add_f32 v[30:31], v[14:15], v[22:23]
    v_pk_add_f32 v[38:39], v[14:15], v[22:23] neg_lo:[0,1] neg_hi:[0,1]
    v_pk_add_f32 v[32:33], v[16:17], v[24:25]
    v_pk_add_f32 v[40:41], v[16:17], v[24:25] neg_lo:[0,1] neg_hi:[0,1]
    v_pk_add_f32 v[12:13], v[26:27], v[30:31]
    v_pk_add_f32 v[16:17], v[26:27], v[30:31] neg_lo:[0,1] neg_hi:[0,1]
    v_pk_add_f32 v[20:21], v[28:29], v[32:33]
    v_pk_add_f32 v[24:25], v[28:29], v[32:33] neg_lo:[0,1] neg_hi:[0,1]
    v_pk_add_f32 v[10:11], v[12:13], v[20:21]
    v_pk_add_f32 v[18:19], v[12:13], v[20:21] neg_lo:[0,1] neg_hi:[0,1]
    v_pk_add_f32 v[14:15], v[16:17], v[24:25] op_sel:[0,1] op_sel_hi:[1,0] neg_hi:[0,1]
    v_pk_add_f32 v[22:23], v[16:17], v[24:25] op_sel:[0,1] op_sel_hi:[1,0] neg_lo:[0,1]
    v_pk_add_f32 v[26:27], v[36:37], v[36:37] op_sel:[0,1] op_sel_hi:[1,0] neg_hi:[0,1]
    v_pk_add_f32 v[28:29], v[40:41], v[40:41] op_sel:[0,1] op_sel_hi:[1,0] neg_lo:[1,0] neg_hi:[1,1]
    v_pk_add_f32 v[30:31], v[26:27], v[28:29]
    v_pk_add_f32 v[32:33], v[26:27], v[28:29] neg_lo:[0,1] neg_hi:[0,1]
    v_pk_add_f32 v[36:37], v[34:35], v[38:39] op_sel:[0,1] op_sel_hi:[1,0] neg_hi:[0,1]
    v_pk_add_f32 v[40:41], v[34:35], v[38:39] op_sel:[0,1] op_sel_hi:[1,0] neg_lo:[0,1]
    v_pk_fma_f32 v[12:13], v[30:31], s[20:21], v[36:37]
    v_pk_fma_f32 v[20:21], v[30:31], s[20:21], v[36:37] neg_lo:[1,0,0] neg_hi:[1,0,0]
    v_pk_fma_f32 v[16:17], v[32:33], s[20:21], v[40:41] op_sel:[1,0,0] op_sel_hi:[0,1,1] neg_hi:[1,0,0]
    v_pk_fma_f32 v[24:25], v[32:33], s[20:21], v[40:41] op_sel:[1,0,0] op_sel_hi:[0,1,1] neg_lo:[1,0,0]
    ds_write_b64 v98, v[10:11] offset:0
    v_pk_mul_f32 v[28:29], v[12:13], v[44:45] op_sel_hi:[1,0]
    v_pk_fma_f32 v[12:13], v[12:13], v[44:45], v[28:29] op_sel:[1,1,0] op_sel_hi:[0,1,1] neg_lo:[1,0,0]
    ds_write_b64 v98, v[12:13] offset:2048
    v_pk_mul_f32 v[30:31], v[14:15], v[46:47] op_sel_hi:[1,0]
    v_pk_fma_f32 v[14:15], v[14:15], v[46:47], v[30:31] op_sel:[1,1,0] op_sel_hi:[0,1,1] neg_lo:[1,0,0]
    ds_write_b64 v98, v[14:15] offset:4096
    v_pk_mul_f32 v[32:33], v[16:17], v[48:49] op_sel_hi:[1,0]
    v_pk_fma_f32 v[16:17], v[16:17], v[48:49], v[32:33] op_sel:[1,1,0] op_sel_hi:[0,1,1] neg_lo:[1,0,0]
    ds_write_b64 v98, v[16:17] offset:6144
    v_pk_mul_f32 v[34:35], v[18:19], v[50:51] op_sel_hi:[1,0]
    v_pk_fma_f32 v[18:19], v[18:19], v[50:51], v[34:35] op_sel:[1,1,0] op_sel_hi:[0,1,1] neg_lo:[1,0,0]
    ds_write_b64 v98, v[18:19] offset:8192
    v_pk_mul_f32 v[36:37], v[20:21], v[52:53] op_sel_hi:[1,0]
    v_pk_fma_f32 v[20:21], v[20:21], v[52:53], v[36:37] op_sel:[1,1,0] op_sel_hi:[0,1,1] neg_lo:[1,0,0]
    ds_write_b64 v98, v[20:21] offset:10240
    v_pk_mul_f32 v[38:39], v[22:23], v[54:55] op_sel_hi:[1,0]
    v_pk_fma_f32 v[22:23], v[22:23], v[54:55], v[38:39] op_sel:[1,1,0] op_sel_hi:[0,1,1] neg_lo:[1,0,0]
    ds_write_b64 v98, v[22:23] offset:12288
    v_pk_mul_f32 v[40:41], v[24:25], v[56:57] op_sel_hi:[1,0]
    v_pk_fma_f32 v[24:25], v[24:25], v[56:57], v[40:41] op_sel:[1,1,0] op_sel_hi:[0,1,1] neg_lo:[1,0,0]
    ds_write_b64 v98, v[24:25] offset:14336
    s_waitcnt lgkmcnt(0)
    s_barrier
    ds_read_b64 v[10:11], v99 offset:0
    ds_read_b64 v[18:19], v99 offset:1024
    ds_read_b64 v[12:13], v99 offset:256
    ds_read_b64 v[20:21], v99 offset:1280
    ds_read_b64 v[14:15], v99 offset:512
    ds_read_b64 v[22:23], v99 offset:1536
    ds_read_b64 v[16:17], v99 offset:768
    ds_read_b64 v[24:25], v99 offset:1792
    s_waitcnt lgkmcnt(6)
    v_pk_add_f32 v[26:27], v[10:11], v[18:19]
    v_pk_add_f32 v[34:35], v[10:11], v[18:19] neg_lo:[0,1] neg_hi:[0,1]
    s_waitcnt lgkmcnt(4)
    v_pk_add_f32 v[28:29], v[12:13], v[20:21]
    v_pk_add_f32 v[36:37], v[12:13], v[20:21] neg_lo:[0,1] neg_hi:[0,1]
    s_waitcnt lgkmcnt(2)
    v_pk_add_f32 v[30:31], v[14:15], v[22:23]
    v_pk_add_f32 v[38:39], v[14:15], v[22:23] neg_lo:[0,1] neg_hi:[0,1]
    s_waitcnt lgkmcnt(0)
    v_pk_add_f32 v[32:33], v[16:17], v[24:25]
    v_pk_add_f32 v[40:41], v[16:17], v[24:25] neg_lo:[0,1] neg_hi:[0,1]
    v_pk_add_f32 v[12:13], v[26:27], v[30:31]
    v_pk_add_f32 v[16:17], v[26:27], v[30:31] neg_lo:[0,1] neg_hi:[0,1]
    v_pk_add_f32 v[20:21], v[28:29], v[32:33]
    v_pk_add_f32 v[24:25], v[28:29], v[32:33] neg_lo:[0,1] neg_hi:[0,1]
    v_pk_add_f32 v[10:11], v[12:13], v[20:21]
    v_pk_add_f32 v[18:19], v[12:13], v[20:21] neg_lo:[0,1] neg_hi:[0,1]
    v_pk_add_f32 v[14:15], v[16:17], v[24:25] op_sel:[0,1] op_sel_hi:[1,0] neg_hi:[0,1]
    v_pk_add_f32 v[22:23], v[16:17], v[24:25] op_sel:[0,1] op_sel_hi:[1,0] neg_lo:[0,1]
    v_pk_add_f32 v[26:27], v[36:37], v[36:37] op_sel:[0,1] op_sel_hi:[1,0] neg_hi:[0,1]
    v_pk_add_f32 v[28:29], v[40:41], v[40:41] op_sel:[0,1] op_sel_hi:[1,0] neg_lo:[1,0] neg_hi:[1,1]
    v_pk_add_f32 v[30:31], v[26:27], v[28:29]
    v_pk_add_f32 v[32:33], v[26:27], v[28:29] neg_lo:[0,1] neg_hi:[0,1]
    v_pk_add_f32 v[36:37], v[34:35], v[38:39] op_sel:[0,1] op_sel_hi:[1,0] neg_hi:[0,1]
    v_pk_add_f32 v[40:41], v[34:35], v[38:39] op_sel:[0,1] op_sel_hi:[1,0] neg_lo:[0,1]
    v_pk_fma_f32 v[12:13], v[30:31], s[20:21], v[36:37]
    v_pk_fma_f32 v[20:21], v[30:31], s[20:21], v[36:37] neg_lo:[1,0,0] neg_hi:[1,0,0]
    v_pk_fma_f32 v[16:17], v[32:33], s[20:21], v[40:41] op_sel:[1,0,0] op_sel_hi:[0,1,1] neg_hi:[1,0,0]
    v_pk_fma_f32 v[24:25], v[32:33], s[20:21], v[40:41] op_sel:[1,0,0] op_sel_hi:[0,1,1] neg_lo:[1,0,0]
    ds_write_b64 v100, v[10:11] offset:36864
    v_pk_mul_f32 v[28:29], v[12:13], v[60:61] op_sel_hi:[1,0]
    v_pk_fma_f32 v[12:13], v[12:13], v[60:61], v[28:29] op_sel:[1,1,0] op_sel_hi:[0,1,1] neg_lo:[1,0,0]
    ds_write_b64 v100, v[12:13] offset:37152
    v_pk_mul_f32 v[30:31], v[14:15], v[62:63] op_sel_hi:[1,0]
    v_pk_fma_f32 v[14:15], v[14:15], v[62:63], v[30:31] op_sel:[1,1,0] op_sel_hi:[0,1,1] neg_lo:[1,0,0]
    ds_write_b64 v100, v[14:15] offset:37440
    v_pk_mul_f32 v[32:33], v[16:17], v[64:65] op_sel_hi:[1,0]
    v_pk_fma_f32 v[16:17], v[16:17], v[64:65], v[32:33] op_sel:[1,1,0] op_sel_hi:[0,1,1] neg_lo:[1,0,0]
    ds_write_b64 v100, v[16:17] offset:37728
    v_pk_mul_f32 v[34:35], v[18:19], v[66:67] op_sel_hi:[1,0]
    v_pk_fma_f32 v[18:19], v[18:19], v[66:67], v[34:35] op_sel:[1,1,0] op_sel_hi:[0,1,1] neg_lo:[1,0,0]
    ds_write_b64 v100, v[18:19] offset:38016
    v_pk_mul_f32 v[36:37], v[20:21], v[68:69] op_sel_hi:[1,0]
    v_pk_fma_f32 v[20:21], v[20:21], v[68:69], v[36:37] op_sel:[1,1,0] op_sel_hi:[0,1,1] neg_lo:[1,0,0]
    ds_write_b64 v100, v[20:21] offset:38304
    v_pk_mul_f32 v[38:39], v[22:23], v[70:71] op_sel_hi:[1,0]
    v_pk_fma_f32 v[22:23], v[22:23], v[70:71], v[38:39] op_sel:[1,1,0] op_sel_hi:[0,1,1] neg_lo:[1,0,0]
    ds_write_b64 v100, v[22:23] offset:38592
    v_pk_mul_f32 v[40:41], v[24:25], v[72:73] op_sel_hi:[1,0]
    v_pk_fma_f32 v[24:25], v[24:25], v[72:73], v[40:41] op_sel:[1,1,0] op_sel_hi:[0,1,1] neg_lo:[1,0,0]
    ds_write_b64 v100, v[24:25] offset:38880
    ds_read_b64 v[10:11], v101 offset:36864
    ds_read_b64 v[18:19], v101 offset:36992
    ds_read_b64 v[12:13], v101 offset:36896
    ds_read_b64 v[20:21], v101 offset:37024
    ds_read_b64 v[14:15], v101 offset:36928
    ds_read_b64 v[22:23], v101 offset:37056
    ds_read_b64 v[16:17], v101 offset:36960
    ds_read_b64 v[24:25], v101 offset:37088
    s_waitcnt lgkmcnt(6)
    v_pk_add_f32 v[26:27], v[10:11], v[18:19]
    v_pk_add_f32 v[34:35], v[10:11], v[18:19] neg_lo:[0,1] neg_hi:[0,1]
    s_waitcnt lgkmcnt(4)
    v_pk_add_f32 v[28:29], v[12:13], v[20:21]
    v_pk_add_f32 v[36:37], v[12:13], v[20:21] neg_lo:[0,1] neg_hi:[0,1]
    s_waitcnt lgkmcnt(2)
    v_pk_add_f32 v[30:31], v[14:15], v[22:23]
    v_pk_add_f32 v[38:39], v[14:15], v[22:23] neg_lo:[0,1] neg_hi:[0,1]
    s_waitcnt lgkmcnt(0)
    v_pk_add_f32 v[32:33], v[16:17], v[24:25]
    v_pk_add_f32 v[40:41], v[16:17], v[24:25] neg_lo:[0,1] neg_hi:[0,1]
    v_pk_add_f32 v[12:13], v[26:27], v[30:31]
    v_pk_add_f32 v[16:17], v[26:27], v[30:31] neg_lo:[0,1] neg_hi:[0,1]
    v_pk_add_f32 v[20:21], v[28:29], v[32:33]
    v_pk_add_f32 v[24:25], v[28:29], v[32:33] neg_lo:[0,1] neg_hi:[0,1]
    v_pk_add_f32 v[10:11], v[12:13], v[20:21]
    v_pk_add_f32 v[18:19], v[12:13], v[20:21] neg_lo:[0,1] neg_hi:[0,1]
    v_pk_add_f32 v[14:15], v[16:17], v[24:25] op_sel:[0,1] op_sel_hi:[1,0] neg_hi:[0,1]
    v_pk_add_f32 v[22:23], v[16:17], v[24:25] op_sel:[0,1] op_sel_hi:[1,0] neg_lo:[0,1]
    v_pk_add_f32 v[26:27], v[36:37], v[36:37] op_sel:[0,1] op_sel_hi:[1,0] neg_hi:[0,1]
    v_pk_add_f32 v[28:29], v[40:41], v[40:41] op_sel:[0,1] op_sel_hi:[1,0] neg_lo:[1,0] neg_hi:[1,1]
    v_pk_add_f32 v[30:31], v[26:27], v[28:29]
    v_pk_add_f32 v[32:33], v[26:27], v[28:29] neg_lo:[0,1] neg_hi:[0,1]
    v_pk_add_f32 v[36:37], v[34:35], v[38:39] op_sel:[0,1] op_sel_hi:[1,0] neg_hi:[0,1]
    v_pk_add_f32 v[40:41], v[34:35], v[38:39] op_sel:[0,1] op_sel_hi:[1,0] neg_lo:[0,1]
    v_pk_fma_f32 v[12:13], v[30:31], s[20:21], v[36:37]
    v_pk_fma_f32 v[20:21], v[30:31], s[20:21], v[36:37] neg_lo:[1,0,0] neg_hi:[1,0,0]
    v_pk_fma_f32 v[16:17], v[32:33], s[20:21], v[40:41] op_sel:[1,0,0] op_sel_hi:[0,1,1] neg_hi:[1,0,0]
    v_pk_fma_f32 v[24:25], v[32:33], s[20:21], v[40:41] op_sel:[1,0,0] op_sel_hi:[0,1,1] neg_lo:[1,0,0]
    ds_write_b64 v102, v[10:11] offset:18432
    v_pk_mul_f32 v[28:29], v[12:13], v[76:77] op_sel_hi:[1,0]
    v_pk_fma_f32 v[12:13], v[12:13], v[76:77], v[28:29] op_sel:[1,1,0] op_sel_hi:[0,1,1] neg_lo:[1,0,0]
    ds_write_b64 v102, v[12:13] offset:20608
    v_pk_mul_f32 v[30:31], v[14:15], v[78:79] op_sel_hi:[1,0]
    v_pk_fma_f32 v[14:15], v[14:15], v[78:79], v[30:31] op_sel:[1,1,0] op_sel_hi:[0,1,1] neg_lo:[1,0,0]
    ds_write_b64 v102, v[14:15] offset:22784
    v_pk_mul_f32 v[32:33], v[16:17], v[80:81] op_sel_hi:[1,0]
    v_pk_fma_f32 v[16:17], v[16:17], v[80:81], v[32:33] op_sel:[1,1,0] op_sel_hi:[0,1,1] neg_lo:[1,0,0]
    ds_write_b64 v102, v[16:17] offset:24960
    v_pk_mul_f32 v[34:35], v[18:19], v[82:83] op_sel_hi:[1,0]
    v_pk_fma_f32 v[18:19], v[18:19], v[82:83], v[34:35] op_sel:[1,1,0] op_sel_hi:[0,1,1] neg_lo:[1,0,0]
    ds_write_b64 v102, v[18:19] offset:27136
    v_pk_mul_f32 v[36:37], v[20:21], v[84:85] op_sel_hi:[1,0]
    v_pk_fma_f32 v[20:21], v[20:21], v[84:85], v[36:37] op_sel:[1,1,0] op_sel_hi:[0,1,1] neg_lo:[1,0,0]
    ds_write_b64 v102, v[20:21] offset:29312
    v_pk_mul_f32 v[38:39], v[22:23], v[86:87] op_sel_hi:[1,0]
    v_pk_fma_f32 v[22:23], v[22:23], v[86:87], v[38:39] op_sel:[1,1,0] op_sel_hi:[0,1,1] neg_lo:[1,0,0]
    ds_write_b64 v102, v[22:23] offset:31488
    v_pk_mul_f32 v[40:41], v[24:25], v[88:89] op_sel_hi:[1,0]
    v_pk_fma_f32 v[24:25], v[24:25], v[88:89], v[40:41] op_sel:[1,1,0] op_sel_hi:[0,1,1] neg_lo:[1,0,0]
    ds_write_b64 v102, v[24:25] offset:33664
    s_waitcnt lgkmcnt(0)
    s_barrier
    ds_read_b64 v[10:11], v103 offset:18432
    ds_read_b64 v[14:15], v103 offset:18976
    ds_read_b64 v[18:19], v103 offset:19520
    ds_read_b64 v[22:23], v103 offset:20064
    ds_read_b64 v[12:13], v103 offset:27136
    ds_read_b64 v[16:17], v103 offset:27680
    ds_read_b64 v[20:21], v103 offset:28224
    ds_read_b64 v[24:25], v103 offset:28768
    s_waitcnt lgkmcnt(0)
    v_pk_add_f32 v[26:27], v[10:11], v[18:19]
    v_pk_add_f32 v[28:29], v[10:11], v[18:19] neg_lo:[0,1] neg_hi:[0,1]
    v_pk_add_f32 v[30:31], v[14:15], v[22:23]
    v_pk_add_f32 v[32:33], v[14:15], v[22:23] neg_lo:[0,1] neg_hi:[0,1]
    v_pk_add_f32 v[10:11], v[26:27], v[30:31]
    v_pk_add_f32 v[18:19], v[26:27], v[30:31] neg_lo:[0,1] neg_hi:[0,1]
    v_pk_add_f32 v[14:15], v[28:29], v[32:33] op_sel:[0,1] op_sel_hi:[1,0] neg_hi:[0,1]
    v_pk_add_f32 v[22:23], v[28:29], v[32:33] op_sel:[0,1] op_sel_hi:[1,0] neg_lo:[0,1]
    v_pk_add_f32 v[34:35], v[12:13], v[20:21]
    v_pk_add_f32 v[36:37], v[12:13], v[20:21] neg_lo:[0,1] neg_hi:[0,1]
    v_pk_add_f32 v[38:39], v[16:17], v[24:25]
    v_pk_add_f32 v[40:41], v[16:17], v[24:25] neg_lo:[0,1] neg_hi:[0,1]
    v_pk_add_f32 v[12:13], v[34:35], v[38:39]
    v_pk_add_f32 v[20:21], v[34:35], v[38:39] neg_lo:[0,1] neg_hi:[0,1]
    v_pk_add_f32 v[16:17], v[36:37], v[40:41] op_sel:[0,1] op_sel_hi:[1,0] neg_hi:[0,1]
    v_pk_add_f32 v[24:25], v[36:37], v[40:41] op_sel:[0,1] op_sel_hi:[1,0] neg_lo:[0,1]
    s_waitcnt vmcnt(0)
    ds_write_b64 v3, v[10:11] offset:36864
    ds_write_b64 v3, v[12:13] offset:38912
    ds_write_b64 v3, v[14:15] offset:40960
    ds_write_b64 v3, v[16:17] offset:43008
    ds_write_b64 v3, v[18:19] offset:45056
    ds_write_b64 v3, v[20:21] offset:47104
    ds_write_b64 v3, v[22:23] offset:49152
    ds_write_b64 v3, v[24:25] offset:51200
    s_waitcnt lgkmcnt(0)
    s_barrier
    v_sub_u32 v7, 2048, v0
    v_and_b32 v7, 2047, v7
    v_lshlrev_b32 v7, 3, v7
    ds_read_b64 v[136:137], v7 offset:36864
    v_sub_u32 v7, 1792, v0
    v_and_b32 v7, 2047, v7
    v_lshlrev_b32 v7, 3, v7
    ds_read_b64 v[138:139], v7 offset:36864
    v_sub_u32 v7, 1536, v0
    v_and_b32 v7, 2047, v7
    v_lshlrev_b32 v7, 3, v7
    ds_read_b64 v[140:141], v7 offset:36864
    v_sub_u32 v7, 1280, v0
    v_and_b32 v7, 2047, v7
    v_lshlrev_b32 v7, 3, v7
    ds_read_b64 v[142:143], v7 offset:36864
    v_sub_u32 v7, 1024, v0
    v_and_b32 v7, 2047, v7
    v_lshlrev_b32 v7, 3, v7
    ds_read_b64 v[144:145], v7 offset:36864
    v_sub_u32 v7, 768, v0
    v_and_b32 v7, 2047, v7
    v_lshlrev_b32 v7, 3, v7
    ds_read_b64 v[146:147], v7 offset:36864
    v_sub_u32 v7, 512, v0
    v_and_b32 v7, 2047, v7
    v_lshlrev_b32 v7, 3, v7
    ds_read_b64 v[148:149], v7 offset:36864
    v_sub_u32 v7, 256, v0
    v_and_b32 v7, 2047, v7
    v_lshlrev_b32 v7, 3, v7
    ds_read_b64 v[150:151], v7 offset:36864
    s_waitcnt lgkmcnt(0)
    v_pk_mul_f32 v[36:37], v[10:11], v[104:105] op_sel_hi:[1,0]
    v_pk_fma_f32 v[34:35], v[10:11], v[104:105], v[36:37] op_sel:[1,1,0] op_sel_hi:[0,1,1] neg_lo:[1,0,0]
    v_xor_b32 v137, 0x80000000, v137
    v_pk_mul_f32 v[40:41], v[136:137], v[106:107] op_sel_hi:[1,0]
    v_pk_fma_f32 v[38:39], v[136:137], v[106:107], v[40:41] op_sel:[1,1,0] op_sel_hi:[0,1,1] neg_lo:[1,0,0]
    v_pk_add_f32 v[10:11], v[34:35], v[38:39]
    v_pk_mul_f32 v[36:37], v[12:13], v[108:109] op_sel_hi:[1,0]
    v_pk_fma_f32 v[34:35], v[12:13], v[108:109], v[36:37] op_sel:[1,1,0] op_sel_hi:[0,1,1] neg_lo:[1,0,0]
    v_xor_b32 v139, 0x80000000, v139
    v_pk_mul_f32 v[40:41], v[138:139], v[110:111] op_sel_hi:[1,0]
    v_pk_fma_f32 v[38:39], v[138:139], v[110:111], v[40:41] op_sel:[1,1,0] op_sel_hi:[0,1,1] neg_lo:[1,0,0]
    v_pk_add_f32 v[12:13], v[34:35], v[38:39]
    v_pk_mul_f32 v[36:37], v[14:15], v[112:113] op_sel_hi:[1,0]
    v_pk_fma_f32 v[34:35], v[14:15], v[112:113], v[36:37] op_sel:[1,1,0] op_sel_hi:[0,1,1] neg_lo:[1,0,0]
    v_xor_b32 v141, 0x80000000, v141
    v_pk_mul_f32 v[40:41], v[140:141], v[114:115] op_sel_hi:[1,0]
    v_pk_fma_f32 v[38:39], v[140:141], v[114:115], v[40:41] op_sel:[1,1,0] op_sel_hi:[0,1,1] neg_lo:[1,0,0]
    v_pk_add_f32 v[14:15], v[34:35], v[38:39]
    v_pk_mul_f32 v[36:37], v[16:17], v[116:117] op_sel_hi:[1,0]
    v_pk_fma_f32 v[34:35], v[16:17], v[116:117], v[36:37] op_sel:[1,1,0] op_sel_hi:[0,1,1] neg_lo:[1,0,0]
    v_xor_b32 v143, 0x80000000, v143
    v_pk_mul_f32 v[40:41], v[142:143], v[118:119] op_sel_hi:[1,0]
    v_pk_fma_f32 v[38:39], v[142:143], v[118:119], v[40:41] op_sel:[1,1,0] op_sel_hi:[0,1,1] neg_lo:[1,0,0]
    v_pk_add_f32 v[16:17], v[34:35], v[38:39]
    v_pk_mul_f32 v[36:37], v[18:19], v[120:121] op_sel_hi:[1,0]
    v_pk_fma_f32 v[34:35], v[18:19], v[120:121], v[36:37] op_sel:[1,1,0] op_sel_hi:[0,1,1] neg_lo:[1,0,0]
    v_xor_b32 v145, 0x80000000, v145
    v_pk_mul_f32 v[40:41], v[144:145], v[122:123] op_sel_hi:[1,0]
    v_pk_fma_f32 v[38:39], v[144:145], v[122:123], v[40:41] op_sel:[1,1,0] op_sel_hi:[0,1,1] neg_lo:[1,0,0]
    v_pk_add_f32 v[18:19], v[34:35], v[38:39]
    v_pk_mul_f32 v[36:37], v[20:21], v[124:125] op_sel_hi:[1,0]
    v_pk_fma_f32 v[34:35], v[20:21], v[124:125], v[36:37] op_sel:[1,1,0] op_sel_hi:[0,1,1] neg_lo:[1,0,0]
    v_xor_b32 v147, 0x80000000, v147
    v_pk_mul_f32 v[40:41], v[146:147], v[126:127] op_sel_hi:[1,0]
    v_pk_fma_f32 v[38:39], v[146:147], v[126:127], v[40:41] op_sel:[1,1,0] op_sel_hi:[0,1,1] neg_lo:[1,0,0]
    v_pk_add_f32 v[20:21], v[34:35], v[38:39]
    v_pk_mul_f32 v[36:37], v[22:23], v[128:129] op_sel_hi:[1,0]
    v_pk_fma_f32 v[34:35], v[22:23], v[128:129], v[36:37] op_sel:[1,1,0] op_sel_hi:[0,1,1] neg_lo:[1,0,0]
    v_xor_b32 v149, 0x80000000, v149
    v_pk_mul_f32 v[40:41], v[148:149], v[130:131] op_sel_hi:[1,0]
    v_pk_fma_f32 v[38:39], v[148:149], v[130:131], v[40:41] op_sel:[1,1,0] op_sel_hi:[0,1,1] neg_lo:[1,0,0]
    v_pk_add_f32 v[22:23], v[34:35], v[38:39]
    v_pk_mul_f32 v[36:37], v[24:25], v[132:133] op_sel_hi:[1,0]
    v_pk_fma_f32 v[34:35], v[24:25], v[132:133], v[36:37] op_sel:[1,1,0] op_sel_hi:[0,1,1] neg_lo:[1,0,0]
    v_xor_b32 v151, 0x80000000, v151
    v_pk_mul_f32 v[40:41], v[150:151], v[134:135] op_sel_hi:[1,0]
    v_pk_fma_f32 v[38:39], v[150:151], v[134:135], v[40:41] op_sel:[1,1,0] op_sel_hi:[0,1,1] neg_lo:[1,0,0]
    v_pk_add_f32 v[24:25], v[34:35], v[38:39]
    v_pk_add_f32 v[26:27], v[10:11], v[18:19]
    v_pk_add_f32 v[34:35], v[10:11], v[18:19] neg_lo:[0,1] neg_hi:[0,1]
    v_pk_add_f32 v[28:29], v[12:13], v[20:21]
    v_pk_add_f32 v[36:37], v[12:13], v[20:21] neg_lo:[0,1] neg_hi:[0,1]
    v_pk_add_f32 v[30:31], v[14:15], v[22:23]
    v_pk_add_f32 v[38:39], v[14:15], v[22:23] neg_lo:[0,1] neg_hi:[0,1]
    v_pk_add_f32 v[32:33], v[16:17], v[24:25]
    v_pk_add_f32 v[40:41], v[16:17], v[24:25] neg_lo:[0,1] neg_hi:[0,1]
    v_pk_add_f32 v[12:13], v[26:27], v[30:31]
    v_pk_add_f32 v[16:17], v[26:27], v[30:31] neg_lo:[0,1] neg_hi:[0,1]
    v_pk_add_f32 v[20:21], v[28:29], v[32:33]
    v_pk_add_f32 v[24:25], v[28:29], v[32:33] neg_lo:[0,1] neg_hi:[0,1]
    v_pk_add_f32 v[10:11], v[12:13], v[20:21]
    v_pk_add_f32 v[18:19], v[12:13], v[20:21] neg_lo:[0,1] neg_hi:[0,1]
    v_pk_add_f32 v[14:15], v[16:17], v[24:25] op_sel:[0,1] op_sel_hi:[1,0] neg_lo:[0,1]
    v_pk_add_f32 v[22:23], v[16:17], v[24:25] op_sel:[0,1] op_sel_hi:[1,0] neg_hi:[0,1]
    v_pk_add_f32 v[26:27], v[36:37], v[36:37] op_sel:[0,1] op_sel_hi:[1,0] neg_lo:[0,1]
    v_pk_add_f32 v[28:29], v[40:41], v[40:41] op_sel:[0,1] op_sel_hi:[1,0] neg_lo:[1,1] neg_hi:[1,0]
    v_pk_add_f32 v[30:31], v[26:27], v[28:29]
    v_pk_add_f32 v[32:33], v[26:27], v[28:29] neg_lo:[0,1] neg_hi:[0,1]
    v_pk_add_f32 v[36:37], v[34:35], v[38:39] op_sel:[0,1] op_sel_hi:[1,0] neg_lo:[0,1]
    v_pk_add_f32 v[40:41], v[34:35], v[38:39] op_sel:[0,1] op_sel_hi:[1,0] neg_hi:[0,1]
    v_pk_fma_f32 v[12:13], v[30:31], s[20:21], v[36:37]
    v_pk_fma_f32 v[20:21], v[30:31], s[20:21], v[36:37] neg_lo:[1,0,0] neg_hi:[1,0,0]
    v_pk_fma_f32 v[16:17], v[32:33], s[20:21], v[40:41] op_sel:[1,0,0] op_sel_hi:[0,1,1] neg_lo:[1,0,0]
    v_pk_fma_f32 v[24:25], v[32:33], s[20:21], v[40:41] op_sel:[1,0,0] op_sel_hi:[0,1,1] neg_hi:[1,0,0]
    ds_write_b64 v98, v[10:11] offset:0
    v_pk_mul_f32 v[28:29], v[12:13], v[44:45] op_sel_hi:[1,0]
    v_pk_fma_f32 v[12:13], v[12:13], v[44:45], v[28:29] op_sel:[1,1,0] op_sel_hi:[0,1,1] neg_hi:[1,0,0]
    ds_write_b64 v98, v[12:13] offset:2048
    v_pk_mul_f32 v[30:31], v[14:15], v[46:47] op_sel_hi:[1,0]
    v_pk_fma_f32 v[14:15], v[14:15], v[46:47], v[30:31] op_sel:[1,1,0] op_sel_hi:[0,1,1] neg_hi:[1,0,0]
    ds_write_b64 v98, v[14:15] offset:4096
    v_pk_mul_f32 v[32:33], v[16:17], v[48:49] op_sel_hi:[1,0]
    v_pk_fma_f32 v[16:17], v[16:17], v[48:49], v[32:33] op_sel:[1,1,0] op_sel_hi:[0,1,1] neg_hi:[1,0,0]
    ds_write_b64 v98, v[16:17] offset:6144
    v_pk_mul_f32 v[34:35], v[18:19], v[50:51] op_sel_hi:[1,0]
    v_pk_fma_f32 v[18:19], v[18:19], v[50:51], v[34:35] op_sel:[1,1,0] op_sel_hi:[0,1,1] neg_hi:[1,0,0]
    ds_write_b64 v98, v[18:19] offset:8192
    v_pk_mul_f32 v[36:37], v[20:21], v[52:53] op_sel_hi:[1,0]
    v_pk_fma_f32 v[20:21], v[20:21], v[52:53], v[36:37] op_sel:[1,1,0] op_sel_hi:[0,1,1] neg_hi:[1,0,0]
    ds_write_b64 v98, v[20:21] offset:10240
    v_pk_mul_f32 v[38:39], v[22:23], v[54:55] op_sel_hi:[1,0]
    v_pk_fma_f32 v[22:23], v[22:23], v[54:55], v[38:39] op_sel:[1,1,0] op_sel_hi:[0,1,1] neg_hi:[1,0,0]
    ds_write_b64 v98, v[22:23] offset:12288
    v_pk_mul_f32 v[40:41], v[24:25], v[56:57] op_sel_hi:[1,0]
    v_pk_fma_f32 v[24:25], v[24:25], v[56:57], v[40:41] op_sel:[1,1,0] op_sel_hi:[0,1,1] neg_hi:[1,0,0]
    ds_write_b64 v98, v[24:25] offset:14336
    s_waitcnt lgkmcnt(0)
    s_barrier
    ds_read_b64 v[10:11], v99 offset:0
    ds_read_b64 v[18:19], v99 offset:1024
    ds_read_b64 v[12:13], v99 offset:256
    ds_read_b64 v[20:21], v99 offset:1280
    ds_read_b64 v[14:15], v99 offset:512
    ds_read_b64 v[22:23], v99 offset:1536
    ds_read_b64 v[16:17], v99 offset:768
    ds_read_b64 v[24:25], v99 offset:1792
    s_waitcnt lgkmcnt(6)
    v_pk_add_f32 v[26:27], v[10:11], v[18:19]
    v_pk_add_f32 v[34:35], v[10:11], v[18:19] neg_lo:[0,1] neg_hi:[0,1]
    s_waitcnt lgkmcnt(4)
    v_pk_add_f32 v[28:29], v[12:13], v[20:21]
    v_pk_add_f32 v[36:37], v[12:13], v[20:21] neg_lo:[0,1] neg_hi:[0,1]
    s_waitcnt lgkmcnt(2)
    v_pk_add_f32 v[30:31], v[14:15], v[22:23]
    v_pk_add_f32 v[38:39], v[14:15], v[22:23] neg_lo:[0,1] neg_hi:[0,1]
    s_waitcnt lgkmcnt(0)
    v_pk_add_f32 v[32:33], v[16:17], v[24:25]
    v_pk_add_f32 v[40:41], v[16:17], v[24:25] neg_lo:[0,1] neg_hi:[0,1]
    v_pk_add_f32 v[12:13], v[26:27], v[30:31]
    v_pk_add_f32 v[16:17], v[26:27], v[30:31] neg_lo:[0,1] neg_hi:[0,1]
    v_pk_add_f32 v[20:21], v[28:29], v[32:33]
    v_pk_add_f32 v[24:25], v[28:29], v[32:33] neg_lo:[0,1] neg_hi:[0,1]
    v_pk_add_f32 v[10:11], v[12:13], v[20:21]
    v_pk_add_f32 v[18:19], v[12:13], v[20:21] neg_lo:[0,1] neg_hi:[0,1]
    v_pk_add_f32 v[14:15], v[16:17], v[24:25] op_sel:[0,1] op_sel_hi:[1,0] neg_lo:[0,1]
    v_pk_add_f32 v[22:23], v[16:17], v[24:25] op_sel:[0,1] op_sel_hi:[1,0] neg_hi:[0,1]
    v_pk_add_f32 v[26:27], v[36:37], v[36:37] op_sel:[0,1] op_sel_hi:[1,0] neg_lo:[0,1]
    v_pk_add_f32 v[28:29], v[40:41], v[40:41] op_sel:[0,1] op_sel_hi:[1,0] neg_lo:[1,1] neg_hi:[1,0]
    v_pk_add_f32 v[30:31], v[26:27], v[28:29]
    v_pk_add_f32 v[32:33], v[26:27], v[28:29] neg_lo:[0,1] neg_hi:[0,1]
    v_pk_add_f32 v[36:37], v[34:35], v[38:39] op_sel:[0,1] op_sel_hi:[1,0] neg_lo:[0,1]
    v_pk_add_f32 v[40:41], v[34:35], v[38:39] op_sel:[0,1] op_sel_hi:[1,0] neg_hi:[0,1]
    v_pk_fma_f32 v[12:13], v[30:31], s[20:21], v[36:37]
    v_pk_fma_f32 v[20:21], v[30:31], s[20:21], v[36:37] neg_lo:[1,0,0] neg_hi:[1,0,0]
    v_pk_fma_f32 v[16:17], v[32:33], s[20:21], v[40:41] op_sel:[1,0,0] op_sel_hi:[0,1,1] neg_lo:[1,0,0]
    v_pk_fma_f32 v[24:25], v[32:33], s[20:21], v[40:41] op_sel:[1,0,0] op_sel_hi:[0,1,1] neg_hi:[1,0,0]
    ds_write_b64 v100, v[10:11] offset:36864
    v_pk_mul_f32 v[28:29], v[12:13], v[60:61] op_sel_hi:[1,0]
    v_pk_fma_f32 v[12:13], v[12:13], v[60:61], v[28:29] op_sel:[1,1,0] op_sel_hi:[0,1,1] neg_hi:[1,0,0]
    ds_write_b64 v100, v[12:13] offset:37152
    v_pk_mul_f32 v[30:31], v[14:15], v[62:63] op_sel_hi:[1,0]
    v_pk_fma_f32 v[14:15], v[14:15], v[62:63], v[30:31] op_sel:[1,1,0] op_sel_hi:[0,1,1] neg_hi:[1,0,0]
    ds_write_b64 v100, v[14:15] offset:37440
    v_pk_mul_f32 v[32:33], v[16:17], v[64:65] op_sel_hi:[1,0]
    v_pk_fma_f32 v[16:17], v[16:17], v[64:65], v[32:33] op_sel:[1,1,0] op_sel_hi:[0,1,1] neg_hi:[1,0,0]
    ds_write_b64 v100, v[16:17] offset:37728
    v_pk_mul_f32 v[34:35], v[18:19], v[66:67] op_sel_hi:[1,0]
    v_pk_fma_f32 v[18:19], v[18:19], v[66:67], v[34:35] op_sel:[1,1,0] op_sel_hi:[0,1,1] neg_hi:[1,0,0]
    ds_write_b64 v100, v[18:19] offset:38016
    v_pk_mul_f32 v[36:37], v[20:21], v[68:69] op_sel_hi:[1,0]
    v_pk_fma_f32 v[20:21], v[20:21], v[68:69], v[36:37] op_sel:[1,1,0] op_sel_hi:[0,1,1] neg_hi:[1,0,0]
    ds_write_b64 v100, v[20:21] offset:38304
    v_pk_mul_f32 v[38:39], v[22:23], v[70:71] op_sel_hi:[1,0]
    v_pk_fma_f32 v[22:23], v[22:23], v[70:71], v[38:39] op_sel:[1,1,0] op_sel_hi:[0,1,1] neg_hi:[1,0,0]
    ds_write_b64 v100, v[22:23] offset:38592
    v_pk_mul_f32 v[40:41], v[24:25], v[72:73] op_sel_hi:[1,0]
    v_pk_fma_f32 v[24:25], v[24:25], v[72:73], v[40:41] op_sel:[1,1,0] op_sel_hi:[0,1,1] neg_hi:[1,0,0]
    ds_write_b64 v100, v[24:25] offset:38880
    ds_read_b64 v[10:11], v101 offset:36864
    ds_read_b64 v[18:19], v101 offset:36992
    ds_read_b64 v[12:13], v101 offset:36896
    ds_read_b64 v[20:21], v101 offset:37024
    ds_read_b64 v[14:15], v101 offset:36928
    ds_read_b64 v[22:23], v101 offset:37056
    ds_read_b64 v[16:17], v101 offset:36960
    ds_read_b64 v[24:25], v101 offset:37088
    s_waitcnt lgkmcnt(6)
    v_pk_add_f32 v[26:27], v[10:11], v[18:19]
    v_pk_add_f32 v[34:35], v[10:11], v[18:19] neg_lo:[0,1] neg_hi:[0,1]
    s_waitcnt lgkmcnt(4)
    v_pk_add_f32 v[28:29], v[12:13], v[20:21]
    v_pk_add_f32 v[36:37], v[12:13], v[20:21] neg_lo:[0,1] neg_hi:[0,1]
    s_waitcnt lgkmcnt(2)
    v_pk_add_f32 v[30:31], v[14:15], v[22:23]
    v_pk_add_f32 v[38:39], v[14:15], v[22:23] neg_lo:[0,1] neg_hi:[0,1]
    s_waitcnt lgkmcnt(0)
    v_pk_add_f32 v[32:33], v[16:17], v[24:25]
    v_pk_add_f32 v[40:41], v[16:17], v[24:25] neg_lo:[0,1] neg_hi:[0,1]
    v_pk_add_f32 v[12:13], v[26:27], v[30:31]
    v_pk_add_f32 v[16:17], v[26:27], v[30:31] neg_lo:[0,1] neg_hi:[0,1]
    v_pk_add_f32 v[20:21], v[28:29], v[32:33]
    v_pk_add_f32 v[24:25], v[28:29], v[32:33] neg_lo:[0,1] neg_hi:[0,1]
    v_pk_add_f32 v[10:11], v[12:13], v[20:21]
    v_pk_add_f32 v[18:19], v[12:13], v[20:21] neg_lo:[0,1] neg_hi:[0,1]
    v_pk_add_f32 v[14:15], v[16:17], v[24:25] op_sel:[0,1] op_sel_hi:[1,0] neg_lo:[0,1]
    v_pk_add_f32 v[22:23], v[16:17], v[24:25] op_sel:[0,1] op_sel_hi:[1,0] neg_hi:[0,1]
    v_pk_add_f32 v[26:27], v[36:37], v[36:37] op_sel:[0,1] op_sel_hi:[1,0] neg_lo:[0,1]
    v_pk_add_f32 v[28:29], v[40:41], v[40:41] op_sel:[0,1] op_sel_hi:[1,0] neg_lo:[1,1] neg_hi:[1,0]
    v_pk_add_f32 v[30:31], v[26:27], v[28:29]
    v_pk_add_f32 v[32:33], v[26:27], v[28:29] neg_lo:[0,1] neg_hi:[0,1]
    v_pk_add_f32 v[36:37], v[34:35], v[38:39] op_sel:[0,1] op_sel_hi:[1,0] neg_lo:[0,1]
    v_pk_add_f32 v[40:41], v[34:35], v[38:39] op_sel:[0,1] op_sel_hi:[1,0] neg_hi:[0,1]
    v_pk_fma_f32 v[12:13], v[30:31], s[20:21], v[36:37]
    v_pk_fma_f32 v[20:21], v[30:31], s[20:21], v[36:37] neg_lo:[1,0,0] neg_hi:[1,0,0]
    v_pk_fma_f32 v[16:17], v[32:33], s[20:21], v[40:41] op_sel:[1,0,0] op_sel_hi:[0,1,1] neg_lo:[1,0,0]
    v_pk_fma_f32 v[24:25], v[32:33], s[20:21], v[40:41] op_sel:[1,0,0] op_sel_hi:[0,1,1] neg_hi:[1,0,0]
    ds_write_b64 v102, v[10:11] offset:18432
    v_pk_mul_f32 v[28:29], v[12:13], v[76:77] op_sel_hi:[1,0]
    v_pk_fma_f32 v[12:13], v[12:13], v[76:77], v[28:29] op_sel:[1,1,0] op_sel_hi:[0,1,1] neg_hi:[1,0,0]
    ds_write_b64 v102, v[12:13] offset:20608
    v_pk_mul_f32 v[30:31], v[14:15], v[78:79] op_sel_hi:[1,0]
    v_pk_fma_f32 v[14:15], v[14:15], v[78:79], v[30:31] op_sel:[1,1,0] op_sel_hi:[0,1,1] neg_hi:[1,0,0]
    ds_write_b64 v102, v[14:15] offset:22784
    v_pk_mul_f32 v[32:33], v[16:17], v[80:81] op_sel_hi:[1,0]
    v_pk_fma_f32 v[16:17], v[16:17], v[80:81], v[32:33] op_sel:[1,1,0] op_sel_hi:[0,1,1] neg_hi:[1,0,0]
    ds_write_b64 v102, v[16:17] offset:24960
    v_pk_mul_f32 v[34:35], v[18:19], v[82:83] op_sel_hi:[1,0]
    v_pk_fma_f32 v[18:19], v[18:19], v[82:83], v[34:35] op_sel:[1,1,0] op_sel_hi:[0,1,1] neg_hi:[1,0,0]
    ds_write_b64 v102, v[18:19] offset:27136
    v_pk_mul_f32 v[36:37], v[20:21], v[84:85] op_sel_hi:[1,0]
    v_pk_fma_f32 v[20:21], v[20:21], v[84:85], v[36:37] op_sel:[1,1,0] op_sel_hi:[0,1,1] neg_hi:[1,0,0]
    ds_write_b64 v102, v[20:21] offset:29312
    v_pk_mul_f32 v[38:39], v[22:23], v[86:87] op_sel_hi:[1,0]
    v_pk_fma_f32 v[22:23], v[22:23], v[86:87], v[38:39] op_sel:[1,1,0] op_sel_hi:[0,1,1] neg_hi:[1,0,0]
    ds_write_b64 v102, v[22:23] offset:31488
    v_pk_mul_f32 v[40:41], v[24:25], v[88:89] op_sel_hi:[1,0]
    v_pk_fma_f32 v[24:25], v[24:25], v[88:89], v[40:41] op_sel:[1,1,0] op_sel_hi:[0,1,1] neg_hi:[1,0,0]
    ds_write_b64 v102, v[24:25] offset:33664
    s_waitcnt lgkmcnt(0)
    s_barrier
    ds_read_b64 v[10:11], v103 offset:18432
    ds_read_b64 v[14:15], v103 offset:18976
    ds_read_b64 v[18:19], v103 offset:19520
    ds_read_b64 v[22:23], v103 offset:20064
    ds_read_b64 v[12:13], v103 offset:27136
    ds_read_b64 v[16:17], v103 offset:27680
    ds_read_b64 v[20:21], v103 offset:28224
    ds_read_b64 v[24:25], v103 offset:28768
    s_waitcnt lgkmcnt(0)
    v_pk_add_f32 v[26:27], v[10:11], v[18:19]
    v_pk_add_f32 v[28:29], v[10:11], v[18:19] neg_lo:[0,1] neg_hi:[0,1]
    v_pk_add_f32 v[30:31], v[14:15], v[22:23]
    v_pk_add_f32 v[32:33], v[14:15], v[22:23] neg_lo:[0,1] neg_hi:[0,1]
    v_pk_add_f32 v[10:11], v[26:27], v[30:31]
    v_pk_add_f32 v[18:19], v[26:27], v[30:31] neg_lo:[0,1] neg_hi:[0,1]
    v_pk_add_f32 v[14:15], v[28:29], v[32:33] op_sel:[0,1] op_sel_hi:[1,0] neg_lo:[0,1]
    v_pk_add_f32 v[22:23], v[28:29], v[32:33] op_sel:[0,1] op_sel_hi:[1,0] neg_hi:[0,1]
    v_pk_add_f32 v[34:35], v[12:13], v[20:21]
    v_pk_add_f32 v[36:37], v[12:13], v[20:21] neg_lo:[0,1] neg_hi:[0,1]
    v_pk_add_f32 v[38:39], v[16:17], v[24:25]
    v_pk_add_f32 v[40:41], v[16:17], v[24:25] neg_lo:[0,1] neg_hi:[0,1]
    v_pk_add_f32 v[12:13], v[34:35], v[38:39]
    v_pk_add_f32 v[20:21], v[34:35], v[38:39] neg_lo:[0,1] neg_hi:[0,1]
    v_pk_add_f32 v[16:17], v[36:37], v[40:41] op_sel:[0,1] op_sel_hi:[1,0] neg_lo:[0,1]
    v_pk_add_f32 v[24:25], v[36:37], v[40:41] op_sel:[0,1] op_sel_hi:[1,0] neg_hi:[0,1]
    v_lshrrev_b32 v4, 3, v0
    v_mul_u32_u24 v4, 16640, v4
    v_and_b32 v5, 7, v0
    v_lshl_add_u32 v4, v5, 3, v4
    s_lshl_b32 s28, s95, 6
    s_add_u32 s29, s28, 0x2a00000
    buffer_store_dwordx2 v[10:11], v4, s[12:15], s29 offen sc1
    s_add_u32 s29, s28, 0x2a82000
    buffer_store_dwordx2 v[12:13], v4, s[12:15], s29 offen sc1
    s_add_u32 s29, s28, 0x2b04000
    buffer_store_dwordx2 v[14:15], v4, s[12:15], s29 offen sc1
    s_add_u32 s29, s28, 0x2b86000
    buffer_store_dwordx2 v[16:17], v4, s[12:15], s29 offen sc1
    s_add_u32 s29, s28, 0x2c08000
    buffer_store_dwordx2 v[18:19], v4, s[12:15], s29 offen sc1
    s_add_u32 s29, s28, 0x2c8a000
    buffer_store_dwordx2 v[20:21], v4, s[12:15], s29 offen sc1
    s_add_u32 s29, s28, 0x2d0c000
    buffer_store_dwordx2 v[22:23], v4, s[12:15], s29 offen sc1
    s_add_u32 s29, s28, 0x2d8e000
    buffer_store_dwordx2 v[24:25], v4, s[12:15], s29 offen sc1
    s_branch Ljoin_64
Lskip_63:
    s_barrier
    s_barrier
    s_barrier
    s_barrier
    s_barrier
    s_barrier
Ljoin_64:
Lspj_57:
    s_waitcnt vmcnt(0)
    s_barrier
    s_cmp_lg_u32 s3, 0
    s_cbranch_scc1 Lpub_68
    s_lshr_b32 s92, s2, 4
    s_lshl_b32 s92, s92, 8
    s_add_u32 s92, s92, 81920
    v_mov_b32 v158, 1
    v_mov_b32 v159, 0
    s_mov_b64 exec, 1
    buffer_atomic_add v158, v159, s[96:99], s92 offen sc0 sc1
    s_waitcnt vmcnt(0)
    v_readfirstlane_b32 s94, v158
    s_cmp_lg_u32 s94, 15
    s_cbranch_scc1 Lpub_68x
    s_mov_b64 exec, 0xffff
    v_mov_b32 v158, 1
    v_lshlrev_b32 v159, 8, v1
    s_mov_b32 s92, 86016
    buffer_atomic_add v158, v159, s[96:99], s92 offen sc1
Lpub_68x:
    s_mov_b64 exec, -1
Lpub_68:
    s_cmp_ge_u32 s3, 4
    s_cbranch_scc1 Lskip_69
    s_getpc_b64 s[16:17]
Lpc_72:
    s_add_u32 s16, s16, tab_tw2048a-Lpc_72
    s_addc_u32 s17, s17, 0
    s_and_b32 s17, s17, 0xffff
    s_mov_b32 s18, 0x800
    s_mov_b32 s19, 0x00020000
    s_mov_b32 s20, 0x3f3504f3
    s_mov_b32 s21, s20
    s_mov_b32 s22, 0x3b000000
    s_mov_b32 s23, s22
    s_mov_b32 s24, 0x35000000
    s_mov_b32 s25, s24
    s_waitcnt lgkmcnt(0)
    s_mov_b64 s[4:5], s[84:85]
    s_mov_b64 s[6:7], s[84:85]
    s_add_u32 s8, s4, 0x1140000
    s_addc_u32 s9, s5, 0
    s_and_b32 s9, s9, 0xffff
    s_mov_b32 s10, 0x200000
    s_mov_b32 s11, 0x00020000
    s_mov_b32 s12, s6
    s_and_b32 s13, s7, 0xffff
    s_mov_b32 s14, 0x10000000
    s_mov_b32 s15, 0x00020000
    v_lshrrev_b32 v7, 2, v0
    v_and_b32 v8, 3, v0
    s_cmp_lg_u32 s3, 0
    s_cbranch_scc1 Lpd_73
    s_lshr_b32 s92, s2, 4
    s_lshl_b32 s92, s92, 8
    s_add_u32 s92, s92, 86016
    v_mov_b32 v159, 0
    s_mov_b32 s93, 0
Lpl_74:
    v_mov_b32 v158, 0
    s_mov_b64 exec, 1
    buffer_atomic_add v158, v159, s[96:99], s92 offen sc0 sc1
    s_mov_b64 exec, -1
    s_waitcnt vmcnt(0)
    v_readfirstlane_b32 s94, v158
    s_add_u32 s93, s93, 1
    s_cmp_ge_u32 s94, 16
    s_cbranch_scc1 Lpd_73
    s_cmp_gt_u32 s93, 0x40000
    s_cbranch_scc1 Lpd_73
    s_sleep 2
    s_branch Lpl_74
Lpd_73:
    v_lshlrev_b32 v4, 5, v1
    buffer_load_dwordx2 v[52:53], v4, s[16:19], 0 offen
    v_and_b32 v5, 7, v1
    v_lshlrev_b32 v5, 8, v5
    buffer_load_dwordx2 v[68:69], v5, s[16:19], 0 offen
    s_barrier
    v_lshlrev_b32 v3, 4, v0
    s_mul_i32 s28, s2, 16640
    s_add_u32 s29, s28, 0x2a00000
    buffer_load_dwordx4 v[104:107], v3, s[12:15], s29 offen
    s_add_u32 s29, s28, 0x2a01000
    buffer_load_dwordx4 v[108:111], v3, s[12:15], s29 offen
    s_add_u32 s29, s28, 0x2a02000
    buffer_load_dwordx4 v[112:115], v3, s[12:15], s29 offen
    s_add_u32 s29, s28, 0x2a03000
    buffer_load_dwordx4 v[116:119], v3, s[12:15], s29 offen
    v_cmp_gt_u32 vcc, 4, v0
    s_and_saveexec_b64 s[34:35], vcc
    s_mov_b64 exec, s[34:35]
    s_lshl_b32 s28, s2, 13
    s_lshl_b32 s29, s3, 11
    s_add_u32 s28, s28, s29
    v_lshlrev_b32 v6, 4, v1
    v_add_u32 v6, s28, v6
    buffer_load_dwordx4 v[42:45], v6, s[8:11], 0 offen
    buffer_load_dwordx4 v[46:49], v6, s[8:11], 0 offen offset:1024
    s_mul_i32 s30, s3, 4768
    v_lshlrev_b32 v96, 3, v1
    v_add_u32 v96, s30, v96
    v_lshrrev_b32 v86, 3, v1
    v_mul_u32_u24 v97, 72, v86
    v_and_b32 v87, 7, v1
    v_add_u32 v97, v97, v87
    v_lshlrev_b32 v97, 3, v97
    v_add_u32 v97, s30, v97
    v_mul_u32_u24 v98, 66, v87
    v_add_u32 v98, v98, v86
    v_lshlrev_b32 v98, 3, v98
    v_add_u32 v98, s30, v98
    v_mul_u32_u24 v8, 4768, v8
    v_lshl_add_u32 v9, v7, 3, v8
    v_sub_u32 v7, 256, v7
    v_lshl_add_u32 v99, v7, 3, v8
    s_waitcnt vmcnt(2)
    v_pk_mul_f32 v[38:39], v[52:53], v[52:53] op_sel_hi:[1,0]
    v_pk_fma_f32 v[54:55], v[52:53], v[52:53], v[38:39] op_sel:[1,1,0] op_sel_hi:[0,1,1] neg_lo:[1,0,0]
    v_pk_mul_f32 v[40:41], v[54:55], v[52:53] op_sel_hi:[1,0]
    v_pk_fma_f32 v[56:57], v[54:55], v[52:53], v[40:41] op_sel:[1,1,0] op_sel_hi:[0,1,1] neg_lo:[1,0,0]
    v_pk_mul_f32 v[38:39], v[54:55], v[54:55] op_sel_hi:[1,0]
    v_pk_fma_f32 v[58:59], v[54:55], v[54:55], v[38:39] op_sel:[1,1,0] op_sel_hi:[0,1,1] neg_lo:[1,0,0]
    v_pk_mul_f32 v[40:41], v[58:59], v[52:53] op_sel_hi:[1,0]
    v_pk_fma_f32 v[60:61], v[58:59], v[52:53], v[40:41] op_sel:[1,1,0] op_sel_hi:[0,1,1] neg_lo:[1,0,0]
    v_pk_mul_f32 v[38:39], v[56:57], v[56:57] op_sel_hi:[1,0]
    v_pk_fma_f32 v[62:63], v[56:57], v[56:57], v[38:39] op_sel:[1,1,0] op_sel_hi:[0,1,1] neg_lo:[1,0,0]
    v_pk_mul_f32 v[40:41], v[58:59], v[56:57] op_sel_hi:[1,0]
    v_pk_fma_f32 v[64:65], v[58:59], v[56:57], v[40:41] op_sel:[1,1,0] op_sel_hi:[0,1,1] neg_lo:[1,0,0]
    v_pk_mul_f32 v[38:39], v[68:69], v[68:69] op_sel_hi:[1,0]
    v_pk_fma_f32 v[70:71], v[68:69], v[68:69], v[38:39] op_sel:[1,1,0] op_sel_hi:[0,1,1] neg_lo:[1,0,0]
    v_pk_mul_f32 v[40:41], v[70:71], v[68:69] op_sel_hi:[1,0]
    v_pk_fma_f32 v[72:73], v[70:71], v[68:69], v[40:41] op_sel:[1,1,0] op_sel_hi:[0,1,1] neg_lo:[1,0,0]
    v_pk_mul_f32 v[38:39], v[70:71], v[70:71] op_sel_hi:[1,0]
    v_pk_fma_f32 v[74:75], v[70:71], v[70:71], v[38:39] op_sel:[1,1,0] op_sel_hi:[0,1,1] neg_lo:[1,0,0]
    v_pk_mul_f32 v[40:41], v[74:75], v[68:69] op_sel_hi:[1,0]
    v_pk_fma_f32 v[76:77], v[74:75], v[68:69], v[40:41] op_sel:[1,1,0] op_sel_hi:[0,1,1] neg_lo:[1,0,0]
    v_pk_mul_f32 v[38:39], v[72:73], v[72:73] op_sel_hi:[1,0]
    v_pk_fma_f32 v[78:79], v[72:73], v[72:73], v[38:39] op_sel:[1,1,0] op_sel_hi:[0,1,1] neg_lo:[1,0,0]
    v_pk_mul_f32 v[40:41], v[74:75], v[72:73] op_sel_hi:[1,0]
    v_pk_fma_f32 v[80:81], v[74:75], v[72:73], v[40:41] op_sel:[1,1,0] op_sel_hi:[0,1,1] neg_lo:[1,0,0]
    s_mov_b64 exec, vcc
    v_mov_b32 v34, v105
    v_mov_b32 v35, v107
    v_mov_b32 v105, 0
    v_mov_b32 v107, 0
    ds_write_b64 v9, v[34:35] offset:2048
    s_mov_b64 exec, s[34:35]
    v_pk_add_f32 v[10:11], v[104:105], v[106:107] op_sel:[0,1] op_sel_hi:[1,0] neg_lo:[0,1]
    v_pk_add_f32 v[26:27], v[104:105], v[106:107] op_sel:[0,1] op_sel_hi:[1,0] neg_hi:[1,0]
    ds_write_b64 v9, v[10:11] offset:0
    ds_write_b64 v99, v[26:27] offset:2048
    v_pk_add_f32 v[12:13], v[108:109], v[110:111] op_sel:[0,1] op_sel_hi:[1,0] neg_lo:[0,1]
    v_pk_add_f32 v[28:29], v[108:109], v[110:111] op_sel:[0,1] op_sel_hi:[1,0] neg_hi:[1,0]
    ds_write_b64 v9, v[12:13] offset:512
    ds_write_b64 v99, v[28:29] offset:1536
    v_pk_add_f32 v[14:15], v[112:113], v[114:115] op_sel:[0,1] op_sel_hi:[1,0] neg_lo:[0,1]
    v_pk_add_f32 v[30:31], v[112:113], v[114:115] op_sel:[0,1] op_sel_hi:[1,0] neg_hi:[1,0]
    ds_write_b64 v9, v[14:15] offset:1024
    ds_write_b64 v99, v[30:31] offset:1024
    v_pk_add_f32 v[16:17], v[116:117], v[118:119] op_sel:[0,1] op_sel_hi:[1,0] neg_lo:[0,1]
    v_pk_add_f32 v[32:33], v[116:117], v[118:119] op_sel:[0,1] op_sel_hi:[1,0] neg_hi:[1,0]
    ds_write_b64 v9, v[16:17] offset:1536
    ds_write_b64 v99, v[32:33] offset:512
    s_waitcnt lgkmcnt(0)
    s_barrier
    ds_read_b64 v[10:11], v96 offset:0
    ds_read_b64 v[12:13], v96 offset:512
    ds_read_b64 v[14:15], v96 offset:1024
    ds_read_b64 v[16:17], v96 offset:1536
    ds_read_b64 v[18:19], v96 offset:2048
    ds_read_b64 v[20:21], v96 offset:2560
    ds_read_b64 v[22:23], v96 offset:3072
    ds_read_b64 v[24:25], v96 offset:3584
    s_waitcnt lgkmcnt(0)
    v_pk_add_f32 v[26:27], v[10:11], v[18:19]
    v_pk_add_f32 v[34:35], v[10:11], v[18:19] neg_lo:[0,1] neg_hi:[0,1]
    v_pk_add_f32 v[28:29], v[12:13], v[20:21]
    v_pk_add_f32 v[36:37], v[12:13], v[20:21] neg_lo:[0,1] neg_hi:[0,1]
    v_pk_add_f32 v[30:31], v[14:15], v[22:23]
    v_pk_add_f32 v[38:39], v[14:15], v[22:23] neg_lo:[0,1] neg_hi:[0,1]
    v_pk_add_f32 v[32:33], v[16:17], v[24:25]
    v_pk_add_f32 v[40:41], v[16:17], v[24:25] neg_lo:[0,1] neg_hi:[0,1]
    v_pk_add_f32 v[12:13], v[26:27], v[30:31]
    v_pk_add_f32 v[16:17], v[26:27], v[30:31] neg_lo:[0,1] neg_hi:[0,1]
    v_pk_add_f32 v[20:21], v[28:29], v[32:33]
    v_pk_add_f32 v[24:25], v[28:29], v[32:33] neg_lo:[0,1] neg_hi:[0,1]
    v_pk_add_f32 v[10:11], v[12:13], v[20:21]
    v_pk_add_f32 v[18:19], v[12:13], v[20:21] neg_lo:[0,1] neg_hi:[0,1]
    v_pk_add_f32 v[14:15], v[16:17], v[24:25] op_sel:[0,1] op_sel_hi:[1,0] neg_lo:[0,1]
    v_pk_add_f32 v[22:23], v[16:17], v[24:25] op_sel:[0,1] op_sel_hi:[1,0] neg_hi:[0,1]
    v_pk_add_f32 v[26:27], v[36:37], v[36:37] op_sel:[0,1] op_sel_hi:[1,0] neg_lo:[0,1]
    v_pk_add_f32 v[28:29], v[40:41], v[40:41] op_sel:[0,1] op_sel_hi:[1,0] neg_lo:[1,1] neg_hi:[1,0]
    v_pk_add_f32 v[30:31], v[26:27], v[28:29]
    v_pk_add_f32 v[32:33], v[26:27], v[28:29] neg_lo:[0,1] neg_hi:[0,1]
    v_pk_add_f32 v[36:37], v[34:35], v[38:39] op_sel:[0,1] op_sel_hi:[1,0] neg_lo:[0,1]
    v_pk_add_f32 v[40:41], v[34:35], v[38:39] op_sel:[0,1] op_sel_hi:[1,0] neg_hi:[0,1]
    v_pk_fma_f32 v[12:13], v[30:31], s[20:21], v[36:37]
    v_pk_fma_f32 v[20:21], v[30:31], s[20:21], v[36:37] neg_lo:[1,0,0] neg_hi:[1,0,0]
    v_pk_fma_f32 v[16:17], v[32:33], s[20:21], v[40:41] op_sel:[1,0,0] op_sel_hi:[0,1,1] neg_lo:[1,0,0]
    v_pk_fma_f32 v[24:25], v[32:33], s[20:21], v[40:41] op_sel:[1,0,0] op_sel_hi:[0,1,1] neg_hi:[1,0,0]
    ds_write_b64 v96, v[10:11] offset:0
    v_pk_mul_f32 v[28:29], v[12:13], v[52:53] op_sel_hi:[1,0]
    v_pk_fma_f32 v[12:13], v[12:13], v[52:53], v[28:29] op_sel:[1,1,0] op_sel_hi:[0,1,1] neg_hi:[1,0,0]
    ds_write_b64 v96, v[12:13] offset:576
    v_pk_mul_f32 v[30:31], v[14:15], v[54:55] op_sel_hi:[1,0]
    v_pk_fma_f32 v[14:15], v[14:15], v[54:55], v[30:31] op_sel:[1,1,0] op_sel_hi:[0,1,1] neg_hi:[1,0,0]
    ds_write_b64 v96, v[14:15] offset:1152
    v_pk_mul_f32 v[32:33], v[16:17], v[56:57] op_sel_hi:[1,0]
    v_pk_fma_f32 v[16:17], v[16:17], v[56:57], v[32:33] op_sel:[1,1,0] op_sel_hi:[0,1,1] neg_hi:[1,0,0]
    ds_write_b64 v96, v[16:17] offset:1728
    v_pk_mul_f32 v[34:35], v[18:19], v[58:59] op_sel_hi:[1,0]
    v_pk_fma_f32 v[18:19], v[18:19], v[58:59], v[34:35] op_sel:[1,1,0] op_sel_hi:[0,1,1] neg_hi:[1,0,0]
    ds_write_b64 v96, v[18:19] offset:2304
    v_pk_mul_f32 v[36:37], v[20:21], v[60:61] op_sel_hi:[1,0]
    v_pk_fma_f32 v[20:21], v[20:21], v[60:61], v[36:37] op_sel:[1,1,0] op_sel_hi:[0,1,1] neg_hi:[1,0,0]
    ds_write_b64 v96, v[20:21] offset:2880
    v_pk_mul_f32 v[38:39], v[22:23], v[62:63] op_sel_hi:[1,0]
    v_pk_fma_f32 v[22:23], v[22:23], v[62:63], v[38:39] op_sel:[1,1,0] op_sel_hi:[0,1,1] neg_hi:[1,0,0]
    ds_write_b64 v96, v[22:23] offset:3456
    v_pk_mul_f32 v[40:41], v[24:25], v[64:65] op_sel_hi:[1,0]
    v_pk_fma_f32 v[24:25], v[24:25], v[64:65], v[40:41] op_sel:[1,1,0] op_sel_hi:[0,1,1] neg_hi:[1,0,0]
    ds_write_b64 v96, v[24:25] offset:4032
    ds_read_b64 v[10:11], v97 offset:0
    ds_read_b64 v[18:19], v97 offset:256
    ds_read_b64 v[12:13], v97 offset:64
    ds_read_b64 v[20:21], v97 offset:320
    ds_read_b64 v[14:15], v97 offset:128
    ds_read_b64 v[22:23], v97 offset:384
    ds_read_b64 v[16:17], v97 offset:192
    ds_read_b64 v[24:25], v97 offset:448
    s_waitcnt lgkmcnt(6)
    v_pk_add_f32 v[26:27], v[10:11], v[18:19]
    v_pk_add_f32 v[34:35], v[10:11], v[18:19] neg_lo:[0,1] neg_hi:[0,1]
    s_waitcnt lgkmcnt(4)
    v_pk_add_f32 v[28:29], v[12:13], v[20:21]
    v_pk_add_f32 v[36:37], v[12:13], v[20:21] neg_lo:[0,1] neg_hi:[0,1]
    s_waitcnt lgkmcnt(2)
    v_pk_add_f32 v[30:31], v[14:15], v[22:23]
    v_pk_add_f32 v[38:39], v[14:15], v[22:23] neg_lo:[0,1] neg_hi:[0,1]
    s_waitcnt lgkmcnt(0)
    v_pk_add_f32 v[32:33], v[16:17], v[24:25]
    v_pk_add_f32 v[40:41], v[16:17], v[24:25] neg_lo:[0,1] neg_hi:[0,1]
    v_pk_add_f32 v[12:13], v[26:27], v[30:31]
    v_pk_add_f32 v[16:17], v[26:27], v[30:31] neg_lo:[0,1] neg_hi:[0,1]
    v_pk_add_f32 v[20:21], v[28:29], v[32:33]
    v_pk_add_f32 v[24:25], v[28:29], v[32:33] neg_lo:[0,1] neg_hi:[0,1]
    v_pk_add_f32 v[10:11], v[12:13], v[20:21]
    v_pk_add_f32 v[18:19], v[12:13], v[20:21] neg_lo:[0,1] neg_hi:[0,1]
    v_pk_add_f32 v[14:15], v[16:17], v[24:25] op_sel:[0,1] op_sel_hi:[1,0] neg_lo:[0,1]
    v_pk_add_f32 v[22:23], v[16:17], v[24:25] op_sel:[0,1] op_sel_hi:[1,0] neg_hi:[0,1]
    v_pk_add_f32 v[26:27], v[36:37], v[36:37] op_sel:[0,1] op_sel_hi:[1,0] neg_lo:[0,1]
    v_pk_add_f32 v[28:29], v[40:41], v[40:41] op_sel:[0,1] op_sel_hi:[1,0] neg_lo:[1,1] neg_hi:[1,0]
    v_pk_add_f32 v[30:31], v[26:27], v[28:29]
    v_pk_add_f32 v[32:33], v[26:27], v[28:29] neg_lo:[0,1] neg_hi:[0,1]
    v_pk_add_f32 v[36:37], v[34:35], v[38:39] op_sel:[0,1] op_sel_hi:[1,0] neg_lo:[0,1]
    v_pk_add_f32 v[40:41], v[34:35], v[38:39] op_sel:[0,1] op_sel_hi:[1,0] neg_hi:[0,1]
    v_pk_fma_f32 v[12:13], v[30:31], s[20:21], v[36:37]
    v_pk_fma_f32 v[20:21], v[30:31], s[20:21], v[36:37] neg_lo:[1,0,0] neg_hi:[1,0,0]
    v_pk_fma_f32 v[16:17], v[32:33], s[20:21], v[40:41] op_sel:[1,0,0] op_sel_hi:[0,1,1] neg_lo:[1,0,0]
    v_pk_fma_f32 v[24:25], v[32:33], s[20:21], v[40:41] op_sel:[1,0,0] op_sel_hi:[0,1,1] neg_hi:[1,0,0]
    ds_write_b64 v98, v[10:11] offset:0
    v_pk_mul_f32 v[28:29], v[12:13], v[68:69] op_sel_hi:[1,0]
    v_pk_fma_f32 v[12:13], v[12:13], v[68:69], v[28:29] op_sel:[1,1,0] op_sel_hi:[0,1,1] neg_hi:[1,0,0]
    ds_write_b64 v98, v[12:13] offset:64
    v_pk_mul_f32 v[30:31], v[14:15], v[70:71] op_sel_hi:[1,0]
    v_pk_fma_f32 v[14:15], v[14:15], v[70:71], v[30:31] op_sel:[1,1,0] op_sel_hi:[0,1,1] neg_hi:[1,0,0]
    ds_write_b64 v98, v[14:15] offset:128
    v_pk_mul_f32 v[32:33], v[16:17], v[72:73] op_sel_hi:[1,0]
    v_pk_fma_f32 v[16:17], v[16:17], v[72:73], v[32:33] op_sel:[1,1,0] op_sel_hi:[0,1,1] neg_hi:[1,0,0]
    ds_write_b64 v98, v[16:17] offset:192
    v_pk_mul_f32 v[34:35], v[18:19], v[74:75] op_sel_hi:[1,0]
    v_pk_fma_f32 v[18:19], v[18:19], v[74:75], v[34:35] op_sel:[1,1,0] op_sel_hi:[0,1,1] neg_hi:[1,0,0]
    ds_write_b64 v98, v[18:19] offset:256
    v_pk_mul_f32 v[36:37], v[20:21], v[76:77] op_sel_hi:[1,0]
    v_pk_fma_f32 v[20:21], v[20:21], v[76:77], v[36:37] op_sel:[1,1,0] op_sel_hi:[0,1,1] neg_hi:[1,0,0]
    ds_write_b64 v98, v[20:21] offset:320
    v_pk_mul_f32 v[38:39], v[22:23], v[78:79] op_sel_hi:[1,0]
    v_pk_fma_f32 v[22:23], v[22:23], v[78:79], v[38:39] op_sel:[1,1,0] op_sel_hi:[0,1,1] neg_hi:[1,0,0]
    ds_write_b64 v98, v[22:23] offset:384
    v_pk_mul_f32 v[40:41], v[24:25], v[80:81] op_sel_hi:[1,0]
    v_pk_fma_f32 v[24:25], v[24:25], v[80:81], v[40:41] op_sel:[1,1,0] op_sel_hi:[0,1,1] neg_hi:[1,0,0]
    ds_write_b64 v98, v[24:25] offset:448
    ds_read_b64 v[10:11], v96 offset:0
    ds_read_b64 v[18:19], v96 offset:2112
    ds_read_b64 v[12:13], v96 offset:528
    ds_read_b64 v[20:21], v96 offset:2640
    ds_read_b64 v[14:15], v96 offset:1056
    ds_read_b64 v[22:23], v96 offset:3168
    ds_read_b64 v[16:17], v96 offset:1584
    ds_read_b64 v[24:25], v96 offset:3696
    s_waitcnt lgkmcnt(6)
    v_pk_add_f32 v[26:27], v[10:11], v[18:19]
    v_pk_add_f32 v[34:35], v[10:11], v[18:19] neg_lo:[0,1] neg_hi:[0,1]
    s_waitcnt lgkmcnt(4)
    v_pk_add_f32 v[28:29], v[12:13], v[20:21]
    v_pk_add_f32 v[36:37], v[12:13], v[20:21] neg_lo:[0,1] neg_hi:[0,1]
    s_waitcnt lgkmcnt(2)
    v_pk_add_f32 v[30:31], v[14:15], v[22:23]
    v_pk_add_f32 v[38:39], v[14:15], v[22:23] neg_lo:[0,1] neg_hi:[0,1]
    s_waitcnt lgkmcnt(0)
    v_pk_add_f32 v[32:33], v[16:17], v[24:25]
    v_pk_add_f32 v[40:41], v[16:17], v[24:25] neg_lo:[0,1] neg_hi:[0,1]
    v_pk_add_f32 v[12:13], v[26:27], v[30:31]
    v_pk_add_f32 v[16:17], v[26:27], v[30:31] neg_lo:[0,1] neg_hi:[0,1]
    v_pk_add_f32 v[20:21], v[28:29], v[32:33]
    v_pk_add_f32 v[24:25], v[28:29], v[32:33] neg_lo:[0,1] neg_hi:[0,1]
    v_pk_add_f32 v[10:11], v[12:13], v[20:21]
    v_pk_add_f32 v[18:19], v[12:13], v[20:21] neg_lo:[0,1] neg_hi:[0,1]
    v_pk_add_f32 v[14:15], v[16:17], v[24:25] op_sel:[0,1] op_sel_hi:[1,0] neg_lo:[0,1]
    v_pk_add_f32 v[22:23], v[16:17], v[24:25] op_sel:[0,1] op_sel_hi:[1,0] neg_hi:[0,1]
    v_pk_add_f32 v[26:27], v[36:37], v[36:37] op_sel:[0,1] op_sel_hi:[1,0] neg_lo:[0,1]
    v_pk_add_f32 v[28:29], v[40:41], v[40:41] op_sel:[0,1] op_sel_hi:[1,0] neg_lo:[1,1] neg_hi:[1,0]
    v_pk_add_f32 v[30:31], v[26:27], v[28:29]
    v_pk_add_f32 v[32:33], v[26:27], v[28:29] neg_lo:[0,1] neg_hi:[0,1]
    v_pk_add_f32 v[36:37], v[34:35], v[38:39] op_sel:[0,1] op_sel_hi:[1,0] neg_lo:[0,1]
    v_pk_add_f32 v[40:41], v[34:35], v[38:39] op_sel:[0,1] op_sel_hi:[1,0] neg_hi:[0,1]
    v_pk_fma_f32 v[12:13], v[30:31], s[20:21], v[36:37]
    v_pk_fma_f32 v[20:21], v[30:31], s[20:21], v[36:37] neg_lo:[1,0,0] neg_hi:[1,0,0]
    v_pk_fma_f32 v[16:17], v[32:33], s[20:21], v[40:41] op_sel:[1,0,0] op_sel_hi:[0,1,1] neg_lo:[1,0,0]
    v_pk_fma_f32 v[24:25], v[32:33], s[20:21], v[40:41] op_sel:[1,0,0] op_sel_hi:[0,1,1] neg_hi:[1,0,0]
    v_bfe_u32 v86, v1, 1, 2
    v_lshrrev_b32 v87, 5, v1
    v_add3_u32 v86, v86, v87, 0
    v_and_b32 v86, 3, v86
    v_lshlrev_b32 v86, 4, v86
    v_lshrrev_b32 v87, 3, v1
    v_lshl_add_u32 v86, v87, 6, v86
    v_and_b32 v87, 1, v1
    v_lshl_add_u32 v86, v87, 3, v86
    v_add_u32 v100, s30, v86
    v_bfe_u32 v86, v1, 1, 2
    v_lshrrev_b32 v87, 5, v1
    v_add3_u32 v86, v86, v87, 2
    v_and_b32 v86, 3, v86
    v_lshlrev_b32 v86, 4, v86
    v_lshrrev_b32 v87, 3, v1
    v_lshl_add_u32 v86, v87, 6, v86
    v_and_b32 v87, 1, v1
    v_lshl_add_u32 v86, v87, 3, v86
    v_add_u32 v101, s30, v86
    ds_write_b64 v100, v[10:11] offset:0
    ds_write_b64 v101, v[12:13] offset:512
    ds_write_b64 v100, v[14:15] offset:1024
    ds_write_b64 v101, v[16:17] offset:1536
    ds_write_b64 v100, v[18:19] offset:2048
    ds_write_b64 v101, v[20:21] offset:2560
    ds_write_b64 v100, v[22:23] offset:3072
    ds_write_b64 v101, v[24:25] offset:3584
    v_lshrrev_b32 v86, 2, v1
    v_lshlrev_b32 v87, 6, v1
    v_add_u32 v87, s30, v87
    v_add_u32 v88, 0, v86
    v_and_b32 v88, 3, v88
    v_lshlrev_b32 v88, 4, v88
    v_add_u32 v26, v87, v88
    v_add_u32 v88, 1, v86
    v_and_b32 v88, 3, v88
    v_lshlrev_b32 v88, 4, v88
    v_add_u32 v28, v87, v88
    v_add_u32 v88, 2, v86
    v_and_b32 v88, 3, v88
    v_lshlrev_b32 v88, 4, v88
    v_add_u32 v30, v87, v88
    v_add_u32 v88, 3, v86
    v_and_b32 v88, 3, v88
    v_lshlrev_b32 v88, 4, v88
    v_add_u32 v32, v87, v88
    ds_read_b128 v[10:13], v26
    ds_read_b128 v[14:17], v28
    ds_read_b128 v[18:21], v30
    ds_read_b128 v[22:25], v32
    s_waitcnt vmcnt(0) lgkmcnt(0)
    v_pk_mul_f32 v[10:11], v[10:11], s[24:25]
    v_pk_mul_f32 v[12:13], v[12:13], s[24:25]
    v_pk_mul_f32 v[14:15], v[14:15], s[24:25]
    v_pk_mul_f32 v[16:17], v[16:17], s[24:25]
    v_pk_mul_f32 v[18:19], v[18:19], s[24:25]
    v_pk_mul_f32 v[20:21], v[20:21], s[24:25]
    v_pk_mul_f32 v[22:23], v[22:23], s[24:25]
    v_pk_mul_f32 v[24:25], v[24:25], s[24:25]
    v_cvt_pk_bf16_f32 v86, v10, v11
    v_cvt_pk_bf16_f32 v87, v12, v13
    v_cvt_pk_bf16_f32 v88, v14, v15
    v_cvt_pk_bf16_f32 v89, v16, v17
    v_cvt_pk_bf16_f32 v90, v18, v19
    v_cvt_pk_bf16_f32 v91, v20, v21
    v_cvt_pk_bf16_f32 v92, v22, v23
    v_cvt_pk_bf16_f32 v93, v24, v25
    v_lshlrev_b32 v10, 16, v86
    v_and_b32 v11, 0xffff0000, v86
    v_lshlrev_b32 v12, 16, v87
    v_and_b32 v13, 0xffff0000, v87
    v_lshlrev_b32 v14, 16, v88
    v_and_b32 v15, 0xffff0000, v88
    v_lshlrev_b32 v16, 16, v89
    v_and_b32 v17, 0xffff0000, v89
    v_lshlrev_b32 v18, 16, v90
    v_and_b32 v19, 0xffff0000, v90
    v_lshlrev_b32 v20, 16, v91
    v_and_b32 v21, 0xffff0000, v91
    v_lshlrev_b32 v22, 16, v92
    v_and_b32 v23, 0xffff0000, v92
    v_lshlrev_b32 v24, 16, v93
    v_and_b32 v25, 0xffff0000, v93
    v_lshlrev_b32 v26, 16, v42
    v_lshlrev_b32 v27, 16, v46
    v_and_b32 v28, 0xffff0000, v42
    v_and_b32 v29, 0xffff0000, v46
    v_lshlrev_b32 v30, 16, v43
    v_lshlrev_b32 v31, 16, v47
    v_and_b32 v32, 0xffff0000, v43
    v_and_b32 v33, 0xffff0000, v47
    v_lshlrev_b32 v34, 16, v44
    v_lshlrev_b32 v35, 16, v48
    v_and_b32 v36, 0xffff0000, v44
    v_and_b32 v37, 0xffff0000, v48
    v_lshlrev_b32 v38, 16, v45
    v_lshlrev_b32 v39, 16, v49
    v_and_b32 v40, 0xffff0000, v45
    v_and_b32 v41, 0xffff0000, v49
    v_pk_add_f32 v[10:11], v[10:11], v[26:27]
    v_pk_add_f32 v[12:13], v[12:13], v[28:29]
    v_pk_add_f32 v[14:15], v[14:15], v[30:31]
    v_pk_add_f32 v[16:17], v[16:17], v[32:33]
    v_pk_add_f32 v[18:19], v[18:19], v[34:35]
    v_pk_add_f32 v[20:21], v[20:21], v[36:37]
    v_pk_add_f32 v[22:23], v[22:23], v[38:39]
    v_pk_add_f32 v[24:25], v[24:25], v[40:41]
    v_cvt_pk_bf16_f32 v42, v10, v12
    v_cvt_pk_bf16_f32 v46, v11, v13
    v_cvt_pk_bf16_f32 v43, v14, v16
    v_cvt_pk_bf16_f32 v47, v15, v17
    v_cvt_pk_bf16_f32 v44, v18, v20
    v_cvt_pk_bf16_f32 v48, v19, v21
    v_cvt_pk_bf16_f32 v45, v22, v24
    v_cvt_pk_bf16_f32 v49, v23, v25
    s_mov_b32 s29, 0x1340000
    buffer_store_dwordx4 v[42:45], v6, s[12:15], s29 offen sc1
    buffer_store_dwordx4 v[46:49], v6, s[12:15], s29 offen offset:1024 sc1
    v_lshlrev_b32 v10, 16, v42
    v_lshlrev_b32 v11, 16, v46
    v_and_b32 v12, 0xffff0000, v42
    v_and_b32 v13, 0xffff0000, v46
    v_lshlrev_b32 v14, 16, v43
    v_lshlrev_b32 v15, 16, v47
    v_and_b32 v16, 0xffff0000, v43
    v_and_b32 v17, 0xffff0000, v47
    v_lshlrev_b32 v18, 16, v44
    v_lshlrev_b32 v19, 16, v48
    v_and_b32 v20, 0xffff0000, v44
    v_and_b32 v21, 0xffff0000, v48
    v_lshlrev_b32 v22, 16, v45
    v_lshlrev_b32 v23, 16, v49
    v_and_b32 v24, 0xffff0000, v45
    v_and_b32 v25, 0xffff0000, v49
    v_readfirstlane_b32 s48, v10
    v_readfirstlane_b32 s49, v11
    s_nop 0
    v_pk_add_f32 v[86:87], v[10:11], s[48:49] neg_lo:[0,1] neg_hi:[0,1]
    v_pk_mul_f32 v[84:85], v[86:87], v[86:87]
    v_pk_add_f32 v[88:89], v[12:13], s[48:49] neg_lo:[0,1] neg_hi:[0,1]
    v_pk_fma_f32 v[84:85], v[88:89], v[88:89], v[84:85]
    v_pk_add_f32 v[82:83], v[86:87], v[88:89]
    v_pk_add_f32 v[86:87], v[14:15], s[48:49] neg_lo:[0,1] neg_hi:[0,1]
    v_pk_fma_f32 v[84:85], v[86:87], v[86:87], v[84:85]
    v_pk_add_f32 v[82:83], v[82:83], v[86:87]
    v_pk_add_f32 v[88:89], v[16:17], s[48:49] neg_lo:[0,1] neg_hi:[0,1]
    v_pk_fma_f32 v[84:85], v[88:89], v[88:89], v[84:85]
    v_pk_add_f32 v[82:83], v[82:83], v[88:89]
    v_pk_add_f32 v[86:87], v[18:19], s[48:49] neg_lo:[0,1] neg_hi:[0,1]
    v_pk_fma_f32 v[84:85], v[86:87], v[86:87], v[84:85]
    v_pk_add_f32 v[82:83], v[82:83], v[86:87]
    v_pk_add_f32 v[88:89], v[20:21], s[48:49] neg_lo:[0,1] neg_hi:[0,1]
    v_pk_fma_f32 v[84:85], v[88:89], v[88:89], v[84:85]
    v_pk_add_f32 v[82:83], v[82:83], v[88:89]
    v_pk_add_f32 v[86:87], v[22:23], s[48:49] neg_lo:[0,1] neg_hi:[0,1]
    v_pk_fma_f32 v[84:85], v[86:87], v[86:87], v[84:85]
    v_pk_add_f32 v[82:83], v[82:83], v[86:87]
    v_pk_add_f32 v[88:89], v[24:25], s[48:49] neg_lo:[0,1] neg_hi:[0,1]
    v_pk_fma_f32 v[84:85], v[88:89], v[88:89], v[84:85]
    v_pk_add_f32 v[82:83], v[82:83], v[88:89]
    v_pk_mul_f32 v[82:83], v[82:83], s[22:23]
    v_pk_mul_f32 v[84:85], v[84:85], s[22:23]
    s_nop 1
    v_add_f32_dpp v82, v82, v82 row_shr:1 row_mask:0xf bank_mask:0xf bound_ctrl:0
    v_add_f32_dpp v83, v83, v83 row_shr:1 row_mask:0xf bank_mask:0xf bound_ctrl:0
    v_add_f32_dpp v84, v84, v84 row_shr:1 row_mask:0xf bank_mask:0xf bound_ctrl:0
    v_add_f32_dpp v85, v85, v85 row_shr:1 row_mask:0xf bank_mask:0xf bound_ctrl:0
    v_add_f32_dpp v82, v82, v82 row_shr:2 row_mask:0xf bank_mask:0xf bound_ctrl:0
    v_add_f32_dpp v83, v83, v83 row_shr:2 row_mask:0xf bank_mask:0xf bound_ctrl:0
    v_add_f32_dpp v84, v84, v84 row_shr:2 row_mask:0xf bank_mask:0xf bound_ctrl:0
    v_add_f32_dpp v85, v85, v85 row_shr:2 row_mask:0xf bank_mask:0xf bound_ctrl:0
    v_add_f32_dpp v82, v82, v82 row_shr:4 row_mask:0xf bank_mask:0xf bound_ctrl:0
    v_add_f32_dpp v83, v83, v83 row_shr:4 row_mask:0xf bank_mask:0xf bound_ctrl:0
    v_add_f32_dpp v84, v84, v84 row_shr:4 row_mask:0xf bank_mask:0xf bound_ctrl:0
    v_add_f32_dpp v85, v85, v85 row_shr:4 row_mask:0xf bank_mask:0xf bound_ctrl:0
    v_add_f32_dpp v82, v82, v82 row_shr:8 row_mask:0xf bank_mask:0xf bound_ctrl:0
    v_add_f32_dpp v83, v83, v83 row_shr:8 row_mask:0xf bank_mask:0xf bound_ctrl:0
    v_add_f32_dpp v84, v84, v84 row_shr:8 row_mask:0xf bank_mask:0xf bound_ctrl:0
    v_add_f32_dpp v85, v85, v85 row_shr:8 row_mask:0xf bank_mask:0xf bound_ctrl:0
    v_add_f32_dpp v82, v82, v82 row_bcast:15 row_mask:0xa bank_mask:0xf
    v_add_f32_dpp v83, v83, v83 row_bcast:15 row_mask:0xa bank_mask:0xf
    v_add_f32_dpp v84, v84, v84 row_bcast:15 row_mask:0xa bank_mask:0xf
    v_add_f32_dpp v85, v85, v85 row_bcast:15 row_mask:0xa bank_mask:0xf
    v_add_f32_dpp v82, v82, v82 row_bcast:31 row_mask:0xc bank_mask:0xf
    v_add_f32_dpp v83, v83, v83 row_bcast:31 row_mask:0xc bank_mask:0xf
    v_add_f32_dpp v84, v84, v84 row_bcast:31 row_mask:0xc bank_mask:0xf
    v_add_f32_dpp v85, v85, v85 row_bcast:31 row_mask:0xc bank_mask:0xf
    s_nop 0
    v_readlane_b32 s44, v82, 63
    v_readlane_b32 s45, v83, 63
    v_readlane_b32 s46, v84, 63
    v_readlane_b32 s47, v85, 63
    s_nop 1
    v_mov_b32 v82, s44
    v_mov_b32 v83, s45
    v_mov_b32 v84, s46
    v_mov_b32 v85, s47
    v_pk_fma_f32 v[84:85], v[82:83], v[82:83], v[84:85] neg_lo:[1,0,0] neg_hi:[1,0,0]
    v_max_f32 v84, 0, v84
    v_max_f32 v85, 0, v85
    v_pk_add_f32 v[82:83], v[82:83], s[48:49]
    v_cvt_pk_bf16_f32 v90, v82, v83
    v_lshlrev_b32 v82, 16, v90
    v_and_b32 v83, 0xffff0000, v90
    v_cvt_pk_bf16_f32 v91, v84, v85
    v_lshlrev_b32 v84, 16, v91
    v_and_b32 v85, 0xffff0000, v91
    v_add_f32 v84, 0x3727c5ac, v84
    v_add_f32 v85, 0x3727c5ac, v85
    v_cvt_pk_bf16_f32 v91, v84, v85
    v_lshlrev_b32 v84, 16, v91
    v_and_b32 v85, 0xffff0000, v91
    v_sqrt_f32 v84, v84
    v_sqrt_f32 v85, v85
    v_pk_add_f32 v[10:11], v[10:11], v[82:83] neg_lo:[0,1] neg_hi:[0,1]
    v_pk_add_f32 v[12:13], v[12:13], v[82:83] neg_lo:[0,1] neg_hi:[0,1]
    v_pk_add_f32 v[14:15], v[14:15], v[82:83] neg_lo:[0,1] neg_hi:[0,1]
    v_pk_add_f32 v[16:17], v[16:17], v[82:83] neg_lo:[0,1] neg_hi:[0,1]
    v_pk_add_f32 v[18:19], v[18:19], v[82:83] neg_lo:[0,1] neg_hi:[0,1]
    v_pk_add_f32 v[20:21], v[20:21], v[82:83] neg_lo:[0,1] neg_hi:[0,1]
    v_pk_add_f32 v[22:23], v[22:23], v[82:83] neg_lo:[0,1] neg_hi:[0,1]
    v_pk_add_f32 v[24:25], v[24:25], v[82:83] neg_lo:[0,1] neg_hi:[0,1]
    v_cvt_pk_bf16_f32 v94, v84, v85
    v_lshlrev_b32 v84, 16, v94
    v_and_b32 v85, 0xffff0000, v94
    v_rcp_f32 v84, v84
    v_rcp_f32 v85, v85
    v_cvt_pk_bf16_f32 v86, v10, v11
    v_cvt_pk_bf16_f32 v87, v12, v13
    v_cvt_pk_bf16_f32 v88, v14, v15
    v_cvt_pk_bf16_f32 v89, v16, v17
    v_cvt_pk_bf16_f32 v90, v18, v19
    v_cvt_pk_bf16_f32 v91, v20, v21
    v_cvt_pk_bf16_f32 v92, v22, v23
    v_cvt_pk_bf16_f32 v93, v24, v25
    v_lshlrev_b32 v10, 16, v86
    v_and_b32 v11, 0xffff0000, v86
    v_lshlrev_b32 v12, 16, v87
    v_and_b32 v13, 0xffff0000, v87
    v_lshlrev_b32 v14, 16, v88
    v_and_b32 v15, 0xffff0000, v88
    v_lshlrev_b32 v16, 16, v89
    v_and_b32 v17, 0xffff0000, v89
    v_lshlrev_b32 v18, 16, v90
    v_and_b32 v19, 0xffff0000, v90
    v_lshlrev_b32 v20, 16, v91
    v_and_b32 v21, 0xffff0000, v91
    v_lshlrev_b32 v22, 16, v92
    v_and_b32 v23, 0xffff0000, v92
    v_lshlrev_b32 v24, 16, v93
    v_and_b32 v25, 0xffff0000, v93
    v_pk_mul_f32 v[10:11], v[10:11], v[84:85]
    v_pk_mul_f32 v[12:13], v[12:13], v[84:85]
    v_pk_mul_f32 v[14:15], v[14:15], v[84:85]
    v_pk_mul_f32 v[16:17], v[16:17], v[84:85]
    v_pk_mul_f32 v[18:19], v[18:19], v[84:85]
    v_pk_mul_f32 v[20:21], v[20:21], v[84:85]
    v_pk_mul_f32 v[22:23], v[22:23], v[84:85]
    v_pk_mul_f32 v[24:25], v[24:25], v[84:85]
    v_cvt_pk_bf16_f32 v86, v10, v11
    v_cvt_pk_bf16_f32 v87, v12, v13
    v_cvt_pk_bf16_f32 v88, v14, v15
    v_cvt_pk_bf16_f32 v89, v16, v17
    v_cvt_pk_bf16_f32 v90, v18, v19
    v_cvt_pk_bf16_f32 v91, v20, v21
    v_cvt_pk_bf16_f32 v92, v22, v23
    v_cvt_pk_bf16_f32 v93, v24, v25
    v_lshlrev_b32 v10, 16, v86
    v_and_b32 v11, 0xffff0000, v86
    v_lshlrev_b32 v12, 16, v87
    v_and_b32 v13, 0xffff0000, v87
    v_lshlrev_b32 v14, 16, v88
    v_and_b32 v15, 0xffff0000, v88
    v_lshlrev_b32 v16, 16, v89
    v_and_b32 v17, 0xffff0000, v89
    v_lshlrev_b32 v18, 16, v90
    v_and_b32 v19, 0xffff0000, v90
    v_lshlrev_b32 v20, 16, v91
    v_and_b32 v21, 0xffff0000, v91
    v_lshlrev_b32 v22, 16, v92
    v_and_b32 v23, 0xffff0000, v92
    v_lshlrev_b32 v24, 16, v93
    v_and_b32 v25, 0xffff0000, v93
    v_cvt_pk_bf16_f32 v26, v10, v12
    v_cvt_pk_bf16_f32 v30, v11, v13
    v_cvt_pk_bf16_f32 v27, v14, v16
    v_cvt_pk_bf16_f32 v31, v15, v17
    v_cvt_pk_bf16_f32 v28, v18, v20
    v_cvt_pk_bf16_f32 v32, v19, v21
    v_cvt_pk_bf16_f32 v29, v22, v24
    v_cvt_pk_bf16_f32 v33, v23, v25
    s_mov_b32 s29, 0x1540000
    buffer_store_dwordx4 v[26:29], v6, s[12:15], s29 offen sc1
    buffer_store_dwordx4 v[30:33], v6, s[12:15], s29 offen offset:1024 sc1
    s_branch Ljoin_70
Lskip_69:
    s_barrier
    s_barrier
Ljoin_70:
    s_waitcnt vmcnt(0)
    s_barrier
    s_cmp_lg_u32 s3, 0
    s_cbranch_scc1 Lpub_75
    s_lshr_b32 s92, s2, 4
    s_lshl_b32 s92, s92, 8
    s_add_u32 s92, s92, 16384
    v_mov_b32 v158, 1
    v_mov_b32 v159, 0
    s_mov_b64 exec, 1
    buffer_atomic_add v158, v159, s[96:99], s92 offen sc1
    s_mov_b64 exec, -1
Lpub_75:
    s_cmp_ge_u32 s2, 224
    s_cbranch_scc1 Lg1skip_76
    s_mov_b64 s[4:5], s[72:73]
    s_mov_b64 s[6:7], s[74:75]
    s_mov_b64 s[8:9], s[84:85]
    s_and_b32 s10, s2, 7
    s_lshr_b32 s11, s2, 3
    s_and_b32 s28, s11, 3
    s_lshr_b32 s11, s11, 2
    s_and_b32 s29, s10, 1
    s_mul_i32 s29, s29, 7
    s_add_u32 s11, s11, s29
    s_lshr_b32 s10, s10, 1
    s_lshl_b32 s10, s10, 2
    s_add_u32 s10, s10, s28
    v_lshrrev_b32 v6, 3, v1
    v_lshlrev_b32 v6, 10, v6
    v_and_b32 v7, 7, v1
    v_lshrrev_b32 v8, 4, v1
    v_xor_b32 v7, v7, v8
    v_lshl_add_u32 v3, v7, 4, v6
    v_xor_b32 v7, 4, v7
    v_lshl_add_u32 v4, v7, 4, v6
    s_lshl_b32 s28, s10, 17
    s_lshl_b32 s29, s3, 14
    s_add_u32 s28, s28, s29
    v_and_b32 v7, 15, v1
    v_lshlrev_b32 v9, 2, v8
    v_xor_b32 v7, v7, v9
    s_movk_i32 s30, 3584
    v_mul_lo_u32 v8, v8, s30
    v_lshl_add_u32 v5, v7, 4, v8
    s_lshl_b32 s31, s11, 8
    s_mul_i32 s29, s3, 28672
    s_add_u32 s31, s31, s29
    s_lshl_b32 s32, s3, 11
    s_waitcnt lgkmcnt(0)
    s_mov_b32 s12, s4
    s_and_b32 s13, s5, 0xffff
    s_mov_b32 s14, 0x1c0000
    s_mov_b32 s15, 0x00020000
    s_add_u32 s20, s8, 0x1540000
    s_addc_u32 s21, s9, 0
    s_and_b32 s21, s21, 0xffff
    s_mov_b32 s22, 0x200000
    s_mov_b32 s23, 0x00020000
    s_cmp_lg_u32 s3, 0
    s_cbranch_scc1 Lpd_78
    s_lshl_b32 s92, s10, 8
    s_add_u32 s92, s92, 16384
    v_mov_b32 v159, 0
    s_mov_b32 s93, 0
Lpl_79:
    v_mov_b32 v158, 0
    s_mov_b64 exec, 1
    buffer_atomic_add v158, v159, s[96:99], s92 offen sc0 sc1
    s_mov_b64 exec, -1
    s_waitcnt vmcnt(0)
    v_readfirstlane_b32 s94, v158
    s_add_u32 s93, s93, 1
    s_cmp_ge_u32 s94, 16
    s_cbranch_scc1 Lpd_78
    s_cmp_gt_u32 s93, 0x40000
    s_cbranch_scc1 Lpd_78
    s_sleep 2
    s_branch Lpl_79
Lpd_78:
    s_add_u32 m0, s32, 16384
    s_add_u32 s33, s31, 0
    buffer_load_dwordx4 v5, s[12:15], s33 offen lds
    s_add_u32 m0, s32, 17408
    s_add_u32 s33, s31, 14336
    buffer_load_dwordx4 v5, s[12:15], s33 offen lds
    s_add_u32 m0, s32, 49152
    s_add_u32 s33, s31, 229376
    buffer_load_dwordx4 v5, s[12:15], s33 offen lds
    s_add_u32 m0, s32, 50176
    s_add_u32 s33, s31, 243712
    buffer_load_dwordx4 v5, s[12:15], s33 offen lds
    s_add_u32 m0, s32, 81920
    s_add_u32 s33, s31, 458752
    buffer_load_dwordx4 v5, s[12:15], s33 offen lds
    s_add_u32 m0, s32, 82944
    s_add_u32 s33, s31, 473088
    buffer_load_dwordx4 v5, s[12:15], s33 offen lds
    s_add_u32 m0, s32, 114688
    s_add_u32 s33, s31, 688128
    buffer_load_dwordx4 v5, s[12:15], s33 offen lds
    s_add_u32 m0, s32, 115712
    s_add_u32 s33, s31, 702464
    buffer_load_dwordx4 v5, s[12:15], s33 offen lds
    s_mov_b32 s16, s6
    s_and_b32 s17, s7, 0xffff
    s_mov_b32 s18, 0xe00
    s_mov_b32 s19, 0x00020000
    s_add_u32 s24, s8, 0x1740000
    s_addc_u32 s25, s9, 0
    s_and_b32 s25, s25, 0xffff
    s_mov_b32 s26, 0x700000
    s_mov_b32 s27, 0x00020000
    s_lshr_b32 s34, s3, 1
    s_and_b32 s35, s3, 1
    v_and_b32 v6, 31, v1
    v_lshlrev_b32 v6, 7, v6
    s_lshl_b32 s37, s35, 13
    v_add_u32 v6, s37, v6
    v_lshrrev_b32 v7, 5, v1
    v_bfe_u32 v8, v1, 1, 3
    v_xor_b32 v7, v7, v8
    v_lshl_add_u32 v6, v7, 4, v6
    v_xor_b32 v26, 0, v6
    v_add_u32 v30, 0x10000, v26
    v_xor_b32 v27, 32, v6
    v_add_u32 v31, 0x10000, v27
    v_xor_b32 v28, 64, v6
    v_add_u32 v32, 0x10000, v28
    v_xor_b32 v29, 96, v6
    v_add_u32 v33, 0x10000, v29
    v_lshrrev_b32 v6, 5, v1
    v_lshlrev_b32 v6, 3, v6
    v_bfe_u32 v7, v1, 2, 2
    v_add_u32 v6, v6, v7
    v_lshlrev_b32 v6, 8, v6
    v_bfe_u32 v8, v1, 4, 1
    v_lshlrev_b32 v8, 1, v8
    v_bfe_u32 v9, v1, 1, 1
    v_add_u32 v8, v8, v9
    s_lshl_b32 s37, s34, 2
    v_add_u32 v8, s37, v8
    v_lshlrev_b32 v7, 2, v7
    v_xor_b32 v8, v8, v7
    v_lshl_add_u32 v6, v8, 4, v6
    v_and_b32 v9, 1, v1
    v_lshl_add_u32 v6, v9, 3, v6
    v_add_u32 v34, 16384, v6
    v_add_u32 v35, 0x10000, v34
    v_add_u32 v36, 0x1c000, v34
    v_mov_b32 v64, 0
    v_mov_b32 v65, 0
    v_mov_b32 v66, 0
    v_mov_b32 v67, 0
    v_mov_b32 v68, 0
    v_mov_b32 v69, 0
    v_mov_b32 v70, 0
    v_mov_b32 v71, 0
    v_mov_b32 v72, 0
    v_mov_b32 v73, 0
    v_mov_b32 v74, 0
    v_mov_b32 v75, 0
    v_mov_b32 v76, 0
    v_mov_b32 v77, 0
    v_mov_b32 v78, 0
    v_mov_b32 v79, 0
    v_mov_b32 v80, 0
    v_mov_b32 v81, 0
    v_mov_b32 v82, 0
    v_mov_b32 v83, 0
    v_mov_b32 v84, 0
    v_mov_b32 v85, 0
    v_mov_b32 v86, 0
    v_mov_b32 v87, 0
    v_mov_b32 v88, 0
    v_mov_b32 v89, 0
    v_mov_b32 v90, 0
    v_mov_b32 v91, 0
    v_mov_b32 v92, 0
    v_mov_b32 v93, 0
    v_mov_b32 v94, 0
    v_mov_b32 v95, 0
    s_barrier
    s_add_u32 m0, s32, 0
    s_add_u32 s33, s28, 0
    buffer_load_dwordx4 v3, s[20:23], s33 offen lds
    s_add_u32 m0, s32, 1024
    s_add_u32 s33, s28, 8192
    buffer_load_dwordx4 v4, s[20:23], s33 offen lds
    s_add_u32 m0, s32, 32768
    s_add_u32 s33, s28, 128
    buffer_load_dwordx4 v3, s[20:23], s33 offen lds
    s_add_u32 m0, s32, 33792
    s_add_u32 s33, s28, 8320
    buffer_load_dwordx4 v4, s[20:23], s33 offen lds
    s_add_u32 m0, s32, 65536
    s_add_u32 s33, s28, 256
    buffer_load_dwordx4 v3, s[20:23], s33 offen lds
    s_add_u32 m0, s32, 66560
    s_add_u32 s33, s28, 8448
    buffer_load_dwordx4 v4, s[20:23], s33 offen lds
    s_add_u32 m0, s32, 98304
    s_add_u32 s33, s28, 384
    buffer_load_dwordx4 v3, s[20:23], s33 offen lds
    s_add_u32 m0, s32, 99328
    s_add_u32 s33, s28, 8576
    buffer_load_dwordx4 v4, s[20:23], s33 offen lds
    v_lshrrev_b32 v6, 5, v1
    v_lshlrev_b32 v6, 3, v6
    s_lshl_b32 s36, s11, 8
    s_lshl_b32 s37, s34, 6
    s_add_u32 s36, s36, s37
    buffer_load_dwordx2 v[10:11], v6, s[16:19], s36 offen offset:0
    buffer_load_dwordx2 v[12:13], v6, s[16:19], s36 offen offset:16
    buffer_load_dwordx2 v[14:15], v6, s[16:19], s36 offen offset:32
    buffer_load_dwordx2 v[16:17], v6, s[16:19], s36 offen offset:48
    s_waitcnt vmcnt(10)
    s_barrier
    ds_read_b64_tr_b16 v[96:97], v34 offset:0
    ds_read_b64_tr_b16 v[98:99], v34 offset:1024
    ds_read_b128 v[100:103], v26 offset:0
    ds_read_b128 v[104:107], v26 offset:4096
    s_waitcnt lgkmcnt(1)
    v_mfma_f32_32x32x16_bf16 v[64:79], v[96:99], v[100:103], v[64:79]
    ds_read_b64_tr_b16 v[108:109], v34 offset:4096
    ds_read_b64_tr_b16 v[110:111], v34 offset:5120
    s_waitcnt lgkmcnt(2)
    v_mfma_f32_32x32x16_bf16 v[80:95], v[96:99], v[104:107], v[80:95]
    ds_read_b128 v[112:115], v27 offset:0
    ds_read_b128 v[116:119], v27 offset:4096
    s_waitcnt lgkmcnt(1)
    v_mfma_f32_32x32x16_bf16 v[64:79], v[108:111], v[112:115], v[64:79]
    ds_read_b64_tr_b16 v[96:97], v34 offset:8192
    ds_read_b64_tr_b16 v[98:99], v34 offset:9216
    s_waitcnt lgkmcnt(2)
    v_mfma_f32_32x32x16_bf16 v[80:95], v[108:111], v[116:119], v[80:95]
    ds_read_b128 v[100:103], v28 offset:0
    ds_read_b128 v[104:107], v28 offset:4096
    s_waitcnt lgkmcnt(1)
    v_mfma_f32_32x32x16_bf16 v[64:79], v[96:99], v[100:103], v[64:79]
    ds_read_b64_tr_b16 v[108:109], v34 offset:12288
    ds_read_b64_tr_b16 v[110:111], v34 offset:13312
    s_waitcnt lgkmcnt(2)
    v_mfma_f32_32x32x16_bf16 v[80:95], v[96:99], v[104:107], v[80:95]
    ds_read_b128 v[112:115], v29 offset:0
    ds_read_b128 v[116:119], v29 offset:4096
    s_waitcnt lgkmcnt(1)
    v_mfma_f32_32x32x16_bf16 v[64:79], v[108:111], v[112:115], v[64:79]
    s_waitcnt vmcnt(8) lgkmcnt(0)
    s_barrier
    ds_read_b64_tr_b16 v[96:97], v34 offset:32768
    ds_read_b64_tr_b16 v[98:99], v34 offset:33792
    ds_read_b128 v[100:103], v26 offset:32768
    ds_read_b128 v[104:107], v26 offset:36864
    v_mfma_f32_32x32x16_bf16 v[80:95], v[108:111], v[116:119], v[80:95]
    s_add_u32 m0, s32, 0
    s_add_u32 s33, s28, 512
    buffer_load_dwordx4 v3, s[20:23], s33 offen lds
    s_add_u32 m0, s32, 1024
    s_add_u32 s33, s28, 8704
    buffer_load_dwordx4 v4, s[20:23], s33 offen lds
    s_add_u32 m0, s32, 16384
    s_add_u32 s33, s31, 917504
    buffer_load_dwordx4 v5, s[12:15], s33 offen lds
    s_add_u32 m0, s32, 17408
    s_add_u32 s33, s31, 931840
    buffer_load_dwordx4 v5, s[12:15], s33 offen lds
    s_waitcnt lgkmcnt(1)
    v_mfma_f32_32x32x16_bf16 v[64:79], v[96:99], v[100:103], v[64:79]
    ds_read_b64_tr_b16 v[108:109], v34 offset:36864
    ds_read_b64_tr_b16 v[110:111], v34 offset:37888
    s_waitcnt lgkmcnt(2)
    v_mfma_f32_32x32x16_bf16 v[80:95], v[96:99], v[104:107], v[80:95]
    ds_read_b128 v[112:115], v27 offset:32768
    ds_read_b128 v[116:119], v27 offset:36864
    s_waitcnt lgkmcnt(1)
    v_mfma_f32_32x32x16_bf16 v[64:79], v[108:111], v[112:115], v[64:79]
    ds_read_b64_tr_b16 v[96:97], v34 offset:40960
    ds_read_b64_tr_b16 v[98:99], v34 offset:41984
    s_waitcnt lgkmcnt(2)
    v_mfma_f32_32x32x16_bf16 v[80:95], v[108:111], v[116:119], v[80:95]
    ds_read_b128 v[100:103], v28 offset:32768
    ds_read_b128 v[104:107], v28 offset:36864
    s_waitcnt lgkmcnt(1)
    v_mfma_f32_32x32x16_bf16 v[64:79], v[96:99], v[100:103], v[64:79]
    ds_read_b64_tr_b16 v[108:109], v34 offset:45056
    ds_read_b64_tr_b16 v[110:111], v34 offset:46080
    s_waitcnt lgkmcnt(2)
    v_mfma_f32_32x32x16_bf16 v[80:95], v[96:99], v[104:107], v[80:95]
    ds_read_b128 v[112:115], v29 offset:32768
    ds_read_b128 v[116:119], v29 offset:36864
    s_waitcnt lgkmcnt(1)
    v_mfma_f32_32x32x16_bf16 v[64:79], v[108:111], v[112:115], v[64:79]
    s_waitcnt vmcnt(10) lgkmcnt(0)
    s_barrier
    ds_read_b64_tr_b16 v[96:97], v35 offset:0
    ds_read_b64_tr_b16 v[98:99], v35 offset:1024
    ds_read_b128 v[100:103], v30 offset:0
    ds_read_b128 v[104:107], v30 offset:4096
    v_mfma_f32_32x32x16_bf16 v[80:95], v[108:111], v[116:119], v[80:95]
    s_add_u32 m0, s32, 32768
    s_add_u32 s33, s28, 640
    buffer_load_dwordx4 v3, s[20:23], s33 offen lds
    s_add_u32 m0, s32, 33792
    s_add_u32 s33, s28, 8832
    buffer_load_dwordx4 v4, s[20:23], s33 offen lds
    s_add_u32 m0, s32, 49152
    s_add_u32 s33, s31, 1146880
    buffer_load_dwordx4 v5, s[12:15], s33 offen lds
    s_add_u32 m0, s32, 50176
    s_add_u32 s33, s31, 1161216
    buffer_load_dwordx4 v5, s[12:15], s33 offen lds
    s_waitcnt lgkmcnt(1)
    v_mfma_f32_32x32x16_bf16 v[64:79], v[96:99], v[100:103], v[64:79]
    ds_read_b64_tr_b16 v[108:109], v35 offset:4096
    ds_read_b64_tr_b16 v[110:111], v35 offset:5120
    s_waitcnt lgkmcnt(2)
    v_mfma_f32_32x32x16_bf16 v[80:95], v[96:99], v[104:107], v[80:95]
    ds_read_b128 v[112:115], v31 offset:0
    ds_read_b128 v[116:119], v31 offset:4096
    s_waitcnt lgkmcnt(1)
    v_mfma_f32_32x32x16_bf16 v[64:79], v[108:111], v[112:115], v[64:79]
    ds_read_b64_tr_b16 v[96:97], v35 offset:8192
    ds_read_b64_tr_b16 v[98:99], v35 offset:9216
    s_waitcnt lgkmcnt(2)
    v_mfma_f32_32x32x16_bf16 v[80:95], v[108:111], v[116:119], v[80:95]
    ds_read_b128 v[100:103], v32 offset:0
    ds_read_b128 v[104:107], v32 offset:4096
    s_waitcnt lgkmcnt(1)
    v_mfma_f32_32x32x16_bf16 v[64:79], v[96:99], v[100:103], v[64:79]
    ds_read_b64_tr_b16 v[108:109], v35 offset:12288
    ds_read_b64_tr_b16 v[110:111], v35 offset:13312
    s_waitcnt lgkmcnt(2)
    v_mfma_f32_32x32x16_bf16 v[80:95], v[96:99], v[104:107], v[80:95]
    ds_read_b128 v[112:115], v33 offset:0
    ds_read_b128 v[116:119], v33 offset:4096
    s_waitcnt lgkmcnt(1)
    v_mfma_f32_32x32x16_bf16 v[64:79], v[108:111], v[112:115], v[64:79]
    s_waitcnt vmcnt(12) lgkmcnt(0)
    s_barrier
    ds_read_b64_tr_b16 v[96:97], v35 offset:32768
    ds_read_b64_tr_b16 v[98:99], v35 offset:33792
    ds_read_b128 v[100:103], v30 offset:32768
    ds_read_b128 v[104:107], v30 offset:36864
    v_mfma_f32_32x32x16_bf16 v[80:95], v[108:111], v[116:119], v[80:95]
    s_add_u32 m0, s32, 65536
    s_add_u32 s33, s28, 768
    buffer_load_dwordx4 v3, s[20:23], s33 offen lds
    s_add_u32 m0, s32, 66560
    s_add_u32 s33, s28, 8960
    buffer_load_dwordx4 v4, s[20:23], s33 offen lds
    s_add_u32 m0, s32, 81920
    s_add_u32 s33, s31, 1376256
    buffer_load_dwordx4 v5, s[12:15], s33 offen lds
    s_add_u32 m0, s32, 82944
    s_add_u32 s33, s31, 1390592
    buffer_load_dwordx4 v5, s[12:15], s33 offen lds
    s_waitcnt lgkmcnt(1)
    v_mfma_f32_32x32x16_bf16 v[64:79], v[96:99], v[100:103], v[64:79]
    ds_read_b64_tr_b16 v[108:109], v35 offset:36864
    ds_read_b64_tr_b16 v[110:111], v35 offset:37888
    s_waitcnt lgkmcnt(2)
    v_mfma_f32_32x32x16_bf16 v[80:95], v[96:99], v[104:107], v[80:95]
    ds_read_b128 v[112:115], v31 offset:32768
    ds_read_b128 v[116:119], v31 offset:36864
    s_waitcnt lgkmcnt(1)
    v_mfma_f32_32x32x16_bf16 v[64:79], v[108:111], v[112:115], v[64:79]
    ds_read_b64_tr_b16 v[96:97], v35 offset:40960
    ds_read_b64_tr_b16 v[98:99], v35 offset:41984
    s_waitcnt lgkmcnt(2)
    v_mfma_f32_32x32x16_bf16 v[80:95], v[108:111], v[116:119], v[80:95]
    ds_read_b128 v[100:103], v32 offset:32768
    ds_read_b128 v[104:107], v32 offset:36864
    s_waitcnt lgkmcnt(1)
    v_mfma_f32_32x32x16_bf16 v[64:79], v[96:99], v[100:103], v[64:79]
    ds_read_b64_tr_b16 v[108:109], v35 offset:45056
    ds_read_b64_tr_b16 v[110:111], v35 offset:46080
    s_waitcnt lgkmcnt(2)
    v_mfma_f32_32x32x16_bf16 v[80:95], v[96:99], v[104:107], v[80:95]
    ds_read_b128 v[112:115], v33 offset:32768
    ds_read_b128 v[116:119], v33 offset:36864
    s_waitcnt lgkmcnt(1)
    v_mfma_f32_32x32x16_bf16 v[64:79], v[108:111], v[112:115], v[64:79]
    s_waitcnt vmcnt(8) lgkmcnt(0)
    s_barrier
    ds_read_b64_tr_b16 v[96:97], v34 offset:0
    ds_read_b64_tr_b16 v[98:99], v34 offset:1024
    ds_read_b128 v[100:103], v26 offset:0
    ds_read_b128 v[104:107], v26 offset:4096
    v_mfma_f32_32x32x16_bf16 v[80:95], v[108:111], v[116:119], v[80:95]
    s_add_u32 m0, s32, 98304
    s_add_u32 s33, s28, 896
    buffer_load_dwordx4 v3, s[20:23], s33 offen lds
    s_add_u32 m0, s32, 99328
    s_add_u32 s33, s28, 9088
    buffer_load_dwordx4 v4, s[20:23], s33 offen lds
    s_add_u32 m0, s32, 114688
    s_add_u32 s33, s31, 1605632
    buffer_load_dwordx4 v5, s[12:15], s33 offen lds
    s_add_u32 m0, s32, 115712
    s_add_u32 s33, s31, 1619968
    buffer_load_dwordx4 v5, s[12:15], s33 offen lds
    s_waitcnt lgkmcnt(1)
    v_mfma_f32_32x32x16_bf16 v[64:79], v[96:99], v[100:103], v[64:79]
    ds_read_b64_tr_b16 v[108:109], v34 offset:4096
    ds_read_b64_tr_b16 v[110:111], v34 offset:5120
    s_waitcnt lgkmcnt(2)
    v_mfma_f32_32x32x16_bf16 v[80:95], v[96:99], v[104:107], v[80:95]
    ds_read_b128 v[112:115], v27 offset:0
    ds_read_b128 v[116:119], v27 offset:4096
    s_waitcnt lgkmcnt(1)
    v_mfma_f32_32x32x16_bf16 v[64:79], v[108:111], v[112:115], v[64:79]
    ds_read_b64_tr_b16 v[96:97], v34 offset:8192
    ds_read_b64_tr_b16 v[98:99], v34 offset:9216
    s_waitcnt lgkmcnt(2)
    v_mfma_f32_32x32x16_bf16 v[80:95], v[108:111], v[116:119], v[80:95]
    ds_read_b128 v[100:103], v28 offset:0
    ds_read_b128 v[104:107], v28 offset:4096
    s_waitcnt lgkmcnt(1)
    v_mfma_f32_32x32x16_bf16 v[64:79], v[96:99], v[100:103], v[64:79]
    ds_read_b64_tr_b16 v[108:109], v34 offset:12288
    ds_read_b64_tr_b16 v[110:111], v34 offset:13312
    s_waitcnt lgkmcnt(2)
    v_mfma_f32_32x32x16_bf16 v[80:95], v[96:99], v[104:107], v[80:95]
    ds_read_b128 v[112:115], v29 offset:0
    ds_read_b128 v[116:119], v29 offset:4096
    s_waitcnt lgkmcnt(1)
    v_mfma_f32_32x32x16_bf16 v[64:79], v[108:111], v[112:115], v[64:79]
    s_waitcnt vmcnt(8) lgkmcnt(0)
    s_barrier
    ds_read_b64_tr_b16 v[96:97], v34 offset:32768
    ds_read_b64_tr_b16 v[98:99], v34 offset:33792
    ds_read_b128 v[100:103], v26 offset:32768
    ds_read_b128 v[104:107], v26 offset:36864
    v_mfma_f32_32x32x16_bf16 v[80:95], v[108:111], v[116:119], v[80:95]
    s_waitcnt lgkmcnt(1)
    v_mfma_f32_32x32x16_bf16 v[64:79], v[96:99], v[100:103], v[64:79]
    ds_read_b64_tr_b16 v[108:109], v34 offset:36864
    ds_read_b64_tr_b16 v[110:111], v34 offset:37888
    s_waitcnt lgkmcnt(2)
    v_mfma_f32_32x32x16_bf16 v[80:95], v[96:99], v[104:107], v[80:95]
    ds_read_b128 v[112:115], v27 offset:32768
    ds_read_b128 v[116:119], v27 offset:36864
    s_waitcnt lgkmcnt(1)
    v_mfma_f32_32x32x16_bf16 v[64:79], v[108:111], v[112:115], v[64:79]
    ds_read_b64_tr_b16 v[96:97], v34 offset:40960
    ds_read_b64_tr_b16 v[98:99], v34 offset:41984
    s_waitcnt lgkmcnt(2)
    v_mfma_f32_32x32x16_bf16 v[80:95], v[108:111], v[116:119], v[80:95]
    ds_read_b128 v[100:103], v28 offset:32768
    ds_read_b128 v[104:107], v28 offset:36864
    s_waitcnt lgkmcnt(1)
    v_mfma_f32_32x32x16_bf16 v[64:79], v[96:99], v[100:103], v[64:79]
    ds_read_b64_tr_b16 v[108:109], v34 offset:45056
    ds_read_b64_tr_b16 v[110:111], v34 offset:46080
    s_waitcnt lgkmcnt(2)
    v_mfma_f32_32x32x16_bf16 v[80:95], v[96:99], v[104:107], v[80:95]
    ds_read_b128 v[112:115], v29 offset:32768
    ds_read_b128 v[116:119], v29 offset:36864
    s_waitcnt lgkmcnt(1)
    v_mfma_f32_32x32x16_bf16 v[64:79], v[108:111], v[112:115], v[64:79]
    s_waitcnt vmcnt(4) lgkmcnt(0)
    s_barrier
    ds_read_b64_tr_b16 v[96:97], v35 offset:0
    ds_read_b64_tr_b16 v[98:99], v35 offset:1024
    ds_read_b128 v[100:103], v30 offset:0
    ds_read_b128 v[104:107], v30 offset:4096
    v_mfma_f32_32x32x16_bf16 v[80:95], v[108:111], v[116:119], v[80:95]
    s_waitcnt lgkmcnt(1)
    v_mfma_f32_32x32x16_bf16 v[64:79], v[96:99], v[100:103], v[64:79]
    ds_read_b64_tr_b16 v[108:109], v35 offset:4096
    ds_read_b64_tr_b16 v[110:111], v35 offset:5120
    s_waitcnt lgkmcnt(2)
    v_mfma_f32_32x32x16_bf16 v[80:95], v[96:99], v[104:107], v[80:95]
    ds_read_b128 v[112:115], v31 offset:0
    ds_read_b128 v[116:119], v31 offset:4096
    s_waitcnt lgkmcnt(1)
    v_mfma_f32_32x32x16_bf16 v[64:79], v[108:111], v[112:115], v[64:79]
    ds_read_b64_tr_b16 v[96:97], v35 offset:8192
    ds_read_b64_tr_b16 v[98:99], v35 offset:9216
    s_waitcnt lgkmcnt(2)
    v_mfma_f32_32x32x16_bf16 v[80:95], v[108:111], v[116:119], v[80:95]
    ds_read_b128 v[100:103], v32 offset:0
    ds_read_b128 v[104:107], v32 offset:4096
    s_waitcnt lgkmcnt(1)
    v_mfma_f32_32x32x16_bf16 v[64:79], v[96:99], v[100:103], v[64:79]
    ds_read_b64_tr_b16 v[108:109], v35 offset:12288
    ds_read_b64_tr_b16 v[110:111], v35 offset:13312
    s_waitcnt lgkmcnt(2)
    v_mfma_f32_32x32x16_bf16 v[80:95], v[96:99], v[104:107], v[80:95]
    ds_read_b128 v[112:115], v33 offset:0
    ds_read_b128 v[116:119], v33 offset:4096
    s_waitcnt lgkmcnt(1)
    v_mfma_f32_32x32x16_bf16 v[64:79], v[108:111], v[112:115], v[64:79]
    s_waitcnt vmcnt(0) lgkmcnt(0)
    s_barrier
    ds_read_b64_tr_b16 v[96:97], v35 offset:32768
    ds_read_b64_tr_b16 v[98:99], v35 offset:33792
    ds_read_b128 v[100:103], v30 offset:32768
    ds_read_b128 v[104:107], v30 offset:36864
    v_mfma_f32_32x32x16_bf16 v[80:95], v[108:111], v[116:119], v[80:95]
    s_waitcnt lgkmcnt(1)
    v_mfma_f32_32x32x16_bf16 v[64:79], v[96:99], v[100:103], v[64:79]
    ds_read_b64_tr_b16 v[108:109], v35 offset:36864
    ds_read_b64_tr_b16 v[110:111], v35 offset:37888
    s_waitcnt lgkmcnt(2)
    v_mfma_f32_32x32x16_bf16 v[80:95], v[96:99], v[104:107], v[80:95]
    ds_read_b128 v[112:115], v31 offset:32768
    ds_read_b128 v[116:119], v31 offset:36864
    s_waitcnt lgkmcnt(1)
    v_mfma_f32_32x32x16_bf16 v[64:79], v[108:111], v[112:115], v[64:79]
    ds_read_b64_tr_b16 v[96:97], v35 offset:40960
    ds_read_b64_tr_b16 v[98:99], v35 offset:41984
    s_waitcnt lgkmcnt(2)
    v_mfma_f32_32x32x16_bf16 v[80:95], v[108:111], v[116:119], v[80:95]
    ds_read_b128 v[100:103], v32 offset:32768
    ds_read_b128 v[104:107], v32 offset:36864
    s_waitcnt lgkmcnt(1)
    v_mfma_f32_32x32x16_bf16 v[64:79], v[96:99], v[100:103], v[64:79]
    ds_read_b64_tr_b16 v[108:109], v35 offset:45056
    ds_read_b64_tr_b16 v[110:111], v35 offset:46080
    s_waitcnt lgkmcnt(2)
    v_mfma_f32_32x32x16_bf16 v[80:95], v[96:99], v[104:107], v[80:95]
    ds_read_b128 v[112:115], v33 offset:32768
    ds_read_b128 v[116:119], v33 offset:36864
    s_waitcnt lgkmcnt(1)
    v_mfma_f32_32x32x16_bf16 v[64:79], v[108:111], v[112:115], v[64:79]
    s_waitcnt lgkmcnt(0)
    v_mfma_f32_32x32x16_bf16 v[80:95], v[108:111], v[116:119], v[80:95]
    s_waitcnt vmcnt(0)
    v_mov_b32 v38, 0xc0135761
    v_mov_b32 v39, 0xc0135761
    s_mov_b32 s42, 0xbdd2d3e8
    s_mov_b32 s43, s42
    s_mov_b32 s44, 1.0
    s_mov_b32 s45, 1.0
    v_lshlrev_b32 v96, 16, v10
    v_and_b32 v97, 0xffff0000, v10
    v_lshlrev_b32 v98, 16, v11
    v_and_b32 v99, 0xffff0000, v11
    v_lshlrev_b32 v100, 16, v12
    v_and_b32 v101, 0xffff0000, v12
    v_lshlrev_b32 v102, 16, v13
    v_and_b32 v103, 0xffff0000, v13
    v_lshlrev_b32 v104, 16, v14
    v_and_b32 v105, 0xffff0000, v14
    v_lshlrev_b32 v106, 16, v15
    v_and_b32 v107, 0xffff0000, v15
    v_lshlrev_b32 v108, 16, v16
    v_and_b32 v109, 0xffff0000, v16
    v_lshlrev_b32 v110, 16, v17
    v_and_b32 v111, 0xffff0000, v17
    s_lshr_b32 s37, s34, 1
    s_lshl_b32 s37, s37, 1
    s_add_u32 s37, s37, s35
    s_lshl_b32 s37, s37, 13
    v_and_b32 v6, 31, v1
    v_lshlrev_b32 v7, 7, v6
    v_add_u32 v7, s37, v7
    v_lshrrev_b32 v8, 5, v1
    v_lshl_add_u32 v7, v8, 3, v7
    v_and_b32 v8, 7, v1
    v_lshl_add_u32 v7, v8, 4, v7
    s_and_b32 s38, s34, 1
    s_lshl_b32 s38, s38, 6
    v_xor_b32 v7, s38, v7
    v_cvt_pk_bf16_f32 v40, v64, v65
    v_cvt_pk_bf16_f32 v41, v66, v67
    v_lshlrev_b32 v64, 16, v40
    v_and_b32 v65, 0xffff0000, v40
    v_lshlrev_b32 v66, 16, v41
    v_and_b32 v67, 0xffff0000, v41
    v_pk_add_f32 v[64:65], v[64:65], v[96:97]
    v_pk_add_f32 v[66:67], v[66:67], v[98:99]
    v_cvt_pk_bf16_f32 v40, v64, v65
    v_cvt_pk_bf16_f32 v41, v66, v67
    v_lshlrev_b32 v64, 16, v40
    v_and_b32 v65, 0xffff0000, v40
    v_lshlrev_b32 v66, 16, v41
    v_and_b32 v67, 0xffff0000, v41
    v_pk_mul_f32 v[40:41], v[64:65], v[64:65]
    v_pk_mul_f32 v[42:43], v[66:67], v[66:67]
    v_pk_fma_f32 v[40:41], v[40:41], s[42:43], v[38:39]
    v_pk_fma_f32 v[42:43], v[42:43], s[42:43], v[38:39]
    v_pk_mul_f32 v[40:41], v[40:41], v[64:65]
    v_pk_mul_f32 v[42:43], v[42:43], v[66:67]
    v_exp_f32 v40, v40
    v_exp_f32 v41, v41
    v_exp_f32 v42, v42
    v_exp_f32 v43, v43
    v_pk_add_f32 v[40:41], v[40:41], s[44:45]
    v_pk_add_f32 v[42:43], v[42:43], s[44:45]
    v_rcp_f32 v40, v40
    v_rcp_f32 v41, v41
    v_rcp_f32 v42, v42
    v_rcp_f32 v43, v43
    v_pk_mul_f32 v[64:65], v[64:65], v[40:41]
    v_pk_mul_f32 v[66:67], v[66:67], v[42:43]
    v_cvt_pk_bf16_f32 v44, v64, v65
    v_cvt_pk_bf16_f32 v45, v66, v67
    v_xor_b32 v46, 0, v7
    ds_write_b64 v46, v[44:45] offset:0
    v_cvt_pk_bf16_f32 v48, v68, v69
    v_cvt_pk_bf16_f32 v49, v70, v71
    v_lshlrev_b32 v68, 16, v48
    v_and_b32 v69, 0xffff0000, v48
    v_lshlrev_b32 v70, 16, v49
    v_and_b32 v71, 0xffff0000, v49
    v_pk_add_f32 v[68:69], v[68:69], v[100:101]
    v_pk_add_f32 v[70:71], v[70:71], v[102:103]
    v_cvt_pk_bf16_f32 v48, v68, v69
    v_cvt_pk_bf16_f32 v49, v70, v71
    v_lshlrev_b32 v68, 16, v48
    v_and_b32 v69, 0xffff0000, v48
    v_lshlrev_b32 v70, 16, v49
    v_and_b32 v71, 0xffff0000, v49
    v_pk_mul_f32 v[48:49], v[68:69], v[68:69]
    v_pk_mul_f32 v[50:51], v[70:71], v[70:71]
    v_pk_fma_f32 v[48:49], v[48:49], s[42:43], v[38:39]
    v_pk_fma_f32 v[50:51], v[50:51], s[42:43], v[38:39]
    v_pk_mul_f32 v[48:49], v[48:49], v[68:69]
    v_pk_mul_f32 v[50:51], v[50:51], v[70:71]
    v_exp_f32 v48, v48
    v_exp_f32 v49, v49
    v_exp_f32 v50, v50
    v_exp_f32 v51, v51
    v_pk_add_f32 v[48:49], v[48:49], s[44:45]
    v_pk_add_f32 v[50:51], v[50:51], s[44:45]
    v_rcp_f32 v48, v48
    v_rcp_f32 v49, v49
    v_rcp_f32 v50, v50
    v_rcp_f32 v51, v51
    v_pk_mul_f32 v[68:69], v[68:69], v[48:49]
    v_pk_mul_f32 v[70:71], v[70:71], v[50:51]
    v_cvt_pk_bf16_f32 v52, v68, v69
    v_cvt_pk_bf16_f32 v53, v70, v71
    v_xor_b32 v54, 16, v7
    ds_write_b64 v54, v[52:53] offset:0
    v_cvt_pk_bf16_f32 v40, v72, v73
    v_cvt_pk_bf16_f32 v41, v74, v75
    v_lshlrev_b32 v72, 16, v40
    v_and_b32 v73, 0xffff0000, v40
    v_lshlrev_b32 v74, 16, v41
    v_and_b32 v75, 0xffff0000, v41
    v_pk_add_f32 v[72:73], v[72:73], v[104:105]
    v_pk_add_f32 v[74:75], v[74:75], v[106:107]
    v_cvt_pk_bf16_f32 v40, v72, v73
    v_cvt_pk_bf16_f32 v41, v74, v75
    v_lshlrev_b32 v72, 16, v40
    v_and_b32 v73, 0xffff0000, v40
    v_lshlrev_b32 v74, 16, v41
    v_and_b32 v75, 0xffff0000, v41
    v_pk_mul_f32 v[40:41], v[72:73], v[72:73]
    v_pk_mul_f32 v[42:43], v[74:75], v[74:75]
    v_pk_fma_f32 v[40:41], v[40:41], s[42:43], v[38:39]
    v_pk_fma_f32 v[42:43], v[42:43], s[42:43], v[38:39]
    v_pk_mul_f32 v[40:41], v[40:41], v[72:73]
    v_pk_mul_f32 v[42:43], v[42:43], v[74:75]
    v_exp_f32 v40, v40
    v_exp_f32 v41, v41
    v_exp_f32 v42, v42
    v_exp_f32 v43, v43
    v_pk_add_f32 v[40:41], v[40:41], s[44:45]
    v_pk_add_f32 v[42:43], v[42:43], s[44:45]
    v_rcp_f32 v40, v40
    v_rcp_f32 v41, v41
    v_rcp_f32 v42, v42
    v_rcp_f32 v43, v43
    v_pk_mul_f32 v[72:73], v[72:73], v[40:41]
    v_pk_mul_f32 v[74:75], v[74:75], v[42:43]
    v_cvt_pk_bf16_f32 v44, v72, v73
    v_cvt_pk_bf16_f32 v45, v74, v75
    v_xor_b32 v46, 32, v7
    ds_write_b64 v46, v[44:45] offset:0
    v_cvt_pk_bf16_f32 v48, v76, v77
    v_cvt_pk_bf16_f32 v49, v78, v79
    v_lshlrev_b32 v76, 16, v48
    v_and_b32 v77, 0xffff0000, v48
    v_lshlrev_b32 v78, 16, v49
    v_and_b32 v79, 0xffff0000, v49
    v_pk_add_f32 v[76:77], v[76:77], v[108:109]
    v_pk_add_f32 v[78:79], v[78:79], v[110:111]
    v_cvt_pk_bf16_f32 v48, v76, v77
    v_cvt_pk_bf16_f32 v49, v78, v79
    v_lshlrev_b32 v76, 16, v48
    v_and_b32 v77, 0xffff0000, v48
    v_lshlrev_b32 v78, 16, v49
    v_and_b32 v79, 0xffff0000, v49
    v_pk_mul_f32 v[48:49], v[76:77], v[76:77]
    v_pk_mul_f32 v[50:51], v[78:79], v[78:79]
    v_pk_fma_f32 v[48:49], v[48:49], s[42:43], v[38:39]
    v_pk_fma_f32 v[50:51], v[50:51], s[42:43], v[38:39]
    v_pk_mul_f32 v[48:49], v[48:49], v[76:77]
    v_pk_mul_f32 v[50:51], v[50:51], v[78:79]
    v_exp_f32 v48, v48
    v_exp_f32 v49, v49
    v_exp_f32 v50, v50
    v_exp_f32 v51, v51
    v_pk_add_f32 v[48:49], v[48:49], s[44:45]
    v_pk_add_f32 v[50:51], v[50:51], s[44:45]
    v_rcp_f32 v48, v48
    v_rcp_f32 v49, v49
    v_rcp_f32 v50, v50
    v_rcp_f32 v51, v51
    v_pk_mul_f32 v[76:77], v[76:77], v[48:49]
    v_pk_mul_f32 v[78:79], v[78:79], v[50:51]
    v_cvt_pk_bf16_f32 v52, v76, v77
    v_cvt_pk_bf16_f32 v53, v78, v79
    v_xor_b32 v54, 48, v7
    ds_write_b64 v54, v[52:53] offset:0
    v_cvt_pk_bf16_f32 v40, v80, v81
    v_cvt_pk_bf16_f32 v41, v82, v83
    v_lshlrev_b32 v80, 16, v40
    v_and_b32 v81, 0xffff0000, v40
    v_lshlrev_b32 v82, 16, v41
    v_and_b32 v83, 0xffff0000, v41
    v_pk_add_f32 v[80:81], v[80:81], v[96:97]
    v_pk_add_f32 v[82:83], v[82:83], v[98:99]
    v_cvt_pk_bf16_f32 v40, v80, v81
    v_cvt_pk_bf16_f32 v41, v82, v83
    v_lshlrev_b32 v80, 16, v40
    v_and_b32 v81, 0xffff0000, v40
    v_lshlrev_b32 v82, 16, v41
    v_and_b32 v83, 0xffff0000, v41
    v_pk_mul_f32 v[40:41], v[80:81], v[80:81]
    v_pk_mul_f32 v[42:43], v[82:83], v[82:83]
    v_pk_fma_f32 v[40:41], v[40:41], s[42:43], v[38:39]
    v_pk_fma_f32 v[42:43], v[42:43], s[42:43], v[38:39]
    v_pk_mul_f32 v[40:41], v[40:41], v[80:81]
    v_pk_mul_f32 v[42:43], v[42:43], v[82:83]
    v_exp_f32 v40, v40
    v_exp_f32 v41, v41
    v_exp_f32 v42, v42
    v_exp_f32 v43, v43
    v_pk_add_f32 v[40:41], v[40:41], s[44:45]
    v_pk_add_f32 v[42:43], v[42:43], s[44:45]
    v_rcp_f32 v40, v40
    v_rcp_f32 v41, v41
    v_rcp_f32 v42, v42
    v_rcp_f32 v43, v43
    v_pk_mul_f32 v[80:81], v[80:81], v[40:41]
    v_pk_mul_f32 v[82:83], v[82:83], v[42:43]
    v_cvt_pk_bf16_f32 v44, v80, v81
    v_cvt_pk_bf16_f32 v45, v82, v83
    v_xor_b32 v46, 0, v7
    ds_write_b64 v46, v[44:45] offset:4096
    v_cvt_pk_bf16_f32 v48, v84, v85
    v_cvt_pk_bf16_f32 v49, v86, v87
    v_lshlrev_b32 v84, 16, v48
    v_and_b32 v85, 0xffff0000, v48
    v_lshlrev_b32 v86, 16, v49
    v_and_b32 v87, 0xffff0000, v49
    v_pk_add_f32 v[84:85], v[84:85], v[100:101]
    v_pk_add_f32 v[86:87], v[86:87], v[102:103]
    v_cvt_pk_bf16_f32 v48, v84, v85
    v_cvt_pk_bf16_f32 v49, v86, v87
    v_lshlrev_b32 v84, 16, v48
    v_and_b32 v85, 0xffff0000, v48
    v_lshlrev_b32 v86, 16, v49
    v_and_b32 v87, 0xffff0000, v49
    v_pk_mul_f32 v[48:49], v[84:85], v[84:85]
    v_pk_mul_f32 v[50:51], v[86:87], v[86:87]
    v_pk_fma_f32 v[48:49], v[48:49], s[42:43], v[38:39]
    v_pk_fma_f32 v[50:51], v[50:51], s[42:43], v[38:39]
    v_pk_mul_f32 v[48:49], v[48:49], v[84:85]
    v_pk_mul_f32 v[50:51], v[50:51], v[86:87]
    v_exp_f32 v48, v48
    v_exp_f32 v49, v49
    v_exp_f32 v50, v50
    v_exp_f32 v51, v51
    v_pk_add_f32 v[48:49], v[48:49], s[44:45]
    v_pk_add_f32 v[50:51], v[50:51], s[44:45]
    v_rcp_f32 v48, v48
    v_rcp_f32 v49, v49
    v_rcp_f32 v50, v50
    v_rcp_f32 v51, v51
    v_pk_mul_f32 v[84:85], v[84:85], v[48:49]
    v_pk_mul_f32 v[86:87], v[86:87], v[50:51]
    v_cvt_pk_bf16_f32 v52, v84, v85
    v_cvt_pk_bf16_f32 v53, v86, v87
    v_xor_b32 v54, 16, v7
    ds_write_b64 v54, v[52:53] offset:4096
    v_cvt_pk_bf16_f32 v40, v88, v89
    v_cvt_pk_bf16_f32 v41, v90, v91
    v_lshlrev_b32 v88, 16, v40
    v_and_b32 v89, 0xffff0000, v40
    v_lshlrev_b32 v90, 16, v41
    v_and_b32 v91, 0xffff0000, v41
    v_pk_add_f32 v[88:89], v[88:89], v[104:105]
    v_pk_add_f32 v[90:91], v[90:91], v[106:107]
    v_cvt_pk_bf16_f32 v40, v88, v89
    v_cvt_pk_bf16_f32 v41, v90, v91
    v_lshlrev_b32 v88, 16, v40
    v_and_b32 v89, 0xffff0000, v40
    v_lshlrev_b32 v90, 16, v41
    v_and_b32 v91, 0xffff0000, v41
    v_pk_mul_f32 v[40:41], v[88:89], v[88:89]
    v_pk_mul_f32 v[42:43], v[90:91], v[90:91]
    v_pk_fma_f32 v[40:41], v[40:41], s[42:43], v[38:39]
    v_pk_fma_f32 v[42:43], v[42:43], s[42:43], v[38:39]
    v_pk_mul_f32 v[40:41], v[40:41], v[88:89]
    v_pk_mul_f32 v[42:43], v[42:43], v[90:91]
    v_exp_f32 v40, v40
    v_exp_f32 v41, v41
    v_exp_f32 v42, v42
    v_exp_f32 v43, v43
    v_pk_add_f32 v[40:41], v[40:41], s[44:45]
    v_pk_add_f32 v[42:43], v[42:43], s[44:45]
    v_rcp_f32 v40, v40
    v_rcp_f32 v41, v41
    v_rcp_f32 v42, v42
    v_rcp_f32 v43, v43
    v_pk_mul_f32 v[88:89], v[88:89], v[40:41]
    v_pk_mul_f32 v[90:91], v[90:91], v[42:43]
    v_cvt_pk_bf16_f32 v44, v88, v89
    v_cvt_pk_bf16_f32 v45, v90, v91
    v_xor_b32 v46, 32, v7
    ds_write_b64 v46, v[44:45] offset:4096
    v_cvt_pk_bf16_f32 v48, v92, v93
    v_cvt_pk_bf16_f32 v49, v94, v95
    v_lshlrev_b32 v92, 16, v48
    v_and_b32 v93, 0xffff0000, v48
    v_lshlrev_b32 v94, 16, v49
    v_and_b32 v95, 0xffff0000, v49
    v_pk_add_f32 v[92:93], v[92:93], v[108:109]
    v_pk_add_f32 v[94:95], v[94:95], v[110:111]
    v_cvt_pk_bf16_f32 v48, v92, v93
    v_cvt_pk_bf16_f32 v49, v94, v95
    v_lshlrev_b32 v92, 16, v48
    v_and_b32 v93, 0xffff0000, v48
    v_lshlrev_b32 v94, 16, v49
    v_and_b32 v95, 0xffff0000, v49
    v_pk_mul_f32 v[48:49], v[92:93], v[92:93]
    v_pk_mul_f32 v[50:51], v[94:95], v[94:95]
    v_pk_fma_f32 v[48:49], v[48:49], s[42:43], v[38:39]
    v_pk_fma_f32 v[50:51], v[50:51], s[42:43], v[38:39]
    v_pk_mul_f32 v[48:49], v[48:49], v[92:93]
    v_pk_mul_f32 v[50:51], v[50:51], v[94:95]
    v_exp_f32 v48, v48
    v_exp_f32 v49, v49
    v_exp_f32 v50, v50
    v_exp_f32 v51, v51
    v_pk_add_f32 v[48:49], v[48:49], s[44:45]
    v_pk_add_f32 v[50:51], v[50:51], s[44:45]
    v_rcp_f32 v48, v48
    v_rcp_f32 v49, v49
    v_rcp_f32 v50, v50
    v_rcp_f32 v51, v51
    v_pk_mul_f32 v[92:93], v[92:93], v[48:49]
    v_pk_mul_f32 v[94:95], v[94:95], v[50:51]
    v_cvt_pk_bf16_f32 v52, v92, v93
    v_cvt_pk_bf16_f32 v53, v94, v95
    v_xor_b32 v54, 48, v7
    ds_write_b64 v54, v[52:53] offset:4096
    v_lshlrev_b32 v6, 4, v1
    s_and_b32 s38, s34, 1
    s_lshl_b32 s39, s38, 12
    s_add_u32 s39, s39, s37
    v_add_u32 v6, s39, v6
    v_lshrrev_b32 v8, 3, v1
    v_and_b32 v9, 7, v1
    v_xor_b32 v9, v9, v8
    v_mul_lo_u32 v8, v8, s30
    v_lshl_add_u32 v8, v9, 4, v8
    s_lshl_b32 s38, s38, 5
    s_lshl_b32 s39, s10, 7
    s_add_u32 s38, s38, s39
    s_lshl_b32 s39, s35, 6
    s_add_u32 s38, s38, s39
    s_mul_i32 s38, s38, 3584
    s_lshl_b32 s39, s11, 8
    s_add_u32 s38, s38, s39
    s_lshr_b32 s39, s34, 1
    s_lshl_b32 s39, s39, 7
    s_add_u32 s38, s38, s39
    s_waitcnt lgkmcnt(0)
    s_barrier
    ds_read_b128 v[64:67], v6 offset:0
    ds_read_b128 v[68:71], v6 offset:1024
    ds_read_b128 v[72:75], v6 offset:2048
    ds_read_b128 v[76:79], v6 offset:3072
    s_waitcnt lgkmcnt(3)
    buffer_store_dwordx4 v[64:67], v8, s[24:27], s38 offen sc1
    s_add_u32 s38, s38, 28672
    s_waitcnt lgkmcnt(2)
    buffer_store_dwordx4 v[68:71], v8, s[24:27], s38 offen sc1
    s_add_u32 s38, s38, 28672
    s_waitcnt lgkmcnt(1)
    buffer_store_dwordx4 v[72:75], v8, s[24:27], s38 offen sc1
    s_add_u32 s38, s38, 28672
    s_waitcnt lgkmcnt(0)
    buffer_store_dwordx4 v[76:79], v8, s[24:27], s38 offen sc1
    s_add_u32 s38, s38, 28672
    s_waitcnt vmcnt(0)
    s_barrier
    s_cmp_lg_u32 s3, 0
    s_cbranch_scc1 Lpub_80
    s_lshl_b32 s92, s10, 8
    s_add_u32 s92, s92, 20480
    v_mov_b32 v158, 1
    v_mov_b32 v159, 0
    s_mov_b64 exec, 1
    buffer_atomic_add v158, v159, s[96:99], s92 offen sc1
    s_mov_b64 exec, -1
Lpub_80:
Lg1skip_76:
    s_cmp_ge_u32 s3, 4
    s_cbranch_scc1 Lskip_81
    s_mov_b64 s[4:5], s[76:77]
    s_mov_b64 s[6:7], s[78:79]
    s_mov_b64 s[8:9], s[84:85]
    s_mov_b64 s[40:41], s[80:81]
    s_and_b32 s10, s2, 7
    s_lshr_b32 s11, s2, 3
    s_and_b32 s28, s11, 3
    s_lshl_b32 s10, s10, 2
    s_add_u32 s10, s10, s28
    s_lshr_b32 s11, s11, 2
    s_waitcnt lgkmcnt(0)
    s_mov_b32 s12, s4
    s_and_b32 s13, s5, 0xffff
    s_mov_b32 s14, 0x1c0000
    s_mov_b32 s15, 0x00020000
    s_mov_b32 s16, s6
    s_and_b32 s17, s7, 0xffff
    s_mov_b32 s18, 0x400
    s_mov_b32 s19, 0x00020000
    s_add_u32 s20, s8, 0x1740000
    s_addc_u32 s21, s9, 0
    s_and_b32 s21, s21, 0xffff
    s_mov_b32 s22, 0x700000
    s_mov_b32 s23, 0x00020000
    s_add_u32 s24, s8, 0x1340000
    s_addc_u32 s25, s9, 0
    s_and_b32 s25, s25, 0xffff
    s_mov_b32 s26, 0x200000
    s_mov_b32 s27, 0x00020000
    s_mov_b32 s44, s40
    s_and_b32 s45, s41, 0xffff
    s_mov_b32 s46, 0x200000
    s_mov_b32 s47, 0x00020000
    v_lshrrev_b32 v6, 3, v1
    s_movk_i32 s30, 3584
    v_mul_lo_u32 v6, v6, s30
    v_and_b32 v7, 7, v1
    v_lshrrev_b32 v8, 4, v1
    v_xor_b32 v7, v7, v8
    v_lshl_add_u32 v3, v7, 4, v6
    v_xor_b32 v7, 4, v7
    v_lshl_add_u32 v4, v7, 4, v6
    s_lshl_b32 s28, s10, 6
    s_mul_i32 s28, s28, 3584
    s_mul_i32 s29, s3, 896
    s_add_u32 s28, s28, s29
    v_lshrrev_b32 v6, 3, v1
    v_lshlrev_b32 v6, 10, v6
    v_and_b32 v7, 7, v1
    v_bfe_u32 v8, v1, 4, 1
    v_lshlrev_b32 v8, 2, v8
    v_xor_b32 v7, v7, v8
    v_lshl_add_u32 v5, v7, 4, v6
    s_mul_i32 s31, s3, 458752
    s_lshl_b32 s29, s11, 7
    s_add_u32 s31, s31, s29
    s_mul_i32 s32, s3, 40960
    s_cmp_lg_u32 s3, 0
    s_cbranch_scc1 Lpd_84
    s_lshr_b32 s92, s10, 1
    s_lshl_b32 s92, s92, 8
    s_add_u32 s92, s92, 20480
    v_mov_b32 v159, 0
    s_mov_b32 s93, 0
Lpl_85:
    v_mov_b32 v158, 0
    s_mov_b64 exec, 1
    buffer_atomic_add v158, v159, s[96:99], s92 offen sc0 sc1
    s_mov_b64 exec, -1
    s_waitcnt vmcnt(0)
    v_readfirstlane_b32 s94, v158
    s_add_u32 s93, s93, 1
    s_cmp_ge_u32 s94, 14
    s_cbranch_scc1 Lpd_84
    s_cmp_gt_u32 s93, 0x40000
    s_cbranch_scc1 Lpd_84
    s_sleep 2
    s_branch Lpl_85
Lpd_84:
    s_add_u32 m0, s32, 8192
    s_add_u32 s33, s31, 0
    buffer_load_dwordx4 v5, s[12:15], s33 offen lds
    s_add_u32 m0, s32, 9216
    s_add_u32 s33, s31, 8192
    buffer_load_dwordx4 v5, s[12:15], s33 offen lds
    s_add_u32 m0, s32, 10240
    s_add_u32 s33, s31, 16384
    buffer_load_dwordx4 v5, s[12:15], s33 offen lds
    s_add_u32 m0, s32, 11264
    s_add_u32 s33, s31, 24576
    buffer_load_dwordx4 v5, s[12:15], s33 offen lds
    s_add_u32 m0, s32, 12288
    s_add_u32 s33, s31, 32768
    buffer_load_dwordx4 v5, s[12:15], s33 offen lds
    s_add_u32 m0, s32, 13312
    s_add_u32 s33, s31, 40960
    buffer_load_dwordx4 v5, s[12:15], s33 offen lds
    s_add_u32 m0, s32, 14336
    s_add_u32 s33, s31, 49152
    buffer_load_dwordx4 v5, s[12:15], s33 offen lds
    s_add_u32 m0, s32, 15360
    s_add_u32 s33, s31, 57344
    buffer_load_dwordx4 v5, s[12:15], s33 offen lds
    s_add_u32 m0, s32, 24576
    s_add_u32 s33, s31, 65536
    buffer_load_dwordx4 v5, s[12:15], s33 offen lds
    s_add_u32 m0, s32, 25600
    s_add_u32 s33, s31, 73728
    buffer_load_dwordx4 v5, s[12:15], s33 offen lds
    s_add_u32 m0, s32, 26624
    s_add_u32 s33, s31, 81920
    buffer_load_dwordx4 v5, s[12:15], s33 offen lds
    s_add_u32 m0, s32, 27648
    s_add_u32 s33, s31, 90112
    buffer_load_dwordx4 v5, s[12:15], s33 offen lds
    s_add_u32 m0, s32, 28672
    s_add_u32 s33, s31, 98304
    buffer_load_dwordx4 v5, s[12:15], s33 offen lds
    s_add_u32 m0, s32, 29696
    s_add_u32 s33, s31, 106496
    buffer_load_dwordx4 v5, s[12:15], s33 offen lds
    s_add_u32 m0, s32, 30720
    s_add_u32 s33, s31, 114688
    buffer_load_dwordx4 v5, s[12:15], s33 offen lds
    s_add_u32 m0, s32, 31744
    s_add_u32 s33, s31, 122880
    buffer_load_dwordx4 v5, s[12:15], s33 offen lds
    v_and_b32 v6, 31, v1
    v_lshlrev_b32 v6, 7, v6
    v_add_u32 v6, s32, v6
    v_lshrrev_b32 v7, 5, v1
    v_bfe_u32 v8, v1, 1, 3
    v_xor_b32 v7, v7, v8
    v_lshl_add_u32 v6, v7, 4, v6
    v_xor_b32 v10, 0, v6
    v_xor_b32 v11, 32, v6
    v_xor_b32 v12, 64, v6
    v_xor_b32 v13, 96, v6
    v_lshrrev_b32 v6, 5, v1
    v_lshlrev_b32 v6, 3, v6
    v_bfe_u32 v7, v1, 2, 2
    v_add_u32 v6, v6, v7
    v_lshlrev_b32 v6, 7, v6
    v_bfe_u32 v8, v1, 4, 1
    v_lshlrev_b32 v8, 1, v8
    v_bfe_u32 v9, v1, 1, 1
    v_add_u32 v8, v8, v9
    v_bfe_u32 v7, v1, 3, 1
    v_lshlrev_b32 v7, 2, v7
    v_xor_b32 v8, v8, v7
    v_lshl_add_u32 v6, v8, 4, v6
    v_and_b32 v9, 1, v1
    v_lshl_add_u32 v6, v9, 3, v6
    v_add_u32 v14, s32, v6
    v_xor_b32 v15, 64, v14
    v_mov_b32 v64, 0
    v_mov_b32 v65, 0
    v_mov_b32 v66, 0
    v_mov_b32 v67, 0
    v_mov_b32 v68, 0
    v_mov_b32 v69, 0
    v_mov_b32 v70, 0
    v_mov_b32 v71, 0
    v_mov_b32 v72, 0
    v_mov_b32 v73, 0
    v_mov_b32 v74, 0
    v_mov_b32 v75, 0
    v_mov_b32 v76, 0
    v_mov_b32 v77, 0
    v_mov_b32 v78, 0
    v_mov_b32 v79, 0
    v_mov_b32 v80, 0
    v_mov_b32 v81, 0
    v_mov_b32 v82, 0
    v_mov_b32 v83, 0
    v_mov_b32 v84, 0
    v_mov_b32 v85, 0
    v_mov_b32 v86, 0
    v_mov_b32 v87, 0
    v_mov_b32 v88, 0
    v_mov_b32 v89, 0
    v_mov_b32 v90, 0
    v_mov_b32 v91, 0
    v_mov_b32 v92, 0
    v_mov_b32 v93, 0
    v_mov_b32 v94, 0
    v_mov_b32 v95, 0
    v_mov_b32 v96, 0
    v_mov_b32 v97, 0
    v_mov_b32 v98, 0
    v_mov_b32 v99, 0
    v_mov_b32 v100, 0
    v_mov_b32 v101, 0
    v_mov_b32 v102, 0
    v_mov_b32 v103, 0
    v_mov_b32 v104, 0
    v_mov_b32 v105, 0
    v_mov_b32 v106, 0
    v_mov_b32 v107, 0
    v_mov_b32 v108, 0
    v_mov_b32 v109, 0
    v_mov_b32 v110, 0
    v_mov_b32 v111, 0
    v_mov_b32 v112, 0
    v_mov_b32 v113, 0
    v_mov_b32 v114, 0
    v_mov_b32 v115, 0
    v_mov_b32 v116, 0
    v_mov_b32 v117, 0
    v_mov_b32 v118, 0
    v_mov_b32 v119, 0
    v_mov_b32 v120, 0
    v_mov_b32 v121, 0
    v_mov_b32 v122, 0
    v_mov_b32 v123, 0
    v_mov_b32 v124, 0
    v_mov_b32 v125, 0
    v_mov_b32 v126, 0
    v_mov_b32 v127, 0
    s_barrier
    s_add_u32 m0, s32, 0
    s_add_u32 s33, s28, 0
    buffer_load_dwordx4 v3, s[20:23], s33 offen lds
    s_add_u32 m0, s32, 1024
    s_add_u32 s33, s28, 28672
    buffer_load_dwordx4 v4, s[20:23], s33 offen lds
    s_add_u32 m0, s32, 2048
    s_add_u32 s33, s28, 57344
    buffer_load_dwordx4 v3, s[20:23], s33 offen lds
    s_add_u32 m0, s32, 3072
    s_add_u32 s33, s28, 86016
    buffer_load_dwordx4 v4, s[20:23], s33 offen lds
    s_add_u32 m0, s32, 4096
    s_add_u32 s33, s28, 114688
    buffer_load_dwordx4 v3, s[20:23], s33 offen lds
    s_add_u32 m0, s32, 5120
    s_add_u32 s33, s28, 143360
    buffer_load_dwordx4 v4, s[20:23], s33 offen lds
    s_add_u32 m0, s32, 6144
    s_add_u32 s33, s28, 172032
    buffer_load_dwordx4 v3, s[20:23], s33 offen lds
    s_add_u32 m0, s32, 7168
    s_add_u32 s33, s28, 200704
    buffer_load_dwordx4 v4, s[20:23], s33 offen lds
    s_add_u32 m0, s32, 16384
    s_add_u32 s33, s28, 128
    buffer_load_dwordx4 v3, s[20:23], s33 offen lds
    s_add_u32 m0, s32, 17408
    s_add_u32 s33, s28, 28800
    buffer_load_dwordx4 v4, s[20:23], s33 offen lds
    s_add_u32 m0, s32, 18432
    s_add_u32 s33, s28, 57472
    buffer_load_dwordx4 v3, s[20:23], s33 offen lds
    s_add_u32 m0, s32, 19456
    s_add_u32 s33, s28, 86144
    buffer_load_dwordx4 v4, s[20:23], s33 offen lds
    s_add_u32 m0, s32, 20480
    s_add_u32 s33, s28, 114816
    buffer_load_dwordx4 v3, s[20:23], s33 offen lds
    s_add_u32 m0, s32, 21504
    s_add_u32 s33, s28, 143488
    buffer_load_dwordx4 v4, s[20:23], s33 offen lds
    s_add_u32 m0, s32, 22528
    s_add_u32 s33, s28, 172160
    buffer_load_dwordx4 v3, s[20:23], s33 offen lds
    s_add_u32 m0, s32, 23552
    s_add_u32 s33, s28, 200832
    buffer_load_dwordx4 v4, s[20:23], s33 offen lds
    s_add_u32 m0, s32, 32768
    s_add_u32 s33, s28, 256
    buffer_load_dwordx4 v3, s[20:23], s33 offen lds
    s_add_u32 m0, s32, 33792
    s_add_u32 s33, s28, 28928
    buffer_load_dwordx4 v4, s[20:23], s33 offen lds
    s_add_u32 m0, s32, 34816
    s_add_u32 s33, s28, 57600
    buffer_load_dwordx4 v3, s[20:23], s33 offen lds
    s_add_u32 m0, s32, 35840
    s_add_u32 s33, s28, 86272
    buffer_load_dwordx4 v4, s[20:23], s33 offen lds
    s_add_u32 m0, s32, 36864
    s_add_u32 s33, s28, 114944
    buffer_load_dwordx4 v3, s[20:23], s33 offen lds
    s_add_u32 m0, s32, 37888
    s_add_u32 s33, s28, 143616
    buffer_load_dwordx4 v4, s[20:23], s33 offen lds
    s_add_u32 m0, s32, 38912
    s_add_u32 s33, s28, 172288
    buffer_load_dwordx4 v3, s[20:23], s33 offen lds
    s_add_u32 m0, s32, 39936
    s_add_u32 s33, s28, 200960
    buffer_load_dwordx4 v4, s[20:23], s33 offen lds
    v_lshrrev_b32 v28, 3, v1
    v_lshlrev_b32 v28, 10, v28
    v_and_b32 v29, 7, v1
    v_lshl_add_u32 v28, v29, 4, v28
    s_lshl_b32 s34, s10, 16
    s_lshl_b32 s35, s3, 14
    s_add_u32 s34, s34, s35
    s_lshl_b32 s35, s11, 7
    s_add_u32 s34, s34, s35
    buffer_load_dwordx4 v[16:19], v28, s[24:27], s34 offen
    s_add_u32 s36, s34, 8192
    buffer_load_dwordx4 v[20:23], v28, s[24:27], s36 offen
    v_lshlrev_b32 v30, 4, v29
    buffer_load_dwordx4 v[24:27], v30, s[16:19], s35 offen
    s_waitcnt vmcnt(19)
    ds_read_b64_tr_b16 v[128:129], v14 offset:8192
    ds_read_b64_tr_b16 v[130:131], v14 offset:8704
    ds_read_b128 v[136:139], v10 offset:0
    ds_read_b128 v[140:143], v10 offset:4096
    ds_read_b64_tr_b16 v[132:133], v15 offset:8192
    ds_read_b64_tr_b16 v[134:135], v15 offset:8704
    s_waitcnt lgkmcnt(3)
    v_mfma_f32_32x32x16_bf16 v[64:79], v[128:131], v[136:139], v[64:79]
    ds_read_b64_tr_b16 v[144:145], v14 offset:10240
    ds_read_b64_tr_b16 v[146:147], v14 offset:10752
    s_waitcnt lgkmcnt(4)
    v_mfma_f32_32x32x16_bf16 v[80:95], v[128:131], v[140:143], v[80:95]
    ds_read_b128 v[152:155], v11 offset:0
    ds_read_b128 v[156:159], v11 offset:4096
    s_waitcnt lgkmcnt(4)
    v_mfma_f32_32x32x16_bf16 v[96:111], v[132:135], v[136:139], v[96:111]
    ds_read_b64_tr_b16 v[148:149], v15 offset:10240
    ds_read_b64_tr_b16 v[150:151], v15 offset:10752
    v_mfma_f32_32x32x16_bf16 v[112:127], v[132:135], v[140:143], v[112:127]
    s_waitcnt lgkmcnt(3)
    v_mfma_f32_32x32x16_bf16 v[64:79], v[144:147], v[152:155], v[64:79]
    ds_read_b64_tr_b16 v[128:129], v14 offset:12288
    ds_read_b64_tr_b16 v[130:131], v14 offset:12800
    s_waitcnt lgkmcnt(4)
    v_mfma_f32_32x32x16_bf16 v[80:95], v[144:147], v[156:159], v[80:95]
    ds_read_b128 v[136:139], v12 offset:0
    ds_read_b128 v[140:143], v12 offset:4096
    s_waitcnt lgkmcnt(4)
    v_mfma_f32_32x32x16_bf16 v[96:111], v[148:151], v[152:155], v[96:111]
    ds_read_b64_tr_b16 v[132:133], v15 offset:12288
    ds_read_b64_tr_b16 v[134:135], v15 offset:12800
    v_mfma_f32_32x32x16_bf16 v[112:127], v[148:151], v[156:159], v[112:127]
    s_waitcnt lgkmcnt(3)
    v_mfma_f32_32x32x16_bf16 v[64:79], v[128:131], v[136:139], v[64:79]
    ds_read_b64_tr_b16 v[144:145], v14 offset:14336
    ds_read_b64_tr_b16 v[146:147], v14 offset:14848
    s_waitcnt lgkmcnt(4)
    v_mfma_f32_32x32x16_bf16 v[80:95], v[128:131], v[140:143], v[80:95]
    ds_read_b128 v[152:155], v13 offset:0
    ds_read_b128 v[156:159], v13 offset:4096
    s_waitcnt lgkmcnt(4)
    v_mfma_f32_32x32x16_bf16 v[96:111], v[132:135], v[136:139], v[96:111]
    ds_read_b64_tr_b16 v[148:149], v15 offset:14336
    ds_read_b64_tr_b16 v[150:151], v15 offset:14848
    v_mfma_f32_32x32x16_bf16 v[112:127], v[132:135], v[140:143], v[112:127]
    s_waitcnt lgkmcnt(3)
    v_mfma_f32_32x32x16_bf16 v[64:79], v[144:147], v[152:155], v[64:79]
    s_waitcnt lgkmcnt(2)
    v_mfma_f32_32x32x16_bf16 v[80:95], v[144:147], v[156:159], v[80:95]
    s_waitcnt vmcnt(11) lgkmcnt(0)
    ds_read_b64_tr_b16 v[128:129], v14 offset:24576
    ds_read_b64_tr_b16 v[130:131], v14 offset:25088
    ds_read_b128 v[136:139], v10 offset:16384
    ds_read_b128 v[140:143], v10 offset:20480
    v_mfma_f32_32x32x16_bf16 v[96:111], v[148:151], v[152:155], v[96:111]
    ds_read_b64_tr_b16 v[132:133], v15 offset:24576
    ds_read_b64_tr_b16 v[134:135], v15 offset:25088
    v_mfma_f32_32x32x16_bf16 v[112:127], v[148:151], v[156:159], v[112:127]
    s_add_u32 m0, s32, 0
    s_add_u32 s33, s31, 131072
    buffer_load_dwordx4 v5, s[12:15], s33 offen lds
    s_add_u32 m0, s32, 1024
    s_add_u32 s33, s31, 139264
    buffer_load_dwordx4 v5, s[12:15], s33 offen lds
    s_add_u32 m0, s32, 2048
    s_add_u32 s33, s31, 147456
    buffer_load_dwordx4 v5, s[12:15], s33 offen lds
    s_add_u32 m0, s32, 3072
    s_add_u32 s33, s31, 155648
    buffer_load_dwordx4 v5, s[12:15], s33 offen lds
    s_add_u32 m0, s32, 4096
    s_add_u32 s33, s31, 163840
    buffer_load_dwordx4 v5, s[12:15], s33 offen lds
    s_add_u32 m0, s32, 5120
    s_add_u32 s33, s31, 172032
    buffer_load_dwordx4 v5, s[12:15], s33 offen lds
    s_add_u32 m0, s32, 6144
    s_add_u32 s33, s31, 180224
    buffer_load_dwordx4 v5, s[12:15], s33 offen lds
    s_add_u32 m0, s32, 7168
    s_add_u32 s33, s31, 188416
    buffer_load_dwordx4 v5, s[12:15], s33 offen lds
    s_add_u32 m0, s32, 8192
    s_add_u32 s33, s28, 384
    buffer_load_dwordx4 v3, s[20:23], s33 offen lds
    s_add_u32 m0, s32, 9216
    s_add_u32 s33, s28, 29056
    buffer_load_dwordx4 v4, s[20:23], s33 offen lds
    s_add_u32 m0, s32, 10240
    s_add_u32 s33, s28, 57728
    buffer_load_dwordx4 v3, s[20:23], s33 offen lds
    s_add_u32 m0, s32, 11264
    s_add_u32 s33, s28, 86400
    buffer_load_dwordx4 v4, s[20:23], s33 offen lds
    s_add_u32 m0, s32, 12288
    s_add_u32 s33, s28, 115072
    buffer_load_dwordx4 v3, s[20:23], s33 offen lds
    s_add_u32 m0, s32, 13312
    s_add_u32 s33, s28, 143744
    buffer_load_dwordx4 v4, s[20:23], s33 offen lds
    s_add_u32 m0, s32, 14336
    s_add_u32 s33, s28, 172416
    buffer_load_dwordx4 v3, s[20:23], s33 offen lds
    s_add_u32 m0, s32, 15360
    s_add_u32 s33, s28, 201088
    buffer_load_dwordx4 v4, s[20:23], s33 offen lds
    s_waitcnt lgkmcnt(3)
    v_mfma_f32_32x32x16_bf16 v[64:79], v[128:131], v[136:139], v[64:79]
    ds_read_b64_tr_b16 v[144:145], v14 offset:26624
    ds_read_b64_tr_b16 v[146:147], v14 offset:27136
    s_waitcnt lgkmcnt(4)
    v_mfma_f32_32x32x16_bf16 v[80:95], v[128:131], v[140:143], v[80:95]
    ds_read_b128 v[152:155], v11 offset:16384
    ds_read_b128 v[156:159], v11 offset:20480
    s_waitcnt lgkmcnt(4)
    v_mfma_f32_32x32x16_bf16 v[96:111], v[132:135], v[136:139], v[96:111]
    ds_read_b64_tr_b16 v[148:149], v15 offset:26624
    ds_read_b64_tr_b16 v[150:151], v15 offset:27136
    v_mfma_f32_32x32x16_bf16 v[112:127], v[132:135], v[140:143], v[112:127]
    s_waitcnt lgkmcnt(3)
    v_mfma_f32_32x32x16_bf16 v[64:79], v[144:147], v[152:155], v[64:79]
    ds_read_b64_tr_b16 v[128:129], v14 offset:28672
    ds_read_b64_tr_b16 v[130:131], v14 offset:29184
    s_waitcnt lgkmcnt(4)
    v_mfma_f32_32x32x16_bf16 v[80:95], v[144:147], v[156:159], v[80:95]
    ds_read_b128 v[136:139], v12 offset:16384
    ds_read_b128 v[140:143], v12 offset:20480
    s_waitcnt lgkmcnt(4)
    v_mfma_f32_32x32x16_bf16 v[96:111], v[148:151], v[152:155], v[96:111]
    ds_read_b64_tr_b16 v[132:133], v15 offset:28672
    ds_read_b64_tr_b16 v[134:135], v15 offset:29184
    v_mfma_f32_32x32x16_bf16 v[112:127], v[148:151], v[156:159], v[112:127]
    s_waitcnt lgkmcnt(3)
    v_mfma_f32_32x32x16_bf16 v[64:79], v[128:131], v[136:139], v[64:79]
    ds_read_b64_tr_b16 v[144:145], v14 offset:30720
    ds_read_b64_tr_b16 v[146:147], v14 offset:31232
    s_waitcnt lgkmcnt(4)
    v_mfma_f32_32x32x16_bf16 v[80:95], v[128:131], v[140:143], v[80:95]
    ds_read_b128 v[152:155], v13 offset:16384
    ds_read_b128 v[156:159], v13 offset:20480
    s_waitcnt lgkmcnt(4)
    v_mfma_f32_32x32x16_bf16 v[96:111], v[132:135], v[136:139], v[96:111]
    ds_read_b64_tr_b16 v[148:149], v15 offset:30720
    ds_read_b64_tr_b16 v[150:151], v15 offset:31232
    v_mfma_f32_32x32x16_bf16 v[112:127], v[132:135], v[140:143], v[112:127]
    s_waitcnt lgkmcnt(3)
    v_mfma_f32_32x32x16_bf16 v[64:79], v[144:147], v[152:155], v[64:79]
    s_waitcnt lgkmcnt(2)
    v_mfma_f32_32x32x16_bf16 v[80:95], v[144:147], v[156:159], v[80:95]
    s_waitcnt vmcnt(8) lgkmcnt(0)
    ds_read_b64_tr_b16 v[128:129], v14 offset:0
    ds_read_b64_tr_b16 v[130:131], v14 offset:512
    ds_read_b128 v[136:139], v10 offset:32768
    ds_read_b128 v[140:143], v10 offset:36864
    v_mfma_f32_32x32x16_bf16 v[96:111], v[148:151], v[152:155], v[96:111]
    ds_read_b64_tr_b16 v[132:133], v15 offset:0
    ds_read_b64_tr_b16 v[134:135], v15 offset:512
    v_mfma_f32_32x32x16_bf16 v[112:127], v[148:151], v[156:159], v[112:127]
    s_add_u32 m0, s32, 16384
    s_add_u32 s33, s31, 196608
    buffer_load_dwordx4 v5, s[12:15], s33 offen lds
    s_add_u32 m0, s32, 17408
    s_add_u32 s33, s31, 204800
    buffer_load_dwordx4 v5, s[12:15], s33 offen lds
    s_add_u32 m0, s32, 18432
    s_add_u32 s33, s31, 212992
    buffer_load_dwordx4 v5, s[12:15], s33 offen lds
    s_add_u32 m0, s32, 19456
    s_add_u32 s33, s31, 221184
    buffer_load_dwordx4 v5, s[12:15], s33 offen lds
    s_add_u32 m0, s32, 20480
    s_add_u32 s33, s31, 229376
    buffer_load_dwordx4 v5, s[12:15], s33 offen lds
    s_add_u32 m0, s32, 21504
    s_add_u32 s33, s31, 237568
    buffer_load_dwordx4 v5, s[12:15], s33 offen lds
    s_add_u32 m0, s32, 22528
    s_add_u32 s33, s31, 245760
    buffer_load_dwordx4 v5, s[12:15], s33 offen lds
    s_add_u32 m0, s32, 23552
    s_add_u32 s33, s31, 253952
    buffer_load_dwordx4 v5, s[12:15], s33 offen lds
    s_add_u32 m0, s32, 24576
    s_add_u32 s33, s28, 512
    buffer_load_dwordx4 v3, s[20:23], s33 offen lds
    s_add_u32 m0, s32, 25600
    s_add_u32 s33, s28, 29184
    buffer_load_dwordx4 v4, s[20:23], s33 offen lds
    s_add_u32 m0, s32, 26624
    s_add_u32 s33, s28, 57856
    buffer_load_dwordx4 v3, s[20:23], s33 offen lds
    s_add_u32 m0, s32, 27648
    s_add_u32 s33, s28, 86528
    buffer_load_dwordx4 v4, s[20:23], s33 offen lds
    s_add_u32 m0, s32, 28672
    s_add_u32 s33, s28, 115200
    buffer_load_dwordx4 v3, s[20:23], s33 offen lds
    s_add_u32 m0, s32, 29696
    s_add_u32 s33, s28, 143872
    buffer_load_dwordx4 v4, s[20:23], s33 offen lds
    s_add_u32 m0, s32, 30720
    s_add_u32 s33, s28, 172544
    buffer_load_dwordx4 v3, s[20:23], s33 offen lds
    s_add_u32 m0, s32, 31744
    s_add_u32 s33, s28, 201216
    buffer_load_dwordx4 v4, s[20:23], s33 offen lds
    s_waitcnt lgkmcnt(3)
    v_mfma_f32_32x32x16_bf16 v[64:79], v[128:131], v[136:139], v[64:79]
    ds_read_b64_tr_b16 v[144:145], v14 offset:2048
    ds_read_b64_tr_b16 v[146:147], v14 offset:2560
    s_waitcnt lgkmcnt(4)
    v_mfma_f32_32x32x16_bf16 v[80:95], v[128:131], v[140:143], v[80:95]
    ds_read_b128 v[152:155], v11 offset:32768
    ds_read_b128 v[156:159], v11 offset:36864
    s_waitcnt lgkmcnt(4)
    v_mfma_f32_32x32x16_bf16 v[96:111], v[132:135], v[136:139], v[96:111]
    ds_read_b64_tr_b16 v[148:149], v15 offset:2048
    ds_read_b64_tr_b16 v[150:151], v15 offset:2560
    v_mfma_f32_32x32x16_bf16 v[112:127], v[132:135], v[140:143], v[112:127]
    s_waitcnt lgkmcnt(3)
    v_mfma_f32_32x32x16_bf16 v[64:79], v[144:147], v[152:155], v[64:79]
    ds_read_b64_tr_b16 v[128:129], v14 offset:4096
    ds_read_b64_tr_b16 v[130:131], v14 offset:4608
    s_waitcnt lgkmcnt(4)
    v_mfma_f32_32x32x16_bf16 v[80:95], v[144:147], v[156:159], v[80:95]
    ds_read_b128 v[136:139], v12 offset:32768
    ds_read_b128 v[140:143], v12 offset:36864
    s_waitcnt lgkmcnt(4)
    v_mfma_f32_32x32x16_bf16 v[96:111], v[148:151], v[152:155], v[96:111]
    ds_read_b64_tr_b16 v[132:133], v15 offset:4096
    ds_read_b64_tr_b16 v[134:135], v15 offset:4608
    v_mfma_f32_32x32x16_bf16 v[112:127], v[148:151], v[156:159], v[112:127]
    s_waitcnt lgkmcnt(3)
    v_mfma_f32_32x32x16_bf16 v[64:79], v[128:131], v[136:139], v[64:79]
    ds_read_b64_tr_b16 v[144:145], v14 offset:6144
    ds_read_b64_tr_b16 v[146:147], v14 offset:6656
    s_waitcnt lgkmcnt(4)
    v_mfma_f32_32x32x16_bf16 v[80:95], v[128:131], v[140:143], v[80:95]
    ds_read_b128 v[152:155], v13 offset:32768
    ds_read_b128 v[156:159], v13 offset:36864
    s_waitcnt lgkmcnt(4)
    v_mfma_f32_32x32x16_bf16 v[96:111], v[132:135], v[136:139], v[96:111]
    ds_read_b64_tr_b16 v[148:149], v15 offset:6144
    ds_read_b64_tr_b16 v[150:151], v15 offset:6656
    v_mfma_f32_32x32x16_bf16 v[112:127], v[132:135], v[140:143], v[112:127]
    s_waitcnt lgkmcnt(3)
    v_mfma_f32_32x32x16_bf16 v[64:79], v[144:147], v[152:155], v[64:79]
    s_waitcnt lgkmcnt(2)
    v_mfma_f32_32x32x16_bf16 v[80:95], v[144:147], v[156:159], v[80:95]
    s_waitcnt vmcnt(8) lgkmcnt(0)
    ds_read_b64_tr_b16 v[128:129], v14 offset:16384
    ds_read_b64_tr_b16 v[130:131], v14 offset:16896
    ds_read_b128 v[136:139], v10 offset:8192
    ds_read_b128 v[140:143], v10 offset:12288
    v_mfma_f32_32x32x16_bf16 v[96:111], v[148:151], v[152:155], v[96:111]
    ds_read_b64_tr_b16 v[132:133], v15 offset:16384
    ds_read_b64_tr_b16 v[134:135], v15 offset:16896
    v_mfma_f32_32x32x16_bf16 v[112:127], v[148:151], v[156:159], v[112:127]
    s_add_u32 m0, s32, 32768
    s_add_u32 s33, s31, 262144
    buffer_load_dwordx4 v5, s[12:15], s33 offen lds
    s_add_u32 m0, s32, 33792
    s_add_u32 s33, s31, 270336
    buffer_load_dwordx4 v5, s[12:15], s33 offen lds
    s_add_u32 m0, s32, 34816
    s_add_u32 s33, s31, 278528
    buffer_load_dwordx4 v5, s[12:15], s33 offen lds
    s_add_u32 m0, s32, 35840
    s_add_u32 s33, s31, 286720
    buffer_load_dwordx4 v5, s[12:15], s33 offen lds
    s_add_u32 m0, s32, 36864
    s_add_u32 s33, s31, 294912
    buffer_load_dwordx4 v5, s[12:15], s33 offen lds
    s_add_u32 m0, s32, 37888
    s_add_u32 s33, s31, 303104
    buffer_load_dwordx4 v5, s[12:15], s33 offen lds
    s_add_u32 m0, s32, 38912
    s_add_u32 s33, s31, 311296
    buffer_load_dwordx4 v5, s[12:15], s33 offen lds
    s_add_u32 m0, s32, 39936
    s_add_u32 s33, s31, 319488
    buffer_load_dwordx4 v5, s[12:15], s33 offen lds
    s_add_u32 m0, s32, 0
    s_add_u32 s33, s28, 640
    buffer_load_dwordx4 v3, s[20:23], s33 offen lds
    s_add_u32 m0, s32, 1024
    s_add_u32 s33, s28, 29312
    buffer_load_dwordx4 v4, s[20:23], s33 offen lds
    s_add_u32 m0, s32, 2048
    s_add_u32 s33, s28, 57984
    buffer_load_dwordx4 v3, s[20:23], s33 offen lds
    s_add_u32 m0, s32, 3072
    s_add_u32 s33, s28, 86656
    buffer_load_dwordx4 v4, s[20:23], s33 offen lds
    s_add_u32 m0, s32, 4096
    s_add_u32 s33, s28, 115328
    buffer_load_dwordx4 v3, s[20:23], s33 offen lds
    s_add_u32 m0, s32, 5120
    s_add_u32 s33, s28, 144000
    buffer_load_dwordx4 v4, s[20:23], s33 offen lds
    s_add_u32 m0, s32, 6144
    s_add_u32 s33, s28, 172672
    buffer_load_dwordx4 v3, s[20:23], s33 offen lds
    s_add_u32 m0, s32, 7168
    s_add_u32 s33, s28, 201344
    buffer_load_dwordx4 v4, s[20:23], s33 offen lds
    s_waitcnt lgkmcnt(3)
    v_mfma_f32_32x32x16_bf16 v[64:79], v[128:131], v[136:139], v[64:79]
    ds_read_b64_tr_b16 v[144:145], v14 offset:18432
    ds_read_b64_tr_b16 v[146:147], v14 offset:18944
    s_waitcnt lgkmcnt(4)
    v_mfma_f32_32x32x16_bf16 v[80:95], v[128:131], v[140:143], v[80:95]
    ds_read_b128 v[152:155], v11 offset:8192
    ds_read_b128 v[156:159], v11 offset:12288
    s_waitcnt lgkmcnt(4)
    v_mfma_f32_32x32x16_bf16 v[96:111], v[132:135], v[136:139], v[96:111]
    ds_read_b64_tr_b16 v[148:149], v15 offset:18432
    ds_read_b64_tr_b16 v[150:151], v15 offset:18944
    v_mfma_f32_32x32x16_bf16 v[112:127], v[132:135], v[140:143], v[112:127]
    s_waitcnt lgkmcnt(3)
    v_mfma_f32_32x32x16_bf16 v[64:79], v[144:147], v[152:155], v[64:79]
    ds_read_b64_tr_b16 v[128:129], v14 offset:20480
    ds_read_b64_tr_b16 v[130:131], v14 offset:20992
    s_waitcnt lgkmcnt(4)
    v_mfma_f32_32x32x16_bf16 v[80:95], v[144:147], v[156:159], v[80:95]
    ds_read_b128 v[136:139], v12 offset:8192
    ds_read_b128 v[140:143], v12 offset:12288
    s_waitcnt lgkmcnt(4)
    v_mfma_f32_32x32x16_bf16 v[96:111], v[148:151], v[152:155], v[96:111]
    ds_read_b64_tr_b16 v[132:133], v15 offset:20480
    ds_read_b64_tr_b16 v[134:135], v15 offset:20992
    v_mfma_f32_32x32x16_bf16 v[112:127], v[148:151], v[156:159], v[112:127]
    s_waitcnt lgkmcnt(3)
    v_mfma_f32_32x32x16_bf16 v[64:79], v[128:131], v[136:139], v[64:79]
    ds_read_b64_tr_b16 v[144:145], v14 offset:22528
    ds_read_b64_tr_b16 v[146:147], v14 offset:23040
    s_waitcnt lgkmcnt(4)
    v_mfma_f32_32x32x16_bf16 v[80:95], v[128:131], v[140:143], v[80:95]
    ds_read_b128 v[152:155], v13 offset:8192
    ds_read_b128 v[156:159], v13 offset:12288
    s_waitcnt lgkmcnt(4)
    v_mfma_f32_32x32x16_bf16 v[96:111], v[132:135], v[136:139], v[96:111]
    ds_read_b64_tr_b16 v[148:149], v15 offset:22528
    ds_read_b64_tr_b16 v[150:151], v15 offset:23040
    v_mfma_f32_32x32x16_bf16 v[112:127], v[132:135], v[140:143], v[112:127]
    s_waitcnt lgkmcnt(3)
    v_mfma_f32_32x32x16_bf16 v[64:79], v[144:147], v[152:155], v[64:79]
    s_waitcnt lgkmcnt(2)
    v_mfma_f32_32x32x16_bf16 v[80:95], v[144:147], v[156:159], v[80:95]
    s_waitcnt vmcnt(8) lgkmcnt(0)
    ds_read_b64_tr_b16 v[128:129], v14 offset:32768
    ds_read_b64_tr_b16 v[130:131], v14 offset:33280
    ds_read_b128 v[136:139], v10 offset:24576
    ds_read_b128 v[140:143], v10 offset:28672
    v_mfma_f32_32x32x16_bf16 v[96:111], v[148:151], v[152:155], v[96:111]
    ds_read_b64_tr_b16 v[132:133], v15 offset:32768
    ds_read_b64_tr_b16 v[134:135], v15 offset:33280
    v_mfma_f32_32x32x16_bf16 v[112:127], v[148:151], v[156:159], v[112:127]
    s_add_u32 m0, s32, 8192
    s_add_u32 s33, s31, 327680
    buffer_load_dwordx4 v5, s[12:15], s33 offen lds
    s_add_u32 m0, s32, 9216
    s_add_u32 s33, s31, 335872
    buffer_load_dwordx4 v5, s[12:15], s33 offen lds
    s_add_u32 m0, s32, 10240
    s_add_u32 s33, s31, 344064
    buffer_load_dwordx4 v5, s[12:15], s33 offen lds
    s_add_u32 m0, s32, 11264
    s_add_u32 s33, s31, 352256
    buffer_load_dwordx4 v5, s[12:15], s33 offen lds
    s_add_u32 m0, s32, 12288
    s_add_u32 s33, s31, 360448
    buffer_load_dwordx4 v5, s[12:15], s33 offen lds
    s_add_u32 m0, s32, 13312
    s_add_u32 s33, s31, 368640
    buffer_load_dwordx4 v5, s[12:15], s33 offen lds
    s_add_u32 m0, s32, 14336
    s_add_u32 s33, s31, 376832
    buffer_load_dwordx4 v5, s[12:15], s33 offen lds
    s_add_u32 m0, s32, 15360
    s_add_u32 s33, s31, 385024
    buffer_load_dwordx4 v5, s[12:15], s33 offen lds
    s_add_u32 m0, s32, 16384
    s_add_u32 s33, s28, 768
    buffer_load_dwordx4 v3, s[20:23], s33 offen lds
    s_add_u32 m0, s32, 17408
    s_add_u32 s33, s28, 29440
    buffer_load_dwordx4 v4, s[20:23], s33 offen lds
    s_add_u32 m0, s32, 18432
    s_add_u32 s33, s28, 58112
    buffer_load_dwordx4 v3, s[20:23], s33 offen lds
    s_add_u32 m0, s32, 19456
    s_add_u32 s33, s28, 86784
    buffer_load_dwordx4 v4, s[20:23], s33 offen lds
    s_add_u32 m0, s32, 20480
    s_add_u32 s33, s28, 115456
    buffer_load_dwordx4 v3, s[20:23], s33 offen lds
    s_add_u32 m0, s32, 21504
    s_add_u32 s33, s28, 144128
    buffer_load_dwordx4 v4, s[20:23], s33 offen lds
    s_add_u32 m0, s32, 22528
    s_add_u32 s33, s28, 172800
    buffer_load_dwordx4 v3, s[20:23], s33 offen lds
    s_add_u32 m0, s32, 23552
    s_add_u32 s33, s28, 201472
    buffer_load_dwordx4 v4, s[20:23], s33 offen lds
    s_waitcnt lgkmcnt(3)
    v_mfma_f32_32x32x16_bf16 v[64:79], v[128:131], v[136:139], v[64:79]
    ds_read_b64_tr_b16 v[144:145], v14 offset:34816
    ds_read_b64_tr_b16 v[146:147], v14 offset:35328
    s_waitcnt lgkmcnt(4)
    v_mfma_f32_32x32x16_bf16 v[80:95], v[128:131], v[140:143], v[80:95]
    ds_read_b128 v[152:155], v11 offset:24576
    ds_read_b128 v[156:159], v11 offset:28672
    s_waitcnt lgkmcnt(4)
    v_mfma_f32_32x32x16_bf16 v[96:111], v[132:135], v[136:139], v[96:111]
    ds_read_b64_tr_b16 v[148:149], v15 offset:34816
    ds_read_b64_tr_b16 v[150:151], v15 offset:35328
    v_mfma_f32_32x32x16_bf16 v[112:127], v[132:135], v[140:143], v[112:127]
    s_waitcnt lgkmcnt(3)
    v_mfma_f32_32x32x16_bf16 v[64:79], v[144:147], v[152:155], v[64:79]
    ds_read_b64_tr_b16 v[128:129], v14 offset:36864
    ds_read_b64_tr_b16 v[130:131], v14 offset:37376
    s_waitcnt lgkmcnt(4)
    v_mfma_f32_32x32x16_bf16 v[80:95], v[144:147], v[156:159], v[80:95]
    ds_read_b128 v[136:139], v12 offset:24576
    ds_read_b128 v[140:143], v12 offset:28672
    s_waitcnt lgkmcnt(4)
    v_mfma_f32_32x32x16_bf16 v[96:111], v[148:151], v[152:155], v[96:111]
    ds_read_b64_tr_b16 v[132:133], v15 offset:36864
    ds_read_b64_tr_b16 v[134:135], v15 offset:37376
    v_mfma_f32_32x32x16_bf16 v[112:127], v[148:151], v[156:159], v[112:127]
    s_waitcnt lgkmcnt(3)
    v_mfma_f32_32x32x16_bf16 v[64:79], v[128:131], v[136:139], v[64:79]
    ds_read_b64_tr_b16 v[144:145], v14 offset:38912
    ds_read_b64_tr_b16 v[146:147], v14 offset:39424
    s_waitcnt lgkmcnt(4)
    v_mfma_f32_32x32x16_bf16 v[80:95], v[128:131], v[140:143], v[80:95]
    ds_read_b128 v[152:155], v13 offset:24576
    ds_read_b128 v[156:159], v13 offset:28672
    s_waitcnt lgkmcnt(4)
    v_mfma_f32_32x32x16_bf16 v[96:111], v[132:135], v[136:139], v[96:111]
    ds_read_b64_tr_b16 v[148:149], v15 offset:38912
    ds_read_b64_tr_b16 v[150:151], v15 offset:39424
    v_mfma_f32_32x32x16_bf16 v[112:127], v[132:135], v[140:143], v[112:127]
    s_waitcnt lgkmcnt(3)
    v_mfma_f32_32x32x16_bf16 v[64:79], v[144:147], v[152:155], v[64:79]
    s_waitcnt lgkmcnt(2)
    v_mfma_f32_32x32x16_bf16 v[80:95], v[144:147], v[156:159], v[80:95]
    s_waitcnt vmcnt(8) lgkmcnt(0)
    ds_read_b64_tr_b16 v[128:129], v14 offset:8192
    ds_read_b64_tr_b16 v[130:131], v14 offset:8704
    ds_read_b128 v[136:139], v10 offset:0
    ds_read_b128 v[140:143], v10 offset:4096
    v_mfma_f32_32x32x16_bf16 v[96:111], v[148:151], v[152:155], v[96:111]
    ds_read_b64_tr_b16 v[132:133], v15 offset:8192
    ds_read_b64_tr_b16 v[134:135], v15 offset:8704
    v_mfma_f32_32x32x16_bf16 v[112:127], v[148:151], v[156:159], v[112:127]
    s_add_u32 m0, s32, 24576
    s_add_u32 s33, s31, 393216
    buffer_load_dwordx4 v5, s[12:15], s33 offen lds
    s_add_u32 m0, s32, 25600
    s_add_u32 s33, s31, 401408
    buffer_load_dwordx4 v5, s[12:15], s33 offen lds
    s_add_u32 m0, s32, 26624
    s_add_u32 s33, s31, 409600
    buffer_load_dwordx4 v5, s[12:15], s33 offen lds
    s_add_u32 m0, s32, 27648
    s_add_u32 s33, s31, 417792
    buffer_load_dwordx4 v5, s[12:15], s33 offen lds
    s_add_u32 m0, s32, 28672
    s_add_u32 s33, s31, 425984
    buffer_load_dwordx4 v5, s[12:15], s33 offen lds
    s_add_u32 m0, s32, 29696
    s_add_u32 s33, s31, 434176
    buffer_load_dwordx4 v5, s[12:15], s33 offen lds
    s_add_u32 m0, s32, 30720
    s_add_u32 s33, s31, 442368
    buffer_load_dwordx4 v5, s[12:15], s33 offen lds
    s_add_u32 m0, s32, 31744
    s_add_u32 s33, s31, 450560
    buffer_load_dwordx4 v5, s[12:15], s33 offen lds
    s_waitcnt lgkmcnt(3)
    v_mfma_f32_32x32x16_bf16 v[64:79], v[128:131], v[136:139], v[64:79]
    ds_read_b64_tr_b16 v[144:145], v14 offset:10240
    ds_read_b64_tr_b16 v[146:147], v14 offset:10752
    s_waitcnt lgkmcnt(4)
    v_mfma_f32_32x32x16_bf16 v[80:95], v[128:131], v[140:143], v[80:95]
    ds_read_b128 v[152:155], v11 offset:0
    ds_read_b128 v[156:159], v11 offset:4096
    s_waitcnt lgkmcnt(4)
    v_mfma_f32_32x32x16_bf16 v[96:111], v[132:135], v[136:139], v[96:111]
    ds_read_b64_tr_b16 v[148:149], v15 offset:10240
    ds_read_b64_tr_b16 v[150:151], v15 offset:10752
    v_mfma_f32_32x32x16_bf16 v[112:127], v[132:135], v[140:143], v[112:127]
    s_waitcnt lgkmcnt(3)
    v_mfma_f32_32x32x16_bf16 v[64:79], v[144:147], v[152:155], v[64:79]
    ds_read_b64_tr_b16 v[128:129], v14 offset:12288
    ds_read_b64_tr_b16 v[130:131], v14 offset:12800
    s_waitcnt lgkmcnt(4)
    v_mfma_f32_32x32x16_bf16 v[80:95], v[144:147], v[156:159], v[80:95]
    ds_read_b128 v[136:139], v12 offset:0
    ds_read_b128 v[140:143], v12 offset:4096
    s_waitcnt lgkmcnt(4)
    v_mfma_f32_32x32x16_bf16 v[96:111], v[148:151], v[152:155], v[96:111]
    ds_read_b64_tr_b16 v[132:133], v15 offset:12288
    ds_read_b64_tr_b16 v[134:135], v15 offset:12800
    v_mfma_f32_32x32x16_bf16 v[112:127], v[148:151], v[156:159], v[112:127]
    s_waitcnt lgkmcnt(3)
    v_mfma_f32_32x32x16_bf16 v[64:79], v[128:131], v[136:139], v[64:79]
    ds_read_b64_tr_b16 v[144:145], v14 offset:14336
    ds_read_b64_tr_b16 v[146:147], v14 offset:14848
    s_waitcnt lgkmcnt(4)
    v_mfma_f32_32x32x16_bf16 v[80:95], v[128:131], v[140:143], v[80:95]
    ds_read_b128 v[152:155], v13 offset:0
    ds_read_b128 v[156:159], v13 offset:4096
    s_waitcnt lgkmcnt(4)
    v_mfma_f32_32x32x16_bf16 v[96:111], v[132:135], v[136:139], v[96:111]
    ds_read_b64_tr_b16 v[148:149], v15 offset:14336
    ds_read_b64_tr_b16 v[150:151], v15 offset:14848
    v_mfma_f32_32x32x16_bf16 v[112:127], v[132:135], v[140:143], v[112:127]
    s_waitcnt lgkmcnt(3)
    v_mfma_f32_32x32x16_bf16 v[64:79], v[144:147], v[152:155], v[64:79]
    s_waitcnt lgkmcnt(2)
    v_mfma_f32_32x32x16_bf16 v[80:95], v[144:147], v[156:159], v[80:95]
    s_waitcnt vmcnt(0) lgkmcnt(0)
    ds_read_b64_tr_b16 v[128:129], v14 offset:24576
    ds_read_b64_tr_b16 v[130:131], v14 offset:25088
    ds_read_b128 v[136:139], v10 offset:16384
    ds_read_b128 v[140:143], v10 offset:20480
    v_mfma_f32_32x32x16_bf16 v[96:111], v[148:151], v[152:155], v[96:111]
    ds_read_b64_tr_b16 v[132:133], v15 offset:24576
    ds_read_b64_tr_b16 v[134:135], v15 offset:25088
    v_mfma_f32_32x32x16_bf16 v[112:127], v[148:151], v[156:159], v[112:127]
    s_waitcnt lgkmcnt(3)
    v_mfma_f32_32x32x16_bf16 v[64:79], v[128:131], v[136:139], v[64:79]
    ds_read_b64_tr_b16 v[144:145], v14 offset:26624
    ds_read_b64_tr_b16 v[146:147], v14 offset:27136
    s_waitcnt lgkmcnt(4)
    v_mfma_f32_32x32x16_bf16 v[80:95], v[128:131], v[140:143], v[80:95]
    ds_read_b128 v[152:155], v11 offset:16384
    ds_read_b128 v[156:159], v11 offset:20480
    s_waitcnt lgkmcnt(4)
    v_mfma_f32_32x32x16_bf16 v[96:111], v[132:135], v[136:139], v[96:111]
    ds_read_b64_tr_b16 v[148:149], v15 offset:26624
    ds_read_b64_tr_b16 v[150:151], v15 offset:27136
    v_mfma_f32_32x32x16_bf16 v[112:127], v[132:135], v[140:143], v[112:127]
    s_waitcnt lgkmcnt(3)
    v_mfma_f32_32x32x16_bf16 v[64:79], v[144:147], v[152:155], v[64:79]
    ds_read_b64_tr_b16 v[128:129], v14 offset:28672
    ds_read_b64_tr_b16 v[130:131], v14 offset:29184
    s_waitcnt lgkmcnt(4)
    v_mfma_f32_32x32x16_bf16 v[80:95], v[144:147], v[156:159], v[80:95]
    ds_read_b128 v[136:139], v12 offset:16384
    ds_read_b128 v[140:143], v12 offset:20480
    s_waitcnt lgkmcnt(4)
    v_mfma_f32_32x32x16_bf16 v[96:111], v[148:151], v[152:155], v[96:111]
    ds_read_b64_tr_b16 v[132:133], v15 offset:28672
    ds_read_b64_tr_b16 v[134:135], v15 offset:29184
    v_mfma_f32_32x32x16_bf16 v[112:127], v[148:151], v[156:159], v[112:127]
    s_waitcnt lgkmcnt(3)
    v_mfma_f32_32x32x16_bf16 v[64:79], v[128:131], v[136:139], v[64:79]
    ds_read_b64_tr_b16 v[144:145], v14 offset:30720
    ds_read_b64_tr_b16 v[146:147], v14 offset:31232
    s_waitcnt lgkmcnt(4)
    v_mfma_f32_32x32x16_bf16 v[80:95], v[128:131], v[140:143], v[80:95]
    ds_read_b128 v[152:155], v13 offset:16384
    ds_read_b128 v[156:159], v13 offset:20480
    s_waitcnt lgkmcnt(4)
    v_mfma_f32_32x32x16_bf16 v[96:111], v[132:135], v[136:139], v[96:111]
    ds_read_b64_tr_b16 v[148:149], v15 offset:30720
    ds_read_b64_tr_b16 v[150:151], v15 offset:31232
    v_mfma_f32_32x32x16_bf16 v[112:127], v[132:135], v[140:143], v[112:127]
    s_waitcnt lgkmcnt(3)
    v_mfma_f32_32x32x16_bf16 v[64:79], v[144:147], v[152:155], v[64:79]
    s_waitcnt lgkmcnt(2)
    v_mfma_f32_32x32x16_bf16 v[80:95], v[144:147], v[156:159], v[80:95]
    s_waitcnt lgkmcnt(0)
    v_mfma_f32_32x32x16_bf16 v[96:111], v[148:151], v[152:155], v[96:111]
    v_mfma_f32_32x32x16_bf16 v[112:127], v[148:151], v[156:159], v[112:127]
    v_mov_b32 v6, v28
    v_and_b32 v7, 7, v1
    s_barrier
    s_mul_i32 s37, s3, 17408
    v_and_b32 v9, 31, v1
    v_mul_u32_u24 v9, 272, v9
    v_lshrrev_b32 v10, 5, v1
    v_lshl_add_u32 v9, v10, 4, v9
    v_add_u32 v9, s37, v9
    s_nop 7
    ds_write_b128 v9, v[64:67] offset:0
    ds_write_b128 v9, v[68:71] offset:32
    ds_write_b128 v9, v[72:75] offset:64
    ds_write_b128 v9, v[76:79] offset:96
    ds_write_b128 v9, v[80:83] offset:8704
    ds_write_b128 v9, v[84:87] offset:8736
    ds_write_b128 v9, v[88:91] offset:8768
    ds_write_b128 v9, v[92:95] offset:8800
    ds_write_b128 v9, v[96:99] offset:128
    ds_write_b128 v9, v[100:103] offset:160
    ds_write_b128 v9, v[104:107] offset:192
    ds_write_b128 v9, v[108:111] offset:224
    ds_write_b128 v9, v[112:115] offset:8832
    ds_write_b128 v9, v[116:119] offset:8864
    ds_write_b128 v9, v[120:123] offset:8896
    ds_write_b128 v9, v[124:127] offset:8928
    s_waitcnt lgkmcnt(0)
    s_barrier
    v_lshrrev_b32 v9, 3, v1
    v_mul_u32_u24 v9, 272, v9
    v_lshl_add_u32 v9, v7, 5, v9
    s_mul_i32 s37, s3, 4352
    v_add_u32 v9, s37, v9
    ds_read_b128 v[64:67], v9 offset:0
    ds_read_b128 v[68:71], v9 offset:16
    ds_read_b128 v[72:75], v9 offset:17408
    ds_read_b128 v[76:79], v9 offset:17424
    ds_read_b128 v[80:83], v9 offset:34816
    ds_read_b128 v[84:87], v9 offset:34832
    ds_read_b128 v[88:91], v9 offset:52224
    ds_read_b128 v[92:95], v9 offset:52240
    ds_read_b128 v[96:99], v9 offset:2176
    ds_read_b128 v[100:103], v9 offset:2192
    ds_read_b128 v[104:107], v9 offset:19584
    ds_read_b128 v[108:111], v9 offset:19600
    ds_read_b128 v[112:115], v9 offset:36992
    ds_read_b128 v[116:119], v9 offset:37008
    ds_read_b128 v[120:123], v9 offset:54400
    ds_read_b128 v[124:127], v9 offset:54416
    s_waitcnt vmcnt(0)
    v_lshlrev_b32 v28, 16, v24
    v_and_b32 v29, 0xffff0000, v24
    v_lshlrev_b32 v30, 16, v25
    v_and_b32 v31, 0xffff0000, v25
    v_lshlrev_b32 v32, 16, v26
    v_and_b32 v33, 0xffff0000, v26
    v_lshlrev_b32 v34, 16, v27
    v_and_b32 v35, 0xffff0000, v27
    s_waitcnt lgkmcnt(0)
    v_pk_add_f32 v[64:65], v[64:65], v[72:73]
    v_pk_add_f32 v[80:81], v[80:81], v[88:89]
    v_pk_add_f32 v[66:67], v[66:67], v[74:75]
    v_pk_add_f32 v[82:83], v[82:83], v[90:91]
    v_pk_add_f32 v[68:69], v[68:69], v[76:77]
    v_pk_add_f32 v[84:85], v[84:85], v[92:93]
    v_pk_add_f32 v[70:71], v[70:71], v[78:79]
    v_pk_add_f32 v[86:87], v[86:87], v[94:95]
    v_pk_add_f32 v[64:65], v[64:65], v[80:81]
    v_pk_add_f32 v[66:67], v[66:67], v[82:83]
    v_pk_add_f32 v[68:69], v[68:69], v[84:85]
    v_pk_add_f32 v[70:71], v[70:71], v[86:87]
    v_cvt_pk_bf16_f32 v36, v64, v65
    v_lshlrev_b32 v64, 16, v36
    v_and_b32 v65, 0xffff0000, v36
    v_cvt_pk_bf16_f32 v37, v66, v67
    v_lshlrev_b32 v66, 16, v37
    v_and_b32 v67, 0xffff0000, v37
    v_cvt_pk_bf16_f32 v38, v68, v69
    v_lshlrev_b32 v68, 16, v38
    v_and_b32 v69, 0xffff0000, v38
    v_cvt_pk_bf16_f32 v39, v70, v71
    v_lshlrev_b32 v70, 16, v39
    v_and_b32 v71, 0xffff0000, v39
    v_pk_add_f32 v[64:65], v[64:65], v[28:29]
    v_pk_add_f32 v[66:67], v[66:67], v[30:31]
    v_pk_add_f32 v[68:69], v[68:69], v[32:33]
    v_pk_add_f32 v[70:71], v[70:71], v[34:35]
    v_cvt_pk_bf16_f32 v36, v64, v65
    v_lshlrev_b32 v64, 16, v36
    v_and_b32 v65, 0xffff0000, v36
    v_cvt_pk_bf16_f32 v37, v66, v67
    v_lshlrev_b32 v66, 16, v37
    v_and_b32 v67, 0xffff0000, v37
    v_cvt_pk_bf16_f32 v38, v68, v69
    v_lshlrev_b32 v68, 16, v38
    v_and_b32 v69, 0xffff0000, v38
    v_cvt_pk_bf16_f32 v39, v70, v71
    v_lshlrev_b32 v70, 16, v39
    v_and_b32 v71, 0xffff0000, v39
    v_lshlrev_b32 v72, 16, v16
    v_and_b32 v73, 0xffff0000, v16
    v_lshlrev_b32 v74, 16, v17
    v_and_b32 v75, 0xffff0000, v17
    v_lshlrev_b32 v76, 16, v18
    v_and_b32 v77, 0xffff0000, v18
    v_lshlrev_b32 v78, 16, v19
    v_and_b32 v79, 0xffff0000, v19
    v_pk_add_f32 v[64:65], v[64:65], v[72:73]
    v_pk_add_f32 v[66:67], v[66:67], v[74:75]
    v_pk_add_f32 v[68:69], v[68:69], v[76:77]
    v_pk_add_f32 v[70:71], v[70:71], v[78:79]
    v_cvt_pk_bf16_f32 v40, v64, v65
    v_cvt_pk_bf16_f32 v41, v66, v67
    v_cvt_pk_bf16_f32 v42, v68, v69
    v_cvt_pk_bf16_f32 v43, v70, v71
    v_pk_add_f32 v[96:97], v[96:97], v[104:105]
    v_pk_add_f32 v[112:113], v[112:113], v[120:121]
    v_pk_add_f32 v[98:99], v[98:99], v[106:107]
    v_pk_add_f32 v[114:115], v[114:115], v[122:123]
    v_pk_add_f32 v[100:101], v[100:101], v[108:109]
    v_pk_add_f32 v[116:117], v[116:117], v[124:125]
    v_pk_add_f32 v[102:103], v[102:103], v[110:111]
    v_pk_add_f32 v[118:119], v[118:119], v[126:127]
    v_pk_add_f32 v[96:97], v[96:97], v[112:113]
    v_pk_add_f32 v[98:99], v[98:99], v[114:115]
    v_pk_add_f32 v[100:101], v[100:101], v[116:117]
    v_pk_add_f32 v[102:103], v[102:103], v[118:119]
    v_cvt_pk_bf16_f32 v36, v96, v97
    v_lshlrev_b32 v96, 16, v36
    v_and_b32 v97, 0xffff0000, v36
    v_cvt_pk_bf16_f32 v37, v98, v99
    v_lshlrev_b32 v98, 16, v37
    v_and_b32 v99, 0xffff0000, v37
    v_cvt_pk_bf16_f32 v38, v100, v101
    v_lshlrev_b32 v100, 16, v38
    v_and_b32 v101, 0xffff0000, v38
    v_cvt_pk_bf16_f32 v39, v102, v103
    v_lshlrev_b32 v102, 16, v39
    v_and_b32 v103, 0xffff0000, v39
    v_pk_add_f32 v[96:97], v[96:97], v[28:29]
    v_pk_add_f32 v[98:99], v[98:99], v[30:31]
    v_pk_add_f32 v[100:101], v[100:101], v[32:33]
    v_pk_add_f32 v[102:103], v[102:103], v[34:35]
    v_cvt_pk_bf16_f32 v36, v96, v97
    v_lshlrev_b32 v96, 16, v36
    v_and_b32 v97, 0xffff0000, v36
    v_cvt_pk_bf16_f32 v37, v98, v99
    v_lshlrev_b32 v98, 16, v37
    v_and_b32 v99, 0xffff0000, v37
    v_cvt_pk_bf16_f32 v38, v100, v101
    v_lshlrev_b32 v100, 16, v38
    v_and_b32 v101, 0xffff0000, v38
    v_cvt_pk_bf16_f32 v39, v102, v103
    v_lshlrev_b32 v102, 16, v39
    v_and_b32 v103, 0xffff0000, v39
    v_lshlrev_b32 v104, 16, v20
    v_and_b32 v105, 0xffff0000, v20
    v_lshlrev_b32 v106, 16, v21
    v_and_b32 v107, 0xffff0000, v21
    v_lshlrev_b32 v108, 16, v22
    v_and_b32 v109, 0xffff0000, v22
    v_lshlrev_b32 v110, 16, v23
    v_and_b32 v111, 0xffff0000, v23
    v_pk_add_f32 v[96:97], v[96:97], v[104:105]
    v_pk_add_f32 v[98:99], v[98:99], v[106:107]
    v_pk_add_f32 v[100:101], v[100:101], v[108:109]
    v_pk_add_f32 v[102:103], v[102:103], v[110:111]
    v_cvt_pk_bf16_f32 v44, v96, v97
    v_cvt_pk_bf16_f32 v45, v98, v99
    v_cvt_pk_bf16_f32 v46, v100, v101
    v_cvt_pk_bf16_f32 v47, v102, v103
    buffer_store_dwordx4 v[40:43], v6, s[44:47], s34 offen sc1
    buffer_store_dwordx4 v[44:47], v6, s[44:47], s36 offen sc1
    s_branch Ljoin_82
Lskip_81:
    s_barrier
    s_barrier
    s_barrier
Ljoin_82:
Lend_1:
    s_endpgm
.p2align 6
.type tab_tw2048a,@object
tab_tw2048a:
    .long 0x3f800000, 0x80000000, 0x3f7fffb1, 0xbb490fc6, 0x3f7ffec4, 0xbbc90f88, 0x3f7ffd39, 0xbc16cb58
    .long 0x3f7ffb11, 0xbc490e90, 0x3f7ff84a, 0xbc7b514b, 0x3f7ff4e6, 0xbc96c9b6, 0x3f7ff0e3, 0xbcafea69
    .long 0x3f7fec43, 0xbcc90ab0, 0x3f7fe705, 0xbce22a7a, 0x3f7fe129, 0xbcfb49ba, 0x3f7fdaaf, 0xbd0a342f
    .long 0x3f7fd397, 0xbd16c32c, 0x3f7fcbe2, 0xbd2351cb, 0x3f7fc38f, 0xbd2fe007, 0x3f7fba9e, 0xbd3c6dd5
    .long 0x3f7fb10f, 0xbd48fb30, 0x3f7fa6e3, 0xbd55880e, 0x3f7f9c18, 0xbd621469, 0x3f7f90b1, 0xbd6ea038
    .long 0x3f7f84ab, 0xbd7b2b74, 0x3f7f7808, 0xbd83db0a, 0x3f7f6ac7, 0xbd8a200a, 0x3f7f5ce9, 0xbd9064b4
    .long 0x3f7f4e6d, 0xbd96a905, 0x3f7f3f54, 0xbd9cecf9, 0x3f7f2f9d, 0xbda3308c, 0x3f7f1f49, 0xbda973ba
    .long 0x3f7f0e58, 0xbdafb680, 0x3f7efcc9, 0xbdb5f8da, 0x3f7eea9d, 0xbdbc3ac3, 0x3f7ed7d4, 0xbdc27c39
    .long 0x3f7ec46d, 0xbdc8bd36, 0x3f7eb069, 0xbdcefdb7, 0x3f7e9bc9, 0xbdd53db9, 0x3f7e868b, 0xbddb7d37
    .long 0x3f7e70b0, 0xbde1bc2e, 0x3f7e5a38, 0xbde7fa9a, 0x3f7e4323, 0xbdee3876, 0x3f7e2b72, 0xbdf475c0
    .long 0x3f7e1324, 0xbdfab273, 0x3f7dfa38, 0xbe007745, 0x3f7de0b1, 0xbe039502, 0x3f7dc68c, 0xbe06b26e
    .long 0x3f7dabcc, 0xbe09cf86, 0x3f7d906e, 0xbe0cec4a, 0x3f7d7474, 0xbe1008b7, 0x3f7d57de, 0xbe1324ca
    .long 0x3f7d3aac, 0xbe164083, 0x3f7d1cdd, 0xbe195be0, 0x3f7cfe73, 0xbe1c76de, 0x3f7cdf6c, 0xbe1f917b
    .long 0x3f7cbfc9, 0xbe22abb6, 0x3f7c9f8a, 0xbe25c58c, 0x3f7c7eb0, 0xbe28defc, 0x3f7c5d3a, 0xbe2bf804
    .long 0x3f7c3b28, 0xbe2f10a2, 0x3f7c187a, 0xbe3228d4, 0x3f7bf531, 0xbe354098, 0x3f7bd14d, 0xbe3857ec
    .long 0x3f7baccd, 0xbe3b6ecf, 0x3f7b87b2, 0xbe3e853e, 0x3f7b61fc, 0xbe419b37, 0x3f7b3bab, 0xbe44b0b9
    .long 0x3f7b14be, 0xbe47c5c2, 0x3f7aed37, 0xbe4ada4f, 0x3f7ac516, 0xbe4dee60, 0x3f7a9c59, 0xbe5101f1
    .long 0x3f7a7302, 0xbe541501, 0x3f7a4910, 0xbe57278f, 0x3f7a1e84, 0xbe5a3997, 0x3f79f35e, 0xbe5d4b1a
    .long 0x3f79c79d, 0xbe605c13, 0x3f799b43, 0xbe636c83, 0x3f796e4e, 0xbe667c66, 0x3f7940c0, 0xbe698bba
    .long 0x3f791298, 0xbe6c9a7f, 0x3f78e3d6, 0xbe6fa8b2, 0x3f78b47b, 0xbe72b651, 0x3f788486, 0xbe75c35a
    .long 0x3f7853f8, 0xbe78cfcc, 0x3f7822d1, 0xbe7bdba4, 0x3f77f110, 0xbe7ee6e1, 0x3f77beb7, 0xbe80f8c0
    .long 0x3f778bc5, 0xbe827dc0, 0x3f77583a, 0xbe840270, 0x3f772417, 0xbe8586ce, 0x3f76ef5b, 0xbe870ada
    .long 0x3f76ba07, 0xbe888e93, 0x3f76841b, 0xbe8a11f7, 0x3f764d97, 0xbe8b9507, 0x3f76167a, 0xbe8d17c0
    .long 0x3f75dec6, 0xbe8e9a22, 0x3f75a67b, 0xbe901c2c, 0x3f756d97, 0xbe919ddd, 0x3f75341d, 0xbe931f35
    .long 0x3f74fa0b, 0xbe94a031, 0x3f74bf62, 0xbe9620d2, 0x3f748422, 0xbe97a117, 0x3f74484b, 0xbe9920fe
    .long 0x3f740bdd, 0xbe9aa086, 0x3f73ced9, 0xbe9c1faf, 0x3f73913f, 0xbe9d9e78, 0x3f73530e, 0xbe9f1cdf
    .long 0x3f731447, 0xbea09ae5, 0x3f72d4eb, 0xbea21887, 0x3f7294f8, 0xbea395c5, 0x3f725470, 0xbea5129f
    .long 0x3f721352, 0xbea68f12, 0x3f71d19f, 0xbea80b1f, 0x3f718f57, 0xbea986c4, 0x3f714c7a, 0xbeab0201
    .long 0x3f710908, 0xbeac7cd4, 0x3f70c501, 0xbeadf73c, 0x3f708066, 0xbeaf713a, 0x3f703b37, 0xbeb0eacb
    .long 0x3f6ff573, 0xbeb263ef, 0x3f6faf1b, 0xbeb3dca5, 0x3f6f6830, 0xbeb554ec, 0x3f6f20b0, 0xbeb6ccc3
    .long 0x3f6ed89e, 0xbeb8442a, 0x3f6e8ff8, 0xbeb9bb1e, 0x3f6e46be, 0xbebb31a0, 0x3f6dfcf2, 0xbebca7af
    .long 0x3f6db293, 0xbebe1d4a, 0x3f6d67a1, 0xbebf926f, 0x3f6d1c1d, 0xbec1071e, 0x3f6cd007, 0xbec27b55
    .long 0x3f6c835e, 0xbec3ef15, 0x3f6c3624, 0xbec5625c, 0x3f6be858, 0xbec6d529, 0x3f6b99fb, 0xbec8477c
    .long 0x3f6b4b0c, 0xbec9b953, 0x3f6afb8c, 0xbecb2aae, 0x3f6aab7b, 0xbecc9b8b, 0x3f6a5ad9, 0xbece0bea
    .long 0x3f6a09a7, 0xbecf7bca, 0x3f69b7e4, 0xbed0eb2a, 0x3f696591, 0xbed25a09, 0x3f6912ae, 0xbed3c867
    .long 0x3f68bf3c, 0xbed53641, 0x3f686b39, 0xbed6a399, 0x3f6816a8, 0xbed8106b, 0x3f67c187, 0xbed97cb9
    .long 0x3f676bd8, 0xbedae880, 0x3f671599, 0xbedc53c1, 0x3f66becc, 0xbeddbe79, 0x3f666771, 0xbedf28a9
    .long 0x3f660f88, 0xbee0924f, 0x3f65b710, 0xbee1fb6a, 0x3f655e0b, 0xbee363fa, 0x3f650479, 0xbee4cbfe
    .long 0x3f64aa59, 0xbee63375, 0x3f644fac, 0xbee79a5d, 0x3f63f473, 0xbee900b7, 0x3f6398ac, 0xbeea6681
    .long 0x3f633c5a, 0xbeebcbbb, 0x3f62df7b, 0xbeed3063, 0x3f628210, 0xbeee9479, 0x3f62241a, 0xbeeff7fb
    .long 0x3f61c598, 0xbef15aea, 0x3f61668a, 0xbef2bd43, 0x3f6106f2, 0xbef41f07, 0x3f60a6cf, 0xbef58035
    .long 0x3f604621, 0xbef6e0cb, 0x3f5fe4e9, 0xbef840c8, 0x3f5f8327, 0xbef9a02d, 0x3f5f20db, 0xbefafef7
    .long 0x3f5ebe05, 0xbefc5d27, 0x3f5e5aa6, 0xbefdbabb, 0x3f5df6be, 0xbeff17b2, 0x3f5d924d, 0xbf003a06
    .long 0x3f5d2d53, 0xbf00e7e4, 0x3f5cc7d1, 0xbf019573, 0x3f5c61c7, 0xbf0242b1, 0x3f5bfb34, 0xbf02ef9f
    .long 0x3f5b941a, 0xbf039c3d, 0x3f5b2c79, 0xbf044889, 0x3f5ac450, 0xbf04f484, 0x3f5a5ba0, 0xbf05a02c
    .long 0x3f59f26a, 0xbf064b82, 0x3f5988ad, 0xbf06f686, 0x3f591e6a, 0xbf07a136, 0x3f58b3a1, 0xbf084b92
    .long 0x3f584853, 0xbf08f59b, 0x3f57dc7f, 0xbf099f4e, 0x3f577026, 0xbf0a48ad, 0x3f570348, 0xbf0af1b7
    .long 0x3f5695e5, 0xbf0b9a6b, 0x3f5627fe, 0xbf0c42c9, 0x3f55b993, 0xbf0cead0, 0x3f554aa4, 0xbf0d9281
    .long 0x3f54db31, 0xbf0e39da, 0x3f546b3b, 0xbf0ee0db, 0x3f53fac3, 0xbf0f8784, 0x3f5389c7, 0xbf102dd5
    .long 0x3f531849, 0xbf10d3cd, 0x3f52a649, 0xbf11796b, 0x3f5233c6, 0xbf121eb0, 0x3f51c0c2, 0xbf12c39a
    .long 0x3f514d3d, 0xbf13682a, 0x3f50d937, 0xbf140c5f, 0x3f5064af, 0xbf14b039, 0x3f4fefa8, 0xbf1553b7
    .long 0x3f4f7a1f, 0xbf15f6d9, 0x3f4f0417, 0xbf16999f, 0x3f4e8d90, 0xbf173c07, 0x3f4e1689, 0xbf17de12
    .long 0x3f4d9f02, 0xbf187fc0, 0x3f4d26fd, 0xbf19210f, 0x3f4cae79, 0xbf19c200, 0x3f4c3578, 0xbf1a6293
    .long 0x3f4bbbf8, 0xbf1b02c6, 0x3f4b41fa, 0xbf1ba299, 0x3f4ac77f, 0xbf1c420c, 0x3f4a4c87, 0xbf1ce11f
    .long 0x3f49d112, 0xbf1d7fd1, 0x3f495521, 0xbf1e1e22, 0x3f48d8b3, 0xbf1ebc12, 0x3f485bca, 0xbf1f599f
    .long 0x3f47de65, 0xbf1ff6cb, 0x3f476085, 0xbf209393, 0x3f46e22a, 0xbf212ff9, 0x3f466354, 0xbf21cbfb
    .long 0x3f45e403, 0xbf226799, 0x3f456439, 0xbf2302d3, 0x3f44e3f5, 0xbf239da9, 0x3f446337, 0xbf24381a
    .long 0x3f43e200, 0xbf24d225, 0x3f436051, 0xbf256bcb, 0x3f42de29, 0xbf26050a, 0x3f425b89, 0xbf269de3
    .long 0x3f41d870, 0xbf273656, 0x3f4154e1, 0xbf27ce61, 0x3f40d0da, 0xbf286605, 0x3f404c5c, 0xbf28fd41
    .long 0x3f3fc767, 0xbf299415, 0x3f3f41fc, 0xbf2a2a80, 0x3f3ebc1b, 0xbf2ac082, 0x3f3e35c5, 0xbf2b561b
    .long 0x3f3daef9, 0xbf2beb4a, 0x3f3d27b8, 0xbf2c800f, 0x3f3ca003, 0xbf2d1469, 0x3f3c17d9, 0xbf2da859
    .long 0x3f3b8f3b, 0xbf2e3bde, 0x3f3b0629, 0xbf2ecef7, 0x3f3a7ca4, 0xbf2f61a5, 0x3f39f2ac, 0xbf2ff3e6
    .long 0x3f396842, 0xbf3085bb, 0x3f38dd65, 0xbf311722, 0x3f385216, 0xbf31a81d, 0x3f37c655, 0xbf3238aa
    .long 0x3f373a23, 0xbf32c8c9, 0x3f36ad7f, 0xbf33587a, 0x3f36206c, 0xbf33e7bc, 0x3f3592e7, 0xbf34768f
code_end:
.section .rodata,"a"
.p2align 6
.amdhsa_kernel mega_kernel
  .amdhsa_next_free_vgpr 160
  .amdhsa_next_free_sgpr 102
  .amdhsa_accum_offset 160
  .amdhsa_group_segment_fixed_size 0
  .amdhsa_kernarg_size 88
  .amdhsa_user_sgpr_count 2
  .amdhsa_user_sgpr_kernarg_segment_ptr 1
  .amdhsa_system_sgpr_workgroup_id_x 1
.end_amdhsa_kernel
```
